```python
import torch

def _softmax(x, axis=-1):
    return torch.softmax(x, dim=axis)
def _gelu(x):
    return torch.nn.functional.gelu(x, approximate="tanh")
def _silu(x):
    return torch.nn.functional.silu(x)
def _sigmoid(x):
    return torch.sigmoid(x)
def _layernorm(x, axis=-1, eps=1e-5):
    m = x.mean(dim=axis, keepdim=True)
    v = x.var(dim=axis, keepdim=True, unbiased=False)
    return (x - m) / torch.sqrt(v + eps)
def _scatter_add(tgt, idx, src, axis=0):
    return tgt.clone().index_add_(axis, idx, src)
def _segment_sum(src, seg, n):
    out = torch.zeros((n,) + src.shape[1:], dtype=src.dtype)
    return out.index_add_(0, seg, src)
def _pad(x, pw):
    flat = tuple(v for pair in reversed(pw) for v in pair)
    return torch.nn.functional.pad(x, flat)

kernel_name = 'concat_heads__gqa_block_cached__mha_block_cached__near_ridge'

def setup_inputs():

    _w = (lambda a: (lambda t: t.to(torch.bfloat16) if t.is_floating_point() else t)(torch.as_tensor(a)))
    def _A_setup():
        B, Sq, D = 16, 160, 512
        Hq, Hkv, Sk, Dh = 32, 32, 512, 128
        assert Hq % Hkv == 0, (Hq, Hkv)
        return {
            "x": _w((lambda *s: torch.randn(*s, dtype=torch.bfloat16) * 0.8)(B, Sq, D)),
            "k_cache": _w((lambda *s: torch.randn(*s, dtype=torch.bfloat16) * 0.8)(B, Hkv, Sk, Dh)),
            "v_cache": _w((lambda *s: torch.randn(*s, dtype=torch.bfloat16) * 0.05)(B, Hkv, Sk, Dh)),
            "wq": _w((lambda *s: torch.randn(*s, dtype=torch.bfloat16) * 0.8)(D, Hq * Dh) * (D ** -0.5)),
            "wo": _w((lambda *s: torch.randn(*s, dtype=torch.bfloat16) * 0.05)(Hq * Dh, D) * ((Hq * Dh) ** -0.5)),
        }
    _A_in = _A_setup()

    def _B_setup():
        B, Sq, D = 16, 160, 512
        H, Sk, Dh = 32, 512, 128
        return {
            "x": _w((lambda *s: torch.randn(*s, dtype=torch.bfloat16) * 0.8)(B, Sq, D)),
            "k_cache": _w((lambda *s: torch.randn(*s, dtype=torch.bfloat16) * 0.8)(B, H, Sk, Dh)),
            "v_cache": _w((lambda *s: torch.randn(*s, dtype=torch.bfloat16) * 0.05)(B, H, Sk, Dh)),
            "wq": _w((lambda *s: torch.randn(*s, dtype=torch.bfloat16) * 0.8)(D, H * Dh) * (D ** -0.5)),
            "wo": _w((lambda *s: torch.randn(*s, dtype=torch.bfloat16) * 0.05)(H * Dh, D) * ((H * Dh) ** -0.5)),
        }
    _B_in = _B_setup()

    return {
        "A_x": _A_in["x"],
        "A_k_cache": _A_in["k_cache"],
        "A_v_cache": _A_in["v_cache"],
        "A_wq": _A_in["wq"],
        "A_wo": _A_in["wo"],
        "B_x": _B_in["x"],
        "B_k_cache": _B_in["k_cache"],
        "B_v_cache": _B_in["v_cache"],
        "B_wq": _B_in["wq"],
        "B_wo": _B_in["wo"],
    }

def reference(A_x, A_k_cache, A_v_cache, A_wq, A_wo, B_x, B_k_cache, B_v_cache, B_wq, B_wo):
    def _A_ref(x, k_cache, v_cache, wq, wo):
        B, Sq, D = x.shape
        Hq, Dh = 32, 128
        Hkv = k_cache.shape[1]
        rep = Hq // Hkv
        q = (lambda x, *d: x.permute(*d))((x @ wq).reshape(B, Sq, Hq, Dh), 0, 2, 1, 3)
        k = (lambda x, n, axis: torch.repeat_interleave(x, n, dim=axis))(k_cache, rep, axis=1)
        v = (lambda x, n, axis: torch.repeat_interleave(x, n, dim=axis))(v_cache, rep, axis=1)
        scores = torch.einsum("bhqd,bhkd->bhqk", q, k) * (Dh ** -0.5)
        p = _softmax(scores, axis=-1)
        o = torch.einsum("bhqk,bhkd->bhqd", p, v)
        return (lambda x, *d: x.permute(*d))(o, 0, 2, 1, 3).reshape(B, Sq, Hq * Dh) @ wo

    def _B_ref(x, k_cache, v_cache, wq, wo):
        B, Sq, D = x.shape
        H, Dh = 32, 128
        q = (lambda x, *d: x.permute(*d))((x @ wq).reshape(B, Sq, H, Dh), 0, 2, 1, 3)
        scores = torch.einsum("bhqd,bhkd->bhqk", q, k_cache) * (Dh ** -0.5)
        p = _softmax(scores, axis=-1)
        o = torch.einsum("bhqk,bhkd->bhqd", p, v_cache)
        return (lambda x, *d: x.permute(*d))(o, 0, 2, 1, 3).reshape(B, Sq, H * Dh) @ wo

    a = _A_ref(A_x, A_k_cache, A_v_cache, A_wq, A_wo)
    b = _B_ref(B_x, B_k_cache, B_v_cache, B_wq, B_wo)
    return torch.concatenate([a, b], axis=-1)
```

```asm
; @launch grid=(256,1,1) block=(256,1,1) lds=159744
.amdgcn_target "amdgcn-amd-amdhsa--gfx950"
.text
.globl concat_heads__gqa_block_cached__mha_block_cached__near_ridge_kernel
.p2align 8
.type concat_heads__gqa_block_cached__mha_block_cached__near_ridge_kernel,@function
concat_heads__gqa_block_cached__mha_block_cached__near_ridge_kernel:
  s_cmp_ge_u32 s2, 256
  s_cbranch_scc1 K1_END
  s_and_b32 s3, s2, 7
  s_lshr_b32 s4, s3, 2
  s_mul_i32 s4, s4, 40
  s_add_u32 s6, s0, s4
  s_addc_u32 s7, s1, 0
  s_load_dwordx8 s[52:59], s[6:7], 0
  s_load_dwordx2 s[60:61], s[0:1], 96
  s_load_dwordx2 s[78:79], s[6:7], 32
  s_load_dwordx2 s[80:81], s[0:1], 80
  s_load_dwordx2 s[84:85], s[0:1], 88
  s_memrealtime s[46:47]
  v_lshrrev_b32 v20, 6, v0
  v_and_b32 v0, 63, v0
  v_readfirstlane_b32 s28, v20
  s_getpc_b64 s[62:63]
  s_lshr_b32 s5, s2, 3
  s_lshl_b32 s5, s5, 2
  v_add_u32 v21, s5, v20
  v_mul_u32_u24 v21, 6, v21
  v_min_u32 v22, 5, v0
  v_add_u32 v21, v21, v22
  v_min_u32 v21, 0x2d4, v21
  v_lshlrev_b32 v21, 7, v21
  global_load_dword v234, v21, s[62:63]
  v_lshrrev_b32 v20, 4, v0
  v_bfe_u32 v21, v0, 2, 2
  v_and_b32 v22, 3, v0
  s_lshr_b32 s5, s2, 3
  s_bfe_u32 s62, s3, 0x10001
  s_and_b32 s63, s3, 1
  s_lshr_b32 s71, s5, 2
  s_lshl_b32 s62, s62, 3
  s_add_u32 s64, s71, s62
  s_and_b32 s4, s5, 3
  s_lshl_b32 s65, s4, 1
  s_lshl_b32 s63, s63, 4
  s_add_u32 s63, s65, s63
  s_lshr_b32 s66, s28, 1
  s_and_b32 s67, s28, 1
  s_add_u32 s65, s63, s66
  s_lshl_b32 s31, s28, 12
  s_lshl_b32 s32, s28, 10
  s_add_u32 s32, s32, 32768
  s_lshl_b32 s36, s65, 8
  s_lshl_b32 s68, s67, 17
  s_add_u32 s36, s36, s68
  s_mul_i32 s69, s64, 163840
  s_mul_i32 s68, s28, 40960
  s_add_u32 s34, s69, s68
  s_lshl_b32 s70, s4, 1
  s_add_u32 s70, s70, s71
  s_and_b32 s70, s70, 7
  s_mov_b32 s35, s3
  v_lshlrev_b32 v25, 4, v22
  v_lshl_add_u32 v25, v20, 6, v25
  v_lshl_add_u32 v9, v21, 8, v25
  v_xor_b32 v10, 32, v9
  v_lshl_add_u32 v11, v21, 13, v25
  v_add_u32 v12, 31744, v11
  v_add_u32 v13, 63488, v11
  v_add_u32 v14, 95232, v11
  v_lshrrev_b32 v24, 5, v0
  v_lshlrev_b32 v25, 1, v24
  v_xor_b32 v25, v25, v22
  v_lshlrev_b32 v25, 4, v25
  v_and_b32 v23, 1, v20
  v_lshl_add_u32 v25, v23, 6, v25
  v_lshl_add_u32 v25, v21, 10, v25
  v_lshl_add_u32 v15, v24, 12, v25
  v_add_u32 v16, 7168, v15
  v_add_u32 v17, 14336, v15
  v_add_u32 v18, 21504, v15
  s_mov_b32 s10, 2621440
  s_mov_b32 s11, 0x20000
  s_mov_b32 s14, 4194304
  s_mov_b32 s15, 0x20000
  s_lshr_b32 s92, s2, 5
  s_mul_i32 s92, s92, 5
  s_and_b32 s92, s92, 7
  s_cmp_lt_u32 s92, 3
  s_cselect_b32 s92, 1, 0
  s_lshl_b32 s68, s92, 11
  s_add_u32 s36, s36, s68
  s_mul_i32 s68, s92, 53248
  s_add_u32 s30, s31, s68
  s_waitcnt lgkmcnt(0)
  s_mov_b32 s8, s52
  s_mov_b32 s9, s53
  s_mov_b32 s12, s58
  s_mov_b32 s13, s59
  s_mov_b32 s6, s34
  s_mov_b32 s7, 0
  s_mov_b32 s3, s70
  s_mov_b32 s71, s35
  s_mov_b32 m0, s30
  s_nop 0
  buffer_load_dwordx4 v11, s[12:15], s36 offen offset:0 lds
  buffer_load_dwordx4 v12, s[12:15], s36 offen offset:1024 lds
  buffer_load_dwordx4 v13, s[12:15], s36 offen offset:2048 lds
  buffer_load_dwordx4 v14, s[12:15], s36 offen offset:3072 lds
  s_add_u32 s36, s36, 0x40000
  s_add_u32 m0, s30, 16384
  s_nop 0
  buffer_load_dwordx4 v11, s[12:15], s36 offen offset:0 lds
  buffer_load_dwordx4 v12, s[12:15], s36 offen offset:1024 lds
  buffer_load_dwordx4 v13, s[12:15], s36 offen offset:2048 lds
  buffer_load_dwordx4 v14, s[12:15], s36 offen offset:3072 lds
  s_add_u32 s36, s36, 0x40000
  s_and_b32 s36, s36, 0x3fffff
  s_add_u32 s37, s6, s7
  s_add_u32 m0, s30, s32
  s_nop 0
  buffer_load_dwordx4 v15, s[8:11], s37 offen offset:0 lds
  buffer_load_dwordx4 v16, s[8:11], s37 offen offset:1024 lds
  buffer_load_dwordx4 v17, s[8:11], s37 offen offset:2048 lds
  buffer_load_dwordx4 v18, s[8:11], s37 offen offset:3072 lds
  s_add_u32 m0, m0, 0x1000
  s_add_u32 s39, s37, 0x8000
  buffer_load_dwordx4 v15, s[8:11], s39 offen lds
  s_add_u32 s7, s7, 128
  s_and_b32 s7, s7, 0x3ff
  s_mul_i32 s68, s92, 106496
  s_sub_u32 s29, 106496, s68
  s_lshl_b32 s68, s64, 5
  s_add_u32 s68, s68, s65
  s_lshl_b32 s91, s68, 17
  s_lshl_b32 s68, s67, 12
  s_add_u32 s33, s91, s68
  s_mul_i32 s34, s2, 40960
  s_lshr_b32 s68, s2, 4
  s_mul_i32 s68, s68, 24576
  s_add_u32 s34, s34, s68
  s_and_b32 s34, s34, 0x1ffff
  s_mov_b32 s35, s34
  s_lshr_b32 s62, s71, 2
  s_lshl_b32 s68, s62, 4
  s_add_u32 s68, s68, s64
  s_lshl_b32 s99, s68, 3
  s_mul_i32 s89, s68, 1310720
  s_mul_i32 s4, s67, 10240
  s_add_u32 s89, s89, s4
  s_lshl_b32 s90, s68, 14
  s_lshl_b32 s4, s67, 7
  s_add_u32 s90, s90, s4
  s_add_u32 s90, s90, 41943040
  s_and_b32 s68, s71, 1
  s_lshl_b32 s68, s68, 2
  s_and_b32 s4, s5, 3
  s_add_u32 s88, s68, s4
  s_mul_i32 s4, s64, 1
  s_add_u32 s88, s88, s4
  s_and_b32 s88, s88, 7
  s_mul_i32 s93, s88, 163840
  s_add_u32 s93, s93, s89
  s_mul_i32 s4, s66, 5120
  s_add_u32 s93, s93, s4
  s_lshl_b32 s48, s88, 11
  s_add_u32 s48, s48, s90
  s_lshl_b32 s4, s66, 2
  s_add_u32 s48, s48, s4
  s_lshl_b32 s4, s64, 1
  s_add_u32 s4, s4, s67
  s_mul_i32 s97, s4, 163840
  s_lshl_b32 s4, s62, 10
  s_add_u32 s97, s97, s4
  s_lshl_b32 s4, s88, 7
  s_add_u32 s97, s97, s4
  s_lshl_b32 s4, s66, 6
  s_add_u32 s97, s97, s4
  s_lshl_b32 s100, s65, 17
  s_lshl_b32 s68, s67, 16
  s_add_u32 s100, s100, s68
  s_add_u32 s4, s88, s66
  s_add_u32 s4, s4, 1
  s_and_b32 s4, s4, 7
  s_lshl_b32 s4, s4, 7
  s_add_u32 s94, s100, s4
  s_lshl_b32 s68, s66, 18
  s_sub_u32 s95, 0x20000, s68
  s_lshl_b32 s68, s66, 15
  s_sub_u32 s101, 0x4000, s68
  s_mov_b32 s41, 0x3e0293ee
  s_mov_b32 s42, 0x44800000
  s_mov_b32 s44, 0
  s_lshl_b32 s69, s66, 13
  s_mul_i32 s70, s67, 10240
  s_add_u32 s70, s70, 32768
  v_and_b32 v23, 1, v21
  v_lshlrev_b32 v23, 1, v23
  v_xor_b32 v23, v23, v20
  v_lshlrev_b32 v23, 4, v23
  v_lshl_add_u32 v23, v22, 6, v23
  v_lshl_add_u32 v1, v21, 10, v23
  v_add_u32 v1, s69, v1
  v_lshl_add_u32 v5, v21, 9, v23
  v_add_u32 v5, s70, v5
  v_and_b32 v23, 1, v20
  v_lshlrev_b32 v23, 5, v23
  v_lshlrev_b32 v24, 3, v22
  v_xor_b32 v23, v23, v24
  v_lshl_add_u32 v23, v21, 6, v23
  v_lshl_add_u32 v23, v20, 10, v23
  v_add_u32 v2, s69, v23
  v_xor_b32 v3, 32, v2
  v_lshlrev_b32 v23, 4, v22
  v_lshl_add_u32 v23, v21, 6, v23
  v_lshl_add_u32 v23, v20, 11, v23
  v_add_u32 v4, s69, v23
  v_lshlrev_b32 v19, 4, v0
  v_lshlrev_b32 v233, 7, v0
  v_and_b32 v23, 1, v20
  v_lshlrev_b32 v23, 1, v23
  v_xor_b32 v23, v23, v22
  v_lshlrev_b32 v23, 4, v23
  v_lshl_add_u32 v23, v21, 6, v23
  v_lshl_add_u32 v23, v20, 9, v23
  s_lshl_b32 s69, s66, 14
  v_add_u32 v244, s69, v23
  s_mul_i32 s69, s28, 5120
  s_add_u32 s69, s69, 32768
  v_add_u32 v236, s69, v19
  v_add_u32 v237, 106496, v236
  s_xor_b32 s69, s28, 2
  s_mul_i32 s69, s69, 5120
  s_add_u32 s69, s69, 32768
  v_add_u32 v238, s69, v19
  v_add_u32 v239, 106496, v238
  s_mov_b32 s68, s78
  s_mov_b32 s69, s79
  s_mov_b32 s70, 4194304
  s_mov_b32 s71, 0x20000
  s_mov_b32 s16, s54
  s_mov_b32 s17, s55
  s_mov_b32 s18, 67108864
  s_mov_b32 s19, 0x20000
  s_mov_b32 s20, s56
  s_mov_b32 s21, s57
  s_mov_b32 s22, 67108864
  s_mov_b32 s23, 0x20000
  s_mov_b32 s24, s60
  s_mov_b32 s25, s61
  s_mov_b32 s26, 42467328
  s_mov_b32 s27, 0x20000
  s_mov_b32 s82, 5242880
  s_mov_b32 s83, 0x20000
  s_mov_b32 s86, 256
  s_mov_b32 s87, 0x20000
  s_add_u32 s4, s88, s28
  s_cmp_lg_u32 s4, 0
  s_cbranch_scc1 K1_NOEP
  s_or_b32 s4, s46, 1
  v_mov_b32 v24, s4
  v_lshlrev_b32 v25, 20, v0
  buffer_store_dword v24, v25, s[84:87], s99 offen sc1
K1_NOEP:
  s_add_u32 s30, s30, 53248
  s_mov_b32 m0, s30
  s_nop 0
  buffer_load_dwordx4 v11, s[12:15], s36 offen offset:0 lds
  buffer_load_dwordx4 v12, s[12:15], s36 offen offset:1024 lds
  buffer_load_dwordx4 v13, s[12:15], s36 offen offset:2048 lds
  buffer_load_dwordx4 v14, s[12:15], s36 offen offset:3072 lds
  s_add_u32 s36, s36, 0x40000
  s_add_u32 m0, s30, 16384
  s_nop 0
  buffer_load_dwordx4 v11, s[12:15], s36 offen offset:0 lds
  buffer_load_dwordx4 v12, s[12:15], s36 offen offset:1024 lds
  buffer_load_dwordx4 v13, s[12:15], s36 offen offset:2048 lds
  buffer_load_dwordx4 v14, s[12:15], s36 offen offset:3072 lds
  s_add_u32 s36, s36, 0x40000
  s_and_b32 s36, s36, 0x3fffff
  s_add_u32 s37, s6, s7
  s_add_u32 m0, s30, s32
  s_nop 0
  buffer_load_dwordx4 v15, s[8:11], s37 offen offset:0 lds
  buffer_load_dwordx4 v16, s[8:11], s37 offen offset:1024 lds
  buffer_load_dwordx4 v17, s[8:11], s37 offen offset:2048 lds
  buffer_load_dwordx4 v18, s[8:11], s37 offen offset:3072 lds
  s_add_u32 m0, m0, 0x1000
  s_add_u32 s39, s37, 0x8000
  buffer_load_dwordx4 v15, s[8:11], s39 offen lds
  s_add_u32 s7, s7, 128
  s_and_b32 s7, s7, 0x3ff
  s_cmp_lg_u32 s92, 0
  s_cbranch_scc1 K1_G2
  s_add_u32 s30, s29, s31
  s_add_u32 s29, s29, 53248
  s_cmp_eq_u32 s29, 159744
  s_cselect_b32 s29, 0, s29
  v_add_u32 v6, s29, v4
  v_add_u32 v7, s29, v5
  s_waitcnt vmcnt(13) lgkmcnt(0)
  s_barrier
  ds_read_b64_tr_b16 v[184:185], v6 offset:0
  s_mov_b32 m0, s30
  ds_read_b64_tr_b16 v[186:187], v6 offset:1024
  ds_read_b128 a[200:203], v7 offset:0
  ds_read_b128 a[204:207], v7 offset:2048
  buffer_load_dwordx4 v11, s[12:15], s36 offen offset:0 lds
  ds_read_b128 a[208:211], v7 offset:4096
  ds_read_b64_tr_b16 v[188:189], v6 offset:8
  ds_read_b64_tr_b16 v[190:191], v6 offset:1032
  ds_read_b128 a[212:215], v7 offset:6144
  ds_read_b128 a[216:219], v7 offset:8192
  buffer_load_dwordx4 v12, s[12:15], s36 offen offset:1024 lds
  ds_read_b64_tr_b16 v[192:193], v6 offset:256
  ds_read_b64_tr_b16 v[194:195], v6 offset:1280
  s_waitcnt lgkmcnt(8)
  v_mfma_f32_16x16x32_bf16 v[24:27], v[184:187], a[200:203], 0
  buffer_load_dwordx4 v13, s[12:15], s36 offen offset:2048 lds
  s_waitcnt lgkmcnt(4)
  v_mfma_f32_16x16x32_bf16 v[28:31], v[188:191], a[200:203], 0
  ds_read_b64_tr_b16 v[196:197], v6 offset:264
  s_waitcnt lgkmcnt(3)
  v_mfma_f32_16x16x32_bf16 v[60:63], v[188:191], a[204:207], 0
  ds_read_b64_tr_b16 v[198:199], v6 offset:1288
  v_mfma_f32_16x16x32_bf16 v[56:59], v[184:187], a[204:207], 0
  ds_read_b128 a[220:223], v7 offset:256
  v_mfma_f32_16x16x32_bf16 v[88:91], v[184:187], a[208:211], 0
  buffer_load_dwordx4 v14, s[12:15], s36 offen offset:3072 lds
  v_mfma_f32_16x16x32_bf16 v[92:95], v[188:191], a[208:211], 0
  ds_read_b64_tr_b16 v[200:201], v6 offset:512
  s_add_u32 s36, s36, 0x40000
  v_mfma_f32_16x16x32_bf16 v[124:127], v[188:191], a[212:215], 0
  ds_read_b64_tr_b16 v[202:203], v6 offset:1536
  s_add_u32 m0, s30, 16384
  v_mfma_f32_16x16x32_bf16 v[120:123], v[184:187], a[212:215], 0
  ds_read_b128 a[224:227], v7 offset:2304
  v_mfma_f32_16x16x32_bf16 v[152:155], v[184:187], a[216:219], 0
  buffer_load_dwordx4 v11, s[12:15], s36 offen offset:0 lds
  v_mfma_f32_16x16x32_bf16 v[156:159], v[188:191], a[216:219], 0
  s_waitcnt lgkmcnt(4)
  v_mfma_f32_16x16x32_bf16 v[160:163], v[192:195], a[216:219], 0
  ds_read_b64_tr_b16 v[204:205], v6 offset:520
  v_mfma_f32_16x16x32_bf16 v[164:167], v[196:199], a[216:219], 0
  ds_read_b64_tr_b16 v[206:207], v6 offset:1544
  v_mfma_f32_16x16x32_bf16 v[132:135], v[196:199], a[212:215], 0
  ds_read_b128 a[228:231], v7 offset:4352
  v_mfma_f32_16x16x32_bf16 v[128:131], v[192:195], a[212:215], 0
  buffer_load_dwordx4 v12, s[12:15], s36 offen offset:1024 lds
  v_mfma_f32_16x16x32_bf16 v[96:99], v[192:195], a[208:211], 0
  v_mfma_f32_16x16x32_bf16 v[100:103], v[196:199], a[208:211], 0
  ds_read_b64_tr_b16 v[208:209], v6 offset:768
  v_mfma_f32_16x16x32_bf16 v[68:71], v[196:199], a[204:207], 0
  ds_read_b64_tr_b16 v[210:211], v6 offset:1792
  v_mfma_f32_16x16x32_bf16 v[64:67], v[192:195], a[204:207], 0
  ds_read_b128 a[232:235], v7 offset:6400
  v_mfma_f32_16x16x32_bf16 v[32:35], v[192:195], a[200:203], 0
  buffer_load_dwordx4 v13, s[12:15], s36 offen offset:2048 lds
  v_mfma_f32_16x16x32_bf16 v[36:39], v[196:199], a[200:203], 0
  s_waitcnt lgkmcnt(4)
  v_mfma_f32_16x16x32_bf16 v[40:43], v[200:203], a[200:203], 0
  ds_read_b64_tr_b16 v[212:213], v6 offset:776
  v_mfma_f32_16x16x32_bf16 v[44:47], v[204:207], a[200:203], 0
  ds_read_b64_tr_b16 v[214:215], v6 offset:1800
  v_mfma_f32_16x16x32_bf16 v[76:79], v[204:207], a[204:207], 0
  ds_read_b128 a[236:239], v7 offset:8448
  v_mfma_f32_16x16x32_bf16 v[72:75], v[200:203], a[204:207], 0
  buffer_load_dwordx4 v14, s[12:15], s36 offen offset:3072 lds
  v_mfma_f32_16x16x32_bf16 v[104:107], v[200:203], a[208:211], 0
  s_add_u32 s36, s36, 0x40000
  s_and_b32 s36, s36, 0x3fffff
  s_add_u32 s37, s6, s7
  v_mfma_f32_16x16x32_bf16 v[108:111], v[204:207], a[208:211], 0
  ds_read_b64_tr_b16 v[184:185], v6 offset:16384
  s_add_u32 m0, s30, s32
  v_mfma_f32_16x16x32_bf16 v[140:143], v[204:207], a[212:215], 0
  ds_read_b64_tr_b16 v[186:187], v6 offset:17408
  v_mfma_f32_16x16x32_bf16 v[136:139], v[200:203], a[212:215], 0
  v_mfma_f32_16x16x32_bf16 v[168:171], v[200:203], a[216:219], 0
  buffer_load_dwordx4 v15, s[8:11], s37 offen offset:0 lds
  v_mfma_f32_16x16x32_bf16 v[172:175], v[204:207], a[216:219], 0
  s_waitcnt lgkmcnt(3)
  v_mfma_f32_16x16x32_bf16 v[176:179], v[208:211], a[216:219], 0
  ds_read_b64_tr_b16 v[188:189], v6 offset:16392
  v_mfma_f32_16x16x32_bf16 v[180:183], v[212:215], a[216:219], 0
  ds_read_b64_tr_b16 v[190:191], v6 offset:17416
  v_mfma_f32_16x16x32_bf16 v[148:151], v[212:215], a[212:215], 0
  v_mfma_f32_16x16x32_bf16 v[144:147], v[208:211], a[212:215], 0
  buffer_load_dwordx4 v16, s[8:11], s37 offen offset:1024 lds
  v_mfma_f32_16x16x32_bf16 v[112:115], v[208:211], a[208:211], 0
  v_mfma_f32_16x16x32_bf16 v[116:119], v[212:215], a[208:211], 0
  ds_read_b64_tr_b16 v[192:193], v6 offset:16640
  v_mfma_f32_16x16x32_bf16 v[84:87], v[212:215], a[204:207], 0
  ds_read_b64_tr_b16 v[194:195], v6 offset:17664
  v_mfma_f32_16x16x32_bf16 v[80:83], v[208:211], a[204:207], 0
  v_mfma_f32_16x16x32_bf16 v[48:51], v[208:211], a[200:203], 0
  buffer_load_dwordx4 v17, s[8:11], s37 offen offset:2048 lds
  v_mfma_f32_16x16x32_bf16 v[52:55], v[212:215], a[200:203], 0
  s_waitcnt lgkmcnt(6)
  s_waitcnt lgkmcnt(2)
  v_mfma_f32_16x16x32_bf16 v[24:27], v[184:187], a[220:223], v[24:27]
  ds_read_b64_tr_b16 v[196:197], v6 offset:16648
  v_mfma_f32_16x16x32_bf16 v[28:31], v[188:191], a[220:223], v[28:31]
  ds_read_b64_tr_b16 v[198:199], v6 offset:17672
  v_mfma_f32_16x16x32_bf16 v[60:63], v[188:191], a[224:227], v[60:63]
  v_mfma_f32_16x16x32_bf16 v[56:59], v[184:187], a[224:227], v[56:59]
  buffer_load_dwordx4 v18, s[8:11], s37 offen offset:3072 lds
  v_mfma_f32_16x16x32_bf16 v[88:91], v[184:187], a[228:231], v[88:91]
  s_add_u32 m0, m0, 0x1000
  s_add_u32 s39, s37, 0x8000
  v_mfma_f32_16x16x32_bf16 v[92:95], v[188:191], a[228:231], v[92:95]
  ds_read_b64_tr_b16 v[200:201], v6 offset:16896
  v_mfma_f32_16x16x32_bf16 v[124:127], v[188:191], a[232:235], v[124:127]
  ds_read_b64_tr_b16 v[202:203], v6 offset:17920
  s_add_u32 s7, s7, 128
  v_mfma_f32_16x16x32_bf16 v[120:123], v[184:187], a[232:235], v[120:123]
  s_and_b32 s7, s7, 0x3ff
  v_mfma_f32_16x16x32_bf16 v[152:155], v[184:187], a[236:239], v[152:155]
  buffer_load_dwordx4 v15, s[8:11], s39 offen lds
  v_mfma_f32_16x16x32_bf16 v[156:159], v[188:191], a[236:239], v[156:159]
  s_waitcnt lgkmcnt(2)
  v_mfma_f32_16x16x32_bf16 v[160:163], v[192:195], a[236:239], v[160:163]
  ds_read_b64_tr_b16 v[204:205], v6 offset:16904
  v_mfma_f32_16x16x32_bf16 v[164:167], v[196:199], a[236:239], v[164:167]
  ds_read_b64_tr_b16 v[206:207], v6 offset:17928
  v_mfma_f32_16x16x32_bf16 v[132:135], v[196:199], a[232:235], v[132:135]
  ds_read_b64_tr_b16 v[208:209], v6 offset:17152
  v_mfma_f32_16x16x32_bf16 v[128:131], v[192:195], a[232:235], v[128:131]
  ds_read_b64_tr_b16 v[210:211], v6 offset:18176
  v_mfma_f32_16x16x32_bf16 v[96:99], v[192:195], a[228:231], v[96:99]
  v_mfma_f32_16x16x32_bf16 v[100:103], v[196:199], a[228:231], v[100:103]
  ds_read_b64_tr_b16 v[212:213], v6 offset:17160
  v_mfma_f32_16x16x32_bf16 v[68:71], v[196:199], a[224:227], v[68:71]
  ds_read_b64_tr_b16 v[214:215], v6 offset:18184
  s_add_u32 s30, s29, s31
  v_mfma_f32_16x16x32_bf16 v[64:67], v[192:195], a[224:227], v[64:67]
  s_add_u32 s29, s29, 53248
  v_mfma_f32_16x16x32_bf16 v[32:35], v[192:195], a[220:223], v[32:35]
  s_cmp_eq_u32 s29, 159744
  s_cselect_b32 s29, 0, s29
  v_mfma_f32_16x16x32_bf16 v[36:39], v[196:199], a[220:223], v[36:39]
  s_waitcnt lgkmcnt(4)
  v_mfma_f32_16x16x32_bf16 v[40:43], v[200:203], a[220:223], v[40:43]
  v_add_u32 v6, s29, v4
  v_mfma_f32_16x16x32_bf16 v[44:47], v[204:207], a[220:223], v[44:47]
  v_add_u32 v7, s29, v5
  v_mfma_f32_16x16x32_bf16 v[76:79], v[204:207], a[224:227], v[76:79]
  v_mfma_f32_16x16x32_bf16 v[72:75], v[200:203], a[224:227], v[72:75]
  s_mov_b32 m0, s30
  v_mfma_f32_16x16x32_bf16 v[104:107], v[200:203], a[228:231], v[104:107]
  s_mov_b32 s43, 4
LP1:
  s_waitcnt vmcnt(13) lgkmcnt(0)
  s_barrier
  v_mfma_f32_16x16x32_bf16 v[108:111], v[204:207], a[228:231], v[108:111]
  ds_read_b64_tr_b16 v[184:185], v6 offset:0
  v_mfma_f32_16x16x32_bf16 v[140:143], v[204:207], a[232:235], v[140:143]
  ds_read_b64_tr_b16 v[186:187], v6 offset:1024
  v_mfma_f32_16x16x32_bf16 v[136:139], v[200:203], a[232:235], v[136:139]
  ds_read_b128 a[200:203], v7 offset:0
  v_mfma_f32_16x16x32_bf16 v[168:171], v[200:203], a[236:239], v[168:171]
  ds_read_b128 a[204:207], v7 offset:2048
  v_mfma_f32_16x16x32_bf16 v[172:175], v[204:207], a[236:239], v[172:175]
  buffer_load_dwordx4 v11, s[12:15], s36 offen offset:0 lds
  v_mfma_f32_16x16x32_bf16 v[176:179], v[208:211], a[236:239], v[176:179]
  ds_read_b128 a[208:211], v7 offset:4096
  v_mfma_f32_16x16x32_bf16 v[180:183], v[212:215], a[236:239], v[180:183]
  v_mfma_f32_16x16x32_bf16 v[148:151], v[212:215], a[232:235], v[148:151]
  ds_read_b64_tr_b16 v[188:189], v6 offset:8
  v_mfma_f32_16x16x32_bf16 v[144:147], v[208:211], a[232:235], v[144:147]
  ds_read_b64_tr_b16 v[190:191], v6 offset:1032
  v_mfma_f32_16x16x32_bf16 v[112:115], v[208:211], a[228:231], v[112:115]
  ds_read_b128 a[212:215], v7 offset:6144
  v_mfma_f32_16x16x32_bf16 v[116:119], v[212:215], a[228:231], v[116:119]
  ds_read_b128 a[216:219], v7 offset:8192
  buffer_load_dwordx4 v12, s[12:15], s36 offen offset:1024 lds
  v_mfma_f32_16x16x32_bf16 v[84:87], v[212:215], a[224:227], v[84:87]
  ds_read_b64_tr_b16 v[192:193], v6 offset:256
  v_mfma_f32_16x16x32_bf16 v[80:83], v[208:211], a[224:227], v[80:83]
  ds_read_b64_tr_b16 v[194:195], v6 offset:1280
  v_mfma_f32_16x16x32_bf16 v[48:51], v[208:211], a[220:223], v[48:51]
  buffer_load_dwordx4 v13, s[12:15], s36 offen offset:2048 lds
  v_mfma_f32_16x16x32_bf16 v[52:55], v[212:215], a[220:223], v[52:55]
  s_waitcnt lgkmcnt(4)
  v_mfma_f32_16x16x32_bf16 v[24:27], v[184:187], a[200:203], v[24:27]
  s_waitcnt lgkmcnt(2)
  v_mfma_f32_16x16x32_bf16 v[28:31], v[188:191], a[200:203], v[28:31]
  ds_read_b64_tr_b16 v[196:197], v6 offset:264
  v_mfma_f32_16x16x32_bf16 v[60:63], v[188:191], a[204:207], v[60:63]
  ds_read_b64_tr_b16 v[198:199], v6 offset:1288
  v_mfma_f32_16x16x32_bf16 v[56:59], v[184:187], a[204:207], v[56:59]
  ds_read_b128 a[220:223], v7 offset:256
  v_mfma_f32_16x16x32_bf16 v[88:91], v[184:187], a[208:211], v[88:91]
  buffer_load_dwordx4 v14, s[12:15], s36 offen offset:3072 lds
  v_mfma_f32_16x16x32_bf16 v[92:95], v[188:191], a[208:211], v[92:95]
  ds_read_b64_tr_b16 v[200:201], v6 offset:512
  s_add_u32 s36, s36, 0x40000
  v_mfma_f32_16x16x32_bf16 v[124:127], v[188:191], a[212:215], v[124:127]
  ds_read_b64_tr_b16 v[202:203], v6 offset:1536
  s_add_u32 m0, s30, 16384
  v_mfma_f32_16x16x32_bf16 v[120:123], v[184:187], a[212:215], v[120:123]
  ds_read_b128 a[224:227], v7 offset:2304
  v_mfma_f32_16x16x32_bf16 v[152:155], v[184:187], a[216:219], v[152:155]
  buffer_load_dwordx4 v11, s[12:15], s36 offen offset:0 lds
  v_mfma_f32_16x16x32_bf16 v[156:159], v[188:191], a[216:219], v[156:159]
  s_waitcnt lgkmcnt(4)
  v_mfma_f32_16x16x32_bf16 v[160:163], v[192:195], a[216:219], v[160:163]
  ds_read_b64_tr_b16 v[204:205], v6 offset:520
  v_mfma_f32_16x16x32_bf16 v[164:167], v[196:199], a[216:219], v[164:167]
  ds_read_b64_tr_b16 v[206:207], v6 offset:1544
  v_mfma_f32_16x16x32_bf16 v[132:135], v[196:199], a[212:215], v[132:135]
  ds_read_b128 a[228:231], v7 offset:4352
  v_mfma_f32_16x16x32_bf16 v[128:131], v[192:195], a[212:215], v[128:131]
  buffer_load_dwordx4 v12, s[12:15], s36 offen offset:1024 lds
  v_mfma_f32_16x16x32_bf16 v[96:99], v[192:195], a[208:211], v[96:99]
  v_mfma_f32_16x16x32_bf16 v[100:103], v[196:199], a[208:211], v[100:103]
  ds_read_b64_tr_b16 v[208:209], v6 offset:768
  v_mfma_f32_16x16x32_bf16 v[68:71], v[196:199], a[204:207], v[68:71]
  ds_read_b64_tr_b16 v[210:211], v6 offset:1792
  v_mfma_f32_16x16x32_bf16 v[64:67], v[192:195], a[204:207], v[64:67]
  ds_read_b128 a[232:235], v7 offset:6400
  v_mfma_f32_16x16x32_bf16 v[32:35], v[192:195], a[200:203], v[32:35]
  buffer_load_dwordx4 v13, s[12:15], s36 offen offset:2048 lds
  v_mfma_f32_16x16x32_bf16 v[36:39], v[196:199], a[200:203], v[36:39]
  s_waitcnt lgkmcnt(4)
  v_mfma_f32_16x16x32_bf16 v[40:43], v[200:203], a[200:203], v[40:43]
  ds_read_b64_tr_b16 v[212:213], v6 offset:776
  v_mfma_f32_16x16x32_bf16 v[44:47], v[204:207], a[200:203], v[44:47]
  ds_read_b64_tr_b16 v[214:215], v6 offset:1800
  v_mfma_f32_16x16x32_bf16 v[76:79], v[204:207], a[204:207], v[76:79]
  ds_read_b128 a[236:239], v7 offset:8448
  v_mfma_f32_16x16x32_bf16 v[72:75], v[200:203], a[204:207], v[72:75]
  buffer_load_dwordx4 v14, s[12:15], s36 offen offset:3072 lds
  v_mfma_f32_16x16x32_bf16 v[104:107], v[200:203], a[208:211], v[104:107]
  s_add_u32 s36, s36, 0x40000
  s_and_b32 s36, s36, 0x3fffff
  s_add_u32 s37, s6, s7
  v_mfma_f32_16x16x32_bf16 v[108:111], v[204:207], a[208:211], v[108:111]
  ds_read_b64_tr_b16 v[184:185], v6 offset:16384
  s_add_u32 m0, s30, s32
  v_mfma_f32_16x16x32_bf16 v[140:143], v[204:207], a[212:215], v[140:143]
  ds_read_b64_tr_b16 v[186:187], v6 offset:17408
  v_mfma_f32_16x16x32_bf16 v[136:139], v[200:203], a[212:215], v[136:139]
  v_mfma_f32_16x16x32_bf16 v[168:171], v[200:203], a[216:219], v[168:171]
  buffer_load_dwordx4 v15, s[8:11], s37 offen offset:0 lds
  v_mfma_f32_16x16x32_bf16 v[172:175], v[204:207], a[216:219], v[172:175]
  s_waitcnt lgkmcnt(3)
  v_mfma_f32_16x16x32_bf16 v[176:179], v[208:211], a[216:219], v[176:179]
  ds_read_b64_tr_b16 v[188:189], v6 offset:16392
  v_mfma_f32_16x16x32_bf16 v[180:183], v[212:215], a[216:219], v[180:183]
  ds_read_b64_tr_b16 v[190:191], v6 offset:17416
  v_mfma_f32_16x16x32_bf16 v[148:151], v[212:215], a[212:215], v[148:151]
  v_mfma_f32_16x16x32_bf16 v[144:147], v[208:211], a[212:215], v[144:147]
  buffer_load_dwordx4 v16, s[8:11], s37 offen offset:1024 lds
  v_mfma_f32_16x16x32_bf16 v[112:115], v[208:211], a[208:211], v[112:115]
  v_mfma_f32_16x16x32_bf16 v[116:119], v[212:215], a[208:211], v[116:119]
  ds_read_b64_tr_b16 v[192:193], v6 offset:16640
  v_mfma_f32_16x16x32_bf16 v[84:87], v[212:215], a[204:207], v[84:87]
  ds_read_b64_tr_b16 v[194:195], v6 offset:17664
  v_mfma_f32_16x16x32_bf16 v[80:83], v[208:211], a[204:207], v[80:83]
  v_mfma_f32_16x16x32_bf16 v[48:51], v[208:211], a[200:203], v[48:51]
  buffer_load_dwordx4 v17, s[8:11], s37 offen offset:2048 lds
  v_mfma_f32_16x16x32_bf16 v[52:55], v[212:215], a[200:203], v[52:55]
  s_waitcnt lgkmcnt(6)
  s_waitcnt lgkmcnt(2)
  v_mfma_f32_16x16x32_bf16 v[24:27], v[184:187], a[220:223], v[24:27]
  ds_read_b64_tr_b16 v[196:197], v6 offset:16648
  v_mfma_f32_16x16x32_bf16 v[28:31], v[188:191], a[220:223], v[28:31]
  ds_read_b64_tr_b16 v[198:199], v6 offset:17672
  v_mfma_f32_16x16x32_bf16 v[60:63], v[188:191], a[224:227], v[60:63]
  v_mfma_f32_16x16x32_bf16 v[56:59], v[184:187], a[224:227], v[56:59]
  buffer_load_dwordx4 v18, s[8:11], s37 offen offset:3072 lds
  v_mfma_f32_16x16x32_bf16 v[88:91], v[184:187], a[228:231], v[88:91]
  s_add_u32 m0, m0, 0x1000
  s_add_u32 s39, s37, 0x8000
  v_mfma_f32_16x16x32_bf16 v[92:95], v[188:191], a[228:231], v[92:95]
  ds_read_b64_tr_b16 v[200:201], v6 offset:16896
  v_mfma_f32_16x16x32_bf16 v[124:127], v[188:191], a[232:235], v[124:127]
  ds_read_b64_tr_b16 v[202:203], v6 offset:17920
  s_add_u32 s7, s7, 128
  v_mfma_f32_16x16x32_bf16 v[120:123], v[184:187], a[232:235], v[120:123]
  s_and_b32 s7, s7, 0x3ff
  v_mfma_f32_16x16x32_bf16 v[152:155], v[184:187], a[236:239], v[152:155]
  buffer_load_dwordx4 v15, s[8:11], s39 offen lds
  v_mfma_f32_16x16x32_bf16 v[156:159], v[188:191], a[236:239], v[156:159]
  s_waitcnt lgkmcnt(2)
  v_mfma_f32_16x16x32_bf16 v[160:163], v[192:195], a[236:239], v[160:163]
  ds_read_b64_tr_b16 v[204:205], v6 offset:16904
  v_mfma_f32_16x16x32_bf16 v[164:167], v[196:199], a[236:239], v[164:167]
  ds_read_b64_tr_b16 v[206:207], v6 offset:17928
  v_mfma_f32_16x16x32_bf16 v[132:135], v[196:199], a[232:235], v[132:135]
  ds_read_b64_tr_b16 v[208:209], v6 offset:17152
  v_mfma_f32_16x16x32_bf16 v[128:131], v[192:195], a[232:235], v[128:131]
  ds_read_b64_tr_b16 v[210:211], v6 offset:18176
  v_mfma_f32_16x16x32_bf16 v[96:99], v[192:195], a[228:231], v[96:99]
  v_mfma_f32_16x16x32_bf16 v[100:103], v[196:199], a[228:231], v[100:103]
  ds_read_b64_tr_b16 v[212:213], v6 offset:17160
  v_mfma_f32_16x16x32_bf16 v[68:71], v[196:199], a[224:227], v[68:71]
  ds_read_b64_tr_b16 v[214:215], v6 offset:18184
  s_add_u32 s30, s29, s31
  v_mfma_f32_16x16x32_bf16 v[64:67], v[192:195], a[224:227], v[64:67]
  s_add_u32 s29, s29, 53248
  v_mfma_f32_16x16x32_bf16 v[32:35], v[192:195], a[220:223], v[32:35]
  s_cmp_eq_u32 s29, 159744
  s_cselect_b32 s29, 0, s29
  v_mfma_f32_16x16x32_bf16 v[36:39], v[196:199], a[220:223], v[36:39]
  s_waitcnt lgkmcnt(4)
  v_mfma_f32_16x16x32_bf16 v[40:43], v[200:203], a[220:223], v[40:43]
  v_add_u32 v6, s29, v4
  v_mfma_f32_16x16x32_bf16 v[44:47], v[204:207], a[220:223], v[44:47]
  v_add_u32 v7, s29, v5
  v_mfma_f32_16x16x32_bf16 v[76:79], v[204:207], a[224:227], v[76:79]
  v_mfma_f32_16x16x32_bf16 v[72:75], v[200:203], a[224:227], v[72:75]
  s_mov_b32 m0, s30
  v_mfma_f32_16x16x32_bf16 v[104:107], v[200:203], a[228:231], v[104:107]
  s_sub_u32 s43, s43, 1
  s_cmp_lg_u32 s43, 0
  s_cbranch_scc1 LP1
  s_waitcnt vmcnt(13) lgkmcnt(0)
  s_barrier
  v_mfma_f32_16x16x32_bf16 v[108:111], v[204:207], a[228:231], v[108:111]
  ds_read_b64_tr_b16 v[184:185], v6 offset:0
  v_mfma_f32_16x16x32_bf16 v[140:143], v[204:207], a[232:235], v[140:143]
  ds_read_b64_tr_b16 v[186:187], v6 offset:1024
  v_mfma_f32_16x16x32_bf16 v[136:139], v[200:203], a[232:235], v[136:139]
  ds_read_b128 a[200:203], v7 offset:0
  v_mfma_f32_16x16x32_bf16 v[168:171], v[200:203], a[236:239], v[168:171]
  ds_read_b128 a[204:207], v7 offset:2048
  v_mfma_f32_16x16x32_bf16 v[172:175], v[204:207], a[236:239], v[172:175]
  buffer_load_dwordx4 v11, s[12:15], s36 offen offset:0 lds
  v_mfma_f32_16x16x32_bf16 v[176:179], v[208:211], a[236:239], v[176:179]
  ds_read_b128 a[208:211], v7 offset:4096
  v_mfma_f32_16x16x32_bf16 v[180:183], v[212:215], a[236:239], v[180:183]
  v_mfma_f32_16x16x32_bf16 v[148:151], v[212:215], a[232:235], v[148:151]
  ds_read_b64_tr_b16 v[188:189], v6 offset:8
  v_mfma_f32_16x16x32_bf16 v[144:147], v[208:211], a[232:235], v[144:147]
  ds_read_b64_tr_b16 v[190:191], v6 offset:1032
  v_mfma_f32_16x16x32_bf16 v[112:115], v[208:211], a[228:231], v[112:115]
  ds_read_b128 a[212:215], v7 offset:6144
  v_mfma_f32_16x16x32_bf16 v[116:119], v[212:215], a[228:231], v[116:119]
  ds_read_b128 a[216:219], v7 offset:8192
  buffer_load_dwordx4 v12, s[12:15], s36 offen offset:1024 lds
  v_mfma_f32_16x16x32_bf16 v[84:87], v[212:215], a[224:227], v[84:87]
  ds_read_b64_tr_b16 v[192:193], v6 offset:256
  v_mfma_f32_16x16x32_bf16 v[80:83], v[208:211], a[224:227], v[80:83]
  ds_read_b64_tr_b16 v[194:195], v6 offset:1280
  v_mfma_f32_16x16x32_bf16 v[48:51], v[208:211], a[220:223], v[48:51]
  buffer_load_dwordx4 v13, s[12:15], s36 offen offset:2048 lds
  v_mfma_f32_16x16x32_bf16 v[52:55], v[212:215], a[220:223], v[52:55]
  s_waitcnt lgkmcnt(4)
  v_mfma_f32_16x16x32_bf16 v[24:27], v[184:187], a[200:203], v[24:27]
  s_waitcnt lgkmcnt(2)
  v_mfma_f32_16x16x32_bf16 v[28:31], v[188:191], a[200:203], v[28:31]
  ds_read_b64_tr_b16 v[196:197], v6 offset:264
  v_mfma_f32_16x16x32_bf16 v[60:63], v[188:191], a[204:207], v[60:63]
  ds_read_b64_tr_b16 v[198:199], v6 offset:1288
  v_mfma_f32_16x16x32_bf16 v[56:59], v[184:187], a[204:207], v[56:59]
  ds_read_b128 a[220:223], v7 offset:256
  v_mfma_f32_16x16x32_bf16 v[88:91], v[184:187], a[208:211], v[88:91]
  buffer_load_dwordx4 v14, s[12:15], s36 offen offset:3072 lds
  v_mfma_f32_16x16x32_bf16 v[92:95], v[188:191], a[208:211], v[92:95]
  ds_read_b64_tr_b16 v[200:201], v6 offset:512
  s_add_u32 s36, s36, 0x40000
  v_mfma_f32_16x16x32_bf16 v[124:127], v[188:191], a[212:215], v[124:127]
  ds_read_b64_tr_b16 v[202:203], v6 offset:1536
  s_add_u32 m0, s30, 16384
  v_mfma_f32_16x16x32_bf16 v[120:123], v[184:187], a[212:215], v[120:123]
  ds_read_b128 a[224:227], v7 offset:2304
  v_mfma_f32_16x16x32_bf16 v[152:155], v[184:187], a[216:219], v[152:155]
  buffer_load_dwordx4 v11, s[12:15], s36 offen offset:0 lds
  v_mfma_f32_16x16x32_bf16 v[156:159], v[188:191], a[216:219], v[156:159]
  s_waitcnt lgkmcnt(4)
  v_mfma_f32_16x16x32_bf16 v[160:163], v[192:195], a[216:219], v[160:163]
  ds_read_b64_tr_b16 v[204:205], v6 offset:520
  v_mfma_f32_16x16x32_bf16 v[164:167], v[196:199], a[216:219], v[164:167]
  ds_read_b64_tr_b16 v[206:207], v6 offset:1544
  v_mfma_f32_16x16x32_bf16 v[132:135], v[196:199], a[212:215], v[132:135]
  ds_read_b128 a[228:231], v7 offset:4352
  v_mfma_f32_16x16x32_bf16 v[128:131], v[192:195], a[212:215], v[128:131]
  buffer_load_dwordx4 v12, s[12:15], s36 offen offset:1024 lds
  v_mfma_f32_16x16x32_bf16 v[96:99], v[192:195], a[208:211], v[96:99]
  v_mfma_f32_16x16x32_bf16 v[100:103], v[196:199], a[208:211], v[100:103]
  ds_read_b64_tr_b16 v[208:209], v6 offset:768
  v_mfma_f32_16x16x32_bf16 v[68:71], v[196:199], a[204:207], v[68:71]
  ds_read_b64_tr_b16 v[210:211], v6 offset:1792
  v_mfma_f32_16x16x32_bf16 v[64:67], v[192:195], a[204:207], v[64:67]
  ds_read_b128 a[232:235], v7 offset:6400
  v_mfma_f32_16x16x32_bf16 v[32:35], v[192:195], a[200:203], v[32:35]
  buffer_load_dwordx4 v13, s[12:15], s36 offen offset:2048 lds
  v_mfma_f32_16x16x32_bf16 v[36:39], v[196:199], a[200:203], v[36:39]
  s_waitcnt lgkmcnt(4)
  v_mfma_f32_16x16x32_bf16 v[40:43], v[200:203], a[200:203], v[40:43]
  ds_read_b64_tr_b16 v[212:213], v6 offset:776
  v_mfma_f32_16x16x32_bf16 v[44:47], v[204:207], a[200:203], v[44:47]
  ds_read_b64_tr_b16 v[214:215], v6 offset:1800
  v_mfma_f32_16x16x32_bf16 v[76:79], v[204:207], a[204:207], v[76:79]
  ds_read_b128 a[236:239], v7 offset:8448
  v_mfma_f32_16x16x32_bf16 v[72:75], v[200:203], a[204:207], v[72:75]
  buffer_load_dwordx4 v14, s[12:15], s36 offen offset:3072 lds
  v_mfma_f32_16x16x32_bf16 v[104:107], v[200:203], a[208:211], v[104:107]
  s_add_u32 s36, s36, 0x40000
  s_and_b32 s36, s36, 0x3fffff
  s_add_u32 s37, s6, s7
  v_mfma_f32_16x16x32_bf16 v[108:111], v[204:207], a[208:211], v[108:111]
  ds_read_b64_tr_b16 v[184:185], v6 offset:16384
  s_add_u32 m0, s30, s32
  v_mfma_f32_16x16x32_bf16 v[140:143], v[204:207], a[212:215], v[140:143]
  ds_read_b64_tr_b16 v[186:187], v6 offset:17408
  v_mfma_f32_16x16x32_bf16 v[136:139], v[200:203], a[212:215], v[136:139]
  v_mfma_f32_16x16x32_bf16 v[168:171], v[200:203], a[216:219], v[168:171]
  buffer_load_dwordx4 v15, s[8:11], s37 offen offset:0 lds
  v_mfma_f32_16x16x32_bf16 v[172:175], v[204:207], a[216:219], v[172:175]
  s_waitcnt lgkmcnt(3)
  v_mfma_f32_16x16x32_bf16 v[176:179], v[208:211], a[216:219], v[176:179]
  ds_read_b64_tr_b16 v[188:189], v6 offset:16392
  v_mfma_f32_16x16x32_bf16 v[180:183], v[212:215], a[216:219], v[180:183]
  ds_read_b64_tr_b16 v[190:191], v6 offset:17416
  v_mfma_f32_16x16x32_bf16 v[148:151], v[212:215], a[212:215], v[148:151]
  v_mfma_f32_16x16x32_bf16 v[144:147], v[208:211], a[212:215], v[144:147]
  buffer_load_dwordx4 v16, s[8:11], s37 offen offset:1024 lds
  v_mfma_f32_16x16x32_bf16 v[112:115], v[208:211], a[208:211], v[112:115]
  v_mfma_f32_16x16x32_bf16 v[116:119], v[212:215], a[208:211], v[116:119]
  ds_read_b64_tr_b16 v[192:193], v6 offset:16640
  v_mfma_f32_16x16x32_bf16 v[84:87], v[212:215], a[204:207], v[84:87]
  ds_read_b64_tr_b16 v[194:195], v6 offset:17664
  v_mfma_f32_16x16x32_bf16 v[80:83], v[208:211], a[204:207], v[80:83]
  v_mfma_f32_16x16x32_bf16 v[48:51], v[208:211], a[200:203], v[48:51]
  buffer_load_dwordx4 v17, s[8:11], s37 offen offset:2048 lds
  v_mfma_f32_16x16x32_bf16 v[52:55], v[212:215], a[200:203], v[52:55]
  s_waitcnt lgkmcnt(6)
  s_waitcnt lgkmcnt(2)
  v_mfma_f32_16x16x32_bf16 v[24:27], v[184:187], a[220:223], v[24:27]
  ds_read_b64_tr_b16 v[196:197], v6 offset:16648
  v_mfma_f32_16x16x32_bf16 v[28:31], v[188:191], a[220:223], v[28:31]
  ds_read_b64_tr_b16 v[198:199], v6 offset:17672
  v_mfma_f32_16x16x32_bf16 v[60:63], v[188:191], a[224:227], v[60:63]
  v_mfma_f32_16x16x32_bf16 v[56:59], v[184:187], a[224:227], v[56:59]
  buffer_load_dwordx4 v18, s[8:11], s37 offen offset:3072 lds
  v_mfma_f32_16x16x32_bf16 v[88:91], v[184:187], a[228:231], v[88:91]
  s_add_u32 m0, m0, 0x1000
  s_add_u32 s39, s37, 0x8000
  v_mfma_f32_16x16x32_bf16 v[92:95], v[188:191], a[228:231], v[92:95]
  ds_read_b64_tr_b16 v[200:201], v6 offset:16896
  v_mfma_f32_16x16x32_bf16 v[124:127], v[188:191], a[232:235], v[124:127]
  ds_read_b64_tr_b16 v[202:203], v6 offset:17920
  s_add_u32 s7, s7, 128
  v_mfma_f32_16x16x32_bf16 v[120:123], v[184:187], a[232:235], v[120:123]
  s_and_b32 s7, s7, 0x3ff
  v_mfma_f32_16x16x32_bf16 v[152:155], v[184:187], a[236:239], v[152:155]
  buffer_load_dwordx4 v15, s[8:11], s39 offen lds
  v_mfma_f32_16x16x32_bf16 v[156:159], v[188:191], a[236:239], v[156:159]
  s_waitcnt lgkmcnt(2)
  v_mfma_f32_16x16x32_bf16 v[160:163], v[192:195], a[236:239], v[160:163]
  ds_read_b64_tr_b16 v[204:205], v6 offset:16904
  v_mfma_f32_16x16x32_bf16 v[164:167], v[196:199], a[236:239], v[164:167]
  ds_read_b64_tr_b16 v[206:207], v6 offset:17928
  v_mfma_f32_16x16x32_bf16 v[132:135], v[196:199], a[232:235], v[132:135]
  ds_read_b64_tr_b16 v[208:209], v6 offset:17152
  v_mfma_f32_16x16x32_bf16 v[128:131], v[192:195], a[232:235], v[128:131]
  ds_read_b64_tr_b16 v[210:211], v6 offset:18176
  v_mfma_f32_16x16x32_bf16 v[96:99], v[192:195], a[228:231], v[96:99]
  v_mfma_f32_16x16x32_bf16 v[100:103], v[196:199], a[228:231], v[100:103]
  ds_read_b64_tr_b16 v[212:213], v6 offset:17160
  v_mfma_f32_16x16x32_bf16 v[68:71], v[196:199], a[224:227], v[68:71]
  ds_read_b64_tr_b16 v[214:215], v6 offset:18184
  s_add_u32 s30, s29, s31
  v_mfma_f32_16x16x32_bf16 v[64:67], v[192:195], a[224:227], v[64:67]
  s_add_u32 s29, s29, 53248
  v_mfma_f32_16x16x32_bf16 v[32:35], v[192:195], a[220:223], v[32:35]
  s_cmp_eq_u32 s29, 159744
  s_cselect_b32 s29, 0, s29
  v_mfma_f32_16x16x32_bf16 v[36:39], v[196:199], a[220:223], v[36:39]
  s_waitcnt lgkmcnt(4)
  v_mfma_f32_16x16x32_bf16 v[40:43], v[200:203], a[220:223], v[40:43]
  v_add_u32 v6, s29, v4
  v_mfma_f32_16x16x32_bf16 v[44:47], v[204:207], a[220:223], v[44:47]
  v_add_u32 v7, s29, v5
  v_mfma_f32_16x16x32_bf16 v[76:79], v[204:207], a[224:227], v[76:79]
  v_mfma_f32_16x16x32_bf16 v[72:75], v[200:203], a[224:227], v[72:75]
  v_mfma_f32_16x16x32_bf16 v[104:107], v[200:203], a[228:231], v[104:107]
  s_waitcnt vmcnt(13) lgkmcnt(0)
  s_barrier
  s_add_u32 s40, s33, s34
  s_add_u32 s34, s34, 0x2000
  v_mfma_f32_16x16x32_bf16 v[108:111], v[204:207], a[228:231], v[108:111]
  ds_read_b64_tr_b16 v[184:185], v6 offset:0
  s_and_b32 s34, s34, 0x1ffff
  v_mfma_f32_16x16x32_bf16 v[140:143], v[204:207], a[232:235], v[140:143]
  ds_read_b64_tr_b16 v[186:187], v6 offset:1024
  s_add_u32 m0, s30, 16384
  v_mfma_f32_16x16x32_bf16 v[136:139], v[200:203], a[232:235], v[136:139]
  ds_read_b128 a[200:203], v7 offset:0
  v_mfma_f32_16x16x32_bf16 v[168:171], v[200:203], a[236:239], v[168:171]
  ds_read_b128 a[204:207], v7 offset:2048
  v_mfma_f32_16x16x32_bf16 v[172:175], v[204:207], a[236:239], v[172:175]
  buffer_load_dwordx4 v9, s[16:19], s40 offen offset:0 nt lds
  v_mfma_f32_16x16x32_bf16 v[176:179], v[208:211], a[236:239], v[176:179]
  ds_read_b128 a[208:211], v7 offset:4096
  v_mfma_f32_16x16x32_bf16 v[180:183], v[212:215], a[236:239], v[180:183]
  v_mfma_f32_16x16x32_bf16 v[148:151], v[212:215], a[232:235], v[148:151]
  ds_read_b64_tr_b16 v[188:189], v6 offset:8
  v_mfma_f32_16x16x32_bf16 v[144:147], v[208:211], a[232:235], v[144:147]
  ds_read_b64_tr_b16 v[190:191], v6 offset:1032
  v_mfma_f32_16x16x32_bf16 v[112:115], v[208:211], a[228:231], v[112:115]
  ds_read_b128 a[212:215], v7 offset:6144
  v_mfma_f32_16x16x32_bf16 v[116:119], v[212:215], a[228:231], v[116:119]
  ds_read_b128 a[216:219], v7 offset:8192
  v_mfma_f32_16x16x32_bf16 v[84:87], v[212:215], a[224:227], v[84:87]
  ds_read_b64_tr_b16 v[192:193], v6 offset:256
  v_mfma_f32_16x16x32_bf16 v[80:83], v[208:211], a[224:227], v[80:83]
  ds_read_b64_tr_b16 v[194:195], v6 offset:1280
  v_mfma_f32_16x16x32_bf16 v[48:51], v[208:211], a[220:223], v[48:51]
  buffer_load_dwordx4 v10, s[16:19], s40 offen offset:1024 nt lds
  v_mfma_f32_16x16x32_bf16 v[52:55], v[212:215], a[220:223], v[52:55]
  s_waitcnt lgkmcnt(4)
  v_mfma_f32_16x16x32_bf16 v[24:27], v[184:187], a[200:203], v[24:27]
  s_waitcnt lgkmcnt(2)
  v_mfma_f32_16x16x32_bf16 v[28:31], v[188:191], a[200:203], v[28:31]
  ds_read_b64_tr_b16 v[196:197], v6 offset:264
  v_mfma_f32_16x16x32_bf16 v[60:63], v[188:191], a[204:207], v[60:63]
  ds_read_b64_tr_b16 v[198:199], v6 offset:1288
  v_mfma_f32_16x16x32_bf16 v[56:59], v[184:187], a[204:207], v[56:59]
  ds_read_b128 a[220:223], v7 offset:256
  v_mfma_f32_16x16x32_bf16 v[88:91], v[184:187], a[208:211], v[88:91]
  v_mfma_f32_16x16x32_bf16 v[92:95], v[188:191], a[208:211], v[92:95]
  ds_read_b64_tr_b16 v[200:201], v6 offset:512
  v_mfma_f32_16x16x32_bf16 v[124:127], v[188:191], a[212:215], v[124:127]
  ds_read_b64_tr_b16 v[202:203], v6 offset:1536
  v_mfma_f32_16x16x32_bf16 v[120:123], v[184:187], a[212:215], v[120:123]
  ds_read_b128 a[224:227], v7 offset:2304
  v_mfma_f32_16x16x32_bf16 v[152:155], v[184:187], a[216:219], v[152:155]
  buffer_load_dwordx4 v9, s[16:19], s40 offen offset:2048 nt lds
  v_mfma_f32_16x16x32_bf16 v[156:159], v[188:191], a[216:219], v[156:159]
  s_waitcnt lgkmcnt(4)
  v_mfma_f32_16x16x32_bf16 v[160:163], v[192:195], a[216:219], v[160:163]
  ds_read_b64_tr_b16 v[204:205], v6 offset:520
  v_mfma_f32_16x16x32_bf16 v[164:167], v[196:199], a[216:219], v[164:167]
  ds_read_b64_tr_b16 v[206:207], v6 offset:1544
  v_mfma_f32_16x16x32_bf16 v[132:135], v[196:199], a[212:215], v[132:135]
  ds_read_b128 a[228:231], v7 offset:4352
  v_mfma_f32_16x16x32_bf16 v[128:131], v[192:195], a[212:215], v[128:131]
  v_mfma_f32_16x16x32_bf16 v[96:99], v[192:195], a[208:211], v[96:99]
  v_mfma_f32_16x16x32_bf16 v[100:103], v[196:199], a[208:211], v[100:103]
  ds_read_b64_tr_b16 v[208:209], v6 offset:768
  v_mfma_f32_16x16x32_bf16 v[68:71], v[196:199], a[204:207], v[68:71]
  ds_read_b64_tr_b16 v[210:211], v6 offset:1792
  v_mfma_f32_16x16x32_bf16 v[64:67], v[192:195], a[204:207], v[64:67]
  ds_read_b128 a[232:235], v7 offset:6400
  v_mfma_f32_16x16x32_bf16 v[32:35], v[192:195], a[200:203], v[32:35]
  buffer_load_dwordx4 v10, s[16:19], s40 offen offset:3072 nt lds
  v_mfma_f32_16x16x32_bf16 v[36:39], v[196:199], a[200:203], v[36:39]
  s_waitcnt lgkmcnt(4)
  v_mfma_f32_16x16x32_bf16 v[40:43], v[200:203], a[200:203], v[40:43]
  ds_read_b64_tr_b16 v[212:213], v6 offset:776
  v_mfma_f32_16x16x32_bf16 v[44:47], v[204:207], a[200:203], v[44:47]
  ds_read_b64_tr_b16 v[214:215], v6 offset:1800
  v_mfma_f32_16x16x32_bf16 v[76:79], v[204:207], a[204:207], v[76:79]
  ds_read_b128 a[236:239], v7 offset:8448
  v_mfma_f32_16x16x32_bf16 v[72:75], v[200:203], a[204:207], v[72:75]
  s_add_u32 s39, s33, s34
  s_add_u32 s34, s34, 0x2000
  s_and_b32 s34, s34, 0x1ffff
  v_mfma_f32_16x16x32_bf16 v[104:107], v[200:203], a[208:211], v[104:107]
  s_mov_b32 m0, s30
  v_mfma_f32_16x16x32_bf16 v[108:111], v[204:207], a[208:211], v[108:111]
  ds_read_b64_tr_b16 v[184:185], v6 offset:16384
  v_mfma_f32_16x16x32_bf16 v[140:143], v[204:207], a[212:215], v[140:143]
  ds_read_b64_tr_b16 v[186:187], v6 offset:17408
  v_mfma_f32_16x16x32_bf16 v[136:139], v[200:203], a[212:215], v[136:139]
  v_mfma_f32_16x16x32_bf16 v[168:171], v[200:203], a[216:219], v[168:171]
  buffer_load_dwordx4 v9, s[16:19], s39 offen offset:0 nt lds
  v_mfma_f32_16x16x32_bf16 v[172:175], v[204:207], a[216:219], v[172:175]
  s_waitcnt lgkmcnt(3)
  v_mfma_f32_16x16x32_bf16 v[176:179], v[208:211], a[216:219], v[176:179]
  ds_read_b64_tr_b16 v[188:189], v6 offset:16392
  v_mfma_f32_16x16x32_bf16 v[180:183], v[212:215], a[216:219], v[180:183]
  ds_read_b64_tr_b16 v[190:191], v6 offset:17416
  v_mfma_f32_16x16x32_bf16 v[148:151], v[212:215], a[212:215], v[148:151]
  v_mfma_f32_16x16x32_bf16 v[144:147], v[208:211], a[212:215], v[144:147]
  v_mfma_f32_16x16x32_bf16 v[112:115], v[208:211], a[208:211], v[112:115]
  v_mfma_f32_16x16x32_bf16 v[116:119], v[212:215], a[208:211], v[116:119]
  ds_read_b64_tr_b16 v[192:193], v6 offset:16640
  v_mfma_f32_16x16x32_bf16 v[84:87], v[212:215], a[204:207], v[84:87]
  ds_read_b64_tr_b16 v[194:195], v6 offset:17664
  v_mfma_f32_16x16x32_bf16 v[80:83], v[208:211], a[204:207], v[80:83]
  v_mfma_f32_16x16x32_bf16 v[48:51], v[208:211], a[200:203], v[48:51]
  buffer_load_dwordx4 v10, s[16:19], s39 offen offset:1024 nt lds
  v_mfma_f32_16x16x32_bf16 v[52:55], v[212:215], a[200:203], v[52:55]
  s_waitcnt lgkmcnt(6)
  s_waitcnt lgkmcnt(2)
  v_mfma_f32_16x16x32_bf16 v[24:27], v[184:187], a[220:223], v[24:27]
  ds_read_b64_tr_b16 v[196:197], v6 offset:16648
  v_mfma_f32_16x16x32_bf16 v[28:31], v[188:191], a[220:223], v[28:31]
  ds_read_b64_tr_b16 v[198:199], v6 offset:17672
  v_mfma_f32_16x16x32_bf16 v[60:63], v[188:191], a[224:227], v[60:63]
  v_mfma_f32_16x16x32_bf16 v[56:59], v[184:187], a[224:227], v[56:59]
  v_mfma_f32_16x16x32_bf16 v[88:91], v[184:187], a[228:231], v[88:91]
  v_mfma_f32_16x16x32_bf16 v[92:95], v[188:191], a[228:231], v[92:95]
  ds_read_b64_tr_b16 v[200:201], v6 offset:16896
  v_mfma_f32_16x16x32_bf16 v[124:127], v[188:191], a[232:235], v[124:127]
  ds_read_b64_tr_b16 v[202:203], v6 offset:17920
  v_mfma_f32_16x16x32_bf16 v[120:123], v[184:187], a[232:235], v[120:123]
  v_mfma_f32_16x16x32_bf16 v[152:155], v[184:187], a[236:239], v[152:155]
  buffer_load_dwordx4 v9, s[16:19], s39 offen offset:2048 nt lds
  v_mfma_f32_16x16x32_bf16 v[156:159], v[188:191], a[236:239], v[156:159]
  s_waitcnt lgkmcnt(2)
  v_mfma_f32_16x16x32_bf16 v[160:163], v[192:195], a[236:239], v[160:163]
  ds_read_b64_tr_b16 v[204:205], v6 offset:16904
  v_mfma_f32_16x16x32_bf16 v[164:167], v[196:199], a[236:239], v[164:167]
  ds_read_b64_tr_b16 v[206:207], v6 offset:17928
  v_mfma_f32_16x16x32_bf16 v[132:135], v[196:199], a[232:235], v[132:135]
  ds_read_b64_tr_b16 v[208:209], v6 offset:17152
  v_mfma_f32_16x16x32_bf16 v[128:131], v[192:195], a[232:235], v[128:131]
  ds_read_b64_tr_b16 v[210:211], v6 offset:18176
  v_mfma_f32_16x16x32_bf16 v[96:99], v[192:195], a[228:231], v[96:99]
  v_mfma_f32_16x16x32_bf16 v[100:103], v[196:199], a[228:231], v[100:103]
  ds_read_b64_tr_b16 v[212:213], v6 offset:17160
  v_mfma_f32_16x16x32_bf16 v[68:71], v[196:199], a[224:227], v[68:71]
  ds_read_b64_tr_b16 v[214:215], v6 offset:18184
  s_add_u32 s30, s29, s31
  v_mfma_f32_16x16x32_bf16 v[64:67], v[192:195], a[224:227], v[64:67]
  s_add_u32 s29, s29, 53248
  v_mfma_f32_16x16x32_bf16 v[32:35], v[192:195], a[220:223], v[32:35]
  buffer_load_dwordx4 v10, s[16:19], s39 offen offset:3072 nt lds
  v_mfma_f32_16x16x32_bf16 v[36:39], v[196:199], a[220:223], v[36:39]
  s_waitcnt lgkmcnt(4)
  s_cmp_eq_u32 s29, 159744
  v_mfma_f32_16x16x32_bf16 v[40:43], v[200:203], a[220:223], v[40:43]
  s_cselect_b32 s29, 0, s29
  v_add_u32 v6, s29, v4
  v_mfma_f32_16x16x32_bf16 v[44:47], v[204:207], a[220:223], v[44:47]
  v_add_u32 v7, s29, v5
  v_mfma_f32_16x16x32_bf16 v[76:79], v[204:207], a[224:227], v[76:79]
  v_mfma_f32_16x16x32_bf16 v[72:75], v[200:203], a[224:227], v[72:75]
  v_mfma_f32_16x16x32_bf16 v[104:107], v[200:203], a[228:231], v[104:107]
  s_waitcnt vmcnt(8) lgkmcnt(0)
  s_barrier
  s_add_u32 s40, s33, s35
  s_add_u32 s35, s35, 0x2000
  v_mfma_f32_16x16x32_bf16 v[108:111], v[204:207], a[228:231], v[108:111]
  ds_read_b64_tr_b16 v[184:185], v6 offset:0
  s_and_b32 s35, s35, 0x1ffff
  v_mfma_f32_16x16x32_bf16 v[140:143], v[204:207], a[232:235], v[140:143]
  ds_read_b64_tr_b16 v[186:187], v6 offset:1024
  s_add_u32 m0, s30, 16384
  v_mfma_f32_16x16x32_bf16 v[136:139], v[200:203], a[232:235], v[136:139]
  ds_read_b128 a[200:203], v7 offset:0
  v_mfma_f32_16x16x32_bf16 v[168:171], v[200:203], a[236:239], v[168:171]
  ds_read_b128 a[204:207], v7 offset:2048
  v_mfma_f32_16x16x32_bf16 v[172:175], v[204:207], a[236:239], v[172:175]
  buffer_load_dwordx4 v9, s[20:23], s40 offen offset:0 nt lds
  v_mfma_f32_16x16x32_bf16 v[176:179], v[208:211], a[236:239], v[176:179]
  ds_read_b128 a[208:211], v7 offset:4096
  v_mfma_f32_16x16x32_bf16 v[180:183], v[212:215], a[236:239], v[180:183]
  v_mfma_f32_16x16x32_bf16 v[148:151], v[212:215], a[232:235], v[148:151]
  ds_read_b64_tr_b16 v[188:189], v6 offset:8
  v_mfma_f32_16x16x32_bf16 v[144:147], v[208:211], a[232:235], v[144:147]
  ds_read_b64_tr_b16 v[190:191], v6 offset:1032
  v_mfma_f32_16x16x32_bf16 v[112:115], v[208:211], a[228:231], v[112:115]
  ds_read_b128 a[212:215], v7 offset:6144
  v_mfma_f32_16x16x32_bf16 v[116:119], v[212:215], a[228:231], v[116:119]
  ds_read_b128 a[216:219], v7 offset:8192
  v_mfma_f32_16x16x32_bf16 v[84:87], v[212:215], a[224:227], v[84:87]
  ds_read_b64_tr_b16 v[192:193], v6 offset:256
  v_mfma_f32_16x16x32_bf16 v[80:83], v[208:211], a[224:227], v[80:83]
  ds_read_b64_tr_b16 v[194:195], v6 offset:1280
  v_mfma_f32_16x16x32_bf16 v[48:51], v[208:211], a[220:223], v[48:51]
  buffer_load_dwordx4 v10, s[20:23], s40 offen offset:1024 nt lds
  v_mfma_f32_16x16x32_bf16 v[52:55], v[212:215], a[220:223], v[52:55]
  s_waitcnt lgkmcnt(4)
  v_mfma_f32_16x16x32_bf16 v[24:27], v[184:187], a[200:203], v[24:27]
  s_waitcnt lgkmcnt(2)
  v_mfma_f32_16x16x32_bf16 v[28:31], v[188:191], a[200:203], v[28:31]
  ds_read_b64_tr_b16 v[196:197], v6 offset:264
  v_mfma_f32_16x16x32_bf16 v[60:63], v[188:191], a[204:207], v[60:63]
  ds_read_b64_tr_b16 v[198:199], v6 offset:1288
  v_mfma_f32_16x16x32_bf16 v[56:59], v[184:187], a[204:207], v[56:59]
  ds_read_b128 a[220:223], v7 offset:256
  v_mfma_f32_16x16x32_bf16 v[88:91], v[184:187], a[208:211], v[88:91]
  v_mfma_f32_16x16x32_bf16 v[92:95], v[188:191], a[208:211], v[92:95]
  ds_read_b64_tr_b16 v[200:201], v6 offset:512
  v_mfma_f32_16x16x32_bf16 v[124:127], v[188:191], a[212:215], v[124:127]
  ds_read_b64_tr_b16 v[202:203], v6 offset:1536
  v_mfma_f32_16x16x32_bf16 v[120:123], v[184:187], a[212:215], v[120:123]
  ds_read_b128 a[224:227], v7 offset:2304
  v_mfma_f32_16x16x32_bf16 v[152:155], v[184:187], a[216:219], v[152:155]
  buffer_load_dwordx4 v9, s[20:23], s40 offen offset:2048 nt lds
  v_mfma_f32_16x16x32_bf16 v[156:159], v[188:191], a[216:219], v[156:159]
  s_waitcnt lgkmcnt(4)
  v_mfma_f32_16x16x32_bf16 v[160:163], v[192:195], a[216:219], v[160:163]
  ds_read_b64_tr_b16 v[204:205], v6 offset:520
  v_mfma_f32_16x16x32_bf16 v[164:167], v[196:199], a[216:219], v[164:167]
  ds_read_b64_tr_b16 v[206:207], v6 offset:1544
  v_mfma_f32_16x16x32_bf16 v[132:135], v[196:199], a[212:215], v[132:135]
  ds_read_b128 a[228:231], v7 offset:4352
  v_mfma_f32_16x16x32_bf16 v[128:131], v[192:195], a[212:215], v[128:131]
  v_mfma_f32_16x16x32_bf16 v[96:99], v[192:195], a[208:211], v[96:99]
  v_mfma_f32_16x16x32_bf16 v[100:103], v[196:199], a[208:211], v[100:103]
  ds_read_b64_tr_b16 v[208:209], v6 offset:768
  v_mfma_f32_16x16x32_bf16 v[68:71], v[196:199], a[204:207], v[68:71]
  ds_read_b64_tr_b16 v[210:211], v6 offset:1792
  v_mfma_f32_16x16x32_bf16 v[64:67], v[192:195], a[204:207], v[64:67]
  ds_read_b128 a[232:235], v7 offset:6400
  v_mfma_f32_16x16x32_bf16 v[32:35], v[192:195], a[200:203], v[32:35]
  buffer_load_dwordx4 v10, s[20:23], s40 offen offset:3072 nt lds
  v_mfma_f32_16x16x32_bf16 v[36:39], v[196:199], a[200:203], v[36:39]
  s_waitcnt lgkmcnt(4)
  v_mfma_f32_16x16x32_bf16 v[40:43], v[200:203], a[200:203], v[40:43]
  ds_read_b64_tr_b16 v[212:213], v6 offset:776
  v_mfma_f32_16x16x32_bf16 v[44:47], v[204:207], a[200:203], v[44:47]
  ds_read_b64_tr_b16 v[214:215], v6 offset:1800
  v_mfma_f32_16x16x32_bf16 v[76:79], v[204:207], a[204:207], v[76:79]
  ds_read_b128 a[236:239], v7 offset:8448
  v_mfma_f32_16x16x32_bf16 v[72:75], v[200:203], a[204:207], v[72:75]
  s_add_u32 s39, s33, s34
  s_add_u32 s34, s34, 0x2000
  s_and_b32 s34, s34, 0x1ffff
  v_mfma_f32_16x16x32_bf16 v[104:107], v[200:203], a[208:211], v[104:107]
  s_mov_b32 m0, s30
  v_mfma_f32_16x16x32_bf16 v[108:111], v[204:207], a[208:211], v[108:111]
  ds_read_b64_tr_b16 v[184:185], v6 offset:16384
  v_mfma_f32_16x16x32_bf16 v[140:143], v[204:207], a[212:215], v[140:143]
  ds_read_b64_tr_b16 v[186:187], v6 offset:17408
  v_mfma_f32_16x16x32_bf16 v[136:139], v[200:203], a[212:215], v[136:139]
  v_mfma_f32_16x16x32_bf16 v[168:171], v[200:203], a[216:219], v[168:171]
  buffer_load_dwordx4 v9, s[16:19], s39 offen offset:0 nt lds
  v_mfma_f32_16x16x32_bf16 v[172:175], v[204:207], a[216:219], v[172:175]
  s_waitcnt lgkmcnt(3)
  v_mfma_f32_16x16x32_bf16 v[176:179], v[208:211], a[216:219], v[176:179]
  ds_read_b64_tr_b16 v[188:189], v6 offset:16392
  v_mfma_f32_16x16x32_bf16 v[180:183], v[212:215], a[216:219], v[180:183]
  ds_read_b64_tr_b16 v[190:191], v6 offset:17416
  v_mfma_f32_16x16x32_bf16 v[148:151], v[212:215], a[212:215], v[148:151]
  v_mfma_f32_16x16x32_bf16 v[144:147], v[208:211], a[212:215], v[144:147]
  v_mfma_f32_16x16x32_bf16 v[112:115], v[208:211], a[208:211], v[112:115]
  v_mfma_f32_16x16x32_bf16 v[116:119], v[212:215], a[208:211], v[116:119]
  ds_read_b64_tr_b16 v[192:193], v6 offset:16640
  v_mfma_f32_16x16x32_bf16 v[84:87], v[212:215], a[204:207], v[84:87]
  ds_read_b64_tr_b16 v[194:195], v6 offset:17664
  v_mfma_f32_16x16x32_bf16 v[80:83], v[208:211], a[204:207], v[80:83]
  v_mfma_f32_16x16x32_bf16 v[48:51], v[208:211], a[200:203], v[48:51]
  buffer_load_dwordx4 v10, s[16:19], s39 offen offset:1024 nt lds
  v_mfma_f32_16x16x32_bf16 v[52:55], v[212:215], a[200:203], v[52:55]
  s_waitcnt lgkmcnt(6)
  s_waitcnt lgkmcnt(2)
  v_mfma_f32_16x16x32_bf16 v[24:27], v[184:187], a[220:223], v[24:27]
  ds_read_b64_tr_b16 v[196:197], v6 offset:16648
  v_mfma_f32_16x16x32_bf16 v[28:31], v[188:191], a[220:223], v[28:31]
  ds_read_b64_tr_b16 v[198:199], v6 offset:17672
  v_mfma_f32_16x16x32_bf16 v[60:63], v[188:191], a[224:227], v[60:63]
  v_mfma_f32_16x16x32_bf16 v[56:59], v[184:187], a[224:227], v[56:59]
  v_mfma_f32_16x16x32_bf16 v[88:91], v[184:187], a[228:231], v[88:91]
  v_mfma_f32_16x16x32_bf16 v[92:95], v[188:191], a[228:231], v[92:95]
  ds_read_b64_tr_b16 v[200:201], v6 offset:16896
  v_mfma_f32_16x16x32_bf16 v[124:127], v[188:191], a[232:235], v[124:127]
  ds_read_b64_tr_b16 v[202:203], v6 offset:17920
  v_mfma_f32_16x16x32_bf16 v[120:123], v[184:187], a[232:235], v[120:123]
  v_mfma_f32_16x16x32_bf16 v[152:155], v[184:187], a[236:239], v[152:155]
  buffer_load_dwordx4 v9, s[16:19], s39 offen offset:2048 nt lds
  v_mfma_f32_16x16x32_bf16 v[156:159], v[188:191], a[236:239], v[156:159]
  s_waitcnt lgkmcnt(2)
  v_mul_f32 v24, s41, v24
  v_mfma_f32_16x16x32_bf16 v[160:163], v[192:195], a[236:239], v[160:163]
  ds_read_b64_tr_b16 v[204:205], v6 offset:16904
  v_mul_f32 v25, s41, v25
  v_mfma_f32_16x16x32_bf16 v[164:167], v[196:199], a[236:239], v[164:167]
  ds_read_b64_tr_b16 v[206:207], v6 offset:17928
  v_mul_f32 v26, s41, v26
  v_mfma_f32_16x16x32_bf16 v[132:135], v[196:199], a[232:235], v[132:135]
  ds_read_b64_tr_b16 v[208:209], v6 offset:17152
  v_mul_f32 v27, s41, v27
  v_mfma_f32_16x16x32_bf16 v[128:131], v[192:195], a[232:235], v[128:131]
  ds_read_b64_tr_b16 v[210:211], v6 offset:18176
  v_mul_f32 v28, s41, v28
  v_mfma_f32_16x16x32_bf16 v[96:99], v[192:195], a[228:231], v[96:99]
  v_mul_f32 v29, s41, v29
  v_mul_f32 v30, s41, v30
  v_mfma_f32_16x16x32_bf16 v[100:103], v[196:199], a[228:231], v[100:103]
  ds_read_b64_tr_b16 v[212:213], v6 offset:17160
  v_mul_f32 v31, s41, v31
  v_mfma_f32_16x16x32_bf16 v[68:71], v[196:199], a[224:227], v[68:71]
  ds_read_b64_tr_b16 v[214:215], v6 offset:18184
  v_cvt_pk_bf16_f32 v24, v24, v25
  v_cvt_pk_bf16_f32 v26, v26, v27
  v_cvt_pk_bf16_f32 v28, v28, v29
  v_cvt_pk_bf16_f32 v30, v30, v31
  v_accvgpr_write_b32 a160, v24
  v_mfma_f32_16x16x32_bf16 v[64:67], v[192:195], a[224:227], v[64:67]
  s_add_u32 s30, s29, s31
  v_accvgpr_write_b32 a161, v26
  v_accvgpr_write_b32 a162, v28
  v_accvgpr_write_b32 a163, v30
  v_mul_f32 v56, s41, v56
  v_mul_f32 v57, s41, v57
  v_mul_f32 v58, s41, v58
  v_mfma_f32_16x16x32_bf16 v[32:35], v[192:195], a[220:223], v[32:35]
  buffer_load_dwordx4 v10, s[16:19], s39 offen offset:3072 nt lds
  v_mul_f32 v59, s41, v59
  v_mul_f32 v60, s41, v60
  v_mul_f32 v61, s41, v61
  v_mul_f32 v62, s41, v62
  v_mul_f32 v63, s41, v63
  v_cvt_pk_bf16_f32 v56, v56, v57
  v_mfma_f32_16x16x32_bf16 v[36:39], v[196:199], a[220:223], v[36:39]
  s_waitcnt lgkmcnt(4)
  v_cvt_pk_bf16_f32 v58, v58, v59
  v_cvt_pk_bf16_f32 v60, v60, v61
  v_cvt_pk_bf16_f32 v62, v62, v63
  v_accvgpr_write_b32 a164, v56
  v_accvgpr_write_b32 a165, v58
  v_accvgpr_write_b32 a166, v60
  v_mfma_f32_16x16x32_bf16 v[40:43], v[200:203], a[220:223], v[40:43]
  v_accvgpr_write_b32 a167, v62
  v_mul_f32 v88, s41, v88
  v_mul_f32 v89, s41, v89
  v_mul_f32 v90, s41, v90
  v_mul_f32 v91, s41, v91
  v_mul_f32 v92, s41, v92
  v_mfma_f32_16x16x32_bf16 v[44:47], v[204:207], a[220:223], v[44:47]
  s_add_u32 s29, s29, 53248
  v_mul_f32 v93, s41, v93
  v_mul_f32 v94, s41, v94
  v_mul_f32 v95, s41, v95
  v_cvt_pk_bf16_f32 v88, v88, v89
  v_cvt_pk_bf16_f32 v90, v90, v91
  v_cvt_pk_bf16_f32 v92, v92, v93
  v_cvt_pk_bf16_f32 v94, v94, v95
  v_mfma_f32_16x16x32_bf16 v[76:79], v[204:207], a[224:227], v[76:79]
  s_cmp_eq_u32 s29, 159744
  v_accvgpr_write_b32 a168, v88
  v_accvgpr_write_b32 a169, v90
  v_accvgpr_write_b32 a170, v92
  v_accvgpr_write_b32 a171, v94
  v_mul_f32 v120, s41, v120
  v_mul_f32 v121, s41, v121
  v_mfma_f32_16x16x32_bf16 v[72:75], v[200:203], a[224:227], v[72:75]
  s_cselect_b32 s29, 0, s29
  v_mul_f32 v122, s41, v122
  v_mul_f32 v123, s41, v123
  v_mul_f32 v124, s41, v124
  v_mul_f32 v125, s41, v125
  v_mul_f32 v126, s41, v126
  v_mul_f32 v127, s41, v127
  v_mfma_f32_16x16x32_bf16 v[104:107], v[200:203], a[228:231], v[104:107]
  s_waitcnt vmcnt(8) lgkmcnt(0)
  s_barrier
  v_cvt_pk_bf16_f32 v120, v120, v121
  v_cvt_pk_bf16_f32 v122, v122, v123
  v_cvt_pk_bf16_f32 v124, v124, v125
  v_cvt_pk_bf16_f32 v126, v126, v127
  v_accvgpr_write_b32 a172, v120
  v_add_u32 v6, s29, v1
  v_accvgpr_write_b32 a173, v122
  v_mfma_f32_16x16x32_bf16 v[108:111], v[204:207], a[228:231], v[108:111]
  ds_read_b128 v[184:187], v6 offset:16384
  v_accvgpr_write_b32 a174, v124
  v_accvgpr_write_b32 a175, v126
  v_mul_f32 v152, s41, v152
  v_add_u32 v7, s29, v2
  v_mul_f32 v153, s41, v153
  v_mul_f32 v154, s41, v154
  v_mul_f32 v155, s41, v155
  v_mfma_f32_16x16x32_bf16 v[140:143], v[204:207], a[232:235], v[140:143]
  s_add_u32 s40, s33, s35
  v_mul_f32 v156, s41, v156
  v_add_u32 v8, s29, v3
  v_mul_f32 v157, s41, v157
  v_mul_f32 v158, s41, v158
  v_mul_f32 v159, s41, v159
  v_cvt_pk_bf16_f32 v152, v152, v153
  v_cvt_pk_bf16_f32 v154, v154, v155
  v_mfma_f32_16x16x32_bf16 v[136:139], v[200:203], a[232:235], v[136:139]
  s_add_u32 s35, s35, 0x2000
  v_cvt_pk_bf16_f32 v156, v156, v157
  v_cvt_pk_bf16_f32 v158, v158, v159
  v_accvgpr_write_b32 a176, v152
  v_accvgpr_write_b32 a177, v154
  v_accvgpr_write_b32 a178, v156
  v_accvgpr_write_b32 a179, v158
  v_mul_f32 v32, s41, v32
  v_mfma_f32_16x16x32_bf16 v[168:171], v[200:203], a[236:239], v[168:171]
  s_and_b32 s35, s35, 0x1ffff
  v_mul_f32 v33, s41, v33
  v_mul_f32 v34, s41, v34
  v_mul_f32 v35, s41, v35
  s_add_u32 m0, s30, 16384
  v_mul_f32 v36, s41, v36
  v_mul_f32 v37, s41, v37
  v_mfma_f32_16x16x32_bf16 v[172:175], v[204:207], a[236:239], v[172:175]
  buffer_load_dwordx4 v9, s[20:23], s40 offen offset:0 nt lds
  v_mul_f32 v38, s41, v38
  v_mul_f32 v39, s41, v39
  v_cvt_pk_bf16_f32 v32, v32, v33
  v_cvt_pk_bf16_f32 v34, v34, v35
  v_cvt_pk_bf16_f32 v36, v36, v37
  v_cvt_pk_bf16_f32 v38, v38, v39
  v_mfma_f32_16x16x32_bf16 v[176:179], v[208:211], a[236:239], v[176:179]
  ds_read_b128 v[188:191], v6 offset:20480
  v_accvgpr_write_b32 a180, v32
  v_accvgpr_write_b32 a181, v34
  v_accvgpr_write_b32 a182, v36
  v_accvgpr_write_b32 a183, v38
  v_mul_f32 v64, s41, v64
  v_mul_f32 v65, s41, v65
  v_mfma_f32_16x16x32_bf16 v[180:183], v[212:215], a[236:239], v[180:183]
  v_mul_f32 v66, s41, v66
  v_mul_f32 v67, s41, v67
  v_mul_f32 v68, s41, v68
  v_mul_f32 v69, s41, v69
  v_mul_f32 v70, s41, v70
  v_mfma_f32_16x16x32_bf16 v[148:151], v[212:215], a[232:235], v[148:151]
  v_mul_f32 v71, s41, v71
  v_cvt_pk_bf16_f32 v64, v64, v65
  v_cvt_pk_bf16_f32 v66, v66, v67
  v_cvt_pk_bf16_f32 v68, v68, v69
  v_cvt_pk_bf16_f32 v70, v70, v71
  v_accvgpr_write_b32 a184, v64
  v_mfma_f32_16x16x32_bf16 v[144:147], v[208:211], a[232:235], v[144:147]
  buffer_load_dwordx4 v10, s[20:23], s40 offen offset:1024 nt lds
  v_accvgpr_write_b32 a185, v66
  v_accvgpr_write_b32 a186, v68
  v_accvgpr_write_b32 a187, v70
  v_mul_f32 v96, s41, v96
  v_mul_f32 v97, s41, v97
  v_mul_f32 v98, s41, v98
  v_mfma_f32_16x16x32_bf16 v[112:115], v[208:211], a[228:231], v[112:115]
  v_mul_f32 v99, s41, v99
  v_mul_f32 v100, s41, v100
  v_mul_f32 v101, s41, v101
  v_mul_f32 v102, s41, v102
  v_mul_f32 v103, s41, v103
  v_cvt_pk_bf16_f32 v96, v96, v97
  v_mfma_f32_16x16x32_bf16 v[116:119], v[212:215], a[228:231], v[116:119]
  ds_read_b128 v[192:195], v6 offset:16640
  v_cvt_pk_bf16_f32 v98, v98, v99
  v_cvt_pk_bf16_f32 v100, v100, v101
  v_cvt_pk_bf16_f32 v102, v102, v103
  v_accvgpr_write_b32 a188, v96
  v_accvgpr_write_b32 a189, v98
  v_mfma_f32_16x16x32_bf16 v[84:87], v[212:215], a[224:227], v[84:87]
  v_accvgpr_write_b32 a190, v100
  v_accvgpr_write_b32 a191, v102
  v_mul_f32 v128, s41, v128
  v_mul_f32 v129, s41, v129
  v_mul_f32 v130, s41, v130
  v_mul_f32 v131, s41, v131
  v_mfma_f32_16x16x32_bf16 v[80:83], v[208:211], a[224:227], v[80:83]
  v_mul_f32 v132, s41, v132
  v_mul_f32 v133, s41, v133
  v_mul_f32 v134, s41, v134
  v_mul_f32 v135, s41, v135
  v_cvt_pk_bf16_f32 v128, v128, v129
  v_cvt_pk_bf16_f32 v130, v130, v131
  v_mfma_f32_16x16x32_bf16 v[48:51], v[208:211], a[220:223], v[48:51]
  buffer_load_dwordx4 v9, s[20:23], s40 offen offset:2048 nt lds
  v_cvt_pk_bf16_f32 v132, v132, v133
  v_cvt_pk_bf16_f32 v134, v134, v135
  v_accvgpr_write_b32 a192, v128
  v_accvgpr_write_b32 a193, v130
  v_accvgpr_write_b32 a194, v132
  v_mfma_f32_16x16x32_bf16 v[52:55], v[212:215], a[220:223], v[52:55]
  s_waitcnt lgkmcnt(2)
  v_accvgpr_write_b32 a195, v134
  v_mul_f32 v160, s41, v160
  v_mul_f32 v161, s41, v161
  v_mul_f32 v162, s41, v162
  v_mul_f32 v163, s41, v163
  v_mul_f32 v164, s41, v164
  v_mfma_f32_16x16x32_bf16 v[24:27], v[184:187], a[160:163], 0
  ds_read_b128 v[196:199], v6 offset:20736
  v_mul_f32 v165, s41, v165
  v_mul_f32 v166, s41, v166
  v_mul_f32 v167, s41, v167
  v_cvt_pk_bf16_f32 v160, v160, v161
  v_cvt_pk_bf16_f32 v162, v162, v163
  v_cvt_pk_bf16_f32 v164, v164, v165
  v_mfma_f32_16x16x32_bf16 v[56:59], v[184:187], a[164:167], 0
  v_cvt_pk_bf16_f32 v166, v166, v167
  v_accvgpr_write_b32 a196, v160
  v_accvgpr_write_b32 a197, v162
  v_accvgpr_write_b32 a198, v164
  v_accvgpr_write_b32 a199, v166
  v_mfma_f32_16x16x32_bf16 v[88:91], v[184:187], a[168:171], 0
  v_mul_f32 v40, s41, v40
  v_mul_f32 v41, s41, v41
  v_mul_f32 v42, s41, v42
  v_mfma_f32_16x16x32_bf16 v[120:123], v[184:187], a[172:175], 0
  buffer_load_dwordx4 v10, s[20:23], s40 offen offset:3072 nt lds
  v_mul_f32 v43, s41, v43
  v_mul_f32 v44, s41, v44
  v_mul_f32 v45, s41, v45
  v_mul_f32 v46, s41, v46
  v_mfma_f32_16x16x32_bf16 v[152:155], v[184:187], a[176:179], 0
  s_waitcnt lgkmcnt(2)
  v_mul_f32 v47, s41, v47
  v_cvt_pk_bf16_f32 v40, v40, v41
  v_cvt_pk_bf16_f32 v42, v42, v43
  v_cvt_pk_bf16_f32 v44, v44, v45
  v_mfma_f32_16x16x32_bf16 v[28:31], v[188:191], a[160:163], 0
  ds_read_b128 v[200:203], v6 offset:16896
  v_cvt_pk_bf16_f32 v46, v46, v47
  v_accvgpr_write_b32 a200, v40
  v_accvgpr_write_b32 a201, v42
  v_accvgpr_write_b32 a202, v44
  v_mfma_f32_16x16x32_bf16 v[60:63], v[188:191], a[164:167], 0
  v_accvgpr_write_b32 a203, v46
  v_mul_f32 v72, s41, v72
  v_mul_f32 v73, s41, v73
  v_mul_f32 v74, s41, v74
  v_mfma_f32_16x16x32_bf16 v[92:95], v[188:191], a[168:171], 0
  v_mul_f32 v75, s41, v75
  v_mul_f32 v76, s41, v76
  v_mul_f32 v77, s41, v77
  v_mul_f32 v78, s41, v78
  v_mul_f32 v79, s41, v79
  v_mfma_f32_16x16x32_bf16 v[124:127], v[188:191], a[172:175], 0
  s_add_u32 s39, s33, s34
  v_cvt_pk_bf16_f32 v72, v72, v73
  v_cvt_pk_bf16_f32 v74, v74, v75
  v_cvt_pk_bf16_f32 v76, v76, v77
  v_cvt_pk_bf16_f32 v78, v78, v79
  v_mfma_f32_16x16x32_bf16 v[156:159], v[188:191], a[176:179], 0
  s_waitcnt lgkmcnt(2)
  v_accvgpr_write_b32 a204, v72
  v_accvgpr_write_b32 a205, v74
  v_accvgpr_write_b32 a206, v76
  v_accvgpr_write_b32 a207, v78
  v_mfma_f32_16x16x32_bf16 v[24:27], v[192:195], a[180:183], v[24:27]
  ds_read_b128 v[204:207], v6 offset:20992
  v_mul_f32 v104, s41, v104
  v_mul_f32 v105, s41, v105
  v_mul_f32 v106, s41, v106
  v_mul_f32 v107, s41, v107
  v_mfma_f32_16x16x32_bf16 v[56:59], v[192:195], a[184:187], v[56:59]
  s_add_u32 s34, s34, 0x2000
  v_mul_f32 v108, s41, v108
  v_mul_f32 v109, s41, v109
  v_mul_f32 v110, s41, v110
  v_mul_f32 v111, s41, v111
  v_cvt_pk_bf16_f32 v104, v104, v105
  v_mfma_f32_16x16x32_bf16 v[88:91], v[192:195], a[188:191], v[88:91]
  s_and_b32 s34, s34, 0x1ffff
  v_cvt_pk_bf16_f32 v106, v106, v107
  v_cvt_pk_bf16_f32 v108, v108, v109
  v_cvt_pk_bf16_f32 v110, v110, v111
  v_accvgpr_write_b32 a208, v104
  v_mfma_f32_16x16x32_bf16 v[120:123], v[192:195], a[192:195], v[120:123]
  s_mov_b32 m0, s30
  v_accvgpr_write_b32 a209, v106
  v_accvgpr_write_b32 a210, v108
  v_accvgpr_write_b32 a211, v110
  v_mul_f32 v136, s41, v136
  v_mfma_f32_16x16x32_bf16 v[152:155], v[192:195], a[196:199], v[152:155]
  buffer_load_dwordx4 v9, s[16:19], s39 offen offset:0 nt lds
  v_mul_f32 v137, s41, v137
  v_mul_f32 v138, s41, v138
  v_mul_f32 v139, s41, v139
  v_mul_f32 v140, s41, v140
  s_waitcnt lgkmcnt(2)
  v_mfma_f32_16x16x32_bf16 v[28:31], v[196:199], a[180:183], v[28:31]
  ds_read_b128 v[208:211], v6 offset:17152
  v_mul_f32 v141, s41, v141
  v_mul_f32 v142, s41, v142
  v_mul_f32 v143, s41, v143
  v_cvt_pk_bf16_f32 v136, v136, v137
  v_mfma_f32_16x16x32_bf16 v[60:63], v[196:199], a[184:187], v[60:63]
  v_cvt_pk_bf16_f32 v138, v138, v139
  v_cvt_pk_bf16_f32 v140, v140, v141
  v_cvt_pk_bf16_f32 v142, v142, v143
  v_accvgpr_write_b32 a212, v136
  v_accvgpr_write_b32 a213, v138
  v_mfma_f32_16x16x32_bf16 v[92:95], v[196:199], a[188:191], v[92:95]
  v_accvgpr_write_b32 a214, v140
  v_accvgpr_write_b32 a215, v142
  v_mul_f32 v168, s41, v168
  v_mul_f32 v169, s41, v169
  v_mfma_f32_16x16x32_bf16 v[124:127], v[196:199], a[192:195], v[124:127]
  buffer_load_dwordx4 v10, s[16:19], s39 offen offset:1024 nt lds
  v_mul_f32 v170, s41, v170
  v_mul_f32 v171, s41, v171
  v_mul_f32 v172, s41, v172
  v_mul_f32 v173, s41, v173
  v_mfma_f32_16x16x32_bf16 v[156:159], v[196:199], a[196:199], v[156:159]
  s_waitcnt lgkmcnt(2)
  v_mul_f32 v174, s41, v174
  v_mul_f32 v175, s41, v175
  v_cvt_pk_bf16_f32 v168, v168, v169
  v_cvt_pk_bf16_f32 v170, v170, v171
  v_mfma_f32_16x16x32_bf16 v[24:27], v[200:203], a[200:203], v[24:27]
  ds_read_b128 v[212:215], v6 offset:21248
  v_cvt_pk_bf16_f32 v172, v172, v173
  v_cvt_pk_bf16_f32 v174, v174, v175
  v_accvgpr_write_b32 a216, v168
  v_accvgpr_write_b32 a217, v170
  v_mfma_f32_16x16x32_bf16 v[56:59], v[200:203], a[204:207], v[56:59]
  v_accvgpr_write_b32 a218, v172
  v_accvgpr_write_b32 a219, v174
  v_mul_f32 v48, s41, v48
  v_mul_f32 v49, s41, v49
  v_mul_f32 v50, s41, v50
  v_mul_f32 v51, s41, v51
  v_mfma_f32_16x16x32_bf16 v[88:91], v[200:203], a[208:211], v[88:91]
  v_mul_f32 v52, s41, v52
  v_mul_f32 v53, s41, v53
  v_mul_f32 v54, s41, v54
  v_mul_f32 v55, s41, v55
  v_cvt_pk_bf16_f32 v48, v48, v49
  v_cvt_pk_bf16_f32 v50, v50, v51
  v_cvt_pk_bf16_f32 v52, v52, v53
  v_cvt_pk_bf16_f32 v54, v54, v55
  v_mfma_f32_16x16x32_bf16 v[120:123], v[200:203], a[212:215], v[120:123]
  buffer_load_dwordx4 v9, s[16:19], s39 offen offset:2048 nt lds
  v_accvgpr_write_b32 a220, v48
  v_accvgpr_write_b32 a221, v50
  v_accvgpr_write_b32 a222, v52
  v_accvgpr_write_b32 a223, v54
  v_mul_f32 v80, s41, v80
  v_mul_f32 v81, s41, v81
  v_mul_f32 v82, s41, v82
  v_mul_f32 v83, s41, v83
  v_mfma_f32_16x16x32_bf16 v[152:155], v[200:203], a[216:219], v[152:155]
  s_waitcnt lgkmcnt(2)
  v_mul_f32 v84, s41, v84
  v_mul_f32 v85, s41, v85
  v_mul_f32 v86, s41, v86
  v_mul_f32 v87, s41, v87
  v_cvt_pk_bf16_f32 v80, v80, v81
  v_cvt_pk_bf16_f32 v82, v82, v83
  v_cvt_pk_bf16_f32 v84, v84, v85
  v_cvt_pk_bf16_f32 v86, v86, v87
  v_mfma_f32_16x16x32_bf16 v[28:31], v[204:207], a[200:203], v[28:31]
  ds_read_b128 v[184:187], v6 offset:0
  v_accvgpr_write_b32 a224, v80
  v_accvgpr_write_b32 a225, v82
  v_accvgpr_write_b32 a226, v84
  v_accvgpr_write_b32 a227, v86
  v_mul_f32 v112, s41, v112
  v_mul_f32 v113, s41, v113
  v_mul_f32 v114, s41, v114
  v_mul_f32 v115, s41, v115
  v_mfma_f32_16x16x32_bf16 v[60:63], v[204:207], a[204:207], v[60:63]
  v_mul_f32 v116, s41, v116
  v_mul_f32 v117, s41, v117
  v_mul_f32 v118, s41, v118
  v_mul_f32 v119, s41, v119
  v_cvt_pk_bf16_f32 v112, v112, v113
  v_cvt_pk_bf16_f32 v114, v114, v115
  v_cvt_pk_bf16_f32 v116, v116, v117
  v_cvt_pk_bf16_f32 v118, v118, v119
  v_mfma_f32_16x16x32_bf16 v[92:95], v[204:207], a[208:211], v[92:95]
  v_accvgpr_write_b32 a228, v112
  v_accvgpr_write_b32 a229, v114
  v_accvgpr_write_b32 a230, v116
  v_accvgpr_write_b32 a231, v118
  v_mul_f32 v144, s41, v144
  v_mul_f32 v145, s41, v145
  v_mul_f32 v146, s41, v146
  v_mul_f32 v147, s41, v147
  v_mfma_f32_16x16x32_bf16 v[124:127], v[204:207], a[212:215], v[124:127]
  buffer_load_dwordx4 v10, s[16:19], s39 offen offset:3072 nt lds
  v_mul_f32 v148, s41, v148
  v_mul_f32 v149, s41, v149
  v_mul_f32 v150, s41, v150
  v_mul_f32 v151, s41, v151
  v_cvt_pk_bf16_f32 v144, v144, v145
  v_cvt_pk_bf16_f32 v146, v146, v147
  v_cvt_pk_bf16_f32 v148, v148, v149
  v_cvt_pk_bf16_f32 v150, v150, v151
  v_mfma_f32_16x16x32_bf16 v[156:159], v[204:207], a[216:219], v[156:159]
  s_waitcnt lgkmcnt(2)
  v_accvgpr_write_b32 a232, v144
  v_accvgpr_write_b32 a233, v146
  v_accvgpr_write_b32 a234, v148
  v_accvgpr_write_b32 a235, v150
  v_mul_f32 v176, s41, v176
  v_mul_f32 v177, s41, v177
  v_mul_f32 v178, s41, v178
  v_mul_f32 v179, s41, v179
  v_mfma_f32_16x16x32_bf16 v[24:27], v[208:211], a[220:223], v[24:27]
  ds_read_b128 v[188:191], v6 offset:256
  v_mul_f32 v180, s41, v180
  v_mul_f32 v181, s41, v181
  v_mul_f32 v182, s41, v182
  v_mul_f32 v183, s41, v183
  v_cvt_pk_bf16_f32 v176, v176, v177
  v_cvt_pk_bf16_f32 v178, v178, v179
  v_cvt_pk_bf16_f32 v180, v180, v181
  v_cvt_pk_bf16_f32 v182, v182, v183
  v_mfma_f32_16x16x32_bf16 v[56:59], v[208:211], a[224:227], v[56:59]
  v_accvgpr_write_b32 a236, v176
  v_accvgpr_write_b32 a237, v178
  v_accvgpr_write_b32 a238, v180
  v_accvgpr_write_b32 a239, v182
  v_mfma_f32_16x16x32_bf16 v[88:91], v[208:211], a[228:231], v[88:91]
  v_mfma_f32_16x16x32_bf16 v[120:123], v[208:211], a[232:235], v[120:123]
  v_mfma_f32_16x16x32_bf16 v[152:155], v[208:211], a[236:239], v[152:155]
  s_waitcnt lgkmcnt(2)
  v_mfma_f32_16x16x32_bf16 v[28:31], v[212:215], a[220:223], v[28:31]
  ds_read_b128 v[192:195], v6 offset:512
  v_mfma_f32_16x16x32_bf16 v[60:63], v[212:215], a[224:227], v[60:63]
  v_max3_f32 v216, v24, v25, v26
  v_max3_f32 v218, v56, v57, v58
  v_mfma_f32_16x16x32_bf16 v[92:95], v[212:215], a[228:231], v[92:95]
  v_max3_f32 v220, v88, v89, v90
  v_max3_f32 v222, v120, v121, v122
  v_mfma_f32_16x16x32_bf16 v[124:127], v[212:215], a[232:235], v[124:127]
  ds_read_b128 v[196:199], v6 offset:768
  v_max3_f32 v224, v152, v153, v154
  v_mfma_f32_16x16x32_bf16 v[156:159], v[212:215], a[236:239], v[156:159]
  ds_read_b128 v[200:203], v6 offset:4096
  v_max3_f32 v217, v27, v28, v29
  v_max3_f32 v216, v216, v30, v31
  v_max_f32 v216, v216, v217
  v_mov_b32 v217, v216
  s_nop 1
  v_permlane16_swap_b32 v216, v217
  v_max_f32 v216, v216, v217
  v_mov_b32 v217, v216
  s_nop 1
  v_permlane32_swap_b32 v216, v217
  v_max_f32 v216, v216, v217
  v_sub_f32 v48, 0, v216
  v_sub_f32 v49, 0, v216
  v_sub_f32 v50, 0, v216
  v_sub_f32 v51, 0, v216
  s_waitcnt lgkmcnt(4)
  s_nop 0
  v_mfma_f32_16x16x32_bf16 v[32:35], v[184:187], a[160:163], v[48:51]
  ds_read_b128 v[204:207], v6 offset:4352
  v_max3_f32 v219, v59, v60, v61
  v_max3_f32 v218, v218, v62, v63
  v_max_f32 v218, v218, v219
  v_mov_b32 v219, v218
  s_nop 1
  v_permlane16_swap_b32 v218, v219
  v_max_f32 v218, v218, v219
  v_mov_b32 v219, v218
  s_nop 1
  v_permlane32_swap_b32 v218, v219
  v_max_f32 v218, v218, v219
  v_sub_f32 v80, 0, v218
  v_sub_f32 v81, 0, v218
  v_sub_f32 v82, 0, v218
  v_sub_f32 v83, 0, v218
  s_nop 1
  v_mfma_f32_16x16x32_bf16 v[64:67], v[184:187], a[164:167], v[80:83]
  v_max3_f32 v221, v91, v92, v93
  v_max3_f32 v220, v220, v94, v95
  v_max3_f32 v223, v123, v124, v125
  v_max3_f32 v225, v155, v156, v157
  v_max3_f32 v222, v222, v126, v127
  v_max3_f32 v224, v224, v158, v159
  v_max_f32 v220, v220, v221
  v_max_f32 v222, v222, v223
  v_max_f32 v224, v224, v225
  v_mov_b32 v221, v220
  v_mov_b32 v223, v222
  v_mov_b32 v225, v224
  v_permlane16_swap_b32 v220, v221
  v_permlane16_swap_b32 v222, v223
  v_permlane16_swap_b32 v224, v225
  v_max_f32 v220, v220, v221
  v_max_f32 v222, v222, v223
  v_max_f32 v224, v224, v225
  v_mov_b32 v221, v220
  v_mov_b32 v223, v222
  v_mov_b32 v225, v224
  v_permlane32_swap_b32 v220, v221
  v_permlane32_swap_b32 v222, v223
  v_permlane32_swap_b32 v224, v225
  v_max_f32 v220, v220, v221
  v_max_f32 v222, v222, v223
  v_max_f32 v224, v224, v225
  v_sub_f32 v112, 0, v220
  v_sub_f32 v144, 0, v222
  v_sub_f32 v176, 0, v224
  v_sub_f32 v113, 0, v220
  v_sub_f32 v145, 0, v222
  v_sub_f32 v177, 0, v224
  v_sub_f32 v114, 0, v220
  v_sub_f32 v146, 0, v222
  v_sub_f32 v178, 0, v224
  v_sub_f32 v115, 0, v220
  v_sub_f32 v147, 0, v222
  v_sub_f32 v179, 0, v224
  v_mfma_f32_16x16x32_bf16 v[96:99], v[184:187], a[168:171], v[112:115]
  ds_read_b128 v[208:211], v6 offset:4608
  v_add_f32 v24, v24, v48
  v_add_f32 v25, v25, v48
  v_add_f32 v26, v26, v48
  v_mfma_f32_16x16x32_bf16 v[128:131], v[184:187], a[172:175], v[144:147]
  ds_read_b128 v[212:215], v6 offset:4864
  v_add_f32 v27, v27, v48
  v_add_f32 v56, v56, v80
  v_add_f32 v57, v57, v80
  v_add_f32 v58, v58, v80
  v_mfma_f32_16x16x32_bf16 v[160:163], v[184:187], a[176:179], v[176:179]
  s_waitcnt lgkmcnt(6)
  v_add_f32 v59, v59, v80
  v_add_f32 v88, v88, v112
  v_add_f32 v89, v89, v112
  v_add_f32 v90, v90, v112
  v_add_f32 v91, v91, v112
  v_mfma_f32_16x16x32_bf16 v[32:35], v[188:191], a[180:183], v[32:35]
  s_add_u32 s30, s29, s31
  v_add_f32 v120, v120, v144
  v_add_f32 v121, v121, v144
  v_add_f32 v122, v122, v144
  v_add_f32 v123, v123, v144
  v_mfma_f32_16x16x32_bf16 v[64:67], v[188:191], a[184:187], v[64:67]
  s_add_u32 s29, s29, 53248
  v_add_f32 v152, v152, v176
  v_add_f32 v153, v153, v176
  v_add_f32 v154, v154, v176
  v_add_f32 v155, v155, v176
  v_add_f32 v28, v28, v48
  v_mfma_f32_16x16x32_bf16 v[96:99], v[188:191], a[188:191], v[96:99]
  s_cmp_eq_u32 s29, 159744
  v_add_f32 v29, v29, v48
  v_add_f32 v30, v30, v48
  v_add_f32 v31, v31, v48
  v_add_f32 v60, v60, v80
  v_add_f32 v61, v61, v80
  v_mfma_f32_16x16x32_bf16 v[128:131], v[188:191], a[192:195], v[128:131]
  s_cselect_b32 s29, 0, s29
  v_add_f32 v62, v62, v80
  v_add_f32 v63, v63, v80
  v_add_f32 v92, v92, v112
  v_add_f32 v93, v93, v112
  v_mfma_f32_16x16x32_bf16 v[160:163], v[188:191], a[196:199], v[160:163]
  s_waitcnt lgkmcnt(5)
  v_add_f32 v94, v94, v112
  v_add_f32 v95, v95, v112
  v_add_f32 v124, v124, v144
  v_add_f32 v125, v125, v144
  v_add_u32 v6, s29, v1
  v_add_f32 v126, v126, v144
  v_mfma_f32_16x16x32_bf16 v[32:35], v[192:195], a[200:203], v[32:35]
  s_waitcnt vmcnt(8) lgkmcnt(0)
  s_barrier
  v_exp_f32 v216, v24
  v_add_f32 v127, v127, v144
  v_add_f32 v156, v156, v176
  v_add_u32 v7, s29, v2
  v_add_f32 v157, v157, v176
  v_add_f32 v158, v158, v176
  v_mfma_f32_16x16x32_bf16 v[64:67], v[192:195], a[204:207], v[64:67]
  s_add_u32 s40, s33, s35
  v_exp_f32 v217, v25
  v_add_f32 v159, v159, v176
  v_add_u32 v8, s29, v3
  v_mfma_f32_16x16x32_bf16 v[96:99], v[192:195], a[208:211], v[96:99]
  s_add_u32 s35, s35, 0x2000
  v_exp_f32 v218, v26
  v_cvt_pk_bf16_f32 v40, v216, v217
  v_exp_f32 v219, v27
  v_mfma_f32_16x16x32_bf16 v[128:131], v[192:195], a[212:215], v[128:131]
  s_and_b32 s35, s35, 0x1ffff
  v_exp_f32 v220, v56
  v_add_f32 v53, v216, v217
  s_add_u32 m0, s30, 16384
  v_cvt_pk_bf16_f32 v41, v218, v219
  v_mfma_f32_16x16x32_bf16 v[160:163], v[192:195], a[216:219], v[160:163]
  buffer_load_dwordx4 v9, s[20:23], s40 offen offset:0 nt lds
  v_exp_f32 v221, v57
  v_add_f32 v53, v53, v218
  v_add_f32 v53, v53, v219
  v_mfma_f32_16x16x32_bf16 v[32:35], v[196:199], a[220:223], v[32:35]
  v_exp_f32 v222, v58
  v_cvt_pk_bf16_f32 v72, v220, v221
  v_exp_f32 v223, v59
  v_mfma_f32_16x16x32_bf16 v[64:67], v[196:199], a[224:227], v[64:67]
  v_exp_f32 v224, v88
  v_add_f32 v85, v220, v221
  v_cvt_pk_bf16_f32 v73, v222, v223
  v_exp_f32 v225, v89
  v_mfma_f32_16x16x32_bf16 v[96:99], v[196:199], a[228:231], v[96:99]
  v_exp_f32 v226, v90
  v_add_f32 v85, v85, v222
  v_add_f32 v85, v85, v223
  v_mfma_f32_16x16x32_bf16 v[128:131], v[196:199], a[232:235], v[128:131]
  buffer_load_dwordx4 v10, s[20:23], s40 offen offset:1024 nt lds
  v_cvt_pk_bf16_f32 v104, v224, v225
  v_exp_f32 v227, v91
  v_add_f32 v117, v224, v225
  v_mfma_f32_16x16x32_bf16 v[160:163], v[196:199], a[236:239], v[160:163]
  v_exp_f32 v228, v120
  v_cvt_pk_bf16_f32 v105, v226, v227
  v_exp_f32 v229, v121
  v_mfma_f32_16x16x32_bf16 v[36:39], v[200:203], a[160:163], v[48:51]
  v_exp_f32 v230, v122
  v_add_f32 v117, v117, v226
  v_add_f32 v117, v117, v227
  v_mfma_f32_16x16x32_bf16 v[68:71], v[200:203], a[164:167], v[80:83]
  v_exp_f32 v231, v123
  v_cvt_pk_bf16_f32 v136, v228, v229
  v_add_f32 v149, v228, v229
  v_mfma_f32_16x16x32_bf16 v[100:103], v[200:203], a[168:171], v[112:115]
  v_exp_f32 v216, v152
  v_cvt_pk_bf16_f32 v137, v230, v231
  v_exp_f32 v217, v153
  v_mfma_f32_16x16x32_bf16 v[132:135], v[200:203], a[172:175], v[144:147]
  v_exp_f32 v218, v154
  v_add_f32 v149, v149, v230
  v_add_f32 v149, v149, v231
  v_mfma_f32_16x16x32_bf16 v[164:167], v[200:203], a[176:179], v[176:179]
  v_exp_f32 v219, v155
  v_cvt_pk_bf16_f32 v168, v216, v217
  v_add_f32 v181, v216, v217
  v_exp_f32 v220, v28
  v_mfma_f32_16x16x32_bf16 v[36:39], v[204:207], a[180:183], v[36:39]
  ds_read_b64_tr_b16 v[184:185], v7 offset:16384
  v_cvt_pk_bf16_f32 v169, v218, v219
  v_exp_f32 v221, v29
  v_add_f32 v181, v181, v218
  v_mfma_f32_16x16x32_bf16 v[68:71], v[204:207], a[184:187], v[68:71]
  ds_read_b64_tr_b16 v[186:187], v7 offset:20480
  v_add_f32 v181, v181, v219
  v_exp_f32 v222, v30
  v_cvt_pk_bf16_f32 v42, v220, v221
  v_mfma_f32_16x16x32_bf16 v[100:103], v[204:207], a[188:191], v[100:103]
  v_exp_f32 v223, v31
  v_add_f32 v53, v53, v220
  v_add_f32 v53, v53, v221
  v_exp_f32 v224, v60
  v_mfma_f32_16x16x32_bf16 v[132:135], v[204:207], a[192:195], v[132:135]
  buffer_load_dwordx4 v9, s[20:23], s40 offen offset:2048 nt lds
  v_cvt_pk_bf16_f32 v43, v222, v223
  v_exp_f32 v225, v61
  v_mfma_f32_16x16x32_bf16 v[164:167], v[204:207], a[196:199], v[164:167]
  v_exp_f32 v226, v62
  v_add_f32 v53, v53, v222
  v_add_f32 v53, v53, v223
  v_cvt_pk_bf16_f32 v74, v224, v225
  v_mfma_f32_16x16x32_bf16 v[36:39], v[208:211], a[200:203], v[36:39]
  ds_read_b64_tr_b16 v[188:189], v8 offset:16384
  v_add_f32 v85, v85, v224
  v_exp_f32 v227, v63
  v_add_f32 v85, v85, v225
  v_mfma_f32_16x16x32_bf16 v[68:71], v[208:211], a[204:207], v[68:71]
  ds_read_b64_tr_b16 v[190:191], v8 offset:20480
  v_cvt_pk_bf16_f32 v75, v226, v227
  v_exp_f32 v228, v92
  v_exp_f32 v229, v93
  v_mfma_f32_16x16x32_bf16 v[100:103], v[208:211], a[208:211], v[100:103]
  v_exp_f32 v230, v94
  v_add_f32 v85, v85, v226
  v_add_f32 v85, v85, v227
  v_mfma_f32_16x16x32_bf16 v[132:135], v[208:211], a[212:215], v[132:135]
  v_exp_f32 v231, v95
  v_cvt_pk_bf16_f32 v106, v228, v229
  v_add_f32 v117, v117, v228
  v_add_f32 v117, v117, v229
  v_mfma_f32_16x16x32_bf16 v[164:167], v[208:211], a[216:219], v[164:167]
  v_exp_f32 v216, v124
  v_cvt_pk_bf16_f32 v107, v230, v231
  v_exp_f32 v217, v125
  v_mfma_f32_16x16x32_bf16 v[36:39], v[212:215], a[220:223], v[36:39]
  ds_read_b128 v[192:195], v6 offset:0
  v_add_f32 v117, v117, v230
  v_add_f32 v117, v117, v231
  v_exp_f32 v218, v126
  v_mfma_f32_16x16x32_bf16 v[68:71], v[212:215], a[224:227], v[68:71]
  v_exp_f32 v219, v127
  v_cvt_pk_bf16_f32 v138, v216, v217
  v_add_f32 v149, v149, v216
  v_add_f32 v149, v149, v217
  v_mfma_f32_16x16x32_bf16 v[100:103], v[212:215], a[228:231], v[100:103]
  v_exp_f32 v220, v156
  v_cvt_pk_bf16_f32 v139, v218, v219
  v_exp_f32 v221, v157
  v_mfma_f32_16x16x32_bf16 v[132:135], v[212:215], a[232:235], v[132:135]
  buffer_load_dwordx4 v10, s[20:23], s40 offen offset:3072 nt lds
  v_add_f32 v149, v149, v218
  v_add_f32 v149, v149, v219
  v_exp_f32 v222, v158
  v_mfma_f32_16x16x32_bf16 v[164:167], v[212:215], a[236:239], v[164:167]
  s_waitcnt lgkmcnt(1)
  v_exp_f32 v223, v159
  v_cvt_pk_bf16_f32 v170, v220, v221
  v_add_f32 v181, v181, v220
  v_mfma_f32_16x16x32_bf16 a[0:3], v[184:187], v[40:43], 0
  ds_read_b128 v[196:199], v6 offset:256
  v_add_f32 v181, v181, v221
  v_cvt_pk_bf16_f32 v171, v222, v223
  v_add_f32 v181, v181, v222
  v_add_f32 v181, v181, v223
  v_mov_b32 v52, v53
  v_mfma_f32_16x16x32_bf16 a[20:23], v[188:191], v[40:43], 0
  v_mov_b32 v84, v85
  v_mov_b32 v116, v117
  v_mov_b32 v148, v149
  v_mov_b32 v180, v181
  v_mfma_f32_16x16x32_bf16 a[24:27], v[188:191], v[72:75], 0
  v_exp_f32 v216, v32
  v_mfma_f32_16x16x32_bf16 a[4:7], v[184:187], v[72:75], 0
  s_add_u32 s39, s33, s34
  v_exp_f32 v217, v33
  v_mfma_f32_16x16x32_bf16 a[8:11], v[184:187], v[104:107], 0
  s_add_u32 s34, s34, 0x2000
  v_exp_f32 v218, v34
  v_mfma_f32_16x16x32_bf16 a[28:31], v[188:191], v[104:107], 0
  ds_read_b64_tr_b16 v[200:201], v7 offset:16640
  v_cvt_pk_bf16_f32 v44, v216, v217
  v_mfma_f32_16x16x32_bf16 a[32:35], v[188:191], v[136:139], 0
  ds_read_b64_tr_b16 v[202:203], v7 offset:20736
  v_add_f32 v53, v216, v217
  v_mfma_f32_16x16x32_bf16 a[12:15], v[184:187], v[136:139], 0
  s_and_b32 s34, s34, 0x1ffff
  v_exp_f32 v219, v35
  v_mfma_f32_16x16x32_bf16 a[16:19], v[184:187], v[168:171], 0
  s_mov_b32 m0, s30
  v_exp_f32 v220, v64
  v_mfma_f32_16x16x32_bf16 a[36:39], v[188:191], v[168:171], 0
  buffer_load_dwordx4 v9, s[16:19], s39 offen offset:0 nt lds
  s_waitcnt lgkmcnt(3)
  v_mfma_f32_16x16x32_bf16 v[152:155], v[192:195], a[176:179], v[176:179]
  ds_read_b64_tr_b16 v[204:205], v8 offset:16640
  v_cvt_pk_bf16_f32 v45, v218, v219
  s_waitcnt lgkmcnt(3)
  v_mfma_f32_16x16x32_bf16 v[152:155], v[196:199], a[196:199], v[152:155]
  v_exp_f32 v221, v65
  v_mfma_f32_16x16x32_bf16 v[120:123], v[196:199], a[192:195], v[144:147]
  ds_read_b64_tr_b16 v[206:207], v8 offset:20736
  v_add_f32 v53, v53, v218
  v_mfma_f32_16x16x32_bf16 v[120:123], v[192:195], a[172:175], v[120:123]
  buffer_load_dwordx4 v10, s[16:19], s39 offen offset:1024 nt lds
  v_add_f32 v53, v53, v219
  v_mfma_f32_16x16x32_bf16 v[88:91], v[192:195], a[168:171], v[112:115]
  v_exp_f32 v222, v66
  v_mfma_f32_16x16x32_bf16 v[88:91], v[196:199], a[188:191], v[88:91]
  ds_read_b128 v[208:211], v6 offset:512
  v_cvt_pk_bf16_f32 v76, v220, v221
  v_exp_f32 v223, v67
  v_mfma_f32_16x16x32_bf16 v[56:59], v[196:199], a[184:187], v[80:83]
  v_exp_f32 v224, v96
  v_add_f32 v85, v220, v221
  v_mfma_f32_16x16x32_bf16 v[56:59], v[192:195], a[164:167], v[56:59]
  v_exp_f32 v225, v97
  v_mfma_f32_16x16x32_bf16 v[24:27], v[192:195], a[160:163], v[48:51]
  v_cvt_pk_bf16_f32 v77, v222, v223
  v_add_f32 v85, v85, v222
  v_mfma_f32_16x16x32_bf16 v[24:27], v[196:199], a[180:183], v[24:27]
  s_waitcnt lgkmcnt(1)
  v_exp_f32 v226, v98
  v_mfma_f32_16x16x32_bf16 a[40:43], v[200:203], v[40:43], 0
  ds_read_b128 v[212:215], v6 offset:768
  v_add_f32 v85, v85, v223
  v_mfma_f32_16x16x32_bf16 a[60:63], v[204:207], v[40:43], 0
  v_exp_f32 v227, v99
  v_mfma_f32_16x16x32_bf16 a[64:67], v[204:207], v[72:75], 0
  v_cvt_pk_bf16_f32 v108, v224, v225
  v_add_f32 v117, v224, v225
  v_mfma_f32_16x16x32_bf16 a[44:47], v[200:203], v[72:75], 0
  buffer_load_dwordx4 v9, s[16:19], s39 offen offset:2048 nt lds
  v_mfma_f32_16x16x32_bf16 a[48:51], v[200:203], v[104:107], 0
  v_exp_f32 v228, v128
  v_mfma_f32_16x16x32_bf16 a[68:71], v[204:207], v[104:107], 0
  ds_read_b64_tr_b16 v[184:185], v7 offset:16896
  v_cvt_pk_bf16_f32 v109, v226, v227
  v_mfma_f32_16x16x32_bf16 a[72:75], v[204:207], v[136:139], 0
  ds_read_b64_tr_b16 v[186:187], v7 offset:20992
  v_add_f32 v117, v117, v226
  v_exp_f32 v229, v129
  v_mfma_f32_16x16x32_bf16 a[52:55], v[200:203], v[136:139], 0
  v_exp_f32 v230, v130
  v_mfma_f32_16x16x32_bf16 a[56:59], v[200:203], v[168:171], 0
  v_add_f32 v117, v117, v227
  v_cvt_pk_bf16_f32 v140, v228, v229
  v_mfma_f32_16x16x32_bf16 a[76:79], v[204:207], v[168:171], 0
  s_waitcnt lgkmcnt(2)
  v_exp_f32 v231, v131
  v_mfma_f32_16x16x32_bf16 v[152:155], v[208:211], a[216:219], v[152:155]
  ds_read_b64_tr_b16 v[188:189], v8 offset:16896
  v_add_f32 v149, v228, v229
  v_mfma_f32_16x16x32_bf16 v[152:155], v[212:215], a[236:239], v[152:155]
  v_exp_f32 v216, v160
  v_mfma_f32_16x16x32_bf16 v[120:123], v[212:215], a[232:235], v[120:123]
  ds_read_b64_tr_b16 v[190:191], v8 offset:20992
  v_cvt_pk_bf16_f32 v141, v230, v231
  v_mfma_f32_16x16x32_bf16 v[120:123], v[208:211], a[212:215], v[120:123]
  buffer_load_dwordx4 v10, s[16:19], s39 offen offset:3072 nt lds
  v_exp_f32 v217, v161
  v_mfma_f32_16x16x32_bf16 v[88:91], v[208:211], a[208:211], v[88:91]
  v_exp_f32 v218, v162
  v_add_f32 v149, v149, v230
  v_mfma_f32_16x16x32_bf16 v[88:91], v[212:215], a[228:231], v[88:91]
  ds_read_b128 v[192:195], v6 offset:4096
  v_add_f32 v149, v149, v231
  v_mfma_f32_16x16x32_bf16 v[56:59], v[212:215], a[224:227], v[56:59]
  v_exp_f32 v219, v163
  v_mfma_f32_16x16x32_bf16 v[56:59], v[208:211], a[204:207], v[56:59]
  v_cvt_pk_bf16_f32 v172, v216, v217
  v_add_f32 v181, v216, v217
  v_mfma_f32_16x16x32_bf16 v[24:27], v[208:211], a[200:203], v[24:27]
  v_exp_f32 v220, v36
  v_mfma_f32_16x16x32_bf16 v[24:27], v[212:215], a[220:223], v[24:27]
  s_waitcnt lgkmcnt(1)
  v_exp_f32 v221, v37
  v_mfma_f32_16x16x32_bf16 a[80:83], v[184:187], v[40:43], 0
  ds_read_b128 v[196:199], v6 offset:4352
  v_cvt_pk_bf16_f32 v173, v218, v219
  v_mfma_f32_16x16x32_bf16 a[100:103], v[188:191], v[40:43], 0
  v_exp_f32 v222, v38
  v_mfma_f32_16x16x32_bf16 a[104:107], v[188:191], v[72:75], 0
  v_add_f32 v181, v181, v218
  v_add_f32 v181, v181, v219
  v_mfma_f32_16x16x32_bf16 a[84:87], v[184:187], v[72:75], 0
  ds_read_b64_tr_b16 v[200:201], v7 offset:17152
  v_cvt_pk_bf16_f32 v46, v220, v221
  v_mfma_f32_16x16x32_bf16 a[88:91], v[184:187], v[104:107], 0
  ds_read_b64_tr_b16 v[202:203], v7 offset:21248
  v_add_f32 v53, v53, v220
  v_mfma_f32_16x16x32_bf16 a[108:111], v[188:191], v[104:107], 0
  ds_read_b64_tr_b16 v[204:205], v8 offset:17152
  v_add_f32 v53, v53, v221
  v_exp_f32 v223, v39
  v_mfma_f32_16x16x32_bf16 a[112:115], v[188:191], v[136:139], 0
  ds_read_b64_tr_b16 v[206:207], v8 offset:21248
  v_cvt_pk_bf16_f32 v47, v222, v223
  v_mfma_f32_16x16x32_bf16 a[92:95], v[184:187], v[136:139], 0
  ds_read_b128 v[208:211], v6 offset:4608
  v_add_f32 v53, v53, v222
  v_exp_f32 v224, v68
  v_mfma_f32_16x16x32_bf16 a[96:99], v[184:187], v[168:171], 0
  ds_read_b128 v[212:215], v6 offset:4864
  v_add_f32 v53, v53, v223
  v_exp_f32 v225, v69
  v_mfma_f32_16x16x32_bf16 a[116:119], v[188:191], v[168:171], 0
  s_waitcnt lgkmcnt(6)
  v_exp_f32 v226, v70
  v_mfma_f32_16x16x32_bf16 v[156:159], v[192:195], a[176:179], v[176:179]
  v_exp_f32 v227, v71
  v_mfma_f32_16x16x32_bf16 v[156:159], v[196:199], a[196:199], v[156:159]
  s_add_u32 s30, s29, s31
  v_cvt_pk_bf16_f32 v78, v224, v225
  v_add_f32 v85, v85, v224
  v_mfma_f32_16x16x32_bf16 v[124:127], v[196:199], a[192:195], v[144:147]
  s_add_u32 s29, s29, 53248
  v_exp_f32 v228, v100
  v_mfma_f32_16x16x32_bf16 v[124:127], v[192:195], a[172:175], v[124:127]
  s_cmp_eq_u32 s29, 159744
  v_add_f32 v85, v85, v225
  v_cvt_pk_bf16_f32 v79, v226, v227
  v_mfma_f32_16x16x32_bf16 v[92:95], v[192:195], a[168:171], v[112:115]
  s_cselect_b32 s29, 0, s29
  v_exp_f32 v229, v101
  v_mfma_f32_16x16x32_bf16 v[92:95], v[196:199], a[188:191], v[92:95]
K1_OUTER:
  s_waitcnt vmcnt(8) lgkmcnt(0)
  s_barrier
  v_add_u32 v6, s29, v1
  v_add_u32 v7, s29, v2
  v_mfma_f32_16x16x32_bf16 v[60:63], v[196:199], a[184:187], v[80:83]
  v_exp_f32 v230, v102
  v_mfma_f32_16x16x32_bf16 v[60:63], v[192:195], a[164:167], v[60:63]
  v_add_u32 v8, s29, v3
  v_add_f32 v85, v85, v226
  v_mfma_f32_16x16x32_bf16 v[28:31], v[192:195], a[160:163], v[48:51]
  s_add_u32 s40, s33, s35
  v_add_f32 v85, v85, v227
  v_cvt_pk_bf16_f32 v110, v228, v229
  v_mfma_f32_16x16x32_bf16 v[28:31], v[196:199], a[180:183], v[28:31]
  v_exp_f32 v231, v103
  v_mfma_f32_16x16x32_bf16 a[120:123], v[200:203], v[40:43], 0
  v_exp_f32 v216, v132
  v_mfma_f32_16x16x32_bf16 a[140:143], v[204:207], v[40:43], 0
  s_add_u32 s35, s35, 0x2000
  v_add_f32 v117, v117, v228
  v_add_f32 v117, v117, v229
  v_mfma_f32_16x16x32_bf16 a[144:147], v[204:207], v[72:75], 0
  s_and_b32 s35, s35, 0x1ffff
  v_exp_f32 v217, v133
  v_mfma_f32_16x16x32_bf16 a[124:127], v[200:203], v[72:75], 0
  s_add_u32 m0, s30, 16384
  v_cvt_pk_bf16_f32 v111, v230, v231
  v_add_f32 v117, v117, v230
  v_mfma_f32_16x16x32_bf16 a[128:131], v[200:203], v[104:107], 0
  s_waitcnt vmcnt(4)
  buffer_load_dwordx4 v9, s[20:23], s40 offen offset:0 nt lds
  v_mfma_f32_16x16x32_bf16 a[148:151], v[204:207], v[104:107], 0
  ds_read_b64_tr_b16 v[184:185], v7 offset:16384
  v_add_f32 v117, v117, v231
  v_mfma_f32_16x16x32_bf16 a[152:155], v[204:207], v[136:139], 0
  ds_read_b64_tr_b16 v[186:187], v7 offset:20480
  v_cvt_pk_bf16_f32 v142, v216, v217
  v_exp_f32 v218, v134
  v_mfma_f32_16x16x32_bf16 a[132:135], v[200:203], v[136:139], 0
  v_exp_f32 v219, v135
  v_mfma_f32_16x16x32_bf16 a[136:139], v[200:203], v[168:171], 0
  s_waitcnt vmcnt(5)
  buffer_load_dwordx4 v10, s[20:23], s40 offen offset:1024 nt lds
  v_mfma_f32_16x16x32_bf16 a[156:159], v[204:207], v[168:171], 0
  v_exp_f32 v220, v164
  v_add_f32 v149, v149, v216
  v_mfma_f32_16x16x32_bf16 v[156:159], v[208:211], a[216:219], v[156:159]
  ds_read_b64_tr_b16 v[188:189], v8 offset:16384
  v_add_f32 v149, v149, v217
  v_mfma_f32_16x16x32_bf16 v[156:159], v[212:215], a[236:239], v[156:159]
  v_exp_f32 v221, v165
  v_mfma_f32_16x16x32_bf16 v[124:127], v[212:215], a[232:235], v[124:127]
  ds_read_b64_tr_b16 v[190:191], v8 offset:20480
  v_cvt_pk_bf16_f32 v143, v218, v219
  v_mfma_f32_16x16x32_bf16 v[124:127], v[208:211], a[212:215], v[124:127]
  v_exp_f32 v222, v166
  v_add_f32 v149, v149, v218
  v_mfma_f32_16x16x32_bf16 v[92:95], v[208:211], a[208:211], v[92:95]
  v_add_f32 v149, v149, v219
  v_cvt_pk_bf16_f32 v174, v220, v221
  v_mfma_f32_16x16x32_bf16 v[92:95], v[212:215], a[228:231], v[92:95]
  ds_read_b128 v[192:195], v6 offset:0
  v_add_f32 v181, v181, v220
  v_mfma_f32_16x16x32_bf16 v[60:63], v[212:215], a[224:227], v[60:63]
  v_exp_f32 v223, v167
  v_mfma_f32_16x16x32_bf16 v[60:63], v[208:211], a[204:207], v[60:63]
  v_add_f32 v181, v181, v221
  v_cvt_pk_bf16_f32 v175, v222, v223
  v_mfma_f32_16x16x32_bf16 v[28:31], v[208:211], a[200:203], v[28:31]
  s_waitcnt vmcnt(4)
  buffer_load_dwordx4 v9, s[20:23], s40 offen offset:2048 nt lds
  v_mfma_f32_16x16x32_bf16 v[28:31], v[212:215], a[220:223], v[28:31]
  s_waitcnt lgkmcnt(1)
  v_add_f32 v181, v181, v222
  v_add_f32 v181, v181, v223
  v_max3_f32 v248, v53, v85, v117
  v_max3_f32 v248, v248, v149, v181
  v_cmp_nge_f32 vcc, s42, v248
  s_nop 0
  s_cbranch_vccnz RARE1_2
RET_2:
  v_mfma_f32_16x16x32_bf16 a[0:3], v[184:187], v[44:47], a[0:3]
  ds_read_b128 v[196:199], v6 offset:256
  v_add_f32 v52, v52, v53
  v_mfma_f32_16x16x32_bf16 a[20:23], v[188:191], v[44:47], a[20:23]
  v_exp_f32 v216, v24
  v_mfma_f32_16x16x32_bf16 a[24:27], v[188:191], v[76:79], a[24:27]
  v_add_f32 v84, v84, v85
  v_add_f32 v116, v116, v117
  v_mfma_f32_16x16x32_bf16 a[4:7], v[184:187], v[76:79], a[4:7]
  v_exp_f32 v217, v25
  v_add_f32 v148, v148, v149
  v_mfma_f32_16x16x32_bf16 a[8:11], v[184:187], v[108:111], a[8:11]
  v_add_f32 v180, v180, v181
  v_cvt_pk_bf16_f32 v40, v216, v217
  v_mfma_f32_16x16x32_bf16 a[28:31], v[188:191], v[108:111], a[28:31]
  ds_read_b64_tr_b16 v[200:201], v7 offset:16640
  v_add_f32 v53, v216, v217
  v_mfma_f32_16x16x32_bf16 a[32:35], v[188:191], v[140:143], a[32:35]
  ds_read_b64_tr_b16 v[202:203], v7 offset:20736
  v_exp_f32 v218, v26
  v_mfma_f32_16x16x32_bf16 a[12:15], v[184:187], v[140:143], a[12:15]
  v_exp_f32 v219, v27
  v_mfma_f32_16x16x32_bf16 a[16:19], v[184:187], v[172:175], a[16:19]
  s_waitcnt vmcnt(5)
  buffer_load_dwordx4 v10, s[20:23], s40 offen offset:3072 nt lds
  v_mfma_f32_16x16x32_bf16 a[36:39], v[188:191], v[172:175], a[36:39]
  s_waitcnt lgkmcnt(2)
  v_exp_f32 v220, v56
  v_mfma_f32_16x16x32_bf16 v[160:163], v[192:195], a[176:179], v[176:179]
  ds_read_b64_tr_b16 v[204:205], v8 offset:16640
  v_cvt_pk_bf16_f32 v41, v218, v219
  v_mfma_f32_16x16x32_bf16 v[160:163], v[196:199], a[196:199], v[160:163]
  v_exp_f32 v221, v57
  v_mfma_f32_16x16x32_bf16 v[128:131], v[196:199], a[192:195], v[144:147]
  ds_read_b64_tr_b16 v[206:207], v8 offset:20736
  v_add_f32 v53, v53, v218
  v_mfma_f32_16x16x32_bf16 v[128:131], v[192:195], a[172:175], v[128:131]
  s_add_u32 s39, s33, s34
  v_exp_f32 v222, v58
  v_add_f32 v53, v53, v219
  v_mfma_f32_16x16x32_bf16 v[96:99], v[192:195], a[168:171], v[112:115]
  s_add_u32 s34, s34, 0x2000
  v_exp_f32 v223, v59
  v_mfma_f32_16x16x32_bf16 v[96:99], v[196:199], a[188:191], v[96:99]
  ds_read_b128 v[208:211], v6 offset:512
  v_cvt_pk_bf16_f32 v72, v220, v221
  v_mfma_f32_16x16x32_bf16 v[64:67], v[196:199], a[184:187], v[80:83]
  s_and_b32 s34, s34, 0x1ffff
  v_exp_f32 v224, v88
  v_add_f32 v85, v220, v221
  v_mfma_f32_16x16x32_bf16 v[64:67], v[192:195], a[164:167], v[64:67]
  s_mov_b32 m0, s30
  v_exp_f32 v225, v89
  v_mfma_f32_16x16x32_bf16 v[32:35], v[192:195], a[160:163], v[48:51]
  s_waitcnt vmcnt(4)
  buffer_load_dwordx4 v9, s[16:19], s39 offen offset:0 nt lds
  v_cvt_pk_bf16_f32 v73, v222, v223
  v_mfma_f32_16x16x32_bf16 v[32:35], v[196:199], a[180:183], v[32:35]
  s_waitcnt lgkmcnt(1)
  v_exp_f32 v226, v90
  v_mfma_f32_16x16x32_bf16 a[40:43], v[200:203], v[44:47], a[40:43]
  ds_read_b128 v[212:215], v6 offset:768
  v_add_f32 v85, v85, v222
  v_add_f32 v85, v85, v223
  v_mfma_f32_16x16x32_bf16 a[60:63], v[204:207], v[44:47], a[60:63]
  v_exp_f32 v227, v91
  v_mfma_f32_16x16x32_bf16 a[64:67], v[204:207], v[76:79], a[64:67]
  v_cvt_pk_bf16_f32 v104, v224, v225
  v_add_f32 v117, v224, v225
  v_mfma_f32_16x16x32_bf16 a[44:47], v[200:203], v[76:79], a[44:47]
  s_waitcnt vmcnt(5)
  buffer_load_dwordx4 v10, s[16:19], s39 offen offset:1024 nt lds
  v_mfma_f32_16x16x32_bf16 a[48:51], v[200:203], v[108:111], a[48:51]
  v_exp_f32 v228, v120
  v_mfma_f32_16x16x32_bf16 a[68:71], v[204:207], v[108:111], a[68:71]
  ds_read_b64_tr_b16 v[184:185], v7 offset:16896
  v_cvt_pk_bf16_f32 v105, v226, v227
  v_mfma_f32_16x16x32_bf16 a[72:75], v[204:207], v[140:143], a[72:75]
  ds_read_b64_tr_b16 v[186:187], v7 offset:20992
  v_add_f32 v117, v117, v226
  v_exp_f32 v229, v121
  v_mfma_f32_16x16x32_bf16 a[52:55], v[200:203], v[140:143], a[52:55]
  v_exp_f32 v230, v122
  v_mfma_f32_16x16x32_bf16 a[56:59], v[200:203], v[172:175], a[56:59]
  v_add_f32 v117, v117, v227
  v_cvt_pk_bf16_f32 v136, v228, v229
  v_mfma_f32_16x16x32_bf16 a[76:79], v[204:207], v[172:175], a[76:79]
  s_waitcnt lgkmcnt(2)
  v_exp_f32 v231, v123
  v_mfma_f32_16x16x32_bf16 v[160:163], v[208:211], a[216:219], v[160:163]
  ds_read_b64_tr_b16 v[188:189], v8 offset:16896
  v_add_f32 v149, v228, v229
  v_mfma_f32_16x16x32_bf16 v[160:163], v[212:215], a[236:239], v[160:163]
  v_exp_f32 v216, v152
  v_mfma_f32_16x16x32_bf16 v[128:131], v[212:215], a[232:235], v[128:131]
  ds_read_b64_tr_b16 v[190:191], v8 offset:20992
  v_cvt_pk_bf16_f32 v137, v230, v231
  v_mfma_f32_16x16x32_bf16 v[128:131], v[208:211], a[212:215], v[128:131]
  s_waitcnt vmcnt(4)
  buffer_load_dwordx4 v9, s[16:19], s39 offen offset:2048 nt lds
  v_exp_f32 v217, v153
  v_mfma_f32_16x16x32_bf16 v[96:99], v[208:211], a[208:211], v[96:99]
  v_exp_f32 v218, v154
  v_add_f32 v149, v149, v230
  v_mfma_f32_16x16x32_bf16 v[96:99], v[212:215], a[228:231], v[96:99]
  ds_read_b128 v[192:195], v6 offset:4096
  v_add_f32 v149, v149, v231
  v_mfma_f32_16x16x32_bf16 v[64:67], v[212:215], a[224:227], v[64:67]
  v_exp_f32 v219, v155
  v_mfma_f32_16x16x32_bf16 v[64:67], v[208:211], a[204:207], v[64:67]
  v_cvt_pk_bf16_f32 v168, v216, v217
  v_add_f32 v181, v216, v217
  v_mfma_f32_16x16x32_bf16 v[32:35], v[208:211], a[200:203], v[32:35]
  v_exp_f32 v220, v28
  v_mfma_f32_16x16x32_bf16 v[32:35], v[212:215], a[220:223], v[32:35]
  s_waitcnt lgkmcnt(1)
  v_exp_f32 v221, v29
  v_mfma_f32_16x16x32_bf16 a[80:83], v[184:187], v[44:47], a[80:83]
  ds_read_b128 v[196:199], v6 offset:4352
  v_cvt_pk_bf16_f32 v169, v218, v219
  v_mfma_f32_16x16x32_bf16 a[100:103], v[188:191], v[44:47], a[100:103]
  v_exp_f32 v222, v30
  v_mfma_f32_16x16x32_bf16 a[104:107], v[188:191], v[76:79], a[104:107]
  v_add_f32 v181, v181, v218
  v_add_f32 v181, v181, v219
  v_mfma_f32_16x16x32_bf16 a[84:87], v[184:187], v[76:79], a[84:87]
  s_waitcnt vmcnt(5)
  buffer_load_dwordx4 v10, s[16:19], s39 offen offset:3072 nt lds
  v_mfma_f32_16x16x32_bf16 a[88:91], v[184:187], v[108:111], a[88:91]
  v_exp_f32 v223, v31
  v_cvt_pk_bf16_f32 v42, v220, v221
  v_mfma_f32_16x16x32_bf16 a[108:111], v[188:191], v[108:111], a[108:111]
  ds_read_b64_tr_b16 v[200:201], v7 offset:17152
  v_add_f32 v53, v53, v220
  v_mfma_f32_16x16x32_bf16 a[112:115], v[188:191], v[140:143], a[112:115]
  ds_read_b64_tr_b16 v[202:203], v7 offset:21248
  v_add_f32 v53, v53, v221
  v_mfma_f32_16x16x32_bf16 a[92:95], v[184:187], v[140:143], a[92:95]
  v_exp_f32 v224, v60
  v_mfma_f32_16x16x32_bf16 a[96:99], v[184:187], v[172:175], a[96:99]
  v_exp_f32 v225, v61
  v_cvt_pk_bf16_f32 v43, v222, v223
  v_mfma_f32_16x16x32_bf16 a[116:119], v[188:191], v[172:175], a[116:119]
  s_waitcnt lgkmcnt(2)
  v_exp_f32 v226, v62
  v_mfma_f32_16x16x32_bf16 v[164:167], v[192:195], a[176:179], v[176:179]
  ds_read_b64_tr_b16 v[204:205], v8 offset:17152
  v_add_f32 v53, v53, v222
  v_add_f32 v53, v53, v223
  v_mfma_f32_16x16x32_bf16 v[164:167], v[196:199], a[196:199], v[164:167]
  v_exp_f32 v227, v63
  v_mfma_f32_16x16x32_bf16 v[132:135], v[196:199], a[192:195], v[144:147]
  ds_read_b64_tr_b16 v[206:207], v8 offset:21248
  v_cvt_pk_bf16_f32 v74, v224, v225
  v_mfma_f32_16x16x32_bf16 v[132:135], v[192:195], a[172:175], v[132:135]
  ds_read_b128 v[208:211], v6 offset:4608
  v_add_f32 v85, v85, v224
  v_mfma_f32_16x16x32_bf16 v[100:103], v[192:195], a[168:171], v[112:115]
  v_exp_f32 v228, v92
  v_add_f32 v85, v85, v225
  v_mfma_f32_16x16x32_bf16 v[100:103], v[196:199], a[188:191], v[100:103]
  ds_read_b128 v[212:215], v6 offset:4864
  v_cvt_pk_bf16_f32 v75, v226, v227
  v_mfma_f32_16x16x32_bf16 v[68:71], v[196:199], a[184:187], v[80:83]
  s_add_u32 s30, s29, s31
  v_exp_f32 v229, v93
  v_mfma_f32_16x16x32_bf16 v[68:71], v[192:195], a[164:167], v[68:71]
  s_add_u32 s29, s29, 53248
  v_exp_f32 v230, v94
  v_add_f32 v85, v85, v226
  v_mfma_f32_16x16x32_bf16 v[36:39], v[192:195], a[160:163], v[48:51]
  s_cmp_eq_u32 s29, 159744
  v_add_f32 v85, v85, v227
  v_cvt_pk_bf16_f32 v106, v228, v229
  v_mfma_f32_16x16x32_bf16 v[36:39], v[196:199], a[180:183], v[36:39]
  s_waitcnt lgkmcnt(2)
  v_exp_f32 v231, v95
  v_mfma_f32_16x16x32_bf16 a[120:123], v[200:203], v[44:47], a[120:123]
  v_exp_f32 v216, v124
  v_mfma_f32_16x16x32_bf16 a[140:143], v[204:207], v[44:47], a[140:143]
  s_cselect_b32 s29, 0, s29
  v_add_f32 v117, v117, v228
  v_add_f32 v117, v117, v229
  v_mfma_f32_16x16x32_bf16 a[144:147], v[204:207], v[76:79], a[144:147]
  v_exp_f32 v217, v125
  v_mfma_f32_16x16x32_bf16 a[124:127], v[200:203], v[76:79], a[124:127]
  v_cvt_pk_bf16_f32 v107, v230, v231
  v_add_u32 v6, s29, v1
  v_mfma_f32_16x16x32_bf16 a[128:131], v[200:203], v[108:111], a[128:131]
  s_waitcnt vmcnt(8) lgkmcnt(0)
  s_barrier
  v_exp_f32 v218, v126
  v_mfma_f32_16x16x32_bf16 a[148:151], v[204:207], v[108:111], a[148:151]
  s_add_u32 s40, s33, s35
  v_add_u32 v7, s29, v2
  v_add_f32 v117, v117, v230
  v_mfma_f32_16x16x32_bf16 a[152:155], v[204:207], v[140:143], a[152:155]
  ds_read_b64_tr_b16 v[184:185], v7 offset:16384
  v_add_u32 v8, s29, v3
  v_add_f32 v117, v117, v231
  v_mfma_f32_16x16x32_bf16 a[132:135], v[200:203], v[140:143], a[132:135]
  ds_read_b64_tr_b16 v[186:187], v7 offset:20480
  v_cvt_pk_bf16_f32 v138, v216, v217
  v_mfma_f32_16x16x32_bf16 a[136:139], v[200:203], v[172:175], a[136:139]
  s_add_u32 s35, s35, 0x2000
  v_exp_f32 v219, v127
  s_and_b32 s35, s35, 0x1ffff
  s_add_u32 m0, s30, 16384
  v_mfma_f32_16x16x32_bf16 a[156:159], v[204:207], v[172:175], a[156:159]
  s_waitcnt vmcnt(4)
  buffer_load_dwordx4 v9, s[20:23], s40 offen offset:0 nt lds
  v_add_f32 v149, v149, v216
  v_mfma_f32_16x16x32_bf16 v[164:167], v[208:211], a[216:219], v[164:167]
  ds_read_b64_tr_b16 v[188:189], v8 offset:16384
  v_add_f32 v149, v149, v217
  v_exp_f32 v220, v156
  v_mfma_f32_16x16x32_bf16 v[164:167], v[212:215], a[236:239], v[164:167]
  v_exp_f32 v221, v157
  v_mfma_f32_16x16x32_bf16 v[132:135], v[212:215], a[232:235], v[132:135]
  ds_read_b64_tr_b16 v[190:191], v8 offset:20480
  v_cvt_pk_bf16_f32 v139, v218, v219
  v_mfma_f32_16x16x32_bf16 v[132:135], v[208:211], a[212:215], v[132:135]
  v_exp_f32 v222, v158
  v_add_f32 v149, v149, v218
  v_mfma_f32_16x16x32_bf16 v[100:103], v[208:211], a[208:211], v[100:103]
  v_add_f32 v149, v149, v219
  v_cvt_pk_bf16_f32 v170, v220, v221
  v_mfma_f32_16x16x32_bf16 v[100:103], v[212:215], a[228:231], v[100:103]
  ds_read_b128 v[192:195], v6 offset:0
  v_add_f32 v181, v181, v220
  v_mfma_f32_16x16x32_bf16 v[68:71], v[212:215], a[224:227], v[68:71]
  v_exp_f32 v223, v159
  v_mfma_f32_16x16x32_bf16 v[68:71], v[208:211], a[204:207], v[68:71]
  v_add_f32 v181, v181, v221
  v_cvt_pk_bf16_f32 v171, v222, v223
  v_mfma_f32_16x16x32_bf16 v[36:39], v[208:211], a[200:203], v[36:39]
  s_waitcnt vmcnt(5)
  buffer_load_dwordx4 v10, s[20:23], s40 offen offset:1024 nt lds
  v_mfma_f32_16x16x32_bf16 v[36:39], v[212:215], a[220:223], v[36:39]
  s_waitcnt lgkmcnt(1)
  v_add_f32 v181, v181, v222
  v_add_f32 v181, v181, v223
  v_max3_f32 v248, v53, v85, v117
  v_max3_f32 v248, v248, v149, v181
  v_cmp_nge_f32 vcc, s42, v248
  s_nop 0
  s_cbranch_vccnz RARE0_3
RET_3:
  v_mfma_f32_16x16x32_bf16 a[0:3], v[184:187], v[40:43], a[0:3]
  ds_read_b128 v[196:199], v6 offset:256
  v_add_f32 v52, v52, v53
  v_mfma_f32_16x16x32_bf16 a[20:23], v[188:191], v[40:43], a[20:23]
  v_exp_f32 v216, v32
  v_mfma_f32_16x16x32_bf16 a[24:27], v[188:191], v[72:75], a[24:27]
  v_add_f32 v84, v84, v85
  v_add_f32 v116, v116, v117
  v_mfma_f32_16x16x32_bf16 a[4:7], v[184:187], v[72:75], a[4:7]
  v_exp_f32 v217, v33
  v_add_f32 v148, v148, v149
  v_mfma_f32_16x16x32_bf16 a[8:11], v[184:187], v[104:107], a[8:11]
  v_add_f32 v180, v180, v181
  v_cvt_pk_bf16_f32 v44, v216, v217
  v_mfma_f32_16x16x32_bf16 a[28:31], v[188:191], v[104:107], a[28:31]
  ds_read_b64_tr_b16 v[200:201], v7 offset:16640
  v_add_f32 v53, v216, v217
  v_mfma_f32_16x16x32_bf16 a[32:35], v[188:191], v[136:139], a[32:35]
  ds_read_b64_tr_b16 v[202:203], v7 offset:20736
  v_exp_f32 v218, v34
  v_mfma_f32_16x16x32_bf16 a[12:15], v[184:187], v[136:139], a[12:15]
  v_exp_f32 v219, v35
  v_mfma_f32_16x16x32_bf16 a[16:19], v[184:187], v[168:171], a[16:19]
  s_waitcnt vmcnt(4)
  buffer_load_dwordx4 v9, s[20:23], s40 offen offset:2048 nt lds
  v_mfma_f32_16x16x32_bf16 a[36:39], v[188:191], v[168:171], a[36:39]
  s_waitcnt lgkmcnt(2)
  v_exp_f32 v220, v64
  v_mfma_f32_16x16x32_bf16 v[152:155], v[192:195], a[176:179], v[176:179]
  ds_read_b64_tr_b16 v[204:205], v8 offset:16640
  v_cvt_pk_bf16_f32 v45, v218, v219
  v_mfma_f32_16x16x32_bf16 v[152:155], v[196:199], a[196:199], v[152:155]
  v_exp_f32 v221, v65
  v_mfma_f32_16x16x32_bf16 v[120:123], v[196:199], a[192:195], v[144:147]
  ds_read_b64_tr_b16 v[206:207], v8 offset:20736
  v_add_f32 v53, v53, v218
  v_mfma_f32_16x16x32_bf16 v[120:123], v[192:195], a[172:175], v[120:123]
  v_exp_f32 v222, v66
  v_add_f32 v53, v53, v219
  v_mfma_f32_16x16x32_bf16 v[88:91], v[192:195], a[168:171], v[112:115]
  v_exp_f32 v223, v67
  v_mfma_f32_16x16x32_bf16 v[88:91], v[196:199], a[188:191], v[88:91]
  ds_read_b128 v[208:211], v6 offset:512
  v_cvt_pk_bf16_f32 v76, v220, v221
  v_mfma_f32_16x16x32_bf16 v[56:59], v[196:199], a[184:187], v[80:83]
  v_exp_f32 v224, v96
  v_add_f32 v85, v220, v221
  v_mfma_f32_16x16x32_bf16 v[56:59], v[192:195], a[164:167], v[56:59]
  v_exp_f32 v225, v97
  v_mfma_f32_16x16x32_bf16 v[24:27], v[192:195], a[160:163], v[48:51]
  s_waitcnt vmcnt(5)
  buffer_load_dwordx4 v10, s[20:23], s40 offen offset:3072 nt lds
  v_cvt_pk_bf16_f32 v77, v222, v223
  v_mfma_f32_16x16x32_bf16 v[24:27], v[196:199], a[180:183], v[24:27]
  s_waitcnt lgkmcnt(1)
  v_exp_f32 v226, v98
  v_mfma_f32_16x16x32_bf16 a[40:43], v[200:203], v[40:43], a[40:43]
  ds_read_b128 v[212:215], v6 offset:768
  v_add_f32 v85, v85, v222
  v_add_f32 v85, v85, v223
  v_mfma_f32_16x16x32_bf16 a[60:63], v[204:207], v[40:43], a[60:63]
  v_exp_f32 v227, v99
  v_mfma_f32_16x16x32_bf16 a[64:67], v[204:207], v[72:75], a[64:67]
  v_cvt_pk_bf16_f32 v108, v224, v225
  v_add_f32 v117, v224, v225
  v_mfma_f32_16x16x32_bf16 a[44:47], v[200:203], v[72:75], a[44:47]
  s_add_u32 s39, s33, s34
  v_exp_f32 v228, v128
  v_mfma_f32_16x16x32_bf16 a[48:51], v[200:203], v[104:107], a[48:51]
  s_add_u32 s34, s34, 0x2000
  v_exp_f32 v229, v129
  v_mfma_f32_16x16x32_bf16 a[68:71], v[204:207], v[104:107], a[68:71]
  ds_read_b64_tr_b16 v[184:185], v7 offset:16896
  v_cvt_pk_bf16_f32 v109, v226, v227
  v_mfma_f32_16x16x32_bf16 a[72:75], v[204:207], v[136:139], a[72:75]
  ds_read_b64_tr_b16 v[186:187], v7 offset:20992
  v_add_f32 v117, v117, v226
  v_mfma_f32_16x16x32_bf16 a[52:55], v[200:203], v[136:139], a[52:55]
  s_and_b32 s34, s34, 0x1ffff
  v_exp_f32 v230, v130
  v_mfma_f32_16x16x32_bf16 a[56:59], v[200:203], v[168:171], a[56:59]
  s_mov_b32 m0, s30
  v_add_f32 v117, v117, v227
  v_cvt_pk_bf16_f32 v140, v228, v229
  v_mfma_f32_16x16x32_bf16 a[76:79], v[204:207], v[168:171], a[76:79]
  s_waitcnt vmcnt(4)
  buffer_load_dwordx4 v9, s[16:19], s39 offen offset:0 nt lds
  s_waitcnt lgkmcnt(3)
  v_mfma_f32_16x16x32_bf16 v[152:155], v[208:211], a[216:219], v[152:155]
  ds_read_b64_tr_b16 v[188:189], v8 offset:16896
  v_add_f32 v149, v228, v229
  v_exp_f32 v231, v131
  s_waitcnt lgkmcnt(3)
  v_mfma_f32_16x16x32_bf16 v[152:155], v[212:215], a[236:239], v[152:155]
  v_exp_f32 v216, v160
  v_mfma_f32_16x16x32_bf16 v[120:123], v[212:215], a[232:235], v[120:123]
  ds_read_b64_tr_b16 v[190:191], v8 offset:20992
  v_cvt_pk_bf16_f32 v141, v230, v231
  v_mfma_f32_16x16x32_bf16 v[120:123], v[208:211], a[212:215], v[120:123]
  v_exp_f32 v217, v161
  v_mfma_f32_16x16x32_bf16 v[88:91], v[208:211], a[208:211], v[88:91]
  v_exp_f32 v218, v162
  v_add_f32 v149, v149, v230
  v_mfma_f32_16x16x32_bf16 v[88:91], v[212:215], a[228:231], v[88:91]
  ds_read_b128 v[192:195], v6 offset:4096
  v_add_f32 v149, v149, v231
  v_mfma_f32_16x16x32_bf16 v[56:59], v[212:215], a[224:227], v[56:59]
  v_exp_f32 v219, v163
  v_mfma_f32_16x16x32_bf16 v[56:59], v[208:211], a[204:207], v[56:59]
  v_cvt_pk_bf16_f32 v172, v216, v217
  v_add_f32 v181, v216, v217
  v_mfma_f32_16x16x32_bf16 v[24:27], v[208:211], a[200:203], v[24:27]
  s_waitcnt vmcnt(5)
  buffer_load_dwordx4 v10, s[16:19], s39 offen offset:1024 nt lds
  v_mfma_f32_16x16x32_bf16 v[24:27], v[212:215], a[220:223], v[24:27]
  s_waitcnt lgkmcnt(1)
  v_exp_f32 v220, v36
  v_mfma_f32_16x16x32_bf16 a[80:83], v[184:187], v[40:43], a[80:83]
  ds_read_b128 v[196:199], v6 offset:4352
  v_cvt_pk_bf16_f32 v173, v218, v219
  v_mfma_f32_16x16x32_bf16 a[100:103], v[188:191], v[40:43], a[100:103]
  v_exp_f32 v221, v37
  v_mfma_f32_16x16x32_bf16 a[104:107], v[188:191], v[72:75], a[104:107]
  v_exp_f32 v222, v38
  v_add_f32 v181, v181, v218
  v_add_f32 v181, v181, v219
  v_mfma_f32_16x16x32_bf16 a[84:87], v[184:187], v[72:75], a[84:87]
  v_exp_f32 v223, v39
  v_mfma_f32_16x16x32_bf16 a[88:91], v[184:187], v[104:107], a[88:91]
  v_cvt_pk_bf16_f32 v46, v220, v221
  v_add_f32 v53, v53, v220
  v_mfma_f32_16x16x32_bf16 a[108:111], v[188:191], v[104:107], a[108:111]
  ds_read_b64_tr_b16 v[200:201], v7 offset:17152
  v_add_f32 v53, v53, v221
  v_mfma_f32_16x16x32_bf16 a[112:115], v[188:191], v[136:139], a[112:115]
  ds_read_b64_tr_b16 v[202:203], v7 offset:21248
  v_cvt_pk_bf16_f32 v47, v222, v223
  v_mfma_f32_16x16x32_bf16 a[92:95], v[184:187], v[136:139], a[92:95]
  v_exp_f32 v224, v68
  v_mfma_f32_16x16x32_bf16 a[96:99], v[184:187], v[168:171], a[96:99]
  s_waitcnt vmcnt(4)
  buffer_load_dwordx4 v9, s[16:19], s39 offen offset:2048 nt lds
  v_exp_f32 v225, v69
  v_mfma_f32_16x16x32_bf16 a[116:119], v[188:191], v[168:171], a[116:119]
  s_waitcnt lgkmcnt(2)
  v_exp_f32 v226, v70
  v_mfma_f32_16x16x32_bf16 v[156:159], v[192:195], a[176:179], v[176:179]
  ds_read_b64_tr_b16 v[204:205], v8 offset:17152
  v_add_f32 v53, v53, v222
  v_add_f32 v53, v53, v223
  v_mfma_f32_16x16x32_bf16 v[156:159], v[196:199], a[196:199], v[156:159]
  v_exp_f32 v227, v71
  v_mfma_f32_16x16x32_bf16 v[124:127], v[196:199], a[192:195], v[144:147]
  ds_read_b64_tr_b16 v[206:207], v8 offset:21248
  v_cvt_pk_bf16_f32 v78, v224, v225
  v_mfma_f32_16x16x32_bf16 v[124:127], v[192:195], a[172:175], v[124:127]
  ds_read_b128 v[208:211], v6 offset:4608
  v_add_f32 v85, v85, v224
  v_mfma_f32_16x16x32_bf16 v[92:95], v[192:195], a[168:171], v[112:115]
  v_exp_f32 v228, v100
  v_add_f32 v85, v85, v225
  v_mfma_f32_16x16x32_bf16 v[92:95], v[196:199], a[188:191], v[92:95]
  ds_read_b128 v[212:215], v6 offset:4864
  v_cvt_pk_bf16_f32 v79, v226, v227
  v_mfma_f32_16x16x32_bf16 v[60:63], v[196:199], a[184:187], v[80:83]
  s_add_u32 s30, s29, s31
  v_exp_f32 v229, v101
  v_mfma_f32_16x16x32_bf16 v[60:63], v[192:195], a[164:167], v[60:63]
  s_add_u32 s29, s29, 53248
  v_exp_f32 v230, v102
  v_add_f32 v85, v85, v226
  v_mfma_f32_16x16x32_bf16 v[28:31], v[192:195], a[160:163], v[48:51]
  s_waitcnt vmcnt(5)
  buffer_load_dwordx4 v10, s[16:19], s39 offen offset:3072 nt lds
  v_add_f32 v85, v85, v227
  v_mfma_f32_16x16x32_bf16 v[28:31], v[196:199], a[180:183], v[28:31]
  s_waitcnt lgkmcnt(2)
  v_exp_f32 v231, v103
  v_mfma_f32_16x16x32_bf16 a[120:123], v[200:203], v[40:43], a[120:123]
  v_cvt_pk_bf16_f32 v110, v228, v229
  v_add_f32 v117, v117, v228
  v_mfma_f32_16x16x32_bf16 a[140:143], v[204:207], v[40:43], a[140:143]
  s_cmp_eq_u32 s29, 159744
  v_exp_f32 v216, v132
  v_mfma_f32_16x16x32_bf16 a[144:147], v[204:207], v[72:75], a[144:147]
  s_cselect_b32 s29, 0, s29
  v_add_f32 v117, v117, v229
  v_cvt_pk_bf16_f32 v111, v230, v231
  v_mfma_f32_16x16x32_bf16 a[124:127], v[200:203], v[72:75], a[124:127]
  v_exp_f32 v217, v133
  v_mfma_f32_16x16x32_bf16 a[128:131], v[200:203], v[104:107], a[128:131]
  s_mov_b32 s43, 4
LP6:
  s_waitcnt vmcnt(8) lgkmcnt(0)
  s_barrier
  v_add_u32 v6, s29, v1
  v_add_u32 v7, s29, v2
  v_mfma_f32_16x16x32_bf16 a[148:151], v[204:207], v[104:107], a[148:151]
  ds_read_b64_tr_b16 v[184:185], v7 offset:16384
  v_add_f32 v117, v117, v230
  v_mfma_f32_16x16x32_bf16 a[152:155], v[204:207], v[136:139], a[152:155]
  ds_read_b64_tr_b16 v[186:187], v7 offset:20480
  v_add_u32 v8, s29, v3
  v_add_f32 v117, v117, v231
  v_exp_f32 v218, v134
  v_mfma_f32_16x16x32_bf16 a[132:135], v[200:203], v[136:139], a[132:135]
  s_add_u32 s40, s33, s35
  v_exp_f32 v219, v135
  v_mfma_f32_16x16x32_bf16 a[136:139], v[200:203], v[168:171], a[136:139]
  s_add_u32 s35, s35, 0x2000
  v_cvt_pk_bf16_f32 v142, v216, v217
  v_add_f32 v149, v149, v216
  s_and_b32 s35, s35, 0x1ffff
  s_add_u32 m0, s30, 16384
  v_mfma_f32_16x16x32_bf16 a[156:159], v[204:207], v[168:171], a[156:159]
  s_waitcnt vmcnt(4)
  buffer_load_dwordx4 v9, s[20:23], s40 offen offset:0 nt lds
  v_mfma_f32_16x16x32_bf16 v[156:159], v[208:211], a[216:219], v[156:159]
  ds_read_b64_tr_b16 v[188:189], v8 offset:16384
  v_add_f32 v149, v149, v217
  v_exp_f32 v220, v164
  v_mfma_f32_16x16x32_bf16 v[156:159], v[212:215], a[236:239], v[156:159]
  v_exp_f32 v221, v165
  v_mfma_f32_16x16x32_bf16 v[124:127], v[212:215], a[232:235], v[124:127]
  ds_read_b64_tr_b16 v[190:191], v8 offset:20480
  v_cvt_pk_bf16_f32 v143, v218, v219
  v_mfma_f32_16x16x32_bf16 v[124:127], v[208:211], a[212:215], v[124:127]
  v_exp_f32 v222, v166
  v_add_f32 v149, v149, v218
  v_mfma_f32_16x16x32_bf16 v[92:95], v[208:211], a[208:211], v[92:95]
  v_add_f32 v149, v149, v219
  v_cvt_pk_bf16_f32 v174, v220, v221
  v_mfma_f32_16x16x32_bf16 v[92:95], v[212:215], a[228:231], v[92:95]
  ds_read_b128 v[192:195], v6 offset:0
  v_add_f32 v181, v181, v220
  v_mfma_f32_16x16x32_bf16 v[60:63], v[212:215], a[224:227], v[60:63]
  v_exp_f32 v223, v167
  v_mfma_f32_16x16x32_bf16 v[60:63], v[208:211], a[204:207], v[60:63]
  v_add_f32 v181, v181, v221
  v_cvt_pk_bf16_f32 v175, v222, v223
  v_mfma_f32_16x16x32_bf16 v[28:31], v[208:211], a[200:203], v[28:31]
  s_waitcnt vmcnt(5)
  buffer_load_dwordx4 v10, s[20:23], s40 offen offset:1024 nt lds
  v_mfma_f32_16x16x32_bf16 v[28:31], v[212:215], a[220:223], v[28:31]
  s_waitcnt lgkmcnt(1)
  v_add_f32 v181, v181, v222
  v_add_f32 v181, v181, v223
  v_max3_f32 v248, v53, v85, v117
  v_max3_f32 v248, v248, v149, v181
  v_cmp_nge_f32 vcc, s42, v248
  s_nop 0
  s_cbranch_vccnz RARE1_4
RET_4:
  v_mfma_f32_16x16x32_bf16 a[0:3], v[184:187], v[44:47], a[0:3]
  ds_read_b128 v[196:199], v6 offset:256
  v_add_f32 v52, v52, v53
  v_mfma_f32_16x16x32_bf16 a[20:23], v[188:191], v[44:47], a[20:23]
  v_exp_f32 v216, v24
  v_mfma_f32_16x16x32_bf16 a[24:27], v[188:191], v[76:79], a[24:27]
  v_add_f32 v84, v84, v85
  v_add_f32 v116, v116, v117
  v_mfma_f32_16x16x32_bf16 a[4:7], v[184:187], v[76:79], a[4:7]
  v_exp_f32 v217, v25
  v_add_f32 v148, v148, v149
  v_mfma_f32_16x16x32_bf16 a[8:11], v[184:187], v[108:111], a[8:11]
  v_add_f32 v180, v180, v181
  v_cvt_pk_bf16_f32 v40, v216, v217
  v_mfma_f32_16x16x32_bf16 a[28:31], v[188:191], v[108:111], a[28:31]
  ds_read_b64_tr_b16 v[200:201], v7 offset:16640
  v_add_f32 v53, v216, v217
  v_mfma_f32_16x16x32_bf16 a[32:35], v[188:191], v[140:143], a[32:35]
  ds_read_b64_tr_b16 v[202:203], v7 offset:20736
  v_exp_f32 v218, v26
  v_mfma_f32_16x16x32_bf16 a[12:15], v[184:187], v[140:143], a[12:15]
  v_exp_f32 v219, v27
  v_mfma_f32_16x16x32_bf16 a[16:19], v[184:187], v[172:175], a[16:19]
  s_waitcnt vmcnt(4)
  buffer_load_dwordx4 v9, s[20:23], s40 offen offset:2048 nt lds
  v_mfma_f32_16x16x32_bf16 a[36:39], v[188:191], v[172:175], a[36:39]
  s_waitcnt lgkmcnt(2)
  v_exp_f32 v220, v56
  v_mfma_f32_16x16x32_bf16 v[160:163], v[192:195], a[176:179], v[176:179]
  ds_read_b64_tr_b16 v[204:205], v8 offset:16640
  v_cvt_pk_bf16_f32 v41, v218, v219
  v_mfma_f32_16x16x32_bf16 v[160:163], v[196:199], a[196:199], v[160:163]
  v_exp_f32 v221, v57
  v_mfma_f32_16x16x32_bf16 v[128:131], v[196:199], a[192:195], v[144:147]
  ds_read_b64_tr_b16 v[206:207], v8 offset:20736
  v_add_f32 v53, v53, v218
  v_mfma_f32_16x16x32_bf16 v[128:131], v[192:195], a[172:175], v[128:131]
  v_exp_f32 v222, v58
  v_add_f32 v53, v53, v219
  v_mfma_f32_16x16x32_bf16 v[96:99], v[192:195], a[168:171], v[112:115]
  v_exp_f32 v223, v59
  v_mfma_f32_16x16x32_bf16 v[96:99], v[196:199], a[188:191], v[96:99]
  ds_read_b128 v[208:211], v6 offset:512
  v_cvt_pk_bf16_f32 v72, v220, v221
  v_mfma_f32_16x16x32_bf16 v[64:67], v[196:199], a[184:187], v[80:83]
  v_exp_f32 v224, v88
  v_add_f32 v85, v220, v221
  v_mfma_f32_16x16x32_bf16 v[64:67], v[192:195], a[164:167], v[64:67]
  v_exp_f32 v225, v89
  v_mfma_f32_16x16x32_bf16 v[32:35], v[192:195], a[160:163], v[48:51]
  s_waitcnt vmcnt(5)
  buffer_load_dwordx4 v10, s[20:23], s40 offen offset:3072 nt lds
  v_cvt_pk_bf16_f32 v73, v222, v223
  v_mfma_f32_16x16x32_bf16 v[32:35], v[196:199], a[180:183], v[32:35]
  s_waitcnt lgkmcnt(1)
  v_exp_f32 v226, v90
  v_mfma_f32_16x16x32_bf16 a[40:43], v[200:203], v[44:47], a[40:43]
  ds_read_b128 v[212:215], v6 offset:768
  v_add_f32 v85, v85, v222
  v_add_f32 v85, v85, v223
  v_mfma_f32_16x16x32_bf16 a[60:63], v[204:207], v[44:47], a[60:63]
  v_exp_f32 v227, v91
  v_mfma_f32_16x16x32_bf16 a[64:67], v[204:207], v[76:79], a[64:67]
  v_cvt_pk_bf16_f32 v104, v224, v225
  v_add_f32 v117, v224, v225
  v_mfma_f32_16x16x32_bf16 a[44:47], v[200:203], v[76:79], a[44:47]
  s_add_u32 s39, s33, s34
  v_exp_f32 v228, v120
  v_mfma_f32_16x16x32_bf16 a[48:51], v[200:203], v[108:111], a[48:51]
  s_add_u32 s34, s34, 0x2000
  v_exp_f32 v229, v121
  v_mfma_f32_16x16x32_bf16 a[68:71], v[204:207], v[108:111], a[68:71]
  ds_read_b64_tr_b16 v[184:185], v7 offset:16896
  v_cvt_pk_bf16_f32 v105, v226, v227
  v_mfma_f32_16x16x32_bf16 a[72:75], v[204:207], v[140:143], a[72:75]
  ds_read_b64_tr_b16 v[186:187], v7 offset:20992
  v_add_f32 v117, v117, v226
  v_mfma_f32_16x16x32_bf16 a[52:55], v[200:203], v[140:143], a[52:55]
  s_and_b32 s34, s34, 0x1ffff
  v_exp_f32 v230, v122
  v_mfma_f32_16x16x32_bf16 a[56:59], v[200:203], v[172:175], a[56:59]
  s_mov_b32 m0, s30
  v_add_f32 v117, v117, v227
  v_cvt_pk_bf16_f32 v136, v228, v229
  v_mfma_f32_16x16x32_bf16 a[76:79], v[204:207], v[172:175], a[76:79]
  s_waitcnt vmcnt(4)
  buffer_load_dwordx4 v9, s[16:19], s39 offen offset:0 nt lds
  s_waitcnt lgkmcnt(3)
  v_mfma_f32_16x16x32_bf16 v[160:163], v[208:211], a[216:219], v[160:163]
  ds_read_b64_tr_b16 v[188:189], v8 offset:16896
  v_add_f32 v149, v228, v229
  v_exp_f32 v231, v123
  s_waitcnt lgkmcnt(3)
  v_mfma_f32_16x16x32_bf16 v[160:163], v[212:215], a[236:239], v[160:163]
  v_exp_f32 v216, v152
  v_mfma_f32_16x16x32_bf16 v[128:131], v[212:215], a[232:235], v[128:131]
  ds_read_b64_tr_b16 v[190:191], v8 offset:20992
  v_cvt_pk_bf16_f32 v137, v230, v231
  v_mfma_f32_16x16x32_bf16 v[128:131], v[208:211], a[212:215], v[128:131]
  v_exp_f32 v217, v153
  v_mfma_f32_16x16x32_bf16 v[96:99], v[208:211], a[208:211], v[96:99]
  v_exp_f32 v218, v154
  v_add_f32 v149, v149, v230
  v_mfma_f32_16x16x32_bf16 v[96:99], v[212:215], a[228:231], v[96:99]
  ds_read_b128 v[192:195], v6 offset:4096
  v_add_f32 v149, v149, v231
  v_mfma_f32_16x16x32_bf16 v[64:67], v[212:215], a[224:227], v[64:67]
  v_exp_f32 v219, v155
  v_mfma_f32_16x16x32_bf16 v[64:67], v[208:211], a[204:207], v[64:67]
  v_cvt_pk_bf16_f32 v168, v216, v217
  v_add_f32 v181, v216, v217
  v_mfma_f32_16x16x32_bf16 v[32:35], v[208:211], a[200:203], v[32:35]
  s_waitcnt vmcnt(5)
  buffer_load_dwordx4 v10, s[16:19], s39 offen offset:1024 nt lds
  v_mfma_f32_16x16x32_bf16 v[32:35], v[212:215], a[220:223], v[32:35]
  s_waitcnt lgkmcnt(1)
  v_exp_f32 v220, v28
  v_mfma_f32_16x16x32_bf16 a[80:83], v[184:187], v[44:47], a[80:83]
  ds_read_b128 v[196:199], v6 offset:4352
  v_cvt_pk_bf16_f32 v169, v218, v219
  v_mfma_f32_16x16x32_bf16 a[100:103], v[188:191], v[44:47], a[100:103]
  v_exp_f32 v221, v29
  v_mfma_f32_16x16x32_bf16 a[104:107], v[188:191], v[76:79], a[104:107]
  v_exp_f32 v222, v30
  v_add_f32 v181, v181, v218
  v_add_f32 v181, v181, v219
  v_mfma_f32_16x16x32_bf16 a[84:87], v[184:187], v[76:79], a[84:87]
  v_exp_f32 v223, v31
  v_mfma_f32_16x16x32_bf16 a[88:91], v[184:187], v[108:111], a[88:91]
  v_cvt_pk_bf16_f32 v42, v220, v221
  v_add_f32 v53, v53, v220
  v_mfma_f32_16x16x32_bf16 a[108:111], v[188:191], v[108:111], a[108:111]
  ds_read_b64_tr_b16 v[200:201], v7 offset:17152
  v_add_f32 v53, v53, v221
  v_mfma_f32_16x16x32_bf16 a[112:115], v[188:191], v[140:143], a[112:115]
  ds_read_b64_tr_b16 v[202:203], v7 offset:21248
  v_cvt_pk_bf16_f32 v43, v222, v223
  v_mfma_f32_16x16x32_bf16 a[92:95], v[184:187], v[140:143], a[92:95]
  v_exp_f32 v224, v60
  v_mfma_f32_16x16x32_bf16 a[96:99], v[184:187], v[172:175], a[96:99]
  s_waitcnt vmcnt(4)
  buffer_load_dwordx4 v9, s[16:19], s39 offen offset:2048 nt lds
  v_exp_f32 v225, v61
  v_mfma_f32_16x16x32_bf16 a[116:119], v[188:191], v[172:175], a[116:119]
  s_waitcnt lgkmcnt(2)
  v_exp_f32 v226, v62
  v_mfma_f32_16x16x32_bf16 v[164:167], v[192:195], a[176:179], v[176:179]
  ds_read_b64_tr_b16 v[204:205], v8 offset:17152
  v_add_f32 v53, v53, v222
  v_add_f32 v53, v53, v223
  v_mfma_f32_16x16x32_bf16 v[164:167], v[196:199], a[196:199], v[164:167]
  v_exp_f32 v227, v63
  v_mfma_f32_16x16x32_bf16 v[132:135], v[196:199], a[192:195], v[144:147]
  ds_read_b64_tr_b16 v[206:207], v8 offset:21248
  v_cvt_pk_bf16_f32 v74, v224, v225
  v_mfma_f32_16x16x32_bf16 v[132:135], v[192:195], a[172:175], v[132:135]
  ds_read_b128 v[208:211], v6 offset:4608
  v_add_f32 v85, v85, v224
  v_mfma_f32_16x16x32_bf16 v[100:103], v[192:195], a[168:171], v[112:115]
  v_exp_f32 v228, v92
  v_add_f32 v85, v85, v225
  v_mfma_f32_16x16x32_bf16 v[100:103], v[196:199], a[188:191], v[100:103]
  ds_read_b128 v[212:215], v6 offset:4864
  v_cvt_pk_bf16_f32 v75, v226, v227
  v_mfma_f32_16x16x32_bf16 v[68:71], v[196:199], a[184:187], v[80:83]
  s_add_u32 s30, s29, s31
  v_exp_f32 v229, v93
  v_mfma_f32_16x16x32_bf16 v[68:71], v[192:195], a[164:167], v[68:71]
  s_add_u32 s29, s29, 53248
  v_exp_f32 v230, v94
  v_add_f32 v85, v85, v226
  v_mfma_f32_16x16x32_bf16 v[36:39], v[192:195], a[160:163], v[48:51]
  s_waitcnt vmcnt(5)
  buffer_load_dwordx4 v10, s[16:19], s39 offen offset:3072 nt lds
  v_add_f32 v85, v85, v227
  v_mfma_f32_16x16x32_bf16 v[36:39], v[196:199], a[180:183], v[36:39]
  s_waitcnt lgkmcnt(2)
  v_exp_f32 v231, v95
  v_mfma_f32_16x16x32_bf16 a[120:123], v[200:203], v[44:47], a[120:123]
  v_cvt_pk_bf16_f32 v106, v228, v229
  v_add_f32 v117, v117, v228
  v_mfma_f32_16x16x32_bf16 a[140:143], v[204:207], v[44:47], a[140:143]
  s_cmp_eq_u32 s29, 159744
  v_exp_f32 v216, v124
  v_mfma_f32_16x16x32_bf16 a[144:147], v[204:207], v[76:79], a[144:147]
  s_cselect_b32 s29, 0, s29
  v_add_f32 v117, v117, v229
  v_cvt_pk_bf16_f32 v107, v230, v231
  v_mfma_f32_16x16x32_bf16 a[124:127], v[200:203], v[76:79], a[124:127]
  v_exp_f32 v217, v125
  v_mfma_f32_16x16x32_bf16 a[128:131], v[200:203], v[108:111], a[128:131]
  s_waitcnt vmcnt(8) lgkmcnt(0)
  s_barrier
  v_add_u32 v6, s29, v1
  v_add_u32 v7, s29, v2
  v_mfma_f32_16x16x32_bf16 a[148:151], v[204:207], v[108:111], a[148:151]
  ds_read_b64_tr_b16 v[184:185], v7 offset:16384
  v_add_f32 v117, v117, v230
  v_mfma_f32_16x16x32_bf16 a[152:155], v[204:207], v[140:143], a[152:155]
  ds_read_b64_tr_b16 v[186:187], v7 offset:20480
  v_add_u32 v8, s29, v3
  v_add_f32 v117, v117, v231
  v_exp_f32 v218, v126
  v_mfma_f32_16x16x32_bf16 a[132:135], v[200:203], v[140:143], a[132:135]
  s_add_u32 s40, s33, s35
  v_exp_f32 v219, v127
  v_mfma_f32_16x16x32_bf16 a[136:139], v[200:203], v[172:175], a[136:139]
  s_add_u32 s35, s35, 0x2000
  v_cvt_pk_bf16_f32 v138, v216, v217
  v_add_f32 v149, v149, v216
  s_and_b32 s35, s35, 0x1ffff
  s_add_u32 m0, s30, 16384
  v_mfma_f32_16x16x32_bf16 a[156:159], v[204:207], v[172:175], a[156:159]
  s_waitcnt vmcnt(4)
  buffer_load_dwordx4 v9, s[20:23], s40 offen offset:0 nt lds
  v_mfma_f32_16x16x32_bf16 v[164:167], v[208:211], a[216:219], v[164:167]
  ds_read_b64_tr_b16 v[188:189], v8 offset:16384
  v_add_f32 v149, v149, v217
  v_exp_f32 v220, v156
  v_mfma_f32_16x16x32_bf16 v[164:167], v[212:215], a[236:239], v[164:167]
  v_exp_f32 v221, v157
  v_mfma_f32_16x16x32_bf16 v[132:135], v[212:215], a[232:235], v[132:135]
  ds_read_b64_tr_b16 v[190:191], v8 offset:20480
  v_cvt_pk_bf16_f32 v139, v218, v219
  v_mfma_f32_16x16x32_bf16 v[132:135], v[208:211], a[212:215], v[132:135]
  v_exp_f32 v222, v158
  v_add_f32 v149, v149, v218
  v_mfma_f32_16x16x32_bf16 v[100:103], v[208:211], a[208:211], v[100:103]
  v_add_f32 v149, v149, v219
  v_cvt_pk_bf16_f32 v170, v220, v221
  v_mfma_f32_16x16x32_bf16 v[100:103], v[212:215], a[228:231], v[100:103]
  ds_read_b128 v[192:195], v6 offset:0
  v_add_f32 v181, v181, v220
  v_mfma_f32_16x16x32_bf16 v[68:71], v[212:215], a[224:227], v[68:71]
  v_exp_f32 v223, v159
  v_mfma_f32_16x16x32_bf16 v[68:71], v[208:211], a[204:207], v[68:71]
  v_add_f32 v181, v181, v221
  v_cvt_pk_bf16_f32 v171, v222, v223
  v_mfma_f32_16x16x32_bf16 v[36:39], v[208:211], a[200:203], v[36:39]
  s_waitcnt vmcnt(5)
  buffer_load_dwordx4 v10, s[20:23], s40 offen offset:1024 nt lds
  v_mfma_f32_16x16x32_bf16 v[36:39], v[212:215], a[220:223], v[36:39]
  s_waitcnt lgkmcnt(1)
  v_add_f32 v181, v181, v222
  v_add_f32 v181, v181, v223
  v_max3_f32 v248, v53, v85, v117
  v_max3_f32 v248, v248, v149, v181
  v_cmp_nge_f32 vcc, s42, v248
  s_nop 0
  s_cbranch_vccnz RARE0_5
RET_5:
  v_mfma_f32_16x16x32_bf16 a[0:3], v[184:187], v[40:43], a[0:3]
  ds_read_b128 v[196:199], v6 offset:256
  v_add_f32 v52, v52, v53
  v_mfma_f32_16x16x32_bf16 a[20:23], v[188:191], v[40:43], a[20:23]
  v_exp_f32 v216, v32
  v_mfma_f32_16x16x32_bf16 a[24:27], v[188:191], v[72:75], a[24:27]
  v_add_f32 v84, v84, v85
  v_add_f32 v116, v116, v117
  v_mfma_f32_16x16x32_bf16 a[4:7], v[184:187], v[72:75], a[4:7]
  v_exp_f32 v217, v33
  v_add_f32 v148, v148, v149
  v_mfma_f32_16x16x32_bf16 a[8:11], v[184:187], v[104:107], a[8:11]
  v_add_f32 v180, v180, v181
  v_cvt_pk_bf16_f32 v44, v216, v217
  v_mfma_f32_16x16x32_bf16 a[28:31], v[188:191], v[104:107], a[28:31]
  ds_read_b64_tr_b16 v[200:201], v7 offset:16640
  v_add_f32 v53, v216, v217
  v_mfma_f32_16x16x32_bf16 a[32:35], v[188:191], v[136:139], a[32:35]
  ds_read_b64_tr_b16 v[202:203], v7 offset:20736
  v_exp_f32 v218, v34
  v_mfma_f32_16x16x32_bf16 a[12:15], v[184:187], v[136:139], a[12:15]
  v_exp_f32 v219, v35
  v_mfma_f32_16x16x32_bf16 a[16:19], v[184:187], v[168:171], a[16:19]
  s_waitcnt vmcnt(4)
  buffer_load_dwordx4 v9, s[20:23], s40 offen offset:2048 nt lds
  v_mfma_f32_16x16x32_bf16 a[36:39], v[188:191], v[168:171], a[36:39]
  s_waitcnt lgkmcnt(2)
  v_exp_f32 v220, v64
  v_mfma_f32_16x16x32_bf16 v[152:155], v[192:195], a[176:179], v[176:179]
  ds_read_b64_tr_b16 v[204:205], v8 offset:16640
  v_cvt_pk_bf16_f32 v45, v218, v219
  v_mfma_f32_16x16x32_bf16 v[152:155], v[196:199], a[196:199], v[152:155]
  v_exp_f32 v221, v65
  v_mfma_f32_16x16x32_bf16 v[120:123], v[196:199], a[192:195], v[144:147]
  ds_read_b64_tr_b16 v[206:207], v8 offset:20736
  v_add_f32 v53, v53, v218
  v_mfma_f32_16x16x32_bf16 v[120:123], v[192:195], a[172:175], v[120:123]
  v_exp_f32 v222, v66
  v_add_f32 v53, v53, v219
  v_mfma_f32_16x16x32_bf16 v[88:91], v[192:195], a[168:171], v[112:115]
  v_exp_f32 v223, v67
  v_mfma_f32_16x16x32_bf16 v[88:91], v[196:199], a[188:191], v[88:91]
  ds_read_b128 v[208:211], v6 offset:512
  v_cvt_pk_bf16_f32 v76, v220, v221
  v_mfma_f32_16x16x32_bf16 v[56:59], v[196:199], a[184:187], v[80:83]
  v_exp_f32 v224, v96
  v_add_f32 v85, v220, v221
  v_mfma_f32_16x16x32_bf16 v[56:59], v[192:195], a[164:167], v[56:59]
  v_exp_f32 v225, v97
  v_mfma_f32_16x16x32_bf16 v[24:27], v[192:195], a[160:163], v[48:51]
  s_waitcnt vmcnt(5)
  buffer_load_dwordx4 v10, s[20:23], s40 offen offset:3072 nt lds
  v_cvt_pk_bf16_f32 v77, v222, v223
  v_mfma_f32_16x16x32_bf16 v[24:27], v[196:199], a[180:183], v[24:27]
  s_waitcnt lgkmcnt(1)
  v_exp_f32 v226, v98
  v_mfma_f32_16x16x32_bf16 a[40:43], v[200:203], v[40:43], a[40:43]
  ds_read_b128 v[212:215], v6 offset:768
  v_add_f32 v85, v85, v222
  v_add_f32 v85, v85, v223
  v_mfma_f32_16x16x32_bf16 a[60:63], v[204:207], v[40:43], a[60:63]
  v_exp_f32 v227, v99
  v_mfma_f32_16x16x32_bf16 a[64:67], v[204:207], v[72:75], a[64:67]
  v_cvt_pk_bf16_f32 v108, v224, v225
  v_add_f32 v117, v224, v225
  v_mfma_f32_16x16x32_bf16 a[44:47], v[200:203], v[72:75], a[44:47]
  s_add_u32 s39, s33, s34
  v_exp_f32 v228, v128
  v_mfma_f32_16x16x32_bf16 a[48:51], v[200:203], v[104:107], a[48:51]
  s_add_u32 s34, s34, 0x2000
  v_exp_f32 v229, v129
  v_mfma_f32_16x16x32_bf16 a[68:71], v[204:207], v[104:107], a[68:71]
  ds_read_b64_tr_b16 v[184:185], v7 offset:16896
  v_cvt_pk_bf16_f32 v109, v226, v227
  v_mfma_f32_16x16x32_bf16 a[72:75], v[204:207], v[136:139], a[72:75]
  ds_read_b64_tr_b16 v[186:187], v7 offset:20992
  v_add_f32 v117, v117, v226
  v_mfma_f32_16x16x32_bf16 a[52:55], v[200:203], v[136:139], a[52:55]
  s_and_b32 s34, s34, 0x1ffff
  v_exp_f32 v230, v130
  v_mfma_f32_16x16x32_bf16 a[56:59], v[200:203], v[168:171], a[56:59]
  s_mov_b32 m0, s30
  v_add_f32 v117, v117, v227
  v_cvt_pk_bf16_f32 v140, v228, v229
  v_mfma_f32_16x16x32_bf16 a[76:79], v[204:207], v[168:171], a[76:79]
  s_waitcnt vmcnt(4)
  buffer_load_dwordx4 v9, s[16:19], s39 offen offset:0 nt lds
  s_waitcnt lgkmcnt(3)
  v_mfma_f32_16x16x32_bf16 v[152:155], v[208:211], a[216:219], v[152:155]
  ds_read_b64_tr_b16 v[188:189], v8 offset:16896
  v_add_f32 v149, v228, v229
  v_exp_f32 v231, v131
  s_waitcnt lgkmcnt(3)
  v_mfma_f32_16x16x32_bf16 v[152:155], v[212:215], a[236:239], v[152:155]
  v_exp_f32 v216, v160
  v_mfma_f32_16x16x32_bf16 v[120:123], v[212:215], a[232:235], v[120:123]
  ds_read_b64_tr_b16 v[190:191], v8 offset:20992
  v_cvt_pk_bf16_f32 v141, v230, v231
  v_mfma_f32_16x16x32_bf16 v[120:123], v[208:211], a[212:215], v[120:123]
  v_exp_f32 v217, v161
  v_mfma_f32_16x16x32_bf16 v[88:91], v[208:211], a[208:211], v[88:91]
  v_exp_f32 v218, v162
  v_add_f32 v149, v149, v230
  v_mfma_f32_16x16x32_bf16 v[88:91], v[212:215], a[228:231], v[88:91]
  ds_read_b128 v[192:195], v6 offset:4096
  v_add_f32 v149, v149, v231
  v_mfma_f32_16x16x32_bf16 v[56:59], v[212:215], a[224:227], v[56:59]
  v_exp_f32 v219, v163
  v_mfma_f32_16x16x32_bf16 v[56:59], v[208:211], a[204:207], v[56:59]
  v_cvt_pk_bf16_f32 v172, v216, v217
  v_add_f32 v181, v216, v217
  v_mfma_f32_16x16x32_bf16 v[24:27], v[208:211], a[200:203], v[24:27]
  s_waitcnt vmcnt(5)
  buffer_load_dwordx4 v10, s[16:19], s39 offen offset:1024 nt lds
  v_mfma_f32_16x16x32_bf16 v[24:27], v[212:215], a[220:223], v[24:27]
  s_waitcnt lgkmcnt(1)
  v_exp_f32 v220, v36
  v_mfma_f32_16x16x32_bf16 a[80:83], v[184:187], v[40:43], a[80:83]
  ds_read_b128 v[196:199], v6 offset:4352
  v_cvt_pk_bf16_f32 v173, v218, v219
  v_mfma_f32_16x16x32_bf16 a[100:103], v[188:191], v[40:43], a[100:103]
  v_exp_f32 v221, v37
  v_mfma_f32_16x16x32_bf16 a[104:107], v[188:191], v[72:75], a[104:107]
  v_exp_f32 v222, v38
  v_add_f32 v181, v181, v218
  v_add_f32 v181, v181, v219
  v_mfma_f32_16x16x32_bf16 a[84:87], v[184:187], v[72:75], a[84:87]
  v_exp_f32 v223, v39
  v_mfma_f32_16x16x32_bf16 a[88:91], v[184:187], v[104:107], a[88:91]
  v_cvt_pk_bf16_f32 v46, v220, v221
  v_add_f32 v53, v53, v220
  v_mfma_f32_16x16x32_bf16 a[108:111], v[188:191], v[104:107], a[108:111]
  ds_read_b64_tr_b16 v[200:201], v7 offset:17152
  v_add_f32 v53, v53, v221
  v_mfma_f32_16x16x32_bf16 a[112:115], v[188:191], v[136:139], a[112:115]
  ds_read_b64_tr_b16 v[202:203], v7 offset:21248
  v_cvt_pk_bf16_f32 v47, v222, v223
  v_mfma_f32_16x16x32_bf16 a[92:95], v[184:187], v[136:139], a[92:95]
  v_exp_f32 v224, v68
  v_mfma_f32_16x16x32_bf16 a[96:99], v[184:187], v[168:171], a[96:99]
  s_waitcnt vmcnt(4)
  buffer_load_dwordx4 v9, s[16:19], s39 offen offset:2048 nt lds
  v_exp_f32 v225, v69
  v_mfma_f32_16x16x32_bf16 a[116:119], v[188:191], v[168:171], a[116:119]
  s_waitcnt lgkmcnt(2)
  v_exp_f32 v226, v70
  v_mfma_f32_16x16x32_bf16 v[156:159], v[192:195], a[176:179], v[176:179]
  ds_read_b64_tr_b16 v[204:205], v8 offset:17152
  v_add_f32 v53, v53, v222
  v_add_f32 v53, v53, v223
  v_mfma_f32_16x16x32_bf16 v[156:159], v[196:199], a[196:199], v[156:159]
  v_exp_f32 v227, v71
  v_mfma_f32_16x16x32_bf16 v[124:127], v[196:199], a[192:195], v[144:147]
  ds_read_b64_tr_b16 v[206:207], v8 offset:21248
  v_cvt_pk_bf16_f32 v78, v224, v225
  v_mfma_f32_16x16x32_bf16 v[124:127], v[192:195], a[172:175], v[124:127]
  ds_read_b128 v[208:211], v6 offset:4608
  v_add_f32 v85, v85, v224
  v_mfma_f32_16x16x32_bf16 v[92:95], v[192:195], a[168:171], v[112:115]
  v_exp_f32 v228, v100
  v_add_f32 v85, v85, v225
  v_mfma_f32_16x16x32_bf16 v[92:95], v[196:199], a[188:191], v[92:95]
  ds_read_b128 v[212:215], v6 offset:4864
  v_cvt_pk_bf16_f32 v79, v226, v227
  v_mfma_f32_16x16x32_bf16 v[60:63], v[196:199], a[184:187], v[80:83]
  s_add_u32 s30, s29, s31
  v_exp_f32 v229, v101
  v_mfma_f32_16x16x32_bf16 v[60:63], v[192:195], a[164:167], v[60:63]
  s_add_u32 s29, s29, 53248
  v_exp_f32 v230, v102
  v_add_f32 v85, v85, v226
  v_mfma_f32_16x16x32_bf16 v[28:31], v[192:195], a[160:163], v[48:51]
  s_waitcnt vmcnt(5)
  buffer_load_dwordx4 v10, s[16:19], s39 offen offset:3072 nt lds
  v_add_f32 v85, v85, v227
  v_mfma_f32_16x16x32_bf16 v[28:31], v[196:199], a[180:183], v[28:31]
  s_waitcnt lgkmcnt(2)
  v_exp_f32 v231, v103
  v_mfma_f32_16x16x32_bf16 a[120:123], v[200:203], v[40:43], a[120:123]
  v_cvt_pk_bf16_f32 v110, v228, v229
  v_add_f32 v117, v117, v228
  v_mfma_f32_16x16x32_bf16 a[140:143], v[204:207], v[40:43], a[140:143]
  s_cmp_eq_u32 s29, 159744
  v_exp_f32 v216, v132
  v_mfma_f32_16x16x32_bf16 a[144:147], v[204:207], v[72:75], a[144:147]
  s_cselect_b32 s29, 0, s29
  v_add_f32 v117, v117, v229
  v_cvt_pk_bf16_f32 v111, v230, v231
  v_mfma_f32_16x16x32_bf16 a[124:127], v[200:203], v[72:75], a[124:127]
  v_exp_f32 v217, v133
  v_mfma_f32_16x16x32_bf16 a[128:131], v[200:203], v[104:107], a[128:131]
  s_sub_u32 s43, s43, 1
  s_cmp_lg_u32 s43, 0
  s_cbranch_scc1 LP6
  s_waitcnt vmcnt(8) lgkmcnt(0)
  s_barrier
  v_add_u32 v6, s29, v1
  v_add_u32 v7, s29, v2
  v_mfma_f32_16x16x32_bf16 a[148:151], v[204:207], v[104:107], a[148:151]
  ds_read_b64_tr_b16 v[184:185], v7 offset:16384
  v_add_f32 v117, v117, v230
  v_mfma_f32_16x16x32_bf16 a[152:155], v[204:207], v[136:139], a[152:155]
  ds_read_b64_tr_b16 v[186:187], v7 offset:20480
  v_add_u32 v8, s29, v3
  v_add_f32 v117, v117, v231
  v_exp_f32 v218, v134
  v_mfma_f32_16x16x32_bf16 a[132:135], v[200:203], v[136:139], a[132:135]
  s_add_u32 s40, s33, s35
  v_exp_f32 v219, v135
  v_mfma_f32_16x16x32_bf16 a[136:139], v[200:203], v[168:171], a[136:139]
  s_add_u32 s35, s35, 0x2000
  v_cvt_pk_bf16_f32 v142, v216, v217
  v_add_f32 v149, v149, v216
  s_and_b32 s35, s35, 0x1ffff
  s_add_u32 m0, s30, 16384
  v_mfma_f32_16x16x32_bf16 a[156:159], v[204:207], v[168:171], a[156:159]
  s_waitcnt vmcnt(4)
  buffer_load_dwordx4 v9, s[20:23], s40 offen offset:0 nt lds
  v_mfma_f32_16x16x32_bf16 v[156:159], v[208:211], a[216:219], v[156:159]
  ds_read_b64_tr_b16 v[188:189], v8 offset:16384
  v_add_f32 v149, v149, v217
  v_exp_f32 v220, v164
  v_mfma_f32_16x16x32_bf16 v[156:159], v[212:215], a[236:239], v[156:159]
  v_exp_f32 v221, v165
  v_mfma_f32_16x16x32_bf16 v[124:127], v[212:215], a[232:235], v[124:127]
  ds_read_b64_tr_b16 v[190:191], v8 offset:20480
  v_cvt_pk_bf16_f32 v143, v218, v219
  v_mfma_f32_16x16x32_bf16 v[124:127], v[208:211], a[212:215], v[124:127]
  v_exp_f32 v222, v166
  v_add_f32 v149, v149, v218
  v_mfma_f32_16x16x32_bf16 v[92:95], v[208:211], a[208:211], v[92:95]
  v_add_f32 v149, v149, v219
  v_cvt_pk_bf16_f32 v174, v220, v221
  v_mfma_f32_16x16x32_bf16 v[92:95], v[212:215], a[228:231], v[92:95]
  ds_read_b128 v[192:195], v6 offset:0
  v_add_f32 v181, v181, v220
  v_mfma_f32_16x16x32_bf16 v[60:63], v[212:215], a[224:227], v[60:63]
  v_exp_f32 v223, v167
  v_mfma_f32_16x16x32_bf16 v[60:63], v[208:211], a[204:207], v[60:63]
  v_add_f32 v181, v181, v221
  v_cvt_pk_bf16_f32 v175, v222, v223
  v_mfma_f32_16x16x32_bf16 v[28:31], v[208:211], a[200:203], v[28:31]
  s_waitcnt vmcnt(5)
  buffer_load_dwordx4 v10, s[20:23], s40 offen offset:1024 nt lds
  v_mfma_f32_16x16x32_bf16 v[28:31], v[212:215], a[220:223], v[28:31]
  s_waitcnt lgkmcnt(1)
  v_add_f32 v181, v181, v222
  v_add_f32 v181, v181, v223
  v_max3_f32 v248, v53, v85, v117
  v_max3_f32 v248, v248, v149, v181
  v_cmp_nge_f32 vcc, s42, v248
  s_nop 0
  s_cbranch_vccnz RARE1_7
RET_7:
  v_mfma_f32_16x16x32_bf16 a[0:3], v[184:187], v[44:47], a[0:3]
  ds_read_b128 v[196:199], v6 offset:256
  v_add_f32 v52, v52, v53
  v_mfma_f32_16x16x32_bf16 a[20:23], v[188:191], v[44:47], a[20:23]
  v_exp_f32 v216, v24
  v_mfma_f32_16x16x32_bf16 a[24:27], v[188:191], v[76:79], a[24:27]
  v_add_f32 v84, v84, v85
  v_add_f32 v116, v116, v117
  v_mfma_f32_16x16x32_bf16 a[4:7], v[184:187], v[76:79], a[4:7]
  v_exp_f32 v217, v25
  v_add_f32 v148, v148, v149
  v_mfma_f32_16x16x32_bf16 a[8:11], v[184:187], v[108:111], a[8:11]
  v_add_f32 v180, v180, v181
  v_cvt_pk_bf16_f32 v40, v216, v217
  v_mfma_f32_16x16x32_bf16 a[28:31], v[188:191], v[108:111], a[28:31]
  ds_read_b64_tr_b16 v[200:201], v7 offset:16640
  v_add_f32 v53, v216, v217
  v_mfma_f32_16x16x32_bf16 a[32:35], v[188:191], v[140:143], a[32:35]
  ds_read_b64_tr_b16 v[202:203], v7 offset:20736
  v_exp_f32 v218, v26
  v_mfma_f32_16x16x32_bf16 a[12:15], v[184:187], v[140:143], a[12:15]
  v_exp_f32 v219, v27
  v_mfma_f32_16x16x32_bf16 a[16:19], v[184:187], v[172:175], a[16:19]
  s_waitcnt vmcnt(4)
  buffer_load_dwordx4 v9, s[20:23], s40 offen offset:2048 nt lds
  v_mfma_f32_16x16x32_bf16 a[36:39], v[188:191], v[172:175], a[36:39]
  s_waitcnt lgkmcnt(2)
  v_exp_f32 v220, v56
  v_mfma_f32_16x16x32_bf16 v[160:163], v[192:195], a[176:179], v[176:179]
  ds_read_b64_tr_b16 v[204:205], v8 offset:16640
  v_cvt_pk_bf16_f32 v41, v218, v219
  v_mfma_f32_16x16x32_bf16 v[160:163], v[196:199], a[196:199], v[160:163]
  v_exp_f32 v221, v57
  v_mfma_f32_16x16x32_bf16 v[128:131], v[196:199], a[192:195], v[144:147]
  ds_read_b64_tr_b16 v[206:207], v8 offset:20736
  v_add_f32 v53, v53, v218
  v_mfma_f32_16x16x32_bf16 v[128:131], v[192:195], a[172:175], v[128:131]
  v_exp_f32 v222, v58
  v_add_f32 v53, v53, v219
  v_mfma_f32_16x16x32_bf16 v[96:99], v[192:195], a[168:171], v[112:115]
  v_exp_f32 v223, v59
  v_mfma_f32_16x16x32_bf16 v[96:99], v[196:199], a[188:191], v[96:99]
  ds_read_b128 v[208:211], v6 offset:512
  v_cvt_pk_bf16_f32 v72, v220, v221
  v_mfma_f32_16x16x32_bf16 v[64:67], v[196:199], a[184:187], v[80:83]
  v_exp_f32 v224, v88
  v_add_f32 v85, v220, v221
  v_mfma_f32_16x16x32_bf16 v[64:67], v[192:195], a[164:167], v[64:67]
  v_exp_f32 v225, v89
  v_mfma_f32_16x16x32_bf16 v[32:35], v[192:195], a[160:163], v[48:51]
  s_waitcnt vmcnt(5)
  buffer_load_dwordx4 v10, s[20:23], s40 offen offset:3072 nt lds
  v_cvt_pk_bf16_f32 v73, v222, v223
  v_mfma_f32_16x16x32_bf16 v[32:35], v[196:199], a[180:183], v[32:35]
  s_waitcnt lgkmcnt(1)
  v_exp_f32 v226, v90
  v_mfma_f32_16x16x32_bf16 a[40:43], v[200:203], v[44:47], a[40:43]
  ds_read_b128 v[212:215], v6 offset:768
  v_add_f32 v85, v85, v222
  v_add_f32 v85, v85, v223
  v_mfma_f32_16x16x32_bf16 a[60:63], v[204:207], v[44:47], a[60:63]
  v_exp_f32 v227, v91
  v_mfma_f32_16x16x32_bf16 a[64:67], v[204:207], v[76:79], a[64:67]
  v_cvt_pk_bf16_f32 v104, v224, v225
  v_add_f32 v117, v224, v225
  v_mfma_f32_16x16x32_bf16 a[44:47], v[200:203], v[76:79], a[44:47]
  s_add_u32 s39, s33, s34
  v_exp_f32 v228, v120
  v_mfma_f32_16x16x32_bf16 a[48:51], v[200:203], v[108:111], a[48:51]
  s_add_u32 s34, s34, 0x2000
  v_exp_f32 v229, v121
  v_mfma_f32_16x16x32_bf16 a[68:71], v[204:207], v[108:111], a[68:71]
  ds_read_b64_tr_b16 v[184:185], v7 offset:16896
  v_cvt_pk_bf16_f32 v105, v226, v227
  v_mfma_f32_16x16x32_bf16 a[72:75], v[204:207], v[140:143], a[72:75]
  ds_read_b64_tr_b16 v[186:187], v7 offset:20992
  v_add_f32 v117, v117, v226
  v_mfma_f32_16x16x32_bf16 a[52:55], v[200:203], v[140:143], a[52:55]
  s_and_b32 s34, s34, 0x1ffff
  v_exp_f32 v230, v122
  v_mfma_f32_16x16x32_bf16 a[56:59], v[200:203], v[172:175], a[56:59]
  s_mov_b32 m0, s30
  v_add_f32 v117, v117, v227
  v_cvt_pk_bf16_f32 v136, v228, v229
  v_mfma_f32_16x16x32_bf16 a[76:79], v[204:207], v[172:175], a[76:79]
  s_waitcnt vmcnt(4)
  buffer_load_dwordx4 v9, s[16:19], s39 offen offset:0 nt lds
  s_waitcnt lgkmcnt(3)
  v_mfma_f32_16x16x32_bf16 v[160:163], v[208:211], a[216:219], v[160:163]
  ds_read_b64_tr_b16 v[188:189], v8 offset:16896
  v_add_f32 v149, v228, v229
  v_exp_f32 v231, v123
  s_waitcnt lgkmcnt(3)
  v_mfma_f32_16x16x32_bf16 v[160:163], v[212:215], a[236:239], v[160:163]
  v_exp_f32 v216, v152
  v_mfma_f32_16x16x32_bf16 v[128:131], v[212:215], a[232:235], v[128:131]
  ds_read_b64_tr_b16 v[190:191], v8 offset:20992
  v_cvt_pk_bf16_f32 v137, v230, v231
  v_mfma_f32_16x16x32_bf16 v[128:131], v[208:211], a[212:215], v[128:131]
  v_exp_f32 v217, v153
  v_mfma_f32_16x16x32_bf16 v[96:99], v[208:211], a[208:211], v[96:99]
  v_exp_f32 v218, v154
  v_add_f32 v149, v149, v230
  v_mfma_f32_16x16x32_bf16 v[96:99], v[212:215], a[228:231], v[96:99]
  ds_read_b128 v[192:195], v6 offset:4096
  v_add_f32 v149, v149, v231
  v_mfma_f32_16x16x32_bf16 v[64:67], v[212:215], a[224:227], v[64:67]
  v_exp_f32 v219, v155
  v_mfma_f32_16x16x32_bf16 v[64:67], v[208:211], a[204:207], v[64:67]
  v_cvt_pk_bf16_f32 v168, v216, v217
  v_add_f32 v181, v216, v217
  v_mfma_f32_16x16x32_bf16 v[32:35], v[208:211], a[200:203], v[32:35]
  s_waitcnt vmcnt(5)
  buffer_load_dwordx4 v10, s[16:19], s39 offen offset:1024 nt lds
  v_mfma_f32_16x16x32_bf16 v[32:35], v[212:215], a[220:223], v[32:35]
  s_waitcnt lgkmcnt(1)
  v_exp_f32 v220, v28
  v_mfma_f32_16x16x32_bf16 a[80:83], v[184:187], v[44:47], a[80:83]
  ds_read_b128 v[196:199], v6 offset:4352
  v_cvt_pk_bf16_f32 v169, v218, v219
  v_mfma_f32_16x16x32_bf16 a[100:103], v[188:191], v[44:47], a[100:103]
  v_exp_f32 v221, v29
  v_mfma_f32_16x16x32_bf16 a[104:107], v[188:191], v[76:79], a[104:107]
  v_exp_f32 v222, v30
  v_add_f32 v181, v181, v218
  v_add_f32 v181, v181, v219
  v_mfma_f32_16x16x32_bf16 a[84:87], v[184:187], v[76:79], a[84:87]
  v_exp_f32 v223, v31
  v_mfma_f32_16x16x32_bf16 a[88:91], v[184:187], v[108:111], a[88:91]
  v_cvt_pk_bf16_f32 v42, v220, v221
  v_add_f32 v53, v53, v220
  v_mfma_f32_16x16x32_bf16 a[108:111], v[188:191], v[108:111], a[108:111]
  ds_read_b64_tr_b16 v[200:201], v7 offset:17152
  v_add_f32 v53, v53, v221
  v_mfma_f32_16x16x32_bf16 a[112:115], v[188:191], v[140:143], a[112:115]
  ds_read_b64_tr_b16 v[202:203], v7 offset:21248
  v_cvt_pk_bf16_f32 v43, v222, v223
  v_mfma_f32_16x16x32_bf16 a[92:95], v[184:187], v[140:143], a[92:95]
  v_exp_f32 v224, v60
  v_mfma_f32_16x16x32_bf16 a[96:99], v[184:187], v[172:175], a[96:99]
  s_waitcnt vmcnt(4)
  buffer_load_dwordx4 v9, s[16:19], s39 offen offset:2048 nt lds
  v_exp_f32 v225, v61
  v_mfma_f32_16x16x32_bf16 a[116:119], v[188:191], v[172:175], a[116:119]
  s_waitcnt lgkmcnt(2)
  v_exp_f32 v226, v62
  v_mfma_f32_16x16x32_bf16 v[164:167], v[192:195], a[176:179], v[176:179]
  ds_read_b64_tr_b16 v[204:205], v8 offset:17152
  v_add_f32 v53, v53, v222
  v_add_f32 v53, v53, v223
  v_mfma_f32_16x16x32_bf16 v[164:167], v[196:199], a[196:199], v[164:167]
  v_exp_f32 v227, v63
  v_mfma_f32_16x16x32_bf16 v[132:135], v[196:199], a[192:195], v[144:147]
  ds_read_b64_tr_b16 v[206:207], v8 offset:21248
  v_cvt_pk_bf16_f32 v74, v224, v225
  v_mfma_f32_16x16x32_bf16 v[132:135], v[192:195], a[172:175], v[132:135]
  ds_read_b128 v[208:211], v6 offset:4608
  v_add_f32 v85, v85, v224
  v_mfma_f32_16x16x32_bf16 v[100:103], v[192:195], a[168:171], v[112:115]
  v_exp_f32 v228, v92
  v_add_f32 v85, v85, v225
  v_mfma_f32_16x16x32_bf16 v[100:103], v[196:199], a[188:191], v[100:103]
  ds_read_b128 v[212:215], v6 offset:4864
  v_cvt_pk_bf16_f32 v75, v226, v227
  v_mfma_f32_16x16x32_bf16 v[68:71], v[196:199], a[184:187], v[80:83]
  s_add_u32 s30, s29, s31
  v_exp_f32 v229, v93
  v_mfma_f32_16x16x32_bf16 v[68:71], v[192:195], a[164:167], v[68:71]
  s_add_u32 s29, s29, 53248
  v_exp_f32 v230, v94
  v_add_f32 v85, v85, v226
  v_mfma_f32_16x16x32_bf16 v[36:39], v[192:195], a[160:163], v[48:51]
  s_waitcnt vmcnt(5)
  buffer_load_dwordx4 v10, s[16:19], s39 offen offset:3072 nt lds
  v_add_f32 v85, v85, v227
  v_mfma_f32_16x16x32_bf16 v[36:39], v[196:199], a[180:183], v[36:39]
  s_waitcnt lgkmcnt(2)
  v_exp_f32 v231, v95
  v_mfma_f32_16x16x32_bf16 a[120:123], v[200:203], v[44:47], a[120:123]
  v_cvt_pk_bf16_f32 v106, v228, v229
  v_add_f32 v117, v117, v228
  v_mfma_f32_16x16x32_bf16 a[140:143], v[204:207], v[44:47], a[140:143]
  s_cmp_eq_u32 s29, 159744
  v_exp_f32 v216, v124
  v_mfma_f32_16x16x32_bf16 a[144:147], v[204:207], v[76:79], a[144:147]
  s_cselect_b32 s29, 0, s29
  v_add_f32 v117, v117, v229
  v_cvt_pk_bf16_f32 v107, v230, v231
  v_mfma_f32_16x16x32_bf16 a[124:127], v[200:203], v[76:79], a[124:127]
  v_exp_f32 v217, v125
  v_mfma_f32_16x16x32_bf16 a[128:131], v[200:203], v[108:111], a[128:131]
  s_cmp_eq_u32 s44, 1
  s_cbranch_scc1 K1_FINAL
  s_cmp_eq_u32 s44, 2
  s_cbranch_scc1 K1_TRANS
  s_waitcnt vmcnt(8) lgkmcnt(0)
  s_barrier
  v_add_u32 v6, s29, v1
  v_add_u32 v7, s29, v2
  v_mfma_f32_16x16x32_bf16 a[148:151], v[204:207], v[108:111], a[148:151]
  ds_read_b64_tr_b16 v[184:185], v7 offset:16384
  v_add_f32 v117, v117, v230
  v_mfma_f32_16x16x32_bf16 a[152:155], v[204:207], v[140:143], a[152:155]
  ds_read_b64_tr_b16 v[186:187], v7 offset:20480
  v_add_u32 v8, s29, v3
  v_add_f32 v117, v117, v231
  v_exp_f32 v218, v126
  v_mfma_f32_16x16x32_bf16 a[132:135], v[200:203], v[140:143], a[132:135]
  s_add_u32 s40, s33, s35
  v_exp_f32 v219, v127
  v_mfma_f32_16x16x32_bf16 a[136:139], v[200:203], v[172:175], a[136:139]
  s_add_u32 s35, s35, 0x2000
  v_cvt_pk_bf16_f32 v138, v216, v217
  v_add_f32 v149, v149, v216
  s_and_b32 s35, s35, 0x1ffff
  s_add_u32 m0, s30, 16384
  v_mfma_f32_16x16x32_bf16 a[156:159], v[204:207], v[172:175], a[156:159]
  s_waitcnt vmcnt(4)
  buffer_load_dwordx4 v9, s[20:23], s40 offen offset:0 nt lds
  v_mfma_f32_16x16x32_bf16 v[164:167], v[208:211], a[216:219], v[164:167]
  ds_read_b64_tr_b16 v[188:189], v8 offset:16384
  v_add_f32 v149, v149, v217
  v_exp_f32 v220, v156
  v_mfma_f32_16x16x32_bf16 v[164:167], v[212:215], a[236:239], v[164:167]
  v_exp_f32 v221, v157
  v_mfma_f32_16x16x32_bf16 v[132:135], v[212:215], a[232:235], v[132:135]
  ds_read_b64_tr_b16 v[190:191], v8 offset:20480
  v_cvt_pk_bf16_f32 v139, v218, v219
  v_mfma_f32_16x16x32_bf16 v[132:135], v[208:211], a[212:215], v[132:135]
  v_exp_f32 v222, v158
  v_add_f32 v149, v149, v218
  v_mfma_f32_16x16x32_bf16 v[100:103], v[208:211], a[208:211], v[100:103]
  v_add_f32 v149, v149, v219
  v_cvt_pk_bf16_f32 v170, v220, v221
  v_mfma_f32_16x16x32_bf16 v[100:103], v[212:215], a[228:231], v[100:103]
  ds_read_b128 v[192:195], v6 offset:0
  v_add_f32 v181, v181, v220
  v_mfma_f32_16x16x32_bf16 v[68:71], v[212:215], a[224:227], v[68:71]
  v_exp_f32 v223, v159
  v_mfma_f32_16x16x32_bf16 v[68:71], v[208:211], a[204:207], v[68:71]
  v_add_f32 v181, v181, v221
  v_cvt_pk_bf16_f32 v171, v222, v223
  v_mfma_f32_16x16x32_bf16 v[36:39], v[208:211], a[200:203], v[36:39]
  s_waitcnt vmcnt(5)
  buffer_load_dwordx4 v10, s[20:23], s40 offen offset:1024 nt lds
  v_mfma_f32_16x16x32_bf16 v[36:39], v[212:215], a[220:223], v[36:39]
  s_waitcnt lgkmcnt(1)
  v_add_f32 v181, v181, v222
  v_add_f32 v181, v181, v223
  v_max3_f32 v248, v53, v85, v117
  v_max3_f32 v248, v248, v149, v181
  v_cmp_nge_f32 vcc, s42, v248
  s_nop 0
  s_cbranch_vccnz RARE0_8
RET_8:
  v_mfma_f32_16x16x32_bf16 a[0:3], v[184:187], v[40:43], a[0:3]
  ds_read_b128 v[196:199], v6 offset:256
  v_add_f32 v52, v52, v53
  v_mfma_f32_16x16x32_bf16 a[20:23], v[188:191], v[40:43], a[20:23]
  v_exp_f32 v216, v32
  v_mfma_f32_16x16x32_bf16 a[24:27], v[188:191], v[72:75], a[24:27]
  v_add_f32 v84, v84, v85
  v_add_f32 v116, v116, v117
  v_mfma_f32_16x16x32_bf16 a[4:7], v[184:187], v[72:75], a[4:7]
  v_exp_f32 v217, v33
  v_add_f32 v148, v148, v149
  v_mfma_f32_16x16x32_bf16 a[8:11], v[184:187], v[104:107], a[8:11]
  v_add_f32 v180, v180, v181
  v_cvt_pk_bf16_f32 v44, v216, v217
  v_mfma_f32_16x16x32_bf16 a[28:31], v[188:191], v[104:107], a[28:31]
  ds_read_b64_tr_b16 v[200:201], v7 offset:16640
  v_add_f32 v53, v216, v217
  v_mfma_f32_16x16x32_bf16 a[32:35], v[188:191], v[136:139], a[32:35]
  ds_read_b64_tr_b16 v[202:203], v7 offset:20736
  v_exp_f32 v218, v34
  v_mfma_f32_16x16x32_bf16 a[12:15], v[184:187], v[136:139], a[12:15]
  v_exp_f32 v219, v35
  v_mfma_f32_16x16x32_bf16 a[16:19], v[184:187], v[168:171], a[16:19]
  s_waitcnt vmcnt(4)
  buffer_load_dwordx4 v9, s[20:23], s40 offen offset:2048 nt lds
  v_mfma_f32_16x16x32_bf16 a[36:39], v[188:191], v[168:171], a[36:39]
  s_waitcnt lgkmcnt(2)
  v_exp_f32 v220, v64
  v_mfma_f32_16x16x32_bf16 v[152:155], v[192:195], a[176:179], v[176:179]
  ds_read_b64_tr_b16 v[204:205], v8 offset:16640
  v_cvt_pk_bf16_f32 v45, v218, v219
  v_mfma_f32_16x16x32_bf16 v[152:155], v[196:199], a[196:199], v[152:155]
  v_exp_f32 v221, v65
  v_mfma_f32_16x16x32_bf16 v[120:123], v[196:199], a[192:195], v[144:147]
  ds_read_b64_tr_b16 v[206:207], v8 offset:20736
  v_add_f32 v53, v53, v218
  v_mfma_f32_16x16x32_bf16 v[120:123], v[192:195], a[172:175], v[120:123]
  v_exp_f32 v222, v66
  v_add_f32 v53, v53, v219
  v_mfma_f32_16x16x32_bf16 v[88:91], v[192:195], a[168:171], v[112:115]
  v_exp_f32 v223, v67
  v_mfma_f32_16x16x32_bf16 v[88:91], v[196:199], a[188:191], v[88:91]
  ds_read_b128 v[208:211], v6 offset:512
  v_cvt_pk_bf16_f32 v76, v220, v221
  v_mfma_f32_16x16x32_bf16 v[56:59], v[196:199], a[184:187], v[80:83]
  v_exp_f32 v224, v96
  v_add_f32 v85, v220, v221
  v_mfma_f32_16x16x32_bf16 v[56:59], v[192:195], a[164:167], v[56:59]
  v_exp_f32 v225, v97
  v_mfma_f32_16x16x32_bf16 v[24:27], v[192:195], a[160:163], v[48:51]
  s_waitcnt vmcnt(5)
  buffer_load_dwordx4 v10, s[20:23], s40 offen offset:3072 nt lds
  v_cvt_pk_bf16_f32 v77, v222, v223
  v_mfma_f32_16x16x32_bf16 v[24:27], v[196:199], a[180:183], v[24:27]
  s_waitcnt lgkmcnt(1)
  v_exp_f32 v226, v98
  v_mfma_f32_16x16x32_bf16 a[40:43], v[200:203], v[40:43], a[40:43]
  ds_read_b128 v[212:215], v6 offset:768
  v_add_f32 v85, v85, v222
  v_add_f32 v85, v85, v223
  v_mfma_f32_16x16x32_bf16 a[60:63], v[204:207], v[40:43], a[60:63]
  v_exp_f32 v227, v99
  v_mfma_f32_16x16x32_bf16 a[64:67], v[204:207], v[72:75], a[64:67]
  v_cvt_pk_bf16_f32 v108, v224, v225
  v_add_f32 v117, v224, v225
  v_mfma_f32_16x16x32_bf16 a[44:47], v[200:203], v[72:75], a[44:47]
  s_add_u32 s39, s33, s35
  v_exp_f32 v228, v128
  v_mfma_f32_16x16x32_bf16 a[48:51], v[200:203], v[104:107], a[48:51]
  s_add_u32 s35, s35, 0x2000
  v_exp_f32 v229, v129
  v_mfma_f32_16x16x32_bf16 a[68:71], v[204:207], v[104:107], a[68:71]
  ds_read_b64_tr_b16 v[184:185], v7 offset:16896
  v_cvt_pk_bf16_f32 v109, v226, v227
  v_mfma_f32_16x16x32_bf16 a[72:75], v[204:207], v[136:139], a[72:75]
  ds_read_b64_tr_b16 v[186:187], v7 offset:20992
  v_add_f32 v117, v117, v226
  v_mfma_f32_16x16x32_bf16 a[52:55], v[200:203], v[136:139], a[52:55]
  s_and_b32 s35, s35, 0x1ffff
  v_exp_f32 v230, v130
  v_mfma_f32_16x16x32_bf16 a[56:59], v[200:203], v[168:171], a[56:59]
  s_mov_b32 m0, s30
  v_add_f32 v117, v117, v227
  v_cvt_pk_bf16_f32 v140, v228, v229
  v_mfma_f32_16x16x32_bf16 a[76:79], v[204:207], v[168:171], a[76:79]
  s_waitcnt vmcnt(4)
  buffer_load_dwordx4 v9, s[20:23], s39 offen offset:0 nt lds
  s_waitcnt lgkmcnt(3)
  v_mfma_f32_16x16x32_bf16 v[152:155], v[208:211], a[216:219], v[152:155]
  ds_read_b64_tr_b16 v[188:189], v8 offset:16896
  v_add_f32 v149, v228, v229
  v_exp_f32 v231, v131
  s_waitcnt lgkmcnt(3)
  v_mfma_f32_16x16x32_bf16 v[152:155], v[212:215], a[236:239], v[152:155]
  v_exp_f32 v216, v160
  v_mfma_f32_16x16x32_bf16 v[120:123], v[212:215], a[232:235], v[120:123]
  ds_read_b64_tr_b16 v[190:191], v8 offset:20992
  v_cvt_pk_bf16_f32 v141, v230, v231
  v_mfma_f32_16x16x32_bf16 v[120:123], v[208:211], a[212:215], v[120:123]
  v_exp_f32 v217, v161
  v_mfma_f32_16x16x32_bf16 v[88:91], v[208:211], a[208:211], v[88:91]
  v_exp_f32 v218, v162
  v_add_f32 v149, v149, v230
  v_mfma_f32_16x16x32_bf16 v[88:91], v[212:215], a[228:231], v[88:91]
  ds_read_b128 v[192:195], v6 offset:4096
  v_add_f32 v149, v149, v231
  v_mfma_f32_16x16x32_bf16 v[56:59], v[212:215], a[224:227], v[56:59]
  v_exp_f32 v219, v163
  v_mfma_f32_16x16x32_bf16 v[56:59], v[208:211], a[204:207], v[56:59]
  v_cvt_pk_bf16_f32 v172, v216, v217
  v_add_f32 v181, v216, v217
  v_mfma_f32_16x16x32_bf16 v[24:27], v[208:211], a[200:203], v[24:27]
  s_waitcnt vmcnt(5)
  buffer_load_dwordx4 v10, s[20:23], s39 offen offset:1024 nt lds
  v_mfma_f32_16x16x32_bf16 v[24:27], v[212:215], a[220:223], v[24:27]
  s_waitcnt lgkmcnt(1)
  v_exp_f32 v220, v36
  v_mfma_f32_16x16x32_bf16 a[80:83], v[184:187], v[40:43], a[80:83]
  ds_read_b128 v[196:199], v6 offset:4352
  v_cvt_pk_bf16_f32 v173, v218, v219
  v_mfma_f32_16x16x32_bf16 a[100:103], v[188:191], v[40:43], a[100:103]
  v_exp_f32 v221, v37
  v_mfma_f32_16x16x32_bf16 a[104:107], v[188:191], v[72:75], a[104:107]
  v_exp_f32 v222, v38
  v_add_f32 v181, v181, v218
  v_add_f32 v181, v181, v219
  v_mfma_f32_16x16x32_bf16 a[84:87], v[184:187], v[72:75], a[84:87]
  v_exp_f32 v223, v39
  v_mfma_f32_16x16x32_bf16 a[88:91], v[184:187], v[104:107], a[88:91]
  v_cvt_pk_bf16_f32 v46, v220, v221
  v_add_f32 v53, v53, v220
  v_mfma_f32_16x16x32_bf16 a[108:111], v[188:191], v[104:107], a[108:111]
  ds_read_b64_tr_b16 v[200:201], v7 offset:17152
  v_add_f32 v53, v53, v221
  v_mfma_f32_16x16x32_bf16 a[112:115], v[188:191], v[136:139], a[112:115]
  ds_read_b64_tr_b16 v[202:203], v7 offset:21248
  v_cvt_pk_bf16_f32 v47, v222, v223
  v_mfma_f32_16x16x32_bf16 a[92:95], v[184:187], v[136:139], a[92:95]
  v_exp_f32 v224, v68
  v_mfma_f32_16x16x32_bf16 a[96:99], v[184:187], v[168:171], a[96:99]
  s_waitcnt vmcnt(4)
  buffer_load_dwordx4 v9, s[20:23], s39 offen offset:2048 nt lds
  v_exp_f32 v225, v69
  v_mfma_f32_16x16x32_bf16 a[116:119], v[188:191], v[168:171], a[116:119]
  s_waitcnt lgkmcnt(2)
  v_exp_f32 v226, v70
  v_mfma_f32_16x16x32_bf16 v[156:159], v[192:195], a[176:179], v[176:179]
  ds_read_b64_tr_b16 v[204:205], v8 offset:17152
  v_add_f32 v53, v53, v222
  v_add_f32 v53, v53, v223
  v_mfma_f32_16x16x32_bf16 v[156:159], v[196:199], a[196:199], v[156:159]
  v_exp_f32 v227, v71
  v_mfma_f32_16x16x32_bf16 v[124:127], v[196:199], a[192:195], v[144:147]
  ds_read_b64_tr_b16 v[206:207], v8 offset:21248
  v_cvt_pk_bf16_f32 v78, v224, v225
  v_mfma_f32_16x16x32_bf16 v[124:127], v[192:195], a[172:175], v[124:127]
  ds_read_b128 v[208:211], v6 offset:4608
  v_add_f32 v85, v85, v224
  v_mfma_f32_16x16x32_bf16 v[92:95], v[192:195], a[168:171], v[112:115]
  v_exp_f32 v228, v100
  v_add_f32 v85, v85, v225
  v_mfma_f32_16x16x32_bf16 v[92:95], v[196:199], a[188:191], v[92:95]
  ds_read_b128 v[212:215], v6 offset:4864
  v_cvt_pk_bf16_f32 v79, v226, v227
  v_mfma_f32_16x16x32_bf16 v[60:63], v[196:199], a[184:187], v[80:83]
  s_add_u32 s30, s29, s31
  v_exp_f32 v229, v101
  v_mfma_f32_16x16x32_bf16 v[60:63], v[192:195], a[164:167], v[60:63]
  s_add_u32 s29, s29, 53248
  v_exp_f32 v230, v102
  v_add_f32 v85, v85, v226
  v_mfma_f32_16x16x32_bf16 v[28:31], v[192:195], a[160:163], v[48:51]
  s_waitcnt vmcnt(5)
  buffer_load_dwordx4 v10, s[20:23], s39 offen offset:3072 nt lds
  v_add_f32 v85, v85, v227
  v_mfma_f32_16x16x32_bf16 v[28:31], v[196:199], a[180:183], v[28:31]
  s_waitcnt lgkmcnt(2)
  v_exp_f32 v231, v103
  v_mfma_f32_16x16x32_bf16 a[120:123], v[200:203], v[40:43], a[120:123]
  v_cvt_pk_bf16_f32 v110, v228, v229
  v_add_f32 v117, v117, v228
  v_mfma_f32_16x16x32_bf16 a[140:143], v[204:207], v[40:43], a[140:143]
  s_cmp_eq_u32 s29, 159744
  v_exp_f32 v216, v132
  v_mfma_f32_16x16x32_bf16 a[144:147], v[204:207], v[72:75], a[144:147]
  s_cselect_b32 s29, 0, s29
  v_add_f32 v117, v117, v229
  v_cvt_pk_bf16_f32 v111, v230, v231
  v_mfma_f32_16x16x32_bf16 a[124:127], v[200:203], v[72:75], a[124:127]
  s_mov_b32 m0, s30
  v_exp_f32 v217, v133
  v_mfma_f32_16x16x32_bf16 a[128:131], v[200:203], v[104:107], a[128:131]
  s_waitcnt vmcnt(8) lgkmcnt(0)
  s_barrier
  v_add_u32 v6, s29, v1
  v_add_u32 v7, s29, v2
  v_mfma_f32_16x16x32_bf16 a[148:151], v[204:207], v[104:107], a[148:151]
  ds_read_b64_tr_b16 v[184:185], v7 offset:16384
  v_add_f32 v117, v117, v230
  v_mfma_f32_16x16x32_bf16 a[152:155], v[204:207], v[136:139], a[152:155]
  ds_read_b64_tr_b16 v[186:187], v7 offset:20480
  v_add_u32 v8, s29, v3
  v_add_f32 v117, v117, v231
  v_exp_f32 v218, v134
  v_mfma_f32_16x16x32_bf16 a[132:135], v[200:203], v[136:139], a[132:135]
  s_add_u32 s33, s33, 0x100000
  v_exp_f32 v219, v135
  v_mfma_f32_16x16x32_bf16 a[136:139], v[200:203], v[168:171], a[136:139]
  s_add_u32 s36, s36, 2048
  v_cvt_pk_bf16_f32 v142, v216, v217
  v_add_f32 v149, v149, v216
  s_lshl_b32 s39, s3, 19
  s_add_u32 s36, s36, s39
  s_lshl_b32 s7, s3, 7
  v_mfma_f32_16x16x32_bf16 a[156:159], v[204:207], v[168:171], a[156:159]
  buffer_load_dwordx4 v11, s[12:15], s36 offen offset:0 lds
  v_mfma_f32_16x16x32_bf16 v[156:159], v[208:211], a[216:219], v[156:159]
  ds_read_b64_tr_b16 v[188:189], v8 offset:16384
  v_add_f32 v149, v149, v217
  v_exp_f32 v220, v164
  v_mfma_f32_16x16x32_bf16 v[156:159], v[212:215], a[236:239], v[156:159]
  v_exp_f32 v221, v165
  v_mfma_f32_16x16x32_bf16 v[124:127], v[212:215], a[232:235], v[124:127]
  ds_read_b64_tr_b16 v[190:191], v8 offset:20480
  v_cvt_pk_bf16_f32 v143, v218, v219
  v_mfma_f32_16x16x32_bf16 v[124:127], v[208:211], a[212:215], v[124:127]
  buffer_load_dwordx4 v12, s[12:15], s36 offen offset:1024 lds
  v_add_f32 v149, v149, v218
  v_mfma_f32_16x16x32_bf16 v[92:95], v[208:211], a[208:211], v[92:95]
  v_exp_f32 v222, v166
  v_add_f32 v149, v149, v219
  v_mfma_f32_16x16x32_bf16 v[92:95], v[212:215], a[228:231], v[92:95]
  ds_read_b128 v[192:195], v6 offset:0
  v_cvt_pk_bf16_f32 v174, v220, v221
  v_mfma_f32_16x16x32_bf16 v[60:63], v[212:215], a[224:227], v[60:63]
  v_exp_f32 v223, v167
  v_mfma_f32_16x16x32_bf16 v[60:63], v[208:211], a[204:207], v[60:63]
  v_add_f32 v181, v181, v220
  v_add_f32 v181, v181, v221
  v_mfma_f32_16x16x32_bf16 v[28:31], v[208:211], a[200:203], v[28:31]
  buffer_load_dwordx4 v13, s[12:15], s36 offen offset:2048 lds
  v_cvt_pk_bf16_f32 v175, v222, v223
  v_mfma_f32_16x16x32_bf16 v[28:31], v[212:215], a[220:223], v[28:31]
  s_waitcnt lgkmcnt(1)
  v_add_f32 v181, v181, v222
  v_add_f32 v181, v181, v223
  v_max3_f32 v248, v53, v85, v117
  v_max3_f32 v248, v248, v149, v181
  v_cmp_nge_f32 vcc, s42, v248
  s_nop 0
  s_cbranch_vccnz RARE1_9
RET_9:
  v_mfma_f32_16x16x32_bf16 a[0:3], v[184:187], v[44:47], a[0:3]
  ds_read_b128 v[196:199], v6 offset:256
  v_add_f32 v52, v52, v53
  v_mfma_f32_16x16x32_bf16 a[20:23], v[188:191], v[44:47], a[20:23]
  v_exp_f32 v216, v24
  v_mfma_f32_16x16x32_bf16 a[24:27], v[188:191], v[76:79], a[24:27]
  v_add_f32 v84, v84, v85
  v_add_f32 v116, v116, v117
  v_mfma_f32_16x16x32_bf16 a[4:7], v[184:187], v[76:79], a[4:7]
  buffer_load_dwordx4 v14, s[12:15], s36 offen offset:3072 lds
  v_add_f32 v148, v148, v149
  v_mfma_f32_16x16x32_bf16 a[8:11], v[184:187], v[108:111], a[8:11]
  s_add_u32 s36, s36, 0x40000
  v_exp_f32 v217, v25
  v_add_f32 v180, v180, v181
  v_mfma_f32_16x16x32_bf16 a[28:31], v[188:191], v[108:111], a[28:31]
  ds_read_b64_tr_b16 v[200:201], v7 offset:16640
  v_cvt_pk_bf16_f32 v40, v216, v217
  v_mfma_f32_16x16x32_bf16 a[32:35], v[188:191], v[140:143], a[32:35]
  ds_read_b64_tr_b16 v[202:203], v7 offset:20736
  v_add_f32 v53, v216, v217
  v_exp_f32 v218, v26
  v_mfma_f32_16x16x32_bf16 a[12:15], v[184:187], v[140:143], a[12:15]
  s_add_u32 m0, s30, 16384
  v_exp_f32 v219, v27
  v_mfma_f32_16x16x32_bf16 a[16:19], v[184:187], v[172:175], a[16:19]
  buffer_load_dwordx4 v11, s[12:15], s36 offen offset:0 lds
  v_mfma_f32_16x16x32_bf16 a[36:39], v[188:191], v[172:175], a[36:39]
  s_waitcnt lgkmcnt(2)
  v_exp_f32 v220, v56
  v_mfma_f32_16x16x32_bf16 v[160:163], v[192:195], a[176:179], v[176:179]
  ds_read_b64_tr_b16 v[204:205], v8 offset:16640
  v_cvt_pk_bf16_f32 v41, v218, v219
  v_mfma_f32_16x16x32_bf16 v[160:163], v[196:199], a[196:199], v[160:163]
  v_exp_f32 v221, v57
  v_mfma_f32_16x16x32_bf16 v[128:131], v[196:199], a[192:195], v[144:147]
  ds_read_b64_tr_b16 v[206:207], v8 offset:20736
  v_add_f32 v53, v53, v218
  v_mfma_f32_16x16x32_bf16 v[128:131], v[192:195], a[172:175], v[128:131]
  buffer_load_dwordx4 v12, s[12:15], s36 offen offset:1024 lds
  v_add_f32 v53, v53, v219
  v_mfma_f32_16x16x32_bf16 v[96:99], v[192:195], a[168:171], v[112:115]
  v_exp_f32 v222, v58
  v_mfma_f32_16x16x32_bf16 v[96:99], v[196:199], a[188:191], v[96:99]
  ds_read_b128 v[208:211], v6 offset:512
  v_cvt_pk_bf16_f32 v72, v220, v221
  v_exp_f32 v223, v59
  v_mfma_f32_16x16x32_bf16 v[64:67], v[196:199], a[184:187], v[80:83]
  v_exp_f32 v224, v88
  v_add_f32 v85, v220, v221
  v_mfma_f32_16x16x32_bf16 v[64:67], v[192:195], a[164:167], v[64:67]
  v_exp_f32 v225, v89
  v_mfma_f32_16x16x32_bf16 v[32:35], v[192:195], a[160:163], v[48:51]
  buffer_load_dwordx4 v13, s[12:15], s36 offen offset:2048 lds
  v_cvt_pk_bf16_f32 v73, v222, v223
  v_mfma_f32_16x16x32_bf16 v[32:35], v[196:199], a[180:183], v[32:35]
  s_waitcnt lgkmcnt(1)
  v_exp_f32 v226, v90
  v_mfma_f32_16x16x32_bf16 a[40:43], v[200:203], v[44:47], a[40:43]
  ds_read_b128 v[212:215], v6 offset:768
  v_add_f32 v85, v85, v222
  v_add_f32 v85, v85, v223
  v_mfma_f32_16x16x32_bf16 a[60:63], v[204:207], v[44:47], a[60:63]
  v_exp_f32 v227, v91
  v_mfma_f32_16x16x32_bf16 a[64:67], v[204:207], v[76:79], a[64:67]
  v_cvt_pk_bf16_f32 v104, v224, v225
  v_add_f32 v117, v224, v225
  v_mfma_f32_16x16x32_bf16 a[44:47], v[200:203], v[76:79], a[44:47]
  buffer_load_dwordx4 v14, s[12:15], s36 offen offset:3072 lds
  v_mfma_f32_16x16x32_bf16 a[48:51], v[200:203], v[108:111], a[48:51]
  s_add_u32 s36, s36, 0x40000
  v_exp_f32 v228, v120
  v_mfma_f32_16x16x32_bf16 a[68:71], v[204:207], v[108:111], a[68:71]
  s_and_b32 s36, s36, 0x3fffff
  v_exp_f32 v229, v121
  v_cvt_pk_bf16_f32 v105, v226, v227
  v_mfma_f32_16x16x32_bf16 a[72:75], v[204:207], v[140:143], a[72:75]
  ds_read_b64_tr_b16 v[184:185], v7 offset:16896
  v_add_f32 v117, v117, v226
  v_mfma_f32_16x16x32_bf16 a[52:55], v[200:203], v[140:143], a[52:55]
  s_add_u32 s37, s6, s7
  v_exp_f32 v230, v122
  v_mfma_f32_16x16x32_bf16 a[56:59], v[200:203], v[172:175], a[56:59]
  s_add_u32 m0, s30, s32
  v_add_f32 v117, v117, v227
  v_cvt_pk_bf16_f32 v136, v228, v229
  ds_read_b64_tr_b16 v[186:187], v7 offset:20992
  v_mfma_f32_16x16x32_bf16 a[76:79], v[204:207], v[172:175], a[76:79]
  buffer_load_dwordx4 v15, s[8:11], s37 offen offset:0 lds
  s_waitcnt lgkmcnt(3)
  v_mfma_f32_16x16x32_bf16 v[160:163], v[208:211], a[216:219], v[160:163]
  ds_read_b64_tr_b16 v[188:189], v8 offset:16896
  v_add_f32 v149, v228, v229
  v_exp_f32 v231, v123
  s_waitcnt lgkmcnt(3)
  v_mfma_f32_16x16x32_bf16 v[160:163], v[212:215], a[236:239], v[160:163]
  v_exp_f32 v216, v152
  v_mfma_f32_16x16x32_bf16 v[128:131], v[212:215], a[232:235], v[128:131]
  ds_read_b64_tr_b16 v[190:191], v8 offset:20992
  v_cvt_pk_bf16_f32 v137, v230, v231
  v_mfma_f32_16x16x32_bf16 v[128:131], v[208:211], a[212:215], v[128:131]
  buffer_load_dwordx4 v16, s[8:11], s37 offen offset:1024 lds
  v_exp_f32 v217, v153
  v_mfma_f32_16x16x32_bf16 v[96:99], v[208:211], a[208:211], v[96:99]
  v_exp_f32 v218, v154
  v_add_f32 v149, v149, v230
  v_mfma_f32_16x16x32_bf16 v[96:99], v[212:215], a[228:231], v[96:99]
  ds_read_b128 v[192:195], v6 offset:4096
  v_add_f32 v149, v149, v231
  v_mfma_f32_16x16x32_bf16 v[64:67], v[212:215], a[224:227], v[64:67]
  v_exp_f32 v219, v155
  v_mfma_f32_16x16x32_bf16 v[64:67], v[208:211], a[204:207], v[64:67]
  v_cvt_pk_bf16_f32 v168, v216, v217
  v_add_f32 v181, v216, v217
  v_mfma_f32_16x16x32_bf16 v[32:35], v[208:211], a[200:203], v[32:35]
  buffer_load_dwordx4 v17, s[8:11], s37 offen offset:2048 lds
  v_mfma_f32_16x16x32_bf16 v[32:35], v[212:215], a[220:223], v[32:35]
  s_waitcnt lgkmcnt(1)
  v_exp_f32 v220, v28
  v_mfma_f32_16x16x32_bf16 a[80:83], v[184:187], v[44:47], a[80:83]
  ds_read_b128 v[196:199], v6 offset:4352
  v_cvt_pk_bf16_f32 v169, v218, v219
  v_mfma_f32_16x16x32_bf16 a[100:103], v[188:191], v[44:47], a[100:103]
  v_exp_f32 v221, v29
  v_mfma_f32_16x16x32_bf16 a[104:107], v[188:191], v[76:79], a[104:107]
  v_exp_f32 v222, v30
  v_add_f32 v181, v181, v218
  v_add_f32 v181, v181, v219
  v_mfma_f32_16x16x32_bf16 a[84:87], v[184:187], v[76:79], a[84:87]
  buffer_load_dwordx4 v18, s[8:11], s37 offen offset:3072 lds
  v_mfma_f32_16x16x32_bf16 a[88:91], v[184:187], v[108:111], a[88:91]
  s_add_u32 m0, m0, 0x1000
  v_exp_f32 v223, v31
  v_cvt_pk_bf16_f32 v42, v220, v221
  v_mfma_f32_16x16x32_bf16 a[108:111], v[188:191], v[108:111], a[108:111]
  ds_read_b64_tr_b16 v[200:201], v7 offset:17152
  v_add_f32 v53, v53, v220
  v_mfma_f32_16x16x32_bf16 a[112:115], v[188:191], v[140:143], a[112:115]
  ds_read_b64_tr_b16 v[202:203], v7 offset:21248
  v_add_f32 v53, v53, v221
  v_mfma_f32_16x16x32_bf16 a[92:95], v[184:187], v[140:143], a[92:95]
  s_add_u32 s39, s37, 0x8000
  v_exp_f32 v224, v60
  v_mfma_f32_16x16x32_bf16 a[96:99], v[184:187], v[172:175], a[96:99]
  buffer_load_dwordx4 v15, s[8:11], s39 offen lds
  v_cvt_pk_bf16_f32 v43, v222, v223
  v_exp_f32 v225, v61
  v_mfma_f32_16x16x32_bf16 a[116:119], v[188:191], v[172:175], a[116:119]
  s_add_u32 s7, s7, 128
  v_exp_f32 v226, v62
  s_waitcnt lgkmcnt(3)
  v_mfma_f32_16x16x32_bf16 v[164:167], v[192:195], a[176:179], v[176:179]
  s_and_b32 s7, s7, 0x3ff
  v_add_f32 v53, v53, v222
  v_add_f32 v53, v53, v223
  s_waitcnt lgkmcnt(2)
  v_mfma_f32_16x16x32_bf16 v[164:167], v[196:199], a[196:199], v[164:167]
  v_exp_f32 v227, v63
  v_mfma_f32_16x16x32_bf16 v[132:135], v[196:199], a[192:195], v[144:147]
  ds_read_b64_tr_b16 v[204:205], v8 offset:17152
  v_cvt_pk_bf16_f32 v74, v224, v225
  v_mfma_f32_16x16x32_bf16 v[132:135], v[192:195], a[172:175], v[132:135]
  ds_read_b64_tr_b16 v[206:207], v8 offset:21248
  v_add_f32 v85, v85, v224
  v_mfma_f32_16x16x32_bf16 v[100:103], v[192:195], a[168:171], v[112:115]
  ds_read_b128 v[208:211], v6 offset:4608
  v_add_f32 v85, v85, v225
  v_mfma_f32_16x16x32_bf16 v[100:103], v[196:199], a[188:191], v[100:103]
  ds_read_b128 v[212:215], v6 offset:4864
  v_cvt_pk_bf16_f32 v75, v226, v227
  v_exp_f32 v228, v92
  v_mfma_f32_16x16x32_bf16 v[68:71], v[196:199], a[184:187], v[80:83]
  s_add_u32 s30, s29, s31
  v_exp_f32 v229, v93
  v_mfma_f32_16x16x32_bf16 v[68:71], v[192:195], a[164:167], v[68:71]
  s_add_u32 s29, s29, 53248
  v_exp_f32 v230, v94
  v_add_f32 v85, v85, v226
  v_mfma_f32_16x16x32_bf16 v[36:39], v[192:195], a[160:163], v[48:51]
  s_cmp_eq_u32 s29, 159744
  v_add_f32 v85, v85, v227
  v_cvt_pk_bf16_f32 v106, v228, v229
  v_mfma_f32_16x16x32_bf16 v[36:39], v[196:199], a[180:183], v[36:39]
  s_waitcnt lgkmcnt(2)
  v_exp_f32 v231, v95
  v_mfma_f32_16x16x32_bf16 a[120:123], v[200:203], v[44:47], a[120:123]
  v_exp_f32 v216, v124
  v_mfma_f32_16x16x32_bf16 a[140:143], v[204:207], v[44:47], a[140:143]
  s_cselect_b32 s29, 0, s29
  v_add_f32 v117, v117, v228
  v_add_f32 v117, v117, v229
  v_mfma_f32_16x16x32_bf16 a[144:147], v[204:207], v[76:79], a[144:147]
  v_exp_f32 v217, v125
  v_mfma_f32_16x16x32_bf16 a[124:127], v[200:203], v[76:79], a[124:127]
  s_mov_b32 m0, s30
  v_cvt_pk_bf16_f32 v107, v230, v231
  v_add_u32 v6, s29, v1
  v_mfma_f32_16x16x32_bf16 a[128:131], v[200:203], v[108:111], a[128:131]
  s_waitcnt vmcnt(13) lgkmcnt(0)
  s_barrier
  v_exp_f32 v218, v126
  v_mfma_f32_16x16x32_bf16 a[148:151], v[204:207], v[108:111], a[148:151]
  v_add_u32 v7, s29, v2
  v_add_f32 v117, v117, v230
  v_mfma_f32_16x16x32_bf16 a[152:155], v[204:207], v[140:143], a[152:155]
  ds_read_b64_tr_b16 v[184:185], v7 offset:16384
  v_add_u32 v8, s29, v3
  v_add_f32 v117, v117, v231
  v_mfma_f32_16x16x32_bf16 a[132:135], v[200:203], v[140:143], a[132:135]
  ds_read_b64_tr_b16 v[186:187], v7 offset:20480
  v_cvt_pk_bf16_f32 v138, v216, v217
  v_mfma_f32_16x16x32_bf16 a[136:139], v[200:203], v[172:175], a[136:139]
  buffer_load_dwordx4 v11, s[12:15], s36 offen offset:0 lds
  v_exp_f32 v219, v127
  v_mfma_f32_16x16x32_bf16 a[156:159], v[204:207], v[172:175], a[156:159]
  v_exp_f32 v220, v156
  v_add_f32 v149, v149, v216
  v_mfma_f32_16x16x32_bf16 v[164:167], v[208:211], a[216:219], v[164:167]
  ds_read_b64_tr_b16 v[188:189], v8 offset:16384
  v_add_f32 v149, v149, v217
  v_mfma_f32_16x16x32_bf16 v[164:167], v[212:215], a[236:239], v[164:167]
  v_exp_f32 v221, v157
  v_mfma_f32_16x16x32_bf16 v[132:135], v[212:215], a[232:235], v[132:135]
  ds_read_b64_tr_b16 v[190:191], v8 offset:20480
  v_cvt_pk_bf16_f32 v139, v218, v219
  v_mfma_f32_16x16x32_bf16 v[132:135], v[208:211], a[212:215], v[132:135]
  buffer_load_dwordx4 v12, s[12:15], s36 offen offset:1024 lds
  v_add_f32 v149, v149, v218
  v_mfma_f32_16x16x32_bf16 v[100:103], v[208:211], a[208:211], v[100:103]
  v_exp_f32 v222, v158
  v_add_f32 v149, v149, v219
  v_mfma_f32_16x16x32_bf16 v[100:103], v[212:215], a[228:231], v[100:103]
  ds_read_b64_tr_b16 v[192:193], v7 offset:16640
  v_cvt_pk_bf16_f32 v170, v220, v221
  v_mfma_f32_16x16x32_bf16 v[68:71], v[212:215], a[224:227], v[68:71]
  ds_read_b64_tr_b16 v[194:195], v7 offset:20736
  v_add_f32 v181, v181, v220
  v_exp_f32 v223, v159
  v_mfma_f32_16x16x32_bf16 v[68:71], v[208:211], a[204:207], v[68:71]
  v_add_f32 v181, v181, v221
  v_cvt_pk_bf16_f32 v171, v222, v223
  v_mfma_f32_16x16x32_bf16 v[36:39], v[208:211], a[200:203], v[36:39]
  buffer_load_dwordx4 v13, s[12:15], s36 offen offset:2048 lds
  v_mfma_f32_16x16x32_bf16 v[36:39], v[212:215], a[220:223], v[36:39]
  s_waitcnt lgkmcnt(4)
  v_add_f32 v181, v181, v222
  v_add_f32 v181, v181, v223
  v_max3_f32 v248, v53, v85, v117
  v_max3_f32 v248, v248, v149, v181
  v_cmp_nge_f32 vcc, s42, v248
  s_nop 0
  s_cbranch_vccnz RARE0_10
RET_10:
  v_mfma_f32_16x16x32_bf16 a[0:3], v[184:187], v[40:43], a[0:3]
  ds_read_b64_tr_b16 v[196:197], v8 offset:16640
  v_add_f32 v52, v52, v53
  v_mfma_f32_16x16x32_bf16 a[4:7], v[184:187], v[72:75], a[4:7]
  ds_read_b64_tr_b16 v[198:199], v8 offset:20736
  v_add_f32 v84, v84, v85
  v_mfma_f32_16x16x32_bf16 a[8:11], v[184:187], v[104:107], a[8:11]
  v_exp_f32 v216, v32
  v_mfma_f32_16x16x32_bf16 a[12:15], v[184:187], v[136:139], a[12:15]
  buffer_load_dwordx4 v14, s[12:15], s36 offen offset:3072 lds
  v_add_f32 v116, v116, v117
  v_add_f32 v148, v148, v149
  v_mfma_f32_16x16x32_bf16 a[16:19], v[184:187], v[168:171], a[16:19]
  s_waitcnt lgkmcnt(4)
  v_exp_f32 v217, v33
  v_add_f32 v180, v180, v181
  v_mfma_f32_16x16x32_bf16 a[20:23], v[188:191], v[40:43], a[20:23]
  ds_read_b64_tr_b16 v[200:201], v7 offset:16896
  v_cvt_pk_bf16_f32 v44, v216, v217
  v_exp_f32 v218, v34
  v_mfma_f32_16x16x32_bf16 a[24:27], v[188:191], v[72:75], a[24:27]
  ds_read_b64_tr_b16 v[202:203], v7 offset:20992
  v_add_f32 v53, v216, v217
  v_exp_f32 v219, v35
  v_mfma_f32_16x16x32_bf16 a[28:31], v[188:191], v[104:107], a[28:31]
  s_add_u32 s36, s36, 0x40000
  v_exp_f32 v220, v64
  v_cvt_pk_bf16_f32 v45, v218, v219
  v_mfma_f32_16x16x32_bf16 a[32:35], v[188:191], v[136:139], a[32:35]
  s_add_u32 m0, s30, 16384
  v_exp_f32 v221, v65
  v_add_f32 v53, v53, v218
  v_add_f32 v53, v53, v219
  v_mfma_f32_16x16x32_bf16 a[36:39], v[188:191], v[168:171], a[36:39]
  buffer_load_dwordx4 v11, s[12:15], s36 offen offset:0 lds
  v_exp_f32 v222, v66
  v_cvt_pk_bf16_f32 v76, v220, v221
  v_exp_f32 v223, v67
  s_waitcnt lgkmcnt(4)
  v_mfma_f32_16x16x32_bf16 a[40:43], v[192:195], v[40:43], a[40:43]
  ds_read_b64_tr_b16 v[204:205], v8 offset:16896
  v_add_f32 v85, v220, v221
  v_exp_f32 v224, v96
  v_mfma_f32_16x16x32_bf16 a[44:47], v[192:195], v[72:75], a[44:47]
  v_exp_f32 v225, v97
  v_cvt_pk_bf16_f32 v77, v222, v223
  v_mfma_f32_16x16x32_bf16 a[48:51], v[192:195], v[104:107], a[48:51]
  ds_read_b64_tr_b16 v[206:207], v8 offset:20992
  v_add_f32 v85, v85, v222
  v_add_f32 v85, v85, v223
  v_exp_f32 v226, v98
  v_mfma_f32_16x16x32_bf16 a[52:55], v[192:195], v[136:139], a[52:55]
  buffer_load_dwordx4 v12, s[12:15], s36 offen offset:1024 lds
  v_cvt_pk_bf16_f32 v108, v224, v225
  v_exp_f32 v227, v99
  v_mfma_f32_16x16x32_bf16 a[56:59], v[192:195], v[168:171], a[56:59]
  s_waitcnt lgkmcnt(4)
  v_exp_f32 v228, v128
  v_add_f32 v117, v224, v225
  v_cvt_pk_bf16_f32 v109, v226, v227
  v_mfma_f32_16x16x32_bf16 a[60:63], v[196:199], v[40:43], a[60:63]
  ds_read_b64_tr_b16 v[208:209], v7 offset:17152
  v_add_f32 v117, v117, v226
  v_exp_f32 v229, v129
  v_mfma_f32_16x16x32_bf16 a[64:67], v[196:199], v[72:75], a[64:67]
  ds_read_b64_tr_b16 v[210:211], v7 offset:21248
  v_add_f32 v117, v117, v227
  v_exp_f32 v230, v130
  v_cvt_pk_bf16_f32 v140, v228, v229
  v_mfma_f32_16x16x32_bf16 a[68:71], v[196:199], v[104:107], a[68:71]
  v_exp_f32 v231, v131
  v_add_f32 v149, v228, v229
  v_exp_f32 v216, v160
  v_mfma_f32_16x16x32_bf16 a[72:75], v[196:199], v[136:139], a[72:75]
  buffer_load_dwordx4 v13, s[12:15], s36 offen offset:2048 lds
  v_cvt_pk_bf16_f32 v141, v230, v231
  v_exp_f32 v217, v161
  v_mfma_f32_16x16x32_bf16 a[76:79], v[196:199], v[168:171], a[76:79]
  s_waitcnt lgkmcnt(4)
  v_exp_f32 v218, v162
  v_add_f32 v149, v149, v230
  v_add_f32 v149, v149, v231
  v_mfma_f32_16x16x32_bf16 a[80:83], v[200:203], v[40:43], a[80:83]
  ds_read_b64_tr_b16 v[212:213], v8 offset:17152
  v_cvt_pk_bf16_f32 v172, v216, v217
  v_exp_f32 v219, v163
  v_mfma_f32_16x16x32_bf16 a[84:87], v[200:203], v[72:75], a[84:87]
  ds_read_b64_tr_b16 v[214:215], v8 offset:21248
  v_add_f32 v181, v216, v217
  v_exp_f32 v220, v36
  v_mfma_f32_16x16x32_bf16 a[88:91], v[200:203], v[104:107], a[88:91]
  v_exp_f32 v221, v37
  v_cvt_pk_bf16_f32 v173, v218, v219
  v_add_f32 v181, v181, v218
  v_mfma_f32_16x16x32_bf16 a[92:95], v[200:203], v[136:139], a[92:95]
  buffer_load_dwordx4 v14, s[12:15], s36 offen offset:3072 lds
  v_add_f32 v181, v181, v219
  v_exp_f32 v222, v38
  v_cvt_pk_bf16_f32 v46, v220, v221
  v_mfma_f32_16x16x32_bf16 a[96:99], v[200:203], v[168:171], a[96:99]
  s_add_u32 s36, s36, 0x40000
  v_exp_f32 v223, v39
  v_add_f32 v53, v53, v220
  s_waitcnt lgkmcnt(4)
  v_mfma_f32_16x16x32_bf16 a[100:103], v[204:207], v[40:43], a[100:103]
  s_and_b32 s36, s36, 0x3fffff
  v_exp_f32 v224, v68
  v_add_f32 v53, v53, v221
  v_cvt_pk_bf16_f32 v47, v222, v223
  v_mfma_f32_16x16x32_bf16 a[104:107], v[204:207], v[72:75], a[104:107]
  v_exp_f32 v225, v69
  v_add_f32 v53, v53, v222
  v_add_f32 v53, v53, v223
  v_mfma_f32_16x16x32_bf16 a[108:111], v[204:207], v[104:107], a[108:111]
  ds_read_b64_tr_b16 v[184:185], v7 offset:0
  v_cvt_pk_bf16_f32 v78, v224, v225
  v_exp_f32 v226, v70
  v_mfma_f32_16x16x32_bf16 a[112:115], v[204:207], v[136:139], a[112:115]
  s_add_u32 s37, s6, s7
  v_exp_f32 v227, v71
  s_add_u32 m0, s30, s32
  v_add_f32 v85, v85, v224
  v_add_f32 v85, v85, v225
  ds_read_b64_tr_b16 v[186:187], v7 offset:4096
  v_mfma_f32_16x16x32_bf16 a[116:119], v[204:207], v[168:171], a[116:119]
  buffer_load_dwordx4 v15, s[8:11], s37 offen offset:0 lds
  v_exp_f32 v228, v100
  v_cvt_pk_bf16_f32 v79, v226, v227
  v_exp_f32 v229, v101
  s_waitcnt lgkmcnt(4)
  v_mfma_f32_16x16x32_bf16 a[120:123], v[208:211], v[40:43], a[120:123]
  ds_read_b64_tr_b16 v[188:189], v8 offset:0
  v_add_f32 v85, v85, v226
  v_add_f32 v85, v85, v227
  v_mfma_f32_16x16x32_bf16 a[124:127], v[208:211], v[72:75], a[124:127]
  v_exp_f32 v230, v102
  v_cvt_pk_bf16_f32 v110, v228, v229
  v_exp_f32 v231, v103
  v_mfma_f32_16x16x32_bf16 a[128:131], v[208:211], v[104:107], a[128:131]
  ds_read_b64_tr_b16 v[190:191], v8 offset:4096
  v_add_f32 v117, v117, v228
  v_add_f32 v117, v117, v229
  v_mfma_f32_16x16x32_bf16 a[132:135], v[208:211], v[136:139], a[132:135]
  buffer_load_dwordx4 v16, s[8:11], s37 offen offset:1024 lds
  v_exp_f32 v216, v132
  v_cvt_pk_bf16_f32 v111, v230, v231
  v_exp_f32 v217, v133
  v_mfma_f32_16x16x32_bf16 a[136:139], v[208:211], v[168:171], a[136:139]
  s_waitcnt lgkmcnt(4)
  v_exp_f32 v218, v134
  v_add_f32 v117, v117, v230
  v_add_f32 v117, v117, v231
  v_mfma_f32_16x16x32_bf16 a[140:143], v[212:215], v[40:43], a[140:143]
  ds_read_b64_tr_b16 v[192:193], v7 offset:256
  v_cvt_pk_bf16_f32 v142, v216, v217
  v_exp_f32 v219, v135
  v_mfma_f32_16x16x32_bf16 a[144:147], v[212:215], v[72:75], a[144:147]
  ds_read_b64_tr_b16 v[194:195], v7 offset:4352
  v_add_f32 v149, v149, v216
  v_add_f32 v149, v149, v217
  v_exp_f32 v220, v164
  v_mfma_f32_16x16x32_bf16 a[148:151], v[212:215], v[104:107], a[148:151]
  v_exp_f32 v221, v165
  v_cvt_pk_bf16_f32 v143, v218, v219
  v_mfma_f32_16x16x32_bf16 a[152:155], v[212:215], v[136:139], a[152:155]
  buffer_load_dwordx4 v17, s[8:11], s37 offen offset:2048 lds
  v_add_f32 v149, v149, v218
  v_add_f32 v149, v149, v219
  v_exp_f32 v222, v166
  v_mfma_f32_16x16x32_bf16 a[156:159], v[212:215], v[168:171], a[156:159]
  s_waitcnt lgkmcnt(4)
  v_exp_f32 v223, v167
  v_cvt_pk_bf16_f32 v174, v220, v221
  v_add_f32 v181, v181, v220
  v_add_f32 v181, v181, v221
  v_cvt_pk_bf16_f32 v175, v222, v223
  v_add_f32 v181, v181, v222
  v_add_f32 v181, v181, v223
  v_max3_f32 v248, v53, v85, v117
  v_max3_f32 v248, v248, v149, v181
  v_cmp_nge_f32 vcc, s42, v248
  s_nop 0
  s_cbranch_vccnz RARE1_11
RET_11:
  v_mfma_f32_16x16x32_bf16 a[0:3], v[184:187], v[44:47], a[0:3]
  ds_read_b64_tr_b16 v[196:197], v8 offset:256
  v_add_f32 v52, v52, v53
  v_mfma_f32_16x16x32_bf16 a[4:7], v[184:187], v[76:79], a[4:7]
  ds_read_b64_tr_b16 v[198:199], v8 offset:4352
  v_add_f32 v84, v84, v85
  v_mfma_f32_16x16x32_bf16 a[8:11], v[184:187], v[108:111], a[8:11]
  v_add_f32 v116, v116, v117
  v_add_f32 v148, v148, v149
  v_mfma_f32_16x16x32_bf16 a[12:15], v[184:187], v[140:143], a[12:15]
  buffer_load_dwordx4 v18, s[8:11], s37 offen offset:3072 lds
  v_mfma_f32_16x16x32_bf16 a[16:19], v[184:187], v[172:175], a[16:19]
  s_waitcnt lgkmcnt(4)
  v_add_f32 v180, v180, v181
  v_mov_b32 v53, v52
  v_mfma_f32_16x16x32_bf16 a[20:23], v[188:191], v[44:47], a[20:23]
  ds_read_b64_tr_b16 v[200:201], v7 offset:512
  v_mov_b32 v85, v84
  v_mov_b32 v117, v116
  v_mfma_f32_16x16x32_bf16 a[24:27], v[188:191], v[76:79], a[24:27]
  ds_read_b64_tr_b16 v[202:203], v7 offset:4608
  v_mov_b32 v149, v148
  v_mov_b32 v181, v180
  v_mfma_f32_16x16x32_bf16 a[28:31], v[188:191], v[108:111], a[28:31]
  s_add_u32 m0, m0, 0x1000
  v_permlane16_swap_b32 v52, v53
  v_permlane16_swap_b32 v84, v85
  v_mfma_f32_16x16x32_bf16 a[32:35], v[188:191], v[140:143], a[32:35]
  s_add_u32 s39, s37, 0x8000
  v_permlane16_swap_b32 v116, v117
  v_permlane16_swap_b32 v148, v149
  v_mfma_f32_16x16x32_bf16 a[36:39], v[188:191], v[172:175], a[36:39]
  buffer_load_dwordx4 v15, s[8:11], s39 offen lds
  v_permlane16_swap_b32 v180, v181
  v_add_f32 v52, v52, v53
  s_waitcnt lgkmcnt(4)
  v_mfma_f32_16x16x32_bf16 a[40:43], v[192:195], v[44:47], a[40:43]
  s_add_u32 s7, s7, 128
  v_add_f32 v84, v84, v85
  v_add_f32 v116, v116, v117
  v_mfma_f32_16x16x32_bf16 a[44:47], v[192:195], v[76:79], a[44:47]
  s_and_b32 s7, s7, 0x3ff
  v_add_f32 v148, v148, v149
  v_add_f32 v180, v180, v181
  v_mfma_f32_16x16x32_bf16 a[48:51], v[192:195], v[108:111], a[48:51]
  ds_read_b64_tr_b16 v[204:205], v8 offset:512
  v_mov_b32 v53, v52
  v_mov_b32 v85, v84
  v_mfma_f32_16x16x32_bf16 a[52:55], v[192:195], v[140:143], a[52:55]
  ds_read_b64_tr_b16 v[206:207], v8 offset:4608
  v_mov_b32 v117, v116
  v_mov_b32 v149, v148
  v_mov_b32 v181, v180
  v_mfma_f32_16x16x32_bf16 a[56:59], v[192:195], v[172:175], a[56:59]
  ds_read_b64_tr_b16 v[208:209], v7 offset:768
  v_permlane32_swap_b32 v52, v53
  v_permlane32_swap_b32 v84, v85
  s_waitcnt lgkmcnt(5)
  v_mfma_f32_16x16x32_bf16 a[60:63], v[196:199], v[44:47], a[60:63]
  ds_read_b64_tr_b16 v[210:211], v7 offset:4864
  v_permlane32_swap_b32 v116, v117
  v_permlane32_swap_b32 v148, v149
  v_mfma_f32_16x16x32_bf16 a[64:67], v[196:199], v[76:79], a[64:67]
  v_permlane32_swap_b32 v180, v181
  v_add_f32 v52, v52, v53
  v_mfma_f32_16x16x32_bf16 a[68:71], v[196:199], v[108:111], a[68:71]
  ds_read_b64_tr_b16 v[212:213], v8 offset:768
  v_add_f32 v84, v84, v85
  v_add_f32 v116, v116, v117
  v_mfma_f32_16x16x32_bf16 a[72:75], v[196:199], v[140:143], a[72:75]
  ds_read_b64_tr_b16 v[214:215], v8 offset:4864
  v_add_f32 v148, v148, v149
  v_add_f32 v180, v180, v181
  v_mfma_f32_16x16x32_bf16 a[76:79], v[196:199], v[172:175], a[76:79]
  s_waitcnt lgkmcnt(6)
  v_rcp_f32 v20, v52
  v_mfma_f32_16x16x32_bf16 a[80:83], v[200:203], v[44:47], a[80:83]
  s_add_u32 s30, s29, s31
  v_rcp_f32 v21, v84
  v_mfma_f32_16x16x32_bf16 a[84:87], v[200:203], v[76:79], a[84:87]
  s_add_u32 s29, s29, 53248
  v_rcp_f32 v22, v116
  v_mfma_f32_16x16x32_bf16 a[88:91], v[200:203], v[108:111], a[88:91]
  s_cmp_eq_u32 s29, 159744
  v_rcp_f32 v23, v148
  v_mfma_f32_16x16x32_bf16 a[92:95], v[200:203], v[140:143], a[92:95]
  s_cselect_b32 s29, 0, s29
  v_rcp_f32 v0, v180
  v_mfma_f32_16x16x32_bf16 a[96:99], v[200:203], v[172:175], a[96:99]
  s_waitcnt lgkmcnt(4)
  v_add_u32 v6, s29, v4
  v_add_u32 v7, s29, v5
  v_mfma_f32_16x16x32_bf16 a[100:103], v[204:207], v[44:47], a[100:103]
  s_waitcnt vmcnt(13) lgkmcnt(0)
  s_barrier
  s_mov_b32 m0, s30
  v_mfma_f32_16x16x32_bf16 a[104:107], v[204:207], v[76:79], a[104:107]
  ds_read_b64_tr_b16 v[184:185], v6 offset:0
  v_mfma_f32_16x16x32_bf16 a[108:111], v[204:207], v[108:111], a[108:111]
  ds_read_b64_tr_b16 v[186:187], v6 offset:1024
  v_mfma_f32_16x16x32_bf16 a[112:115], v[204:207], v[140:143], a[112:115]
  ds_read_b128 a[200:203], v7 offset:0
  v_mfma_f32_16x16x32_bf16 a[116:119], v[204:207], v[172:175], a[116:119]
  ds_read_b128 a[204:207], v7 offset:2048
  v_mfma_f32_16x16x32_bf16 a[120:123], v[208:211], v[44:47], a[120:123]
  buffer_load_dwordx4 v11, s[12:15], s36 offen offset:0 lds
  v_mfma_f32_16x16x32_bf16 a[124:127], v[208:211], v[76:79], a[124:127]
  ds_read_b128 a[208:211], v7 offset:4096
  v_mfma_f32_16x16x32_bf16 a[128:131], v[208:211], v[108:111], a[128:131]
  ds_read_b64_tr_b16 v[188:189], v6 offset:8
  v_mfma_f32_16x16x32_bf16 a[132:135], v[208:211], v[140:143], a[132:135]
  ds_read_b64_tr_b16 v[190:191], v6 offset:1032
  v_mfma_f32_16x16x32_bf16 a[136:139], v[208:211], v[172:175], a[136:139]
  ds_read_b128 a[212:215], v7 offset:6144
  v_mfma_f32_16x16x32_bf16 a[140:143], v[212:215], v[44:47], a[140:143]
  ds_read_b128 a[216:219], v7 offset:8192
  buffer_load_dwordx4 v12, s[12:15], s36 offen offset:1024 lds
  v_mfma_f32_16x16x32_bf16 a[144:147], v[212:215], v[76:79], a[144:147]
  ds_read_b64_tr_b16 v[192:193], v6 offset:256
  v_mfma_f32_16x16x32_bf16 a[148:151], v[212:215], v[108:111], a[148:151]
  ds_read_b64_tr_b16 v[194:195], v6 offset:1280
  v_mfma_f32_16x16x32_bf16 a[152:155], v[212:215], v[140:143], a[152:155]
  buffer_load_dwordx4 v13, s[12:15], s36 offen offset:2048 lds
  v_mfma_f32_16x16x32_bf16 a[156:159], v[212:215], v[172:175], a[156:159]
  s_waitcnt lgkmcnt(4)
  v_mfma_f32_16x16x32_bf16 v[24:27], v[184:187], a[200:203], 0
  s_waitcnt lgkmcnt(2)
  v_mfma_f32_16x16x32_bf16 v[28:31], v[188:191], a[200:203], 0
  ds_read_b64_tr_b16 v[196:197], v6 offset:264
  v_accvgpr_read_b32 v248, a80
  v_mfma_f32_16x16x32_bf16 v[60:63], v[188:191], a[204:207], 0
  ds_read_b64_tr_b16 v[198:199], v6 offset:1288
  v_accvgpr_read_b32 v249, a81
  v_mfma_f32_16x16x32_bf16 v[56:59], v[184:187], a[204:207], 0
  ds_read_b128 a[220:223], v7 offset:256
  v_accvgpr_read_b32 v250, a82
  v_mfma_f32_16x16x32_bf16 v[88:91], v[184:187], a[208:211], 0
  buffer_load_dwordx4 v14, s[12:15], s36 offen offset:3072 lds
  v_mfma_f32_16x16x32_bf16 v[92:95], v[188:191], a[208:211], 0
  ds_read_b64_tr_b16 v[200:201], v6 offset:512
  v_accvgpr_read_b32 v251, a83
  v_mfma_f32_16x16x32_bf16 v[124:127], v[188:191], a[212:215], 0
  ds_read_b64_tr_b16 v[202:203], v6 offset:1536
  v_accvgpr_read_b32 v252, a100
  v_mfma_f32_16x16x32_bf16 v[120:123], v[184:187], a[212:215], 0
  s_add_u32 s36, s36, 0x40000
  v_accvgpr_read_b32 v253, a101
  v_accvgpr_read_b32 v254, a102
  v_mfma_f32_16x16x32_bf16 v[152:155], v[184:187], a[216:219], 0
  s_add_u32 m0, s30, 16384
  v_accvgpr_read_b32 v255, a103
  v_mfma_f32_16x16x32_bf16 v[156:159], v[188:191], a[216:219], 0
  ds_read_b128 a[224:227], v7 offset:2304
  v_mul_f32 v248, v20, v248
  s_waitcnt lgkmcnt(6)
  v_mfma_f32_16x16x32_bf16 v[160:163], v[192:195], a[216:219], 0
  buffer_load_dwordx4 v11, s[12:15], s36 offen offset:0 lds
  s_waitcnt lgkmcnt(4)
  v_mfma_f32_16x16x32_bf16 v[164:167], v[196:199], a[216:219], 0
  v_mul_f32 v249, v20, v249
  v_mul_f32 v250, v20, v250
  v_mfma_f32_16x16x32_bf16 v[132:135], v[196:199], a[212:215], 0
  ds_read_b64_tr_b16 v[204:205], v6 offset:520
  v_mul_f32 v251, v20, v251
  v_mfma_f32_16x16x32_bf16 v[128:131], v[192:195], a[212:215], 0
  ds_read_b64_tr_b16 v[206:207], v6 offset:1544
  v_mul_f32 v252, v20, v252
  v_mfma_f32_16x16x32_bf16 v[96:99], v[192:195], a[208:211], 0
  ds_read_b128 a[228:231], v7 offset:4352
  v_mul_f32 v253, v20, v253
  v_mfma_f32_16x16x32_bf16 v[100:103], v[196:199], a[208:211], 0
  buffer_load_dwordx4 v12, s[12:15], s36 offen offset:1024 lds
  v_mfma_f32_16x16x32_bf16 v[68:71], v[196:199], a[204:207], 0
  ds_read_b64_tr_b16 v[208:209], v6 offset:768
  v_mul_f32 v254, v20, v254
  v_mfma_f32_16x16x32_bf16 v[64:67], v[192:195], a[204:207], 0
  ds_read_b64_tr_b16 v[210:211], v6 offset:1792
  v_mul_f32 v255, v20, v255
  v_mfma_f32_16x16x32_bf16 v[32:35], v[192:195], a[200:203], 0
  ds_read_b128 a[232:235], v7 offset:6400
  v_cvt_pk_bf16_f32 v224, v248, v249
  v_mfma_f32_16x16x32_bf16 v[36:39], v[196:199], a[200:203], 0
  buffer_load_dwordx4 v13, s[12:15], s36 offen offset:2048 lds
  s_waitcnt lgkmcnt(7)
  v_mfma_f32_16x16x32_bf16 v[40:43], v[200:203], a[200:203], 0
  ds_read_b64_tr_b16 v[212:213], v6 offset:776
  v_cvt_pk_bf16_f32 v225, v250, v251
  s_waitcnt lgkmcnt(5)
  v_mfma_f32_16x16x32_bf16 v[44:47], v[204:207], a[200:203], 0
  v_cvt_pk_bf16_f32 v226, v252, v253
  v_cvt_pk_bf16_f32 v227, v254, v255
  v_mfma_f32_16x16x32_bf16 v[76:79], v[204:207], a[204:207], 0
  ds_read_b64_tr_b16 v[214:215], v6 offset:1800
  v_accvgpr_write_b32 a80, v224
  v_mfma_f32_16x16x32_bf16 v[72:75], v[200:203], a[204:207], 0
  ds_read_b128 a[236:239], v7 offset:8448
  v_accvgpr_write_b32 a81, v225
  v_mfma_f32_16x16x32_bf16 v[104:107], v[200:203], a[208:211], 0
  buffer_load_dwordx4 v14, s[12:15], s36 offen offset:3072 lds
  v_mfma_f32_16x16x32_bf16 v[108:111], v[204:207], a[208:211], 0
  s_add_u32 s36, s36, 0x40000
  v_accvgpr_write_b32 a82, v226
  v_accvgpr_write_b32 a83, v227
  v_mfma_f32_16x16x32_bf16 v[140:143], v[204:207], a[212:215], 0
  s_and_b32 s36, s36, 0x3fffff
  v_accvgpr_read_b32 v248, a84
  v_accvgpr_read_b32 v249, a85
  v_mfma_f32_16x16x32_bf16 v[136:139], v[200:203], a[212:215], 0
  ds_read_b64_tr_b16 v[184:185], v6 offset:16384
  v_accvgpr_read_b32 v250, a86
  v_mfma_f32_16x16x32_bf16 v[168:171], v[200:203], a[216:219], 0
  s_add_u32 s37, s6, s7
  v_accvgpr_read_b32 v251, a87
  s_add_u32 m0, s30, s32
  ds_read_b64_tr_b16 v[186:187], v6 offset:17408
  v_mfma_f32_16x16x32_bf16 v[172:175], v[204:207], a[216:219], 0
  buffer_load_dwordx4 v15, s[8:11], s37 offen offset:0 lds
  s_waitcnt lgkmcnt(6)
  v_mfma_f32_16x16x32_bf16 v[176:179], v[208:211], a[216:219], 0
  ds_read_b64_tr_b16 v[188:189], v6 offset:16392
  v_accvgpr_read_b32 v252, a104
  s_waitcnt lgkmcnt(4)
  v_mfma_f32_16x16x32_bf16 v[180:183], v[212:215], a[216:219], 0
  v_accvgpr_read_b32 v253, a105
  v_accvgpr_read_b32 v254, a106
  v_mfma_f32_16x16x32_bf16 v[148:151], v[212:215], a[212:215], 0
  ds_read_b64_tr_b16 v[190:191], v6 offset:17416
  v_accvgpr_read_b32 v255, a107
  v_mfma_f32_16x16x32_bf16 v[144:147], v[208:211], a[212:215], 0
  buffer_load_dwordx4 v16, s[8:11], s37 offen offset:1024 lds
  v_mfma_f32_16x16x32_bf16 v[112:115], v[208:211], a[208:211], 0
  v_mul_f32 v248, v21, v248
  v_mul_f32 v249, v21, v249
  v_mfma_f32_16x16x32_bf16 v[116:119], v[212:215], a[208:211], 0
  ds_read_b64_tr_b16 v[192:193], v6 offset:16640
  v_mul_f32 v250, v21, v250
  v_mfma_f32_16x16x32_bf16 v[84:87], v[212:215], a[204:207], 0
  ds_read_b64_tr_b16 v[194:195], v6 offset:17664
  v_mul_f32 v251, v21, v251
  v_mfma_f32_16x16x32_bf16 v[80:83], v[208:211], a[204:207], 0
  v_mul_f32 v252, v21, v252
  v_mul_f32 v253, v21, v253
  v_mfma_f32_16x16x32_bf16 v[48:51], v[208:211], a[200:203], 0
  buffer_load_dwordx4 v17, s[8:11], s37 offen offset:2048 lds
  v_mfma_f32_16x16x32_bf16 v[52:55], v[212:215], a[200:203], 0
  s_waitcnt lgkmcnt(6)
  v_mul_f32 v254, v21, v254
  v_mul_f32 v255, v21, v255
  s_waitcnt lgkmcnt(4)
  v_mfma_f32_16x16x32_bf16 v[24:27], v[184:187], a[220:223], v[24:27]
  ds_read_b64_tr_b16 v[196:197], v6 offset:16648
  v_cvt_pk_bf16_f32 v228, v248, v249
  s_waitcnt lgkmcnt(3)
  v_mfma_f32_16x16x32_bf16 v[28:31], v[188:191], a[220:223], v[28:31]
  v_cvt_pk_bf16_f32 v229, v250, v251
  v_mfma_f32_16x16x32_bf16 v[60:63], v[188:191], a[224:227], v[60:63]
  ds_read_b64_tr_b16 v[198:199], v6 offset:17672
  v_cvt_pk_bf16_f32 v230, v252, v253
  v_mfma_f32_16x16x32_bf16 v[56:59], v[184:187], a[224:227], v[56:59]
  buffer_load_dwordx4 v18, s[8:11], s37 offen offset:3072 lds
  v_mfma_f32_16x16x32_bf16 v[88:91], v[184:187], a[228:231], v[88:91]
  s_add_u32 m0, m0, 0x1000
  v_cvt_pk_bf16_f32 v231, v254, v255
  v_accvgpr_write_b32 a84, v228
  v_mfma_f32_16x16x32_bf16 v[92:95], v[188:191], a[228:231], v[92:95]
  ds_read_b64_tr_b16 v[200:201], v6 offset:16896
  v_accvgpr_write_b32 a85, v229
  v_mfma_f32_16x16x32_bf16 v[124:127], v[188:191], a[232:235], v[124:127]
  ds_read_b64_tr_b16 v[202:203], v6 offset:17920
  v_accvgpr_write_b32 a86, v230
  v_mfma_f32_16x16x32_bf16 v[120:123], v[184:187], a[232:235], v[120:123]
  s_add_u32 s39, s37, 0x8000
  v_accvgpr_write_b32 a87, v231
  s_add_u32 s7, s7, 128
  v_mfma_f32_16x16x32_bf16 v[152:155], v[184:187], a[236:239], v[152:155]
  buffer_load_dwordx4 v15, s[8:11], s39 offen lds
  v_mfma_f32_16x16x32_bf16 v[156:159], v[188:191], a[236:239], v[156:159]
  s_and_b32 s7, s7, 0x3ff
  v_accvgpr_read_b32 v248, a88
  v_accvgpr_read_b32 v249, a89
  s_waitcnt lgkmcnt(4)
  v_mfma_f32_16x16x32_bf16 v[160:163], v[192:195], a[236:239], v[160:163]
  ds_read_b64_tr_b16 v[204:205], v6 offset:16904
  v_accvgpr_read_b32 v250, a90
  s_waitcnt lgkmcnt(3)
  v_mfma_f32_16x16x32_bf16 v[164:167], v[196:199], a[236:239], v[164:167]
  v_accvgpr_read_b32 v251, a91
  v_mfma_f32_16x16x32_bf16 v[132:135], v[196:199], a[232:235], v[132:135]
  ds_read_b64_tr_b16 v[206:207], v6 offset:17928
  v_accvgpr_read_b32 v252, a108
  v_mfma_f32_16x16x32_bf16 v[128:131], v[192:195], a[232:235], v[128:131]
  ds_read_b64_tr_b16 v[208:209], v6 offset:17152
  v_accvgpr_read_b32 v253, a109
  v_mfma_f32_16x16x32_bf16 v[96:99], v[192:195], a[228:231], v[96:99]
  ds_read_b64_tr_b16 v[210:211], v6 offset:18176
  v_accvgpr_read_b32 v254, a110
  v_mfma_f32_16x16x32_bf16 v[100:103], v[196:199], a[228:231], v[100:103]
  ds_read_b64_tr_b16 v[212:213], v6 offset:17160
  v_accvgpr_read_b32 v255, a111
  v_mfma_f32_16x16x32_bf16 v[68:71], v[196:199], a[224:227], v[68:71]
  ds_read_b64_tr_b16 v[214:215], v6 offset:18184
  v_mul_f32 v248, v22, v248
  v_mfma_f32_16x16x32_bf16 v[64:67], v[192:195], a[224:227], v[64:67]
  s_add_u32 s30, s29, s31
  v_mul_f32 v249, v22, v249
  s_add_u32 s29, s29, 53248
  v_mfma_f32_16x16x32_bf16 v[32:35], v[192:195], a[220:223], v[32:35]
  s_cmp_eq_u32 s29, 159744
  v_mul_f32 v250, v22, v250
  s_cselect_b32 s29, 0, s29
  v_mfma_f32_16x16x32_bf16 v[36:39], v[196:199], a[220:223], v[36:39]
  s_waitcnt lgkmcnt(4)
  v_mul_f32 v251, v22, v251
  v_mul_f32 v252, v22, v252
  v_mfma_f32_16x16x32_bf16 v[40:43], v[200:203], a[220:223], v[40:43]
  v_add_u32 v6, s29, v4
  v_mul_f32 v253, v22, v253
  v_mfma_f32_16x16x32_bf16 v[44:47], v[204:207], a[220:223], v[44:47]
  v_add_u32 v7, s29, v5
  v_mul_f32 v254, v22, v254
  v_mfma_f32_16x16x32_bf16 v[76:79], v[204:207], a[224:227], v[76:79]
  v_mul_f32 v255, v22, v255
  v_mfma_f32_16x16x32_bf16 v[72:75], v[200:203], a[224:227], v[72:75]
  s_mov_b32 m0, s30
  v_cvt_pk_bf16_f32 v216, v248, v249
  v_mfma_f32_16x16x32_bf16 v[104:107], v[200:203], a[228:231], v[104:107]
K1_JOIN:
  s_waitcnt vmcnt(13) lgkmcnt(0)
  s_barrier
  v_cvt_pk_bf16_f32 v217, v250, v251
  v_mfma_f32_16x16x32_bf16 v[108:111], v[204:207], a[228:231], v[108:111]
  ds_read_b64_tr_b16 v[184:185], v6 offset:0
  v_cvt_pk_bf16_f32 v218, v252, v253
  v_mfma_f32_16x16x32_bf16 v[140:143], v[204:207], a[232:235], v[140:143]
  ds_read_b64_tr_b16 v[186:187], v6 offset:1024
  v_cvt_pk_bf16_f32 v219, v254, v255
  v_mfma_f32_16x16x32_bf16 v[136:139], v[200:203], a[232:235], v[136:139]
  ds_read_b128 a[200:203], v7 offset:0
  v_accvgpr_write_b32 a88, v216
  v_mfma_f32_16x16x32_bf16 v[168:171], v[200:203], a[236:239], v[168:171]
  ds_read_b128 a[204:207], v7 offset:2048
  v_accvgpr_write_b32 a89, v217
  v_mfma_f32_16x16x32_bf16 v[172:175], v[204:207], a[236:239], v[172:175]
  buffer_load_dwordx4 v11, s[12:15], s36 offen offset:0 lds
  v_mfma_f32_16x16x32_bf16 v[176:179], v[208:211], a[236:239], v[176:179]
  ds_read_b128 a[208:211], v7 offset:4096
  v_accvgpr_write_b32 a90, v218
  v_mfma_f32_16x16x32_bf16 v[180:183], v[212:215], a[236:239], v[180:183]
  v_accvgpr_write_b32 a91, v219
  v_accvgpr_read_b32 v248, a92
  v_mfma_f32_16x16x32_bf16 v[148:151], v[212:215], a[232:235], v[148:151]
  ds_read_b64_tr_b16 v[188:189], v6 offset:8
  v_accvgpr_read_b32 v249, a93
  v_mfma_f32_16x16x32_bf16 v[144:147], v[208:211], a[232:235], v[144:147]
  ds_read_b64_tr_b16 v[190:191], v6 offset:1032
  v_accvgpr_read_b32 v250, a94
  v_mfma_f32_16x16x32_bf16 v[112:115], v[208:211], a[228:231], v[112:115]
  ds_read_b128 a[212:215], v7 offset:6144
  v_accvgpr_read_b32 v251, a95
  v_mfma_f32_16x16x32_bf16 v[116:119], v[212:215], a[228:231], v[116:119]
  ds_read_b128 a[216:219], v7 offset:8192
  v_accvgpr_read_b32 v252, a112
  buffer_load_dwordx4 v12, s[12:15], s36 offen offset:1024 lds
  v_mfma_f32_16x16x32_bf16 v[84:87], v[212:215], a[224:227], v[84:87]
  ds_read_b64_tr_b16 v[192:193], v6 offset:256
  v_accvgpr_read_b32 v253, a113
  v_mfma_f32_16x16x32_bf16 v[80:83], v[208:211], a[224:227], v[80:83]
  ds_read_b64_tr_b16 v[194:195], v6 offset:1280
  v_accvgpr_read_b32 v254, a114
  v_mfma_f32_16x16x32_bf16 v[48:51], v[208:211], a[220:223], v[48:51]
  buffer_load_dwordx4 v13, s[12:15], s36 offen offset:2048 lds
  v_mfma_f32_16x16x32_bf16 v[52:55], v[212:215], a[220:223], v[52:55]
  s_waitcnt lgkmcnt(4)
  v_accvgpr_read_b32 v255, a115
  v_mul_f32 v248, v23, v248
  v_mfma_f32_16x16x32_bf16 v[24:27], v[184:187], a[200:203], v[24:27]
  s_waitcnt lgkmcnt(2)
  v_mul_f32 v249, v23, v249
  v_mfma_f32_16x16x32_bf16 v[28:31], v[188:191], a[200:203], v[28:31]
  ds_read_b64_tr_b16 v[196:197], v6 offset:264
  v_mul_f32 v250, v23, v250
  v_mfma_f32_16x16x32_bf16 v[60:63], v[188:191], a[204:207], v[60:63]
  ds_read_b64_tr_b16 v[198:199], v6 offset:1288
  v_mul_f32 v251, v23, v251
  v_mfma_f32_16x16x32_bf16 v[56:59], v[184:187], a[204:207], v[56:59]
  ds_read_b128 a[220:223], v7 offset:256
  v_mul_f32 v252, v23, v252
  v_mfma_f32_16x16x32_bf16 v[88:91], v[184:187], a[208:211], v[88:91]
  buffer_load_dwordx4 v14, s[12:15], s36 offen offset:3072 lds
  v_mfma_f32_16x16x32_bf16 v[92:95], v[188:191], a[208:211], v[92:95]
  ds_read_b64_tr_b16 v[200:201], v6 offset:512
  v_mul_f32 v253, v23, v253
  v_mfma_f32_16x16x32_bf16 v[124:127], v[188:191], a[212:215], v[124:127]
  ds_read_b64_tr_b16 v[202:203], v6 offset:1536
  v_mul_f32 v254, v23, v254
  v_mfma_f32_16x16x32_bf16 v[120:123], v[184:187], a[212:215], v[120:123]
  s_add_u32 s36, s36, 0x40000
  v_mul_f32 v255, v23, v255
  v_cvt_pk_bf16_f32 v220, v248, v249
  v_mfma_f32_16x16x32_bf16 v[152:155], v[184:187], a[216:219], v[152:155]
  s_add_u32 m0, s30, 16384
  v_cvt_pk_bf16_f32 v221, v250, v251
  v_cvt_pk_bf16_f32 v222, v252, v253
  v_mfma_f32_16x16x32_bf16 v[156:159], v[188:191], a[216:219], v[156:159]
  ds_read_b128 a[224:227], v7 offset:2304
  v_cvt_pk_bf16_f32 v223, v254, v255
  s_waitcnt lgkmcnt(6)
  v_mfma_f32_16x16x32_bf16 v[160:163], v[192:195], a[216:219], v[160:163]
  buffer_load_dwordx4 v11, s[12:15], s36 offen offset:0 lds
  s_waitcnt lgkmcnt(4)
  v_mfma_f32_16x16x32_bf16 v[164:167], v[196:199], a[216:219], v[164:167]
  v_accvgpr_write_b32 a92, v220
  v_accvgpr_write_b32 a93, v221
  v_mfma_f32_16x16x32_bf16 v[132:135], v[196:199], a[212:215], v[132:135]
  ds_read_b64_tr_b16 v[204:205], v6 offset:520
  v_accvgpr_write_b32 a94, v222
  v_mfma_f32_16x16x32_bf16 v[128:131], v[192:195], a[212:215], v[128:131]
  ds_read_b64_tr_b16 v[206:207], v6 offset:1544
  v_accvgpr_write_b32 a95, v223
  v_mfma_f32_16x16x32_bf16 v[96:99], v[192:195], a[208:211], v[96:99]
  ds_read_b128 a[228:231], v7 offset:4352
  v_accvgpr_read_b32 v248, a96
  v_mfma_f32_16x16x32_bf16 v[100:103], v[196:199], a[208:211], v[100:103]
  buffer_load_dwordx4 v12, s[12:15], s36 offen offset:1024 lds
  v_mfma_f32_16x16x32_bf16 v[68:71], v[196:199], a[204:207], v[68:71]
  ds_read_b64_tr_b16 v[208:209], v6 offset:768
  v_accvgpr_read_b32 v249, a97
  v_mfma_f32_16x16x32_bf16 v[64:67], v[192:195], a[204:207], v[64:67]
  ds_read_b64_tr_b16 v[210:211], v6 offset:1792
  v_accvgpr_read_b32 v250, a98
  v_mfma_f32_16x16x32_bf16 v[32:35], v[192:195], a[200:203], v[32:35]
  ds_read_b128 a[232:235], v7 offset:6400
  v_accvgpr_read_b32 v251, a99
  v_mfma_f32_16x16x32_bf16 v[36:39], v[196:199], a[200:203], v[36:39]
  buffer_load_dwordx4 v13, s[12:15], s36 offen offset:2048 lds
  s_waitcnt lgkmcnt(7)
  v_mfma_f32_16x16x32_bf16 v[40:43], v[200:203], a[200:203], v[40:43]
  ds_read_b64_tr_b16 v[212:213], v6 offset:776
  v_accvgpr_read_b32 v252, a116
  s_waitcnt lgkmcnt(5)
  v_mfma_f32_16x16x32_bf16 v[44:47], v[204:207], a[200:203], v[44:47]
  v_accvgpr_read_b32 v253, a117
  v_accvgpr_read_b32 v254, a118
  v_mfma_f32_16x16x32_bf16 v[76:79], v[204:207], a[204:207], v[76:79]
  ds_read_b64_tr_b16 v[214:215], v6 offset:1800
  v_accvgpr_read_b32 v255, a119
  v_mfma_f32_16x16x32_bf16 v[72:75], v[200:203], a[204:207], v[72:75]
  ds_read_b128 a[236:239], v7 offset:8448
  v_mul_f32 v248, v0, v248
  v_mfma_f32_16x16x32_bf16 v[104:107], v[200:203], a[208:211], v[104:107]
  buffer_load_dwordx4 v14, s[12:15], s36 offen offset:3072 lds
  v_mfma_f32_16x16x32_bf16 v[108:111], v[204:207], a[208:211], v[108:111]
  s_add_u32 s36, s36, 0x40000
  v_mul_f32 v249, v0, v249
  v_mul_f32 v250, v0, v250
  v_mfma_f32_16x16x32_bf16 v[140:143], v[204:207], a[212:215], v[140:143]
  s_and_b32 s36, s36, 0x3fffff
  v_mul_f32 v251, v0, v251
  v_mul_f32 v252, v0, v252
  v_mfma_f32_16x16x32_bf16 v[136:139], v[200:203], a[212:215], v[136:139]
  ds_read_b64_tr_b16 v[184:185], v6 offset:16384
  v_mul_f32 v253, v0, v253
  v_mfma_f32_16x16x32_bf16 v[168:171], v[200:203], a[216:219], v[168:171]
  s_add_u32 s37, s6, s7
  v_mul_f32 v254, v0, v254
  s_add_u32 m0, s30, s32
  ds_read_b64_tr_b16 v[186:187], v6 offset:17408
  v_mfma_f32_16x16x32_bf16 v[172:175], v[204:207], a[216:219], v[172:175]
  buffer_load_dwordx4 v15, s[8:11], s37 offen offset:0 lds
  s_waitcnt lgkmcnt(6)
  v_mfma_f32_16x16x32_bf16 v[176:179], v[208:211], a[216:219], v[176:179]
  ds_read_b64_tr_b16 v[188:189], v6 offset:16392
  v_mul_f32 v255, v0, v255
  s_waitcnt lgkmcnt(4)
  v_mfma_f32_16x16x32_bf16 v[180:183], v[212:215], a[216:219], v[180:183]
  v_cvt_pk_bf16_f32 v224, v248, v249
  v_cvt_pk_bf16_f32 v225, v250, v251
  v_mfma_f32_16x16x32_bf16 v[148:151], v[212:215], a[212:215], v[148:151]
  ds_read_b64_tr_b16 v[190:191], v6 offset:17416
  v_cvt_pk_bf16_f32 v226, v252, v253
  v_mfma_f32_16x16x32_bf16 v[144:147], v[208:211], a[212:215], v[144:147]
  buffer_load_dwordx4 v16, s[8:11], s37 offen offset:1024 lds
  v_mfma_f32_16x16x32_bf16 v[112:115], v[208:211], a[208:211], v[112:115]
  v_cvt_pk_bf16_f32 v227, v254, v255
  v_accvgpr_write_b32 a96, v224
  v_mfma_f32_16x16x32_bf16 v[116:119], v[212:215], a[208:211], v[116:119]
  ds_read_b64_tr_b16 v[192:193], v6 offset:16640
  v_accvgpr_write_b32 a97, v225
  v_mfma_f32_16x16x32_bf16 v[84:87], v[212:215], a[204:207], v[84:87]
  ds_read_b64_tr_b16 v[194:195], v6 offset:17664
  v_accvgpr_write_b32 a98, v226
  v_mfma_f32_16x16x32_bf16 v[80:83], v[208:211], a[204:207], v[80:83]
  v_accvgpr_write_b32 a99, v227
  v_accvgpr_read_b32 v248, a0
  v_mfma_f32_16x16x32_bf16 v[48:51], v[208:211], a[200:203], v[48:51]
  buffer_load_dwordx4 v17, s[8:11], s37 offen offset:2048 lds
  v_mfma_f32_16x16x32_bf16 v[52:55], v[212:215], a[200:203], v[52:55]
  s_waitcnt lgkmcnt(6)
  v_accvgpr_read_b32 v249, a1
  v_accvgpr_read_b32 v250, a2
  s_waitcnt lgkmcnt(4)
  v_mfma_f32_16x16x32_bf16 v[24:27], v[184:187], a[220:223], v[24:27]
  ds_read_b64_tr_b16 v[196:197], v6 offset:16648
  v_accvgpr_read_b32 v251, a3
  s_waitcnt lgkmcnt(3)
  v_mfma_f32_16x16x32_bf16 v[28:31], v[188:191], a[220:223], v[28:31]
  v_accvgpr_read_b32 v252, a20
  v_mfma_f32_16x16x32_bf16 v[60:63], v[188:191], a[224:227], v[60:63]
  ds_read_b64_tr_b16 v[198:199], v6 offset:17672
  v_accvgpr_read_b32 v253, a21
  v_mfma_f32_16x16x32_bf16 v[56:59], v[184:187], a[224:227], v[56:59]
  buffer_load_dwordx4 v18, s[8:11], s37 offen offset:3072 lds
  v_mfma_f32_16x16x32_bf16 v[88:91], v[184:187], a[228:231], v[88:91]
  s_add_u32 m0, m0, 0x1000
  v_accvgpr_read_b32 v254, a22
  v_accvgpr_read_b32 v255, a23
  v_mfma_f32_16x16x32_bf16 v[92:95], v[188:191], a[228:231], v[92:95]
  ds_read_b64_tr_b16 v[200:201], v6 offset:16896
  v_mul_f32 v248, v20, v248
  v_mfma_f32_16x16x32_bf16 v[124:127], v[188:191], a[232:235], v[124:127]
  ds_read_b64_tr_b16 v[202:203], v6 offset:17920
  v_mul_f32 v249, v20, v249
  v_mfma_f32_16x16x32_bf16 v[120:123], v[184:187], a[232:235], v[120:123]
  s_add_u32 s39, s37, 0x8000
  v_mul_f32 v250, v20, v250
  s_add_u32 s7, s7, 128
  v_mfma_f32_16x16x32_bf16 v[152:155], v[184:187], a[236:239], v[152:155]
  buffer_load_dwordx4 v15, s[8:11], s39 offen lds
  v_mfma_f32_16x16x32_bf16 v[156:159], v[188:191], a[236:239], v[156:159]
  s_and_b32 s7, s7, 0x3ff
  v_mul_f32 v251, v20, v251
  v_mul_f32 v252, v20, v252
  s_waitcnt lgkmcnt(4)
  v_mfma_f32_16x16x32_bf16 v[160:163], v[192:195], a[236:239], v[160:163]
  ds_read_b64_tr_b16 v[204:205], v6 offset:16904
  v_mul_f32 v253, v20, v253
  s_waitcnt lgkmcnt(3)
  v_mfma_f32_16x16x32_bf16 v[164:167], v[196:199], a[236:239], v[164:167]
  v_mul_f32 v254, v20, v254
  v_mfma_f32_16x16x32_bf16 v[132:135], v[196:199], a[232:235], v[132:135]
  ds_read_b64_tr_b16 v[206:207], v6 offset:17928
  v_mul_f32 v255, v20, v255
  v_mfma_f32_16x16x32_bf16 v[128:131], v[192:195], a[232:235], v[128:131]
  ds_read_b64_tr_b16 v[208:209], v6 offset:17152
  v_cvt_pk_bf16_f32 v216, v248, v249
  v_mfma_f32_16x16x32_bf16 v[96:99], v[192:195], a[228:231], v[96:99]
  ds_read_b64_tr_b16 v[210:211], v6 offset:18176
  v_cvt_pk_bf16_f32 v217, v250, v251
  v_mfma_f32_16x16x32_bf16 v[100:103], v[196:199], a[228:231], v[100:103]
  ds_read_b64_tr_b16 v[212:213], v6 offset:17160
  v_cvt_pk_bf16_f32 v218, v252, v253
  v_mfma_f32_16x16x32_bf16 v[68:71], v[196:199], a[224:227], v[68:71]
  ds_read_b64_tr_b16 v[214:215], v6 offset:18184
  v_cvt_pk_bf16_f32 v219, v254, v255
  v_mfma_f32_16x16x32_bf16 v[64:67], v[192:195], a[224:227], v[64:67]
  s_add_u32 s30, s29, s31
  v_accvgpr_write_b32 a0, v216
  s_add_u32 s29, s29, 53248
  v_mfma_f32_16x16x32_bf16 v[32:35], v[192:195], a[220:223], v[32:35]
  s_cmp_eq_u32 s29, 159744
  v_accvgpr_write_b32 a1, v217
  s_cselect_b32 s29, 0, s29
  v_mfma_f32_16x16x32_bf16 v[36:39], v[196:199], a[220:223], v[36:39]
  s_waitcnt lgkmcnt(4)
  v_accvgpr_write_b32 a2, v218
  v_mfma_f32_16x16x32_bf16 v[40:43], v[200:203], a[220:223], v[40:43]
  v_accvgpr_write_b32 a3, v219
  v_add_u32 v6, s29, v4
  v_mfma_f32_16x16x32_bf16 v[44:47], v[204:207], a[220:223], v[44:47]
  v_add_u32 v7, s29, v5
  v_accvgpr_read_b32 v248, a4
  v_mfma_f32_16x16x32_bf16 v[76:79], v[204:207], a[224:227], v[76:79]
  v_accvgpr_read_b32 v249, a5
  v_mfma_f32_16x16x32_bf16 v[72:75], v[200:203], a[224:227], v[72:75]
  s_mov_b32 m0, s30
  v_accvgpr_read_b32 v250, a6
  v_mfma_f32_16x16x32_bf16 v[104:107], v[200:203], a[228:231], v[104:107]
  s_waitcnt vmcnt(13) lgkmcnt(0)
  s_barrier
  v_accvgpr_read_b32 v251, a7
  v_mfma_f32_16x16x32_bf16 v[108:111], v[204:207], a[228:231], v[108:111]
  ds_read_b64_tr_b16 v[184:185], v6 offset:0
  v_accvgpr_read_b32 v252, a24
  v_mfma_f32_16x16x32_bf16 v[140:143], v[204:207], a[232:235], v[140:143]
  ds_read_b64_tr_b16 v[186:187], v6 offset:1024
  v_accvgpr_read_b32 v253, a25
  v_mfma_f32_16x16x32_bf16 v[136:139], v[200:203], a[232:235], v[136:139]
  ds_read_b128 a[200:203], v7 offset:0
  v_accvgpr_read_b32 v254, a26
  v_mfma_f32_16x16x32_bf16 v[168:171], v[200:203], a[236:239], v[168:171]
  ds_read_b128 a[204:207], v7 offset:2048
  v_accvgpr_read_b32 v255, a27
  v_mfma_f32_16x16x32_bf16 v[172:175], v[204:207], a[236:239], v[172:175]
  buffer_load_dwordx4 v11, s[12:15], s36 offen offset:0 lds
  v_mfma_f32_16x16x32_bf16 v[176:179], v[208:211], a[236:239], v[176:179]
  ds_read_b128 a[208:211], v7 offset:4096
  v_mul_f32 v248, v21, v248
  v_mfma_f32_16x16x32_bf16 v[180:183], v[212:215], a[236:239], v[180:183]
  v_mul_f32 v249, v21, v249
  v_mul_f32 v250, v21, v250
  v_mfma_f32_16x16x32_bf16 v[148:151], v[212:215], a[232:235], v[148:151]
  ds_read_b64_tr_b16 v[188:189], v6 offset:8
  v_mul_f32 v251, v21, v251
  v_mfma_f32_16x16x32_bf16 v[144:147], v[208:211], a[232:235], v[144:147]
  ds_read_b64_tr_b16 v[190:191], v6 offset:1032
  v_mul_f32 v252, v21, v252
  v_mfma_f32_16x16x32_bf16 v[112:115], v[208:211], a[228:231], v[112:115]
  ds_read_b128 a[212:215], v7 offset:6144
  v_mul_f32 v253, v21, v253
  v_mfma_f32_16x16x32_bf16 v[116:119], v[212:215], a[228:231], v[116:119]
  ds_read_b128 a[216:219], v7 offset:8192
  v_mul_f32 v254, v21, v254
  buffer_load_dwordx4 v12, s[12:15], s36 offen offset:1024 lds
  v_mfma_f32_16x16x32_bf16 v[84:87], v[212:215], a[224:227], v[84:87]
  ds_read_b64_tr_b16 v[192:193], v6 offset:256
  v_mul_f32 v255, v21, v255
  v_mfma_f32_16x16x32_bf16 v[80:83], v[208:211], a[224:227], v[80:83]
  ds_read_b64_tr_b16 v[194:195], v6 offset:1280
  v_cvt_pk_bf16_f32 v220, v248, v249
  v_mfma_f32_16x16x32_bf16 v[48:51], v[208:211], a[220:223], v[48:51]
  buffer_load_dwordx4 v13, s[12:15], s36 offen offset:2048 lds
  v_mfma_f32_16x16x32_bf16 v[52:55], v[212:215], a[220:223], v[52:55]
  s_waitcnt lgkmcnt(4)
  v_cvt_pk_bf16_f32 v221, v250, v251
  v_cvt_pk_bf16_f32 v222, v252, v253
  v_mfma_f32_16x16x32_bf16 v[24:27], v[184:187], a[200:203], v[24:27]
  s_waitcnt lgkmcnt(2)
  v_cvt_pk_bf16_f32 v223, v254, v255
  v_accvgpr_write_b32 a4, v220
  v_mfma_f32_16x16x32_bf16 v[28:31], v[188:191], a[200:203], v[28:31]
  v_accvgpr_write_b32 a5, v221
  v_mfma_f32_16x16x32_bf16 v[60:63], v[188:191], a[204:207], v[60:63]
  ds_read_b64_tr_b16 v[196:197], v6 offset:264
  v_accvgpr_write_b32 a6, v222
  v_mfma_f32_16x16x32_bf16 v[56:59], v[184:187], a[204:207], v[56:59]
  ds_read_b64_tr_b16 v[198:199], v6 offset:1288
  v_accvgpr_write_b32 a7, v223
  v_mfma_f32_16x16x32_bf16 v[88:91], v[184:187], a[208:211], v[88:91]
  ds_read_b128 a[220:223], v7 offset:256
  v_accvgpr_read_b32 v248, a8
  v_mfma_f32_16x16x32_bf16 v[92:95], v[188:191], a[208:211], v[92:95]
  buffer_load_dwordx4 v14, s[12:15], s36 offen offset:3072 lds
  v_mfma_f32_16x16x32_bf16 v[124:127], v[188:191], a[212:215], v[124:127]
  ds_read_b64_tr_b16 v[200:201], v6 offset:512
  v_accvgpr_read_b32 v249, a9
  v_mfma_f32_16x16x32_bf16 v[120:123], v[184:187], a[212:215], v[120:123]
  s_add_u32 s36, s36, 0x40000
  v_accvgpr_read_b32 v250, a10
  v_accvgpr_read_b32 v251, a11
  v_mfma_f32_16x16x32_bf16 v[152:155], v[184:187], a[216:219], v[152:155]
  s_add_u32 m0, s30, 16384
  v_accvgpr_read_b32 v252, a28
  ds_read_b64_tr_b16 v[202:203], v6 offset:1536
  v_mfma_f32_16x16x32_bf16 v[156:159], v[188:191], a[216:219], v[156:159]
  ds_read_b128 a[224:227], v7 offset:2304
  v_accvgpr_read_b32 v253, a29
  s_waitcnt lgkmcnt(6)
  v_mfma_f32_16x16x32_bf16 v[160:163], v[192:195], a[216:219], v[160:163]
  buffer_load_dwordx4 v11, s[12:15], s36 offen offset:0 lds
  s_waitcnt lgkmcnt(4)
  v_mfma_f32_16x16x32_bf16 v[164:167], v[196:199], a[216:219], v[164:167]
  v_accvgpr_read_b32 v254, a30
  v_accvgpr_read_b32 v255, a31
  v_mfma_f32_16x16x32_bf16 v[132:135], v[196:199], a[212:215], v[132:135]
  ds_read_b64_tr_b16 v[204:205], v6 offset:520
  v_mul_f32 v248, v22, v248
  v_mfma_f32_16x16x32_bf16 v[128:131], v[192:195], a[212:215], v[128:131]
  ds_read_b64_tr_b16 v[206:207], v6 offset:1544
  v_mul_f32 v249, v22, v249
  v_mfma_f32_16x16x32_bf16 v[96:99], v[192:195], a[208:211], v[96:99]
  ds_read_b128 a[228:231], v7 offset:4352
  v_mul_f32 v250, v22, v250
  v_mfma_f32_16x16x32_bf16 v[100:103], v[196:199], a[208:211], v[100:103]
  buffer_load_dwordx4 v12, s[12:15], s36 offen offset:1024 lds
  v_mfma_f32_16x16x32_bf16 v[68:71], v[196:199], a[204:207], v[68:71]
  ds_read_b64_tr_b16 v[208:209], v6 offset:768
  v_mul_f32 v251, v22, v251
  v_mfma_f32_16x16x32_bf16 v[64:67], v[192:195], a[204:207], v[64:67]
  ds_read_b64_tr_b16 v[210:211], v6 offset:1792
  v_mul_f32 v252, v22, v252
  v_mfma_f32_16x16x32_bf16 v[32:35], v[192:195], a[200:203], v[32:35]
  ds_read_b128 a[232:235], v7 offset:6400
  v_mul_f32 v253, v22, v253
  v_mfma_f32_16x16x32_bf16 v[36:39], v[196:199], a[200:203], v[36:39]
  buffer_load_dwordx4 v13, s[12:15], s36 offen offset:2048 lds
  s_waitcnt lgkmcnt(7)
  v_mfma_f32_16x16x32_bf16 v[40:43], v[200:203], a[200:203], v[40:43]
  ds_read_b64_tr_b16 v[212:213], v6 offset:776
  v_mul_f32 v254, v22, v254
  s_waitcnt lgkmcnt(5)
  v_mfma_f32_16x16x32_bf16 v[44:47], v[204:207], a[200:203], v[44:47]
  v_mul_f32 v255, v22, v255
  v_cvt_pk_bf16_f32 v224, v248, v249
  v_mfma_f32_16x16x32_bf16 v[76:79], v[204:207], a[204:207], v[76:79]
  ds_read_b64_tr_b16 v[214:215], v6 offset:1800
  v_cvt_pk_bf16_f32 v225, v250, v251
  v_mfma_f32_16x16x32_bf16 v[72:75], v[200:203], a[204:207], v[72:75]
  ds_read_b128 a[236:239], v7 offset:8448
  v_cvt_pk_bf16_f32 v226, v252, v253
  v_mfma_f32_16x16x32_bf16 v[104:107], v[200:203], a[208:211], v[104:107]
  buffer_load_dwordx4 v14, s[12:15], s36 offen offset:3072 lds
  v_mfma_f32_16x16x32_bf16 v[108:111], v[204:207], a[208:211], v[108:111]
  s_add_u32 s36, s36, 0x40000
  v_cvt_pk_bf16_f32 v227, v254, v255
  v_accvgpr_write_b32 a8, v224
  v_mfma_f32_16x16x32_bf16 v[140:143], v[204:207], a[212:215], v[140:143]
  s_and_b32 s36, s36, 0x3fffff
  v_accvgpr_write_b32 a9, v225
  v_accvgpr_write_b32 a10, v226
  v_mfma_f32_16x16x32_bf16 v[136:139], v[200:203], a[212:215], v[136:139]
  ds_read_b64_tr_b16 v[184:185], v6 offset:16384
  v_accvgpr_write_b32 a11, v227
  v_mfma_f32_16x16x32_bf16 v[168:171], v[200:203], a[216:219], v[168:171]
  s_add_u32 s37, s6, s7
  v_accvgpr_read_b32 v248, a12
  v_accvgpr_read_b32 v249, a13
  s_add_u32 m0, s30, s32
  ds_read_b64_tr_b16 v[186:187], v6 offset:17408
  v_mfma_f32_16x16x32_bf16 v[172:175], v[204:207], a[216:219], v[172:175]
  buffer_load_dwordx4 v15, s[8:11], s37 offen offset:0 lds
  s_waitcnt lgkmcnt(6)
  v_mfma_f32_16x16x32_bf16 v[176:179], v[208:211], a[216:219], v[176:179]
  ds_read_b64_tr_b16 v[188:189], v6 offset:16392
  v_accvgpr_read_b32 v250, a14
  s_waitcnt lgkmcnt(4)
  v_mfma_f32_16x16x32_bf16 v[180:183], v[212:215], a[216:219], v[180:183]
  v_accvgpr_read_b32 v251, a15
  v_accvgpr_read_b32 v252, a32
  v_mfma_f32_16x16x32_bf16 v[148:151], v[212:215], a[212:215], v[148:151]
  ds_read_b64_tr_b16 v[190:191], v6 offset:17416
  v_accvgpr_read_b32 v253, a33
  v_mfma_f32_16x16x32_bf16 v[144:147], v[208:211], a[212:215], v[144:147]
  buffer_load_dwordx4 v16, s[8:11], s37 offen offset:1024 lds
  v_mfma_f32_16x16x32_bf16 v[112:115], v[208:211], a[208:211], v[112:115]
  v_accvgpr_read_b32 v254, a34
  v_accvgpr_read_b32 v255, a35
  v_mfma_f32_16x16x32_bf16 v[116:119], v[212:215], a[208:211], v[116:119]
  ds_read_b64_tr_b16 v[192:193], v6 offset:16640
  v_mul_f32 v248, v23, v248
  v_mfma_f32_16x16x32_bf16 v[84:87], v[212:215], a[204:207], v[84:87]
  ds_read_b64_tr_b16 v[194:195], v6 offset:17664
  v_mul_f32 v249, v23, v249
  v_mfma_f32_16x16x32_bf16 v[80:83], v[208:211], a[204:207], v[80:83]
  v_mul_f32 v250, v23, v250
  v_mfma_f32_16x16x32_bf16 v[48:51], v[208:211], a[200:203], v[48:51]
  buffer_load_dwordx4 v17, s[8:11], s37 offen offset:2048 lds
  v_mfma_f32_16x16x32_bf16 v[52:55], v[212:215], a[200:203], v[52:55]
  s_waitcnt lgkmcnt(6)
  v_mul_f32 v251, v23, v251
  v_mul_f32 v252, v23, v252
  s_waitcnt lgkmcnt(4)
  v_mfma_f32_16x16x32_bf16 v[24:27], v[184:187], a[220:223], v[24:27]
  ds_read_b64_tr_b16 v[196:197], v6 offset:16648
  v_mul_f32 v253, v23, v253
  s_waitcnt lgkmcnt(3)
  v_mfma_f32_16x16x32_bf16 v[28:31], v[188:191], a[220:223], v[28:31]
  v_mul_f32 v254, v23, v254
  v_mfma_f32_16x16x32_bf16 v[60:63], v[188:191], a[224:227], v[60:63]
  ds_read_b64_tr_b16 v[198:199], v6 offset:17672
  v_mul_f32 v255, v23, v255
  v_mfma_f32_16x16x32_bf16 v[56:59], v[184:187], a[224:227], v[56:59]
  buffer_load_dwordx4 v18, s[8:11], s37 offen offset:3072 lds
  v_mfma_f32_16x16x32_bf16 v[88:91], v[184:187], a[228:231], v[88:91]
  s_add_u32 m0, m0, 0x1000
  v_cvt_pk_bf16_f32 v228, v248, v249
  v_cvt_pk_bf16_f32 v229, v250, v251
  v_mfma_f32_16x16x32_bf16 v[92:95], v[188:191], a[228:231], v[92:95]
  ds_read_b64_tr_b16 v[200:201], v6 offset:16896
  v_cvt_pk_bf16_f32 v230, v252, v253
  v_mfma_f32_16x16x32_bf16 v[124:127], v[188:191], a[232:235], v[124:127]
  ds_read_b64_tr_b16 v[202:203], v6 offset:17920
  v_cvt_pk_bf16_f32 v231, v254, v255
  v_mfma_f32_16x16x32_bf16 v[120:123], v[184:187], a[232:235], v[120:123]
  s_add_u32 s39, s37, 0x8000
  v_accvgpr_write_b32 a12, v228
  v_accvgpr_write_b32 a13, v229
  v_mfma_f32_16x16x32_bf16 v[152:155], v[184:187], a[236:239], v[152:155]
  buffer_load_dwordx4 v15, s[8:11], s39 offen lds
  v_mfma_f32_16x16x32_bf16 v[156:159], v[188:191], a[236:239], v[156:159]
  s_add_u32 s7, s7, 128
  v_accvgpr_write_b32 a14, v230
  v_accvgpr_write_b32 a15, v231
  s_waitcnt lgkmcnt(4)
  v_mfma_f32_16x16x32_bf16 v[160:163], v[192:195], a[236:239], v[160:163]
  s_and_b32 s7, s7, 0x3ff
  v_accvgpr_read_b32 v248, a16
  s_waitcnt lgkmcnt(2)
  v_mfma_f32_16x16x32_bf16 v[164:167], v[196:199], a[236:239], v[164:167]
  v_accvgpr_read_b32 v249, a17
  v_mfma_f32_16x16x32_bf16 v[132:135], v[196:199], a[232:235], v[132:135]
  ds_read_b64_tr_b16 v[204:205], v6 offset:16904
  v_accvgpr_read_b32 v250, a18
  v_mfma_f32_16x16x32_bf16 v[128:131], v[192:195], a[232:235], v[128:131]
  ds_read_b64_tr_b16 v[206:207], v6 offset:17928
  v_accvgpr_read_b32 v251, a19
  v_mfma_f32_16x16x32_bf16 v[96:99], v[192:195], a[228:231], v[96:99]
  ds_read_b64_tr_b16 v[208:209], v6 offset:17152
  v_accvgpr_read_b32 v252, a36
  v_mfma_f32_16x16x32_bf16 v[100:103], v[196:199], a[228:231], v[100:103]
  ds_read_b64_tr_b16 v[210:211], v6 offset:18176
  v_accvgpr_read_b32 v253, a37
  v_mfma_f32_16x16x32_bf16 v[68:71], v[196:199], a[224:227], v[68:71]
  ds_read_b64_tr_b16 v[212:213], v6 offset:17160
  v_accvgpr_read_b32 v254, a38
  v_mfma_f32_16x16x32_bf16 v[64:67], v[192:195], a[224:227], v[64:67]
  ds_read_b64_tr_b16 v[214:215], v6 offset:18184
  v_accvgpr_read_b32 v255, a39
  v_mfma_f32_16x16x32_bf16 v[32:35], v[192:195], a[220:223], v[32:35]
  s_add_u32 s30, s29, s31
  v_mul_f32 v248, v0, v248
  s_add_u32 s29, s29, 53248
  v_mfma_f32_16x16x32_bf16 v[36:39], v[196:199], a[220:223], v[36:39]
  s_waitcnt lgkmcnt(4)
  v_mul_f32 v249, v0, v249
  v_mfma_f32_16x16x32_bf16 v[40:43], v[200:203], a[220:223], v[40:43]
  s_cmp_eq_u32 s29, 159744
  v_mul_f32 v250, v0, v250
  s_cselect_b32 s29, 0, s29
  v_mfma_f32_16x16x32_bf16 v[44:47], v[204:207], a[220:223], v[44:47]
  v_add_u32 v6, s29, v4
  v_add_u32 v7, s29, v5
  v_mfma_f32_16x16x32_bf16 v[76:79], v[204:207], a[224:227], v[76:79]
  v_mul_f32 v251, v0, v251
  v_mul_f32 v252, v0, v252
  v_mfma_f32_16x16x32_bf16 v[72:75], v[200:203], a[224:227], v[72:75]
  s_mov_b32 m0, s30
  v_mul_f32 v253, v0, v253
  v_mfma_f32_16x16x32_bf16 v[104:107], v[200:203], a[228:231], v[104:107]
  s_waitcnt vmcnt(13) lgkmcnt(0)
  s_barrier
  v_mul_f32 v254, v0, v254
  v_mfma_f32_16x16x32_bf16 v[108:111], v[204:207], a[228:231], v[108:111]
  ds_read_b64_tr_b16 v[184:185], v6 offset:0
  v_mul_f32 v255, v0, v255
  v_mfma_f32_16x16x32_bf16 v[140:143], v[204:207], a[232:235], v[140:143]
  ds_read_b64_tr_b16 v[186:187], v6 offset:1024
  v_cvt_pk_bf16_f32 v216, v248, v249
  v_mfma_f32_16x16x32_bf16 v[136:139], v[200:203], a[232:235], v[136:139]
  ds_read_b128 a[200:203], v7 offset:0
  v_cvt_pk_bf16_f32 v217, v250, v251
  v_mfma_f32_16x16x32_bf16 v[168:171], v[200:203], a[236:239], v[168:171]
  ds_read_b128 a[204:207], v7 offset:2048
  v_cvt_pk_bf16_f32 v218, v252, v253
  v_mfma_f32_16x16x32_bf16 v[172:175], v[204:207], a[236:239], v[172:175]
  buffer_load_dwordx4 v11, s[12:15], s36 offen offset:0 lds
  v_mfma_f32_16x16x32_bf16 v[176:179], v[208:211], a[236:239], v[176:179]
  ds_read_b128 a[208:211], v7 offset:4096
  v_cvt_pk_bf16_f32 v219, v254, v255
  v_mfma_f32_16x16x32_bf16 v[180:183], v[212:215], a[236:239], v[180:183]
  v_accvgpr_write_b32 a16, v216
  v_accvgpr_write_b32 a17, v217
  v_mfma_f32_16x16x32_bf16 v[148:151], v[212:215], a[232:235], v[148:151]
  ds_read_b64_tr_b16 v[188:189], v6 offset:8
  v_accvgpr_write_b32 a18, v218
  v_mfma_f32_16x16x32_bf16 v[144:147], v[208:211], a[232:235], v[144:147]
  ds_read_b64_tr_b16 v[190:191], v6 offset:1032
  v_accvgpr_write_b32 a19, v219
  v_mfma_f32_16x16x32_bf16 v[112:115], v[208:211], a[228:231], v[112:115]
  ds_read_b128 a[212:215], v7 offset:6144
  v_accvgpr_read_b32 v248, a40
  v_mfma_f32_16x16x32_bf16 v[116:119], v[212:215], a[228:231], v[116:119]
  ds_read_b128 a[216:219], v7 offset:8192
  v_accvgpr_read_b32 v249, a41
  buffer_load_dwordx4 v12, s[12:15], s36 offen offset:1024 lds
  v_mfma_f32_16x16x32_bf16 v[84:87], v[212:215], a[224:227], v[84:87]
  ds_read_b64_tr_b16 v[192:193], v6 offset:256
  v_accvgpr_read_b32 v250, a42
  v_mfma_f32_16x16x32_bf16 v[80:83], v[208:211], a[224:227], v[80:83]
  ds_read_b64_tr_b16 v[194:195], v6 offset:1280
  v_accvgpr_read_b32 v251, a43
  v_mfma_f32_16x16x32_bf16 v[48:51], v[208:211], a[220:223], v[48:51]
  buffer_load_dwordx4 v13, s[12:15], s36 offen offset:2048 lds
  v_mfma_f32_16x16x32_bf16 v[52:55], v[212:215], a[220:223], v[52:55]
  s_waitcnt lgkmcnt(4)
  v_accvgpr_read_b32 v252, a60
  v_accvgpr_read_b32 v253, a61
  v_mfma_f32_16x16x32_bf16 v[24:27], v[184:187], a[200:203], v[24:27]
  s_waitcnt lgkmcnt(2)
  v_accvgpr_read_b32 v254, a62
  v_accvgpr_read_b32 v255, a63
  v_mfma_f32_16x16x32_bf16 v[28:31], v[188:191], a[200:203], v[28:31]
  v_mul_f32 v248, v20, v248
  v_mfma_f32_16x16x32_bf16 v[60:63], v[188:191], a[204:207], v[60:63]
  ds_read_b64_tr_b16 v[196:197], v6 offset:264
  v_mul_f32 v249, v20, v249
  v_mfma_f32_16x16x32_bf16 v[56:59], v[184:187], a[204:207], v[56:59]
  ds_read_b64_tr_b16 v[198:199], v6 offset:1288
  v_mul_f32 v250, v20, v250
  v_mfma_f32_16x16x32_bf16 v[88:91], v[184:187], a[208:211], v[88:91]
  ds_read_b128 a[220:223], v7 offset:256
  v_mul_f32 v251, v20, v251
  v_mfma_f32_16x16x32_bf16 v[92:95], v[188:191], a[208:211], v[92:95]
  buffer_load_dwordx4 v14, s[12:15], s36 offen offset:3072 lds
  v_mfma_f32_16x16x32_bf16 v[124:127], v[188:191], a[212:215], v[124:127]
  ds_read_b64_tr_b16 v[200:201], v6 offset:512
  v_mul_f32 v252, v20, v252
  v_mfma_f32_16x16x32_bf16 v[120:123], v[184:187], a[212:215], v[120:123]
  s_add_u32 s36, s36, 0x40000
  v_mul_f32 v253, v20, v253
  v_mul_f32 v254, v20, v254
  v_mfma_f32_16x16x32_bf16 v[152:155], v[184:187], a[216:219], v[152:155]
  s_add_u32 m0, s30, 16384
  v_mul_f32 v255, v20, v255
  ds_read_b64_tr_b16 v[202:203], v6 offset:1536
  v_mfma_f32_16x16x32_bf16 v[156:159], v[188:191], a[216:219], v[156:159]
  ds_read_b128 a[224:227], v7 offset:2304
  v_cvt_pk_bf16_f32 v220, v248, v249
  s_waitcnt lgkmcnt(6)
  v_mfma_f32_16x16x32_bf16 v[160:163], v[192:195], a[216:219], v[160:163]
  buffer_load_dwordx4 v11, s[12:15], s36 offen offset:0 lds
  s_waitcnt lgkmcnt(4)
  v_mfma_f32_16x16x32_bf16 v[164:167], v[196:199], a[216:219], v[164:167]
  v_cvt_pk_bf16_f32 v221, v250, v251
  v_cvt_pk_bf16_f32 v222, v252, v253
  v_mfma_f32_16x16x32_bf16 v[132:135], v[196:199], a[212:215], v[132:135]
  ds_read_b64_tr_b16 v[204:205], v6 offset:520
  v_cvt_pk_bf16_f32 v223, v254, v255
  v_mfma_f32_16x16x32_bf16 v[128:131], v[192:195], a[212:215], v[128:131]
  ds_read_b64_tr_b16 v[206:207], v6 offset:1544
  v_accvgpr_write_b32 a40, v220
  v_mfma_f32_16x16x32_bf16 v[96:99], v[192:195], a[208:211], v[96:99]
  ds_read_b128 a[228:231], v7 offset:4352
  v_accvgpr_write_b32 a41, v221
  v_mfma_f32_16x16x32_bf16 v[100:103], v[196:199], a[208:211], v[100:103]
  buffer_load_dwordx4 v12, s[12:15], s36 offen offset:1024 lds
  v_mfma_f32_16x16x32_bf16 v[68:71], v[196:199], a[204:207], v[68:71]
  ds_read_b64_tr_b16 v[208:209], v6 offset:768
  v_accvgpr_write_b32 a42, v222
  v_mfma_f32_16x16x32_bf16 v[64:67], v[192:195], a[204:207], v[64:67]
  ds_read_b64_tr_b16 v[210:211], v6 offset:1792
  v_accvgpr_write_b32 a43, v223
  v_mfma_f32_16x16x32_bf16 v[32:35], v[192:195], a[200:203], v[32:35]
  ds_read_b128 a[232:235], v7 offset:6400
  v_accvgpr_read_b32 v248, a44
  v_mfma_f32_16x16x32_bf16 v[36:39], v[196:199], a[200:203], v[36:39]
  buffer_load_dwordx4 v13, s[12:15], s36 offen offset:2048 lds
  s_waitcnt lgkmcnt(7)
  v_mfma_f32_16x16x32_bf16 v[40:43], v[200:203], a[200:203], v[40:43]
  ds_read_b64_tr_b16 v[212:213], v6 offset:776
  v_accvgpr_read_b32 v249, a45
  s_waitcnt lgkmcnt(5)
  v_mfma_f32_16x16x32_bf16 v[44:47], v[204:207], a[200:203], v[44:47]
  v_accvgpr_read_b32 v250, a46
  v_accvgpr_read_b32 v251, a47
  v_mfma_f32_16x16x32_bf16 v[76:79], v[204:207], a[204:207], v[76:79]
  ds_read_b64_tr_b16 v[214:215], v6 offset:1800
  v_accvgpr_read_b32 v252, a64
  v_mfma_f32_16x16x32_bf16 v[72:75], v[200:203], a[204:207], v[72:75]
  ds_read_b128 a[236:239], v7 offset:8448
  v_accvgpr_read_b32 v253, a65
  v_mfma_f32_16x16x32_bf16 v[104:107], v[200:203], a[208:211], v[104:107]
  buffer_load_dwordx4 v14, s[12:15], s36 offen offset:3072 lds
  v_mfma_f32_16x16x32_bf16 v[108:111], v[204:207], a[208:211], v[108:111]
  s_add_u32 s36, s36, 0x40000
  v_accvgpr_read_b32 v254, a66
  v_accvgpr_read_b32 v255, a67
  v_mfma_f32_16x16x32_bf16 v[140:143], v[204:207], a[212:215], v[140:143]
  s_and_b32 s36, s36, 0x3fffff
  v_mul_f32 v248, v21, v248
  v_mul_f32 v249, v21, v249
  v_mfma_f32_16x16x32_bf16 v[136:139], v[200:203], a[212:215], v[136:139]
  ds_read_b64_tr_b16 v[184:185], v6 offset:16384
  v_mul_f32 v250, v21, v250
  v_mfma_f32_16x16x32_bf16 v[168:171], v[200:203], a[216:219], v[168:171]
  s_add_u32 s37, s6, s7
  v_mul_f32 v251, v21, v251
  v_mul_f32 v252, v21, v252
  s_add_u32 m0, s30, s32
  ds_read_b64_tr_b16 v[186:187], v6 offset:17408
  v_mfma_f32_16x16x32_bf16 v[172:175], v[204:207], a[216:219], v[172:175]
  buffer_load_dwordx4 v15, s[8:11], s37 offen offset:0 lds
  s_waitcnt lgkmcnt(6)
  v_mfma_f32_16x16x32_bf16 v[176:179], v[208:211], a[216:219], v[176:179]
  ds_read_b64_tr_b16 v[188:189], v6 offset:16392
  v_mul_f32 v253, v21, v253
  s_waitcnt lgkmcnt(4)
  v_mfma_f32_16x16x32_bf16 v[180:183], v[212:215], a[216:219], v[180:183]
  v_mul_f32 v254, v21, v254
  v_mul_f32 v255, v21, v255
  v_mfma_f32_16x16x32_bf16 v[148:151], v[212:215], a[212:215], v[148:151]
  ds_read_b64_tr_b16 v[190:191], v6 offset:17416
  v_cvt_pk_bf16_f32 v224, v248, v249
  v_mfma_f32_16x16x32_bf16 v[144:147], v[208:211], a[212:215], v[144:147]
  buffer_load_dwordx4 v16, s[8:11], s37 offen offset:1024 lds
  v_mfma_f32_16x16x32_bf16 v[112:115], v[208:211], a[208:211], v[112:115]
  v_cvt_pk_bf16_f32 v225, v250, v251
  v_cvt_pk_bf16_f32 v226, v252, v253
  v_mfma_f32_16x16x32_bf16 v[116:119], v[212:215], a[208:211], v[116:119]
  ds_read_b64_tr_b16 v[192:193], v6 offset:16640
  v_cvt_pk_bf16_f32 v227, v254, v255
  v_mfma_f32_16x16x32_bf16 v[84:87], v[212:215], a[204:207], v[84:87]
  ds_read_b64_tr_b16 v[194:195], v6 offset:17664
  v_accvgpr_write_b32 a44, v224
  v_mfma_f32_16x16x32_bf16 v[80:83], v[208:211], a[204:207], v[80:83]
  v_accvgpr_write_b32 a45, v225
  v_mfma_f32_16x16x32_bf16 v[48:51], v[208:211], a[200:203], v[48:51]
  buffer_load_dwordx4 v17, s[8:11], s37 offen offset:2048 lds
  v_mfma_f32_16x16x32_bf16 v[52:55], v[212:215], a[200:203], v[52:55]
  s_waitcnt lgkmcnt(6)
  v_accvgpr_write_b32 a46, v226
  v_accvgpr_write_b32 a47, v227
  s_waitcnt lgkmcnt(4)
  v_mfma_f32_16x16x32_bf16 v[24:27], v[184:187], a[220:223], v[24:27]
  ds_read_b64_tr_b16 v[196:197], v6 offset:16648
  v_accvgpr_read_b32 v248, a48
  s_waitcnt lgkmcnt(3)
  v_mfma_f32_16x16x32_bf16 v[28:31], v[188:191], a[220:223], v[28:31]
  v_accvgpr_read_b32 v249, a49
  v_mfma_f32_16x16x32_bf16 v[60:63], v[188:191], a[224:227], v[60:63]
  ds_read_b64_tr_b16 v[198:199], v6 offset:17672
  v_accvgpr_read_b32 v250, a50
  v_mfma_f32_16x16x32_bf16 v[56:59], v[184:187], a[224:227], v[56:59]
  buffer_load_dwordx4 v18, s[8:11], s37 offen offset:3072 lds
  v_mfma_f32_16x16x32_bf16 v[88:91], v[184:187], a[228:231], v[88:91]
  s_add_u32 m0, m0, 0x1000
  v_accvgpr_read_b32 v251, a51
  v_accvgpr_read_b32 v252, a68
  v_mfma_f32_16x16x32_bf16 v[92:95], v[188:191], a[228:231], v[92:95]
  ds_read_b64_tr_b16 v[200:201], v6 offset:16896
  v_accvgpr_read_b32 v253, a69
  v_mfma_f32_16x16x32_bf16 v[124:127], v[188:191], a[232:235], v[124:127]
  ds_read_b64_tr_b16 v[202:203], v6 offset:17920
  v_accvgpr_read_b32 v254, a70
  v_mfma_f32_16x16x32_bf16 v[120:123], v[184:187], a[232:235], v[120:123]
  s_add_u32 s39, s37, 0x8000
  v_accvgpr_read_b32 v255, a71
  s_add_u32 s7, s7, 128
  v_mfma_f32_16x16x32_bf16 v[152:155], v[184:187], a[236:239], v[152:155]
  buffer_load_dwordx4 v15, s[8:11], s39 offen lds
  v_mfma_f32_16x16x32_bf16 v[156:159], v[188:191], a[236:239], v[156:159]
  s_and_b32 s7, s7, 0x3ff
  v_mul_f32 v248, v22, v248
  v_mul_f32 v249, v22, v249
  s_waitcnt lgkmcnt(4)
  v_mfma_f32_16x16x32_bf16 v[160:163], v[192:195], a[236:239], v[160:163]
  ds_read_b64_tr_b16 v[204:205], v6 offset:16904
  v_mul_f32 v250, v22, v250
  s_waitcnt lgkmcnt(3)
  v_mfma_f32_16x16x32_bf16 v[164:167], v[196:199], a[236:239], v[164:167]
  v_mul_f32 v251, v22, v251
  v_mul_f32 v252, v22, v252
  v_mfma_f32_16x16x32_bf16 v[132:135], v[196:199], a[232:235], v[132:135]
  ds_read_b64_tr_b16 v[206:207], v6 offset:17928
  v_mul_f32 v253, v22, v253
  v_mfma_f32_16x16x32_bf16 v[128:131], v[192:195], a[232:235], v[128:131]
  ds_read_b64_tr_b16 v[208:209], v6 offset:17152
  v_mul_f32 v254, v22, v254
  v_mfma_f32_16x16x32_bf16 v[96:99], v[192:195], a[228:231], v[96:99]
  ds_read_b64_tr_b16 v[210:211], v6 offset:18176
  v_mul_f32 v255, v22, v255
  v_mfma_f32_16x16x32_bf16 v[100:103], v[196:199], a[228:231], v[100:103]
  ds_read_b64_tr_b16 v[212:213], v6 offset:17160
  v_cvt_pk_bf16_f32 v228, v248, v249
  v_mfma_f32_16x16x32_bf16 v[68:71], v[196:199], a[224:227], v[68:71]
  ds_read_b64_tr_b16 v[214:215], v6 offset:18184
  v_cvt_pk_bf16_f32 v229, v250, v251
  v_mfma_f32_16x16x32_bf16 v[64:67], v[192:195], a[224:227], v[64:67]
  s_add_u32 s30, s29, s31
  v_cvt_pk_bf16_f32 v230, v252, v253
  s_add_u32 s29, s29, 53248
  v_mfma_f32_16x16x32_bf16 v[32:35], v[192:195], a[220:223], v[32:35]
  s_cmp_eq_u32 s29, 159744
  v_cvt_pk_bf16_f32 v231, v254, v255
  s_cselect_b32 s29, 0, s29
  v_mfma_f32_16x16x32_bf16 v[36:39], v[196:199], a[220:223], v[36:39]
  s_waitcnt lgkmcnt(4)
  v_accvgpr_write_b32 a48, v228
  v_mfma_f32_16x16x32_bf16 v[40:43], v[200:203], a[220:223], v[40:43]
  v_add_u32 v6, s29, v4
  v_accvgpr_write_b32 a49, v229
  v_mfma_f32_16x16x32_bf16 v[44:47], v[204:207], a[220:223], v[44:47]
  v_add_u32 v7, s29, v5
  v_accvgpr_write_b32 a50, v230
  v_mfma_f32_16x16x32_bf16 v[76:79], v[204:207], a[224:227], v[76:79]
  v_accvgpr_write_b32 a51, v231
  v_mfma_f32_16x16x32_bf16 v[72:75], v[200:203], a[224:227], v[72:75]
  s_mov_b32 m0, s30
  v_accvgpr_read_b32 v248, a52
  v_mfma_f32_16x16x32_bf16 v[104:107], v[200:203], a[228:231], v[104:107]
  s_waitcnt vmcnt(13) lgkmcnt(0)
  s_barrier
  v_accvgpr_read_b32 v249, a53
  v_mfma_f32_16x16x32_bf16 v[108:111], v[204:207], a[228:231], v[108:111]
  ds_read_b64_tr_b16 v[184:185], v6 offset:0
  v_accvgpr_read_b32 v250, a54
  v_mfma_f32_16x16x32_bf16 v[140:143], v[204:207], a[232:235], v[140:143]
  ds_read_b64_tr_b16 v[186:187], v6 offset:1024
  v_accvgpr_read_b32 v251, a55
  v_mfma_f32_16x16x32_bf16 v[136:139], v[200:203], a[232:235], v[136:139]
  ds_read_b128 a[200:203], v7 offset:0
  v_accvgpr_read_b32 v252, a72
  v_mfma_f32_16x16x32_bf16 v[168:171], v[200:203], a[236:239], v[168:171]
  ds_read_b128 a[204:207], v7 offset:2048
  v_accvgpr_read_b32 v253, a73
  v_mfma_f32_16x16x32_bf16 v[172:175], v[204:207], a[236:239], v[172:175]
  buffer_load_dwordx4 v11, s[12:15], s36 offen offset:0 lds
  v_mfma_f32_16x16x32_bf16 v[176:179], v[208:211], a[236:239], v[176:179]
  ds_read_b128 a[208:211], v7 offset:4096
  v_accvgpr_read_b32 v254, a74
  v_mfma_f32_16x16x32_bf16 v[180:183], v[212:215], a[236:239], v[180:183]
  v_accvgpr_read_b32 v255, a75
  v_mul_f32 v248, v23, v248
  v_mfma_f32_16x16x32_bf16 v[148:151], v[212:215], a[232:235], v[148:151]
  ds_read_b64_tr_b16 v[188:189], v6 offset:8
  v_mul_f32 v249, v23, v249
  v_mfma_f32_16x16x32_bf16 v[144:147], v[208:211], a[232:235], v[144:147]
  ds_read_b64_tr_b16 v[190:191], v6 offset:1032
  v_mul_f32 v250, v23, v250
  v_mfma_f32_16x16x32_bf16 v[112:115], v[208:211], a[228:231], v[112:115]
  ds_read_b128 a[212:215], v7 offset:6144
  v_mul_f32 v251, v23, v251
  v_mfma_f32_16x16x32_bf16 v[116:119], v[212:215], a[228:231], v[116:119]
  ds_read_b128 a[216:219], v7 offset:8192
  v_mul_f32 v252, v23, v252
  buffer_load_dwordx4 v12, s[12:15], s36 offen offset:1024 lds
  v_mfma_f32_16x16x32_bf16 v[84:87], v[212:215], a[224:227], v[84:87]
  ds_read_b64_tr_b16 v[192:193], v6 offset:256
  v_mul_f32 v253, v23, v253
  v_mfma_f32_16x16x32_bf16 v[80:83], v[208:211], a[224:227], v[80:83]
  ds_read_b64_tr_b16 v[194:195], v6 offset:1280
  v_mul_f32 v254, v23, v254
  v_mfma_f32_16x16x32_bf16 v[48:51], v[208:211], a[220:223], v[48:51]
  buffer_load_dwordx4 v13, s[12:15], s36 offen offset:2048 lds
  v_mfma_f32_16x16x32_bf16 v[52:55], v[212:215], a[220:223], v[52:55]
  s_waitcnt lgkmcnt(4)
  v_mul_f32 v255, v23, v255
  v_cvt_pk_bf16_f32 v216, v248, v249
  v_mfma_f32_16x16x32_bf16 v[24:27], v[184:187], a[200:203], v[24:27]
  s_waitcnt lgkmcnt(2)
  v_cvt_pk_bf16_f32 v217, v250, v251
  v_cvt_pk_bf16_f32 v218, v252, v253
  v_mfma_f32_16x16x32_bf16 v[28:31], v[188:191], a[200:203], v[28:31]
  v_cvt_pk_bf16_f32 v219, v254, v255
  v_mfma_f32_16x16x32_bf16 v[60:63], v[188:191], a[204:207], v[60:63]
  ds_read_b64_tr_b16 v[196:197], v6 offset:264
  v_accvgpr_write_b32 a52, v216
  v_mfma_f32_16x16x32_bf16 v[56:59], v[184:187], a[204:207], v[56:59]
  ds_read_b64_tr_b16 v[198:199], v6 offset:1288
  v_accvgpr_write_b32 a53, v217
  v_mfma_f32_16x16x32_bf16 v[88:91], v[184:187], a[208:211], v[88:91]
  ds_read_b128 a[220:223], v7 offset:256
  v_accvgpr_write_b32 a54, v218
  v_mfma_f32_16x16x32_bf16 v[92:95], v[188:191], a[208:211], v[92:95]
  buffer_load_dwordx4 v14, s[12:15], s36 offen offset:3072 lds
  v_mfma_f32_16x16x32_bf16 v[124:127], v[188:191], a[212:215], v[124:127]
  ds_read_b64_tr_b16 v[200:201], v6 offset:512
  v_accvgpr_write_b32 a55, v219
  v_mfma_f32_16x16x32_bf16 v[120:123], v[184:187], a[212:215], v[120:123]
  s_add_u32 s36, s36, 0x40000
  v_accvgpr_read_b32 v248, a56
  v_accvgpr_read_b32 v249, a57
  v_mfma_f32_16x16x32_bf16 v[152:155], v[184:187], a[216:219], v[152:155]
  s_add_u32 m0, s30, 16384
  v_accvgpr_read_b32 v250, a58
  ds_read_b64_tr_b16 v[202:203], v6 offset:1536
  v_mfma_f32_16x16x32_bf16 v[156:159], v[188:191], a[216:219], v[156:159]
  ds_read_b128 a[224:227], v7 offset:2304
  v_accvgpr_read_b32 v251, a59
  s_waitcnt lgkmcnt(6)
  v_mfma_f32_16x16x32_bf16 v[160:163], v[192:195], a[216:219], v[160:163]
  buffer_load_dwordx4 v11, s[12:15], s36 offen offset:0 lds
  s_waitcnt lgkmcnt(4)
  v_mfma_f32_16x16x32_bf16 v[164:167], v[196:199], a[216:219], v[164:167]
  v_accvgpr_read_b32 v252, a76
  v_accvgpr_read_b32 v253, a77
  v_mfma_f32_16x16x32_bf16 v[132:135], v[196:199], a[212:215], v[132:135]
  ds_read_b64_tr_b16 v[204:205], v6 offset:520
  v_accvgpr_read_b32 v254, a78
  v_mfma_f32_16x16x32_bf16 v[128:131], v[192:195], a[212:215], v[128:131]
  ds_read_b64_tr_b16 v[206:207], v6 offset:1544
  v_accvgpr_read_b32 v255, a79
  v_mfma_f32_16x16x32_bf16 v[96:99], v[192:195], a[208:211], v[96:99]
  ds_read_b128 a[228:231], v7 offset:4352
  v_mul_f32 v248, v0, v248
  v_mfma_f32_16x16x32_bf16 v[100:103], v[196:199], a[208:211], v[100:103]
  buffer_load_dwordx4 v12, s[12:15], s36 offen offset:1024 lds
  v_mfma_f32_16x16x32_bf16 v[68:71], v[196:199], a[204:207], v[68:71]
  ds_read_b64_tr_b16 v[208:209], v6 offset:768
  v_mul_f32 v249, v0, v249
  v_mfma_f32_16x16x32_bf16 v[64:67], v[192:195], a[204:207], v[64:67]
  ds_read_b64_tr_b16 v[210:211], v6 offset:1792
  v_mul_f32 v250, v0, v250
  v_mfma_f32_16x16x32_bf16 v[32:35], v[192:195], a[200:203], v[32:35]
  ds_read_b128 a[232:235], v7 offset:6400
  v_mul_f32 v251, v0, v251
  v_mfma_f32_16x16x32_bf16 v[36:39], v[196:199], a[200:203], v[36:39]
  buffer_load_dwordx4 v13, s[12:15], s36 offen offset:2048 lds
  s_waitcnt lgkmcnt(7)
  v_mfma_f32_16x16x32_bf16 v[40:43], v[200:203], a[200:203], v[40:43]
  ds_read_b64_tr_b16 v[212:213], v6 offset:776
  v_mul_f32 v252, v0, v252
  s_waitcnt lgkmcnt(5)
  v_mfma_f32_16x16x32_bf16 v[44:47], v[204:207], a[200:203], v[44:47]
  v_mul_f32 v253, v0, v253
  v_mul_f32 v254, v0, v254
  v_mfma_f32_16x16x32_bf16 v[76:79], v[204:207], a[204:207], v[76:79]
  ds_read_b64_tr_b16 v[214:215], v6 offset:1800
  v_mul_f32 v255, v0, v255
  v_mfma_f32_16x16x32_bf16 v[72:75], v[200:203], a[204:207], v[72:75]
  ds_read_b128 a[236:239], v7 offset:8448
  v_cvt_pk_bf16_f32 v220, v248, v249
  v_mfma_f32_16x16x32_bf16 v[104:107], v[200:203], a[208:211], v[104:107]
  buffer_load_dwordx4 v14, s[12:15], s36 offen offset:3072 lds
  v_mfma_f32_16x16x32_bf16 v[108:111], v[204:207], a[208:211], v[108:111]
  s_add_u32 s36, s36, 0x40000
  v_cvt_pk_bf16_f32 v221, v250, v251
  v_cvt_pk_bf16_f32 v222, v252, v253
  v_mfma_f32_16x16x32_bf16 v[140:143], v[204:207], a[212:215], v[140:143]
  s_and_b32 s36, s36, 0x3fffff
  v_cvt_pk_bf16_f32 v223, v254, v255
  v_accvgpr_write_b32 a56, v220
  v_mfma_f32_16x16x32_bf16 v[136:139], v[200:203], a[212:215], v[136:139]
  ds_read_b64_tr_b16 v[184:185], v6 offset:16384
  v_accvgpr_write_b32 a57, v221
  v_mfma_f32_16x16x32_bf16 v[168:171], v[200:203], a[216:219], v[168:171]
  s_add_u32 s37, s6, s7
  v_accvgpr_write_b32 a58, v222
  v_accvgpr_write_b32 a59, v223
  s_add_u32 m0, s30, s32
  ds_read_b64_tr_b16 v[186:187], v6 offset:17408
  v_mfma_f32_16x16x32_bf16 v[172:175], v[204:207], a[216:219], v[172:175]
  buffer_load_dwordx4 v15, s[8:11], s37 offen offset:0 lds
  s_waitcnt lgkmcnt(6)
  v_mfma_f32_16x16x32_bf16 v[176:179], v[208:211], a[216:219], v[176:179]
  ds_read_b64_tr_b16 v[188:189], v6 offset:16392
  v_accvgpr_read_b32 v248, a120
  s_waitcnt lgkmcnt(4)
  v_mfma_f32_16x16x32_bf16 v[180:183], v[212:215], a[216:219], v[180:183]
  v_accvgpr_read_b32 v249, a121
  v_accvgpr_read_b32 v250, a122
  v_mfma_f32_16x16x32_bf16 v[148:151], v[212:215], a[212:215], v[148:151]
  ds_read_b64_tr_b16 v[190:191], v6 offset:17416
  v_accvgpr_read_b32 v251, a123
  v_mfma_f32_16x16x32_bf16 v[144:147], v[208:211], a[212:215], v[144:147]
  buffer_load_dwordx4 v16, s[8:11], s37 offen offset:1024 lds
  v_mfma_f32_16x16x32_bf16 v[112:115], v[208:211], a[208:211], v[112:115]
  v_accvgpr_read_b32 v252, a140
  v_accvgpr_read_b32 v253, a141
  v_mfma_f32_16x16x32_bf16 v[116:119], v[212:215], a[208:211], v[116:119]
  ds_read_b64_tr_b16 v[192:193], v6 offset:16640
  v_accvgpr_read_b32 v254, a142
  v_mfma_f32_16x16x32_bf16 v[84:87], v[212:215], a[204:207], v[84:87]
  ds_read_b64_tr_b16 v[194:195], v6 offset:17664
  v_accvgpr_read_b32 v255, a143
  v_mfma_f32_16x16x32_bf16 v[80:83], v[208:211], a[204:207], v[80:83]
  v_mul_f32 v248, v20, v248
  v_mfma_f32_16x16x32_bf16 v[48:51], v[208:211], a[200:203], v[48:51]
  buffer_load_dwordx4 v17, s[8:11], s37 offen offset:2048 lds
  v_mfma_f32_16x16x32_bf16 v[52:55], v[212:215], a[200:203], v[52:55]
  s_waitcnt lgkmcnt(6)
  v_mul_f32 v249, v20, v249
  v_mul_f32 v250, v20, v250
  s_waitcnt lgkmcnt(4)
  v_mfma_f32_16x16x32_bf16 v[24:27], v[184:187], a[220:223], v[24:27]
  ds_read_b64_tr_b16 v[196:197], v6 offset:16648
  v_mul_f32 v251, v20, v251
  s_waitcnt lgkmcnt(3)
  v_mfma_f32_16x16x32_bf16 v[28:31], v[188:191], a[220:223], v[28:31]
  v_mul_f32 v252, v20, v252
  v_mfma_f32_16x16x32_bf16 v[60:63], v[188:191], a[224:227], v[60:63]
  ds_read_b64_tr_b16 v[198:199], v6 offset:17672
  v_mul_f32 v253, v20, v253
  v_mfma_f32_16x16x32_bf16 v[56:59], v[184:187], a[224:227], v[56:59]
  buffer_load_dwordx4 v18, s[8:11], s37 offen offset:3072 lds
  v_mfma_f32_16x16x32_bf16 v[88:91], v[184:187], a[228:231], v[88:91]
  s_add_u32 m0, m0, 0x1000
  v_mul_f32 v254, v20, v254
  v_mul_f32 v255, v20, v255
  v_mfma_f32_16x16x32_bf16 v[92:95], v[188:191], a[228:231], v[92:95]
  ds_read_b64_tr_b16 v[200:201], v6 offset:16896
  v_cvt_pk_bf16_f32 v228, v248, v249
  v_mfma_f32_16x16x32_bf16 v[124:127], v[188:191], a[232:235], v[124:127]
  ds_read_b64_tr_b16 v[202:203], v6 offset:17920
  v_cvt_pk_bf16_f32 v229, v250, v251
  v_mfma_f32_16x16x32_bf16 v[120:123], v[184:187], a[232:235], v[120:123]
  s_add_u32 s39, s37, 0x8000
  v_cvt_pk_bf16_f32 v230, v252, v253
  s_add_u32 s7, s7, 128
  v_mfma_f32_16x16x32_bf16 v[152:155], v[184:187], a[236:239], v[152:155]
  buffer_load_dwordx4 v15, s[8:11], s39 offen lds
  v_mfma_f32_16x16x32_bf16 v[156:159], v[188:191], a[236:239], v[156:159]
  s_and_b32 s7, s7, 0x3ff
  v_cvt_pk_bf16_f32 v231, v254, v255
  v_accvgpr_write_b32 a240, v228
  s_waitcnt lgkmcnt(4)
  v_mfma_f32_16x16x32_bf16 v[160:163], v[192:195], a[236:239], v[160:163]
  ds_read_b64_tr_b16 v[204:205], v6 offset:16904
  v_accvgpr_write_b32 a241, v229
  s_waitcnt lgkmcnt(3)
  v_mfma_f32_16x16x32_bf16 v[164:167], v[196:199], a[236:239], v[164:167]
  v_accvgpr_write_b32 a242, v230
  v_mfma_f32_16x16x32_bf16 v[132:135], v[196:199], a[232:235], v[132:135]
  ds_read_b64_tr_b16 v[206:207], v6 offset:17928
  v_accvgpr_write_b32 a243, v231
  v_mfma_f32_16x16x32_bf16 v[128:131], v[192:195], a[232:235], v[128:131]
  ds_read_b64_tr_b16 v[208:209], v6 offset:17152
  v_accvgpr_read_b32 v248, a124
  v_mfma_f32_16x16x32_bf16 v[96:99], v[192:195], a[228:231], v[96:99]
  ds_read_b64_tr_b16 v[210:211], v6 offset:18176
  v_accvgpr_read_b32 v249, a125
  v_mfma_f32_16x16x32_bf16 v[100:103], v[196:199], a[228:231], v[100:103]
  ds_read_b64_tr_b16 v[212:213], v6 offset:17160
  v_accvgpr_read_b32 v250, a126
  v_mfma_f32_16x16x32_bf16 v[68:71], v[196:199], a[224:227], v[68:71]
  ds_read_b64_tr_b16 v[214:215], v6 offset:18184
  v_accvgpr_read_b32 v251, a127
  v_mfma_f32_16x16x32_bf16 v[64:67], v[192:195], a[224:227], v[64:67]
  s_add_u32 s30, s29, s31
  v_accvgpr_read_b32 v252, a144
  v_accvgpr_read_b32 v253, a145
  v_mfma_f32_16x16x32_bf16 v[32:35], v[192:195], a[220:223], v[32:35]
  s_add_u32 s29, s29, 53248
  v_accvgpr_read_b32 v254, a146
  s_cmp_eq_u32 s29, 159744
  v_mfma_f32_16x16x32_bf16 v[36:39], v[196:199], a[220:223], v[36:39]
  s_waitcnt lgkmcnt(4)
  v_accvgpr_read_b32 v255, a147
  v_mfma_f32_16x16x32_bf16 v[40:43], v[200:203], a[220:223], v[40:43]
  s_cselect_b32 s29, 0, s29
  v_add_u32 v6, s29, v4
  v_mul_f32 v248, v21, v248
  v_mfma_f32_16x16x32_bf16 v[44:47], v[204:207], a[220:223], v[44:47]
  v_add_u32 v7, s29, v5
  v_mul_f32 v249, v21, v249
  v_mfma_f32_16x16x32_bf16 v[76:79], v[204:207], a[224:227], v[76:79]
  v_mul_f32 v250, v21, v250
  v_mfma_f32_16x16x32_bf16 v[72:75], v[200:203], a[224:227], v[72:75]
  s_mov_b32 m0, s30
  v_mul_f32 v251, v21, v251
  v_mfma_f32_16x16x32_bf16 v[104:107], v[200:203], a[228:231], v[104:107]
  s_waitcnt vmcnt(13) lgkmcnt(0)
  s_barrier
  v_mul_f32 v252, v21, v252
  v_mfma_f32_16x16x32_bf16 v[108:111], v[204:207], a[228:231], v[108:111]
  ds_read_b64_tr_b16 v[184:185], v6 offset:0
  v_mul_f32 v253, v21, v253
  v_mfma_f32_16x16x32_bf16 v[140:143], v[204:207], a[232:235], v[140:143]
  ds_read_b64_tr_b16 v[186:187], v6 offset:1024
  v_mul_f32 v254, v21, v254
  v_mfma_f32_16x16x32_bf16 v[136:139], v[200:203], a[232:235], v[136:139]
  ds_read_b128 a[200:203], v7 offset:0
  v_mul_f32 v255, v21, v255
  v_mfma_f32_16x16x32_bf16 v[168:171], v[200:203], a[236:239], v[168:171]
  ds_read_b128 a[204:207], v7 offset:2048
  v_cvt_pk_bf16_f32 v216, v248, v249
  v_mfma_f32_16x16x32_bf16 v[172:175], v[204:207], a[236:239], v[172:175]
  buffer_load_dwordx4 v11, s[12:15], s36 offen offset:0 lds
  v_mfma_f32_16x16x32_bf16 v[176:179], v[208:211], a[236:239], v[176:179]
  ds_read_b128 a[208:211], v7 offset:4096
  v_cvt_pk_bf16_f32 v217, v250, v251
  v_mfma_f32_16x16x32_bf16 v[180:183], v[212:215], a[236:239], v[180:183]
  v_cvt_pk_bf16_f32 v218, v252, v253
  v_cvt_pk_bf16_f32 v219, v254, v255
  v_mfma_f32_16x16x32_bf16 v[148:151], v[212:215], a[232:235], v[148:151]
  ds_read_b64_tr_b16 v[188:189], v6 offset:8
  v_accvgpr_write_b32 a244, v216
  v_mfma_f32_16x16x32_bf16 v[144:147], v[208:211], a[232:235], v[144:147]
  ds_read_b64_tr_b16 v[190:191], v6 offset:1032
  v_accvgpr_write_b32 a245, v217
  v_mfma_f32_16x16x32_bf16 v[112:115], v[208:211], a[228:231], v[112:115]
  ds_read_b128 a[212:215], v7 offset:6144
  v_accvgpr_write_b32 a246, v218
  v_mfma_f32_16x16x32_bf16 v[116:119], v[212:215], a[228:231], v[116:119]
  ds_read_b128 a[216:219], v7 offset:8192
  v_accvgpr_write_b32 a247, v219
  buffer_load_dwordx4 v12, s[12:15], s36 offen offset:1024 lds
  v_mfma_f32_16x16x32_bf16 v[84:87], v[212:215], a[224:227], v[84:87]
  ds_read_b64_tr_b16 v[192:193], v6 offset:256
  v_accvgpr_read_b32 v248, a128
  v_mfma_f32_16x16x32_bf16 v[80:83], v[208:211], a[224:227], v[80:83]
  ds_read_b64_tr_b16 v[194:195], v6 offset:1280
  v_accvgpr_read_b32 v249, a129
  v_mfma_f32_16x16x32_bf16 v[48:51], v[208:211], a[220:223], v[48:51]
  buffer_load_dwordx4 v13, s[12:15], s36 offen offset:2048 lds
  v_mfma_f32_16x16x32_bf16 v[52:55], v[212:215], a[220:223], v[52:55]
  s_waitcnt lgkmcnt(4)
  v_accvgpr_read_b32 v250, a130
  v_accvgpr_read_b32 v251, a131
  v_mfma_f32_16x16x32_bf16 v[24:27], v[184:187], a[200:203], v[24:27]
  s_waitcnt lgkmcnt(2)
  v_accvgpr_read_b32 v252, a148
  v_mfma_f32_16x16x32_bf16 v[28:31], v[188:191], a[200:203], v[28:31]
  ds_read_b64_tr_b16 v[196:197], v6 offset:264
  v_accvgpr_read_b32 v253, a149
  v_mfma_f32_16x16x32_bf16 v[60:63], v[188:191], a[204:207], v[60:63]
  ds_read_b64_tr_b16 v[198:199], v6 offset:1288
  v_accvgpr_read_b32 v254, a150
  v_mfma_f32_16x16x32_bf16 v[56:59], v[184:187], a[204:207], v[56:59]
  ds_read_b128 a[220:223], v7 offset:256
  v_accvgpr_read_b32 v255, a151
  v_mfma_f32_16x16x32_bf16 v[88:91], v[184:187], a[208:211], v[88:91]
  buffer_load_dwordx4 v14, s[12:15], s36 offen offset:3072 lds
  v_mfma_f32_16x16x32_bf16 v[92:95], v[188:191], a[208:211], v[92:95]
  ds_read_b64_tr_b16 v[200:201], v6 offset:512
  v_mul_f32 v248, v22, v248
  v_mfma_f32_16x16x32_bf16 v[124:127], v[188:191], a[212:215], v[124:127]
  ds_read_b64_tr_b16 v[202:203], v6 offset:1536
  v_mul_f32 v249, v22, v249
  v_mfma_f32_16x16x32_bf16 v[120:123], v[184:187], a[212:215], v[120:123]
  s_add_u32 s36, s36, 0x40000
  v_mul_f32 v250, v22, v250
  v_mul_f32 v251, v22, v251
  v_mfma_f32_16x16x32_bf16 v[152:155], v[184:187], a[216:219], v[152:155]
  s_add_u32 m0, s30, 16384
  v_mul_f32 v252, v22, v252
  v_mul_f32 v253, v22, v253
  v_mfma_f32_16x16x32_bf16 v[156:159], v[188:191], a[216:219], v[156:159]
  ds_read_b128 a[224:227], v7 offset:2304
  v_mul_f32 v254, v22, v254
  s_waitcnt lgkmcnt(6)
  v_mfma_f32_16x16x32_bf16 v[160:163], v[192:195], a[216:219], v[160:163]
  buffer_load_dwordx4 v11, s[12:15], s36 offen offset:0 lds
  s_waitcnt lgkmcnt(4)
  v_mfma_f32_16x16x32_bf16 v[164:167], v[196:199], a[216:219], v[164:167]
  v_mul_f32 v255, v22, v255
  v_cvt_pk_bf16_f32 v220, v248, v249
  v_mfma_f32_16x16x32_bf16 v[132:135], v[196:199], a[212:215], v[132:135]
  ds_read_b64_tr_b16 v[204:205], v6 offset:520
  v_cvt_pk_bf16_f32 v221, v250, v251
  v_mfma_f32_16x16x32_bf16 v[128:131], v[192:195], a[212:215], v[128:131]
  ds_read_b64_tr_b16 v[206:207], v6 offset:1544
  v_cvt_pk_bf16_f32 v222, v252, v253
  v_mfma_f32_16x16x32_bf16 v[96:99], v[192:195], a[208:211], v[96:99]
  ds_read_b128 a[228:231], v7 offset:4352
  v_cvt_pk_bf16_f32 v223, v254, v255
  v_mfma_f32_16x16x32_bf16 v[100:103], v[196:199], a[208:211], v[100:103]
  buffer_load_dwordx4 v12, s[12:15], s36 offen offset:1024 lds
  v_mfma_f32_16x16x32_bf16 v[68:71], v[196:199], a[204:207], v[68:71]
  ds_read_b64_tr_b16 v[208:209], v6 offset:768
  v_accvgpr_write_b32 a248, v220
  v_mfma_f32_16x16x32_bf16 v[64:67], v[192:195], a[204:207], v[64:67]
  ds_read_b64_tr_b16 v[210:211], v6 offset:1792
  v_accvgpr_write_b32 a249, v221
  v_mfma_f32_16x16x32_bf16 v[32:35], v[192:195], a[200:203], v[32:35]
  ds_read_b128 a[232:235], v7 offset:6400
  v_accvgpr_write_b32 a250, v222
  v_mfma_f32_16x16x32_bf16 v[36:39], v[196:199], a[200:203], v[36:39]
  buffer_load_dwordx4 v13, s[12:15], s36 offen offset:2048 lds
  s_waitcnt lgkmcnt(7)
  v_mfma_f32_16x16x32_bf16 v[40:43], v[200:203], a[200:203], v[40:43]
  ds_read_b64_tr_b16 v[212:213], v6 offset:776
  v_accvgpr_write_b32 a251, v223
  s_waitcnt lgkmcnt(5)
  v_mfma_f32_16x16x32_bf16 v[44:47], v[204:207], a[200:203], v[44:47]
  v_accvgpr_read_b32 v248, a132
  v_accvgpr_read_b32 v249, a133
  v_mfma_f32_16x16x32_bf16 v[76:79], v[204:207], a[204:207], v[76:79]
  ds_read_b64_tr_b16 v[214:215], v6 offset:1800
  v_accvgpr_read_b32 v250, a134
  v_mfma_f32_16x16x32_bf16 v[72:75], v[200:203], a[204:207], v[72:75]
  ds_read_b128 a[236:239], v7 offset:8448
  v_accvgpr_read_b32 v251, a135
  v_mfma_f32_16x16x32_bf16 v[104:107], v[200:203], a[208:211], v[104:107]
  buffer_load_dwordx4 v14, s[12:15], s36 offen offset:3072 lds
  v_mfma_f32_16x16x32_bf16 v[108:111], v[204:207], a[208:211], v[108:111]
  s_add_u32 s36, s36, 0x40000
  v_accvgpr_read_b32 v252, a152
  v_accvgpr_read_b32 v253, a153
  v_mfma_f32_16x16x32_bf16 v[140:143], v[204:207], a[212:215], v[140:143]
  s_and_b32 s36, s36, 0x3fffff
  v_accvgpr_read_b32 v254, a154
  v_accvgpr_read_b32 v255, a155
  v_mfma_f32_16x16x32_bf16 v[136:139], v[200:203], a[212:215], v[136:139]
  ds_read_b64_tr_b16 v[184:185], v6 offset:16384
  v_mul_f32 v248, v23, v248
  v_mfma_f32_16x16x32_bf16 v[168:171], v[200:203], a[216:219], v[168:171]
  s_add_u32 s37, s6, s7
  v_mul_f32 v249, v23, v249
  s_add_u32 m0, s30, s32
  ds_read_b64_tr_b16 v[186:187], v6 offset:17408
  v_mfma_f32_16x16x32_bf16 v[172:175], v[204:207], a[216:219], v[172:175]
  buffer_load_dwordx4 v15, s[8:11], s37 offen offset:0 lds
  s_waitcnt lgkmcnt(6)
  v_mfma_f32_16x16x32_bf16 v[176:179], v[208:211], a[216:219], v[176:179]
  ds_read_b64_tr_b16 v[188:189], v6 offset:16392
  v_mul_f32 v250, v23, v250
  s_waitcnt lgkmcnt(4)
  v_mfma_f32_16x16x32_bf16 v[180:183], v[212:215], a[216:219], v[180:183]
  v_mul_f32 v251, v23, v251
  v_mul_f32 v252, v23, v252
  v_mfma_f32_16x16x32_bf16 v[148:151], v[212:215], a[212:215], v[148:151]
  ds_read_b64_tr_b16 v[190:191], v6 offset:17416
  v_mul_f32 v253, v23, v253
  v_mfma_f32_16x16x32_bf16 v[144:147], v[208:211], a[212:215], v[144:147]
  buffer_load_dwordx4 v16, s[8:11], s37 offen offset:1024 lds
  v_mfma_f32_16x16x32_bf16 v[112:115], v[208:211], a[208:211], v[112:115]
  v_mul_f32 v254, v23, v254
  v_mul_f32 v255, v23, v255
  v_mfma_f32_16x16x32_bf16 v[116:119], v[212:215], a[208:211], v[116:119]
  ds_read_b64_tr_b16 v[192:193], v6 offset:16640
  v_cvt_pk_bf16_f32 v224, v248, v249
  v_mfma_f32_16x16x32_bf16 v[84:87], v[212:215], a[204:207], v[84:87]
  ds_read_b64_tr_b16 v[194:195], v6 offset:17664
  v_cvt_pk_bf16_f32 v225, v250, v251
  v_mfma_f32_16x16x32_bf16 v[80:83], v[208:211], a[204:207], v[80:83]
  v_cvt_pk_bf16_f32 v226, v252, v253
  v_cvt_pk_bf16_f32 v227, v254, v255
  v_mfma_f32_16x16x32_bf16 v[48:51], v[208:211], a[200:203], v[48:51]
  buffer_load_dwordx4 v17, s[8:11], s37 offen offset:2048 lds
  v_mfma_f32_16x16x32_bf16 v[52:55], v[212:215], a[200:203], v[52:55]
  s_waitcnt lgkmcnt(6)
  v_accvgpr_write_b32 a252, v224
  v_accvgpr_write_b32 a253, v225
  s_waitcnt lgkmcnt(4)
  v_mfma_f32_16x16x32_bf16 v[24:27], v[184:187], a[220:223], v[24:27]
  ds_read_b64_tr_b16 v[196:197], v6 offset:16648
  v_accvgpr_write_b32 a254, v226
  s_waitcnt lgkmcnt(3)
  v_mfma_f32_16x16x32_bf16 v[28:31], v[188:191], a[220:223], v[28:31]
  v_accvgpr_write_b32 a255, v227
  v_mfma_f32_16x16x32_bf16 v[60:63], v[188:191], a[224:227], v[60:63]
  ds_read_b64_tr_b16 v[198:199], v6 offset:17672
  v_accvgpr_read_b32 v248, a136
  v_mfma_f32_16x16x32_bf16 v[56:59], v[184:187], a[224:227], v[56:59]
  buffer_load_dwordx4 v18, s[8:11], s37 offen offset:3072 lds
  v_mfma_f32_16x16x32_bf16 v[88:91], v[184:187], a[228:231], v[88:91]
  s_add_u32 m0, m0, 0x1000
  v_accvgpr_read_b32 v249, a137
  v_accvgpr_read_b32 v250, a138
  v_mfma_f32_16x16x32_bf16 v[92:95], v[188:191], a[228:231], v[92:95]
  ds_read_b64_tr_b16 v[200:201], v6 offset:16896
  v_accvgpr_read_b32 v251, a139
  v_mfma_f32_16x16x32_bf16 v[124:127], v[188:191], a[232:235], v[124:127]
  ds_read_b64_tr_b16 v[202:203], v6 offset:17920
  v_accvgpr_read_b32 v252, a156
  v_mfma_f32_16x16x32_bf16 v[120:123], v[184:187], a[232:235], v[120:123]
  s_add_u32 s39, s37, 0x8000
  v_accvgpr_read_b32 v253, a157
  s_add_u32 s7, s7, 128
  v_mfma_f32_16x16x32_bf16 v[152:155], v[184:187], a[236:239], v[152:155]
  buffer_load_dwordx4 v15, s[8:11], s39 offen lds
  v_mfma_f32_16x16x32_bf16 v[156:159], v[188:191], a[236:239], v[156:159]
  s_and_b32 s7, s7, 0x3ff
  v_accvgpr_read_b32 v254, a158
  v_accvgpr_read_b32 v255, a159
  s_waitcnt lgkmcnt(4)
  v_mfma_f32_16x16x32_bf16 v[160:163], v[192:195], a[236:239], v[160:163]
  ds_read_b64_tr_b16 v[204:205], v6 offset:16904
  v_mul_f32 v248, v0, v248
  s_waitcnt lgkmcnt(3)
  v_mfma_f32_16x16x32_bf16 v[164:167], v[196:199], a[236:239], v[164:167]
  v_mul_f32 v249, v0, v249
  v_mfma_f32_16x16x32_bf16 v[132:135], v[196:199], a[232:235], v[132:135]
  ds_read_b64_tr_b16 v[206:207], v6 offset:17928
  v_mul_f32 v250, v0, v250
  v_mfma_f32_16x16x32_bf16 v[128:131], v[192:195], a[232:235], v[128:131]
  ds_read_b64_tr_b16 v[208:209], v6 offset:17152
  v_mul_f32 v251, v0, v251
  v_mfma_f32_16x16x32_bf16 v[96:99], v[192:195], a[228:231], v[96:99]
  ds_read_b64_tr_b16 v[210:211], v6 offset:18176
  v_mul_f32 v252, v0, v252
  v_mfma_f32_16x16x32_bf16 v[100:103], v[196:199], a[228:231], v[100:103]
  ds_read_b64_tr_b16 v[212:213], v6 offset:17160
  v_mul_f32 v253, v0, v253
  v_mfma_f32_16x16x32_bf16 v[68:71], v[196:199], a[224:227], v[68:71]
  ds_read_b64_tr_b16 v[214:215], v6 offset:18184
  v_mul_f32 v254, v0, v254
  v_mfma_f32_16x16x32_bf16 v[64:67], v[192:195], a[224:227], v[64:67]
  s_add_u32 s30, s29, s31
  v_mul_f32 v255, v0, v255
  s_add_u32 s29, s29, 53248
  v_mfma_f32_16x16x32_bf16 v[32:35], v[192:195], a[220:223], v[32:35]
  s_cmp_eq_u32 s29, 159744
  v_cvt_pk_bf16_f32 v240, v248, v249
  s_cselect_b32 s29, 0, s29
  v_mfma_f32_16x16x32_bf16 v[36:39], v[196:199], a[220:223], v[36:39]
  s_waitcnt lgkmcnt(4)
  v_cvt_pk_bf16_f32 v241, v250, v251
  v_mfma_f32_16x16x32_bf16 v[40:43], v[200:203], a[220:223], v[40:43]
  v_cvt_pk_bf16_f32 v242, v252, v253
  v_add_u32 v6, s29, v4
  v_mfma_f32_16x16x32_bf16 v[44:47], v[204:207], a[220:223], v[44:47]
  v_cvt_pk_bf16_f32 v243, v254, v255
  v_add_u32 v7, s29, v5
  v_mfma_f32_16x16x32_bf16 v[76:79], v[204:207], a[224:227], v[76:79]
  v_mfma_f32_16x16x32_bf16 v[72:75], v[200:203], a[224:227], v[72:75]
  v_mfma_f32_16x16x32_bf16 v[104:107], v[200:203], a[228:231], v[104:107]
  s_waitcnt vmcnt(13) lgkmcnt(0)
  s_barrier
  s_add_u32 s40, s33, s34
  s_add_u32 s34, s34, 0x2000
  v_mfma_f32_16x16x32_bf16 v[108:111], v[204:207], a[228:231], v[108:111]
  ds_read_b64_tr_b16 v[184:185], v6 offset:0
  s_and_b32 s34, s34, 0x1ffff
  v_mfma_f32_16x16x32_bf16 v[140:143], v[204:207], a[232:235], v[140:143]
  ds_read_b64_tr_b16 v[186:187], v6 offset:1024
  s_add_u32 m0, s30, 16384
  v_mfma_f32_16x16x32_bf16 v[136:139], v[200:203], a[232:235], v[136:139]
  ds_read_b128 a[200:203], v7 offset:0
  v_mfma_f32_16x16x32_bf16 v[168:171], v[200:203], a[236:239], v[168:171]
  ds_read_b128 a[204:207], v7 offset:2048
  v_mfma_f32_16x16x32_bf16 v[172:175], v[204:207], a[236:239], v[172:175]
  buffer_load_dwordx4 v9, s[16:19], s40 offen offset:0 nt lds
  v_mfma_f32_16x16x32_bf16 v[176:179], v[208:211], a[236:239], v[176:179]
  ds_read_b128 a[208:211], v7 offset:4096
  v_mfma_f32_16x16x32_bf16 v[180:183], v[212:215], a[236:239], v[180:183]
  v_mfma_f32_16x16x32_bf16 v[148:151], v[212:215], a[232:235], v[148:151]
  ds_read_b64_tr_b16 v[188:189], v6 offset:8
  v_mfma_f32_16x16x32_bf16 v[144:147], v[208:211], a[232:235], v[144:147]
  ds_read_b64_tr_b16 v[190:191], v6 offset:1032
  v_mfma_f32_16x16x32_bf16 v[112:115], v[208:211], a[228:231], v[112:115]
  ds_read_b128 a[212:215], v7 offset:6144
  v_mfma_f32_16x16x32_bf16 v[116:119], v[212:215], a[228:231], v[116:119]
  ds_read_b128 a[216:219], v7 offset:8192
  v_mfma_f32_16x16x32_bf16 v[84:87], v[212:215], a[224:227], v[84:87]
  ds_read_b64_tr_b16 v[192:193], v6 offset:256
  v_mfma_f32_16x16x32_bf16 v[80:83], v[208:211], a[224:227], v[80:83]
  ds_read_b64_tr_b16 v[194:195], v6 offset:1280
  v_mfma_f32_16x16x32_bf16 v[48:51], v[208:211], a[220:223], v[48:51]
  buffer_load_dwordx4 v10, s[16:19], s40 offen offset:1024 nt lds
  v_mfma_f32_16x16x32_bf16 v[52:55], v[212:215], a[220:223], v[52:55]
  s_waitcnt lgkmcnt(4)
  v_mfma_f32_16x16x32_bf16 v[24:27], v[184:187], a[200:203], v[24:27]
  s_waitcnt lgkmcnt(2)
  v_mfma_f32_16x16x32_bf16 v[28:31], v[188:191], a[200:203], v[28:31]
  ds_read_b64_tr_b16 v[196:197], v6 offset:264
  v_mfma_f32_16x16x32_bf16 v[60:63], v[188:191], a[204:207], v[60:63]
  ds_read_b64_tr_b16 v[198:199], v6 offset:1288
  v_mfma_f32_16x16x32_bf16 v[56:59], v[184:187], a[204:207], v[56:59]
  ds_read_b128 a[220:223], v7 offset:256
  v_mfma_f32_16x16x32_bf16 v[88:91], v[184:187], a[208:211], v[88:91]
  ds_write_b128 v237, a[80:83] offset:0
  v_mfma_f32_16x16x32_bf16 v[92:95], v[188:191], a[208:211], v[92:95]
  ds_read_b64_tr_b16 v[200:201], v6 offset:512
  v_mfma_f32_16x16x32_bf16 v[124:127], v[188:191], a[212:215], v[124:127]
  ds_read_b64_tr_b16 v[202:203], v6 offset:1536
  v_mfma_f32_16x16x32_bf16 v[120:123], v[184:187], a[212:215], v[120:123]
  ds_read_b128 a[224:227], v7 offset:2304
  v_mfma_f32_16x16x32_bf16 v[152:155], v[184:187], a[216:219], v[152:155]
  buffer_load_dwordx4 v9, s[16:19], s40 offen offset:2048 nt lds
  v_mfma_f32_16x16x32_bf16 v[156:159], v[188:191], a[216:219], v[156:159]
  ds_write_b128 v237, a[84:87] offset:1024
  s_waitcnt lgkmcnt(6)
  v_mfma_f32_16x16x32_bf16 v[160:163], v[192:195], a[216:219], v[160:163]
  ds_read_b64_tr_b16 v[204:205], v6 offset:520
  v_mfma_f32_16x16x32_bf16 v[164:167], v[196:199], a[216:219], v[164:167]
  ds_read_b64_tr_b16 v[206:207], v6 offset:1544
  v_mfma_f32_16x16x32_bf16 v[132:135], v[196:199], a[212:215], v[132:135]
  ds_read_b128 a[228:231], v7 offset:4352
  v_mfma_f32_16x16x32_bf16 v[128:131], v[192:195], a[212:215], v[128:131]
  v_mfma_f32_16x16x32_bf16 v[96:99], v[192:195], a[208:211], v[96:99]
  ds_write_b128 v237, a[88:91] offset:2048
  v_mfma_f32_16x16x32_bf16 v[100:103], v[196:199], a[208:211], v[100:103]
  ds_read_b64_tr_b16 v[208:209], v6 offset:768
  v_mfma_f32_16x16x32_bf16 v[68:71], v[196:199], a[204:207], v[68:71]
  ds_read_b64_tr_b16 v[210:211], v6 offset:1792
  v_mfma_f32_16x16x32_bf16 v[64:67], v[192:195], a[204:207], v[64:67]
  ds_read_b128 a[232:235], v7 offset:6400
  v_mfma_f32_16x16x32_bf16 v[32:35], v[192:195], a[200:203], v[32:35]
  buffer_load_dwordx4 v10, s[16:19], s40 offen offset:3072 nt lds
  v_mfma_f32_16x16x32_bf16 v[36:39], v[196:199], a[200:203], v[36:39]
  ds_write_b128 v237, a[92:95] offset:3072
  s_waitcnt lgkmcnt(6)
  v_mfma_f32_16x16x32_bf16 v[40:43], v[200:203], a[200:203], v[40:43]
  ds_read_b64_tr_b16 v[212:213], v6 offset:776
  v_mfma_f32_16x16x32_bf16 v[44:47], v[204:207], a[200:203], v[44:47]
  ds_read_b64_tr_b16 v[214:215], v6 offset:1800
  v_mfma_f32_16x16x32_bf16 v[76:79], v[204:207], a[204:207], v[76:79]
  ds_read_b128 a[236:239], v7 offset:8448
  v_mfma_f32_16x16x32_bf16 v[72:75], v[200:203], a[204:207], v[72:75]
  s_add_u32 s39, s33, s34
  s_add_u32 s34, s34, 0x2000
  s_and_b32 s34, s34, 0x1ffff
  v_mfma_f32_16x16x32_bf16 v[104:107], v[200:203], a[208:211], v[104:107]
  ds_write_b128 v237, a[96:99] offset:4096
  s_mov_b32 m0, s30
  v_mfma_f32_16x16x32_bf16 v[108:111], v[204:207], a[208:211], v[108:111]
  ds_read_b64_tr_b16 v[184:185], v6 offset:16384
  v_mfma_f32_16x16x32_bf16 v[140:143], v[204:207], a[212:215], v[140:143]
  ds_read_b64_tr_b16 v[186:187], v6 offset:17408
  v_mfma_f32_16x16x32_bf16 v[136:139], v[200:203], a[212:215], v[136:139]
  v_mfma_f32_16x16x32_bf16 v[168:171], v[200:203], a[216:219], v[168:171]
  buffer_load_dwordx4 v9, s[16:19], s39 offen offset:0 nt lds
  v_mfma_f32_16x16x32_bf16 v[172:175], v[204:207], a[216:219], v[172:175]
  s_waitcnt lgkmcnt(4)
  v_mfma_f32_16x16x32_bf16 v[176:179], v[208:211], a[216:219], v[176:179]
  ds_read_b64_tr_b16 v[188:189], v6 offset:16392
  v_mfma_f32_16x16x32_bf16 v[180:183], v[212:215], a[216:219], v[180:183]
  ds_read_b64_tr_b16 v[190:191], v6 offset:17416
  v_mfma_f32_16x16x32_bf16 v[148:151], v[212:215], a[212:215], v[148:151]
  v_mfma_f32_16x16x32_bf16 v[144:147], v[208:211], a[212:215], v[144:147]
  v_mfma_f32_16x16x32_bf16 v[112:115], v[208:211], a[208:211], v[112:115]
  v_mfma_f32_16x16x32_bf16 v[116:119], v[212:215], a[208:211], v[116:119]
  ds_read_b64_tr_b16 v[192:193], v6 offset:16640
  v_mfma_f32_16x16x32_bf16 v[84:87], v[212:215], a[204:207], v[84:87]
  ds_read_b64_tr_b16 v[194:195], v6 offset:17664
  v_mfma_f32_16x16x32_bf16 v[80:83], v[208:211], a[204:207], v[80:83]
  v_mfma_f32_16x16x32_bf16 v[48:51], v[208:211], a[200:203], v[48:51]
  buffer_load_dwordx4 v10, s[16:19], s39 offen offset:1024 nt lds
  v_mfma_f32_16x16x32_bf16 v[52:55], v[212:215], a[200:203], v[52:55]
  s_waitcnt lgkmcnt(7)
  s_waitcnt lgkmcnt(2)
  v_mfma_f32_16x16x32_bf16 v[24:27], v[184:187], a[220:223], v[24:27]
  ds_read_b64_tr_b16 v[196:197], v6 offset:16648
  v_mfma_f32_16x16x32_bf16 v[28:31], v[188:191], a[220:223], v[28:31]
  ds_read_b64_tr_b16 v[198:199], v6 offset:17672
  v_mfma_f32_16x16x32_bf16 v[60:63], v[188:191], a[224:227], v[60:63]
  v_mfma_f32_16x16x32_bf16 v[56:59], v[184:187], a[224:227], v[56:59]
  v_mfma_f32_16x16x32_bf16 v[88:91], v[184:187], a[228:231], v[88:91]
  v_mfma_f32_16x16x32_bf16 v[92:95], v[188:191], a[228:231], v[92:95]
  ds_read_b64_tr_b16 v[200:201], v6 offset:16896
  v_mfma_f32_16x16x32_bf16 v[124:127], v[188:191], a[232:235], v[124:127]
  ds_read_b64_tr_b16 v[202:203], v6 offset:17920
  v_mfma_f32_16x16x32_bf16 v[120:123], v[184:187], a[232:235], v[120:123]
  v_mfma_f32_16x16x32_bf16 v[152:155], v[184:187], a[236:239], v[152:155]
  buffer_load_dwordx4 v9, s[16:19], s39 offen offset:2048 nt lds
  v_mfma_f32_16x16x32_bf16 v[156:159], v[188:191], a[236:239], v[156:159]
  s_waitcnt lgkmcnt(2)
  v_mfma_f32_16x16x32_bf16 v[160:163], v[192:195], a[236:239], v[160:163]
  ds_read_b64_tr_b16 v[204:205], v6 offset:16904
  v_mfma_f32_16x16x32_bf16 v[164:167], v[196:199], a[236:239], v[164:167]
  ds_read_b64_tr_b16 v[206:207], v6 offset:17928
  v_mfma_f32_16x16x32_bf16 v[132:135], v[196:199], a[232:235], v[132:135]
  ds_read_b64_tr_b16 v[208:209], v6 offset:17152
  v_mfma_f32_16x16x32_bf16 v[128:131], v[192:195], a[232:235], v[128:131]
  ds_read_b64_tr_b16 v[210:211], v6 offset:18176
  v_mfma_f32_16x16x32_bf16 v[96:99], v[192:195], a[228:231], v[96:99]
  v_mfma_f32_16x16x32_bf16 v[100:103], v[196:199], a[228:231], v[100:103]
  ds_read_b64_tr_b16 v[212:213], v6 offset:17160
  v_mfma_f32_16x16x32_bf16 v[68:71], v[196:199], a[224:227], v[68:71]
  ds_read_b64_tr_b16 v[214:215], v6 offset:18184
  s_add_u32 s30, s29, s31
  v_mfma_f32_16x16x32_bf16 v[64:67], v[192:195], a[224:227], v[64:67]
  s_add_u32 s29, s29, 53248
  v_mfma_f32_16x16x32_bf16 v[32:35], v[192:195], a[220:223], v[32:35]
  buffer_load_dwordx4 v10, s[16:19], s39 offen offset:3072 nt lds
  v_mfma_f32_16x16x32_bf16 v[36:39], v[196:199], a[220:223], v[36:39]
  s_waitcnt lgkmcnt(4)
  s_cmp_eq_u32 s29, 159744
  v_mfma_f32_16x16x32_bf16 v[40:43], v[200:203], a[220:223], v[40:43]
  s_cselect_b32 s29, 0, s29
  v_add_u32 v6, s29, v4
  v_mfma_f32_16x16x32_bf16 v[44:47], v[204:207], a[220:223], v[44:47]
  v_add_u32 v7, s29, v5
  v_mfma_f32_16x16x32_bf16 v[76:79], v[204:207], a[224:227], v[76:79]
  v_mfma_f32_16x16x32_bf16 v[72:75], v[200:203], a[224:227], v[72:75]
  v_mfma_f32_16x16x32_bf16 v[104:107], v[200:203], a[228:231], v[104:107]
  s_waitcnt vmcnt(8) lgkmcnt(0)
  s_barrier
  s_add_u32 s40, s33, s35
  s_add_u32 s35, s35, 0x2000
  v_mfma_f32_16x16x32_bf16 v[108:111], v[204:207], a[228:231], v[108:111]
  ds_read_b64_tr_b16 v[184:185], v6 offset:0
  s_and_b32 s35, s35, 0x1ffff
  v_mfma_f32_16x16x32_bf16 v[140:143], v[204:207], a[232:235], v[140:143]
  ds_read_b64_tr_b16 v[186:187], v6 offset:1024
  s_add_u32 m0, s30, 16384
  v_mfma_f32_16x16x32_bf16 v[136:139], v[200:203], a[232:235], v[136:139]
  ds_read_b128 a[200:203], v7 offset:0
  v_mfma_f32_16x16x32_bf16 v[168:171], v[200:203], a[236:239], v[168:171]
  ds_read_b128 a[204:207], v7 offset:2048
  v_mfma_f32_16x16x32_bf16 v[172:175], v[204:207], a[236:239], v[172:175]
  buffer_load_dwordx4 v9, s[20:23], s40 offen offset:0 nt lds
  v_mfma_f32_16x16x32_bf16 v[176:179], v[208:211], a[236:239], v[176:179]
  ds_read_b128 a[208:211], v7 offset:4096
  v_mfma_f32_16x16x32_bf16 v[180:183], v[212:215], a[236:239], v[180:183]
  v_mfma_f32_16x16x32_bf16 v[148:151], v[212:215], a[232:235], v[148:151]
  ds_read_b64_tr_b16 v[188:189], v6 offset:8
  v_mfma_f32_16x16x32_bf16 v[144:147], v[208:211], a[232:235], v[144:147]
  ds_read_b64_tr_b16 v[190:191], v6 offset:1032
  v_mfma_f32_16x16x32_bf16 v[112:115], v[208:211], a[228:231], v[112:115]
  ds_read_b128 a[212:215], v7 offset:6144
  v_mfma_f32_16x16x32_bf16 v[116:119], v[212:215], a[228:231], v[116:119]
  ds_read_b128 a[216:219], v7 offset:8192
  v_mfma_f32_16x16x32_bf16 v[84:87], v[212:215], a[224:227], v[84:87]
  ds_read_b64_tr_b16 v[192:193], v6 offset:256
  v_mfma_f32_16x16x32_bf16 v[80:83], v[208:211], a[224:227], v[80:83]
  ds_read_b64_tr_b16 v[194:195], v6 offset:1280
  v_mfma_f32_16x16x32_bf16 v[48:51], v[208:211], a[220:223], v[48:51]
  buffer_load_dwordx4 v10, s[20:23], s40 offen offset:1024 nt lds
  v_mfma_f32_16x16x32_bf16 v[52:55], v[212:215], a[220:223], v[52:55]
  s_waitcnt lgkmcnt(4)
  v_mfma_f32_16x16x32_bf16 v[24:27], v[184:187], a[200:203], v[24:27]
  s_waitcnt lgkmcnt(2)
  v_mfma_f32_16x16x32_bf16 v[28:31], v[188:191], a[200:203], v[28:31]
  ds_read_b64_tr_b16 v[196:197], v6 offset:264
  v_mfma_f32_16x16x32_bf16 v[60:63], v[188:191], a[204:207], v[60:63]
  ds_read_b64_tr_b16 v[198:199], v6 offset:1288
  v_mfma_f32_16x16x32_bf16 v[56:59], v[184:187], a[204:207], v[56:59]
  ds_read_b128 a[220:223], v7 offset:256
  v_mfma_f32_16x16x32_bf16 v[88:91], v[184:187], a[208:211], v[88:91]
  ds_write_b128 v236, a[0:3] offset:0
  v_mfma_f32_16x16x32_bf16 v[92:95], v[188:191], a[208:211], v[92:95]
  ds_read_b64_tr_b16 v[200:201], v6 offset:512
  v_mfma_f32_16x16x32_bf16 v[124:127], v[188:191], a[212:215], v[124:127]
  ds_read_b64_tr_b16 v[202:203], v6 offset:1536
  v_mfma_f32_16x16x32_bf16 v[120:123], v[184:187], a[212:215], v[120:123]
  ds_read_b128 a[224:227], v7 offset:2304
  v_mfma_f32_16x16x32_bf16 v[152:155], v[184:187], a[216:219], v[152:155]
  buffer_load_dwordx4 v9, s[20:23], s40 offen offset:2048 nt lds
  v_mfma_f32_16x16x32_bf16 v[156:159], v[188:191], a[216:219], v[156:159]
  ds_write_b128 v236, a[4:7] offset:1024
  s_waitcnt lgkmcnt(6)
  v_mfma_f32_16x16x32_bf16 v[160:163], v[192:195], a[216:219], v[160:163]
  ds_read_b64_tr_b16 v[204:205], v6 offset:520
  v_mfma_f32_16x16x32_bf16 v[164:167], v[196:199], a[216:219], v[164:167]
  ds_read_b64_tr_b16 v[206:207], v6 offset:1544
  v_mfma_f32_16x16x32_bf16 v[132:135], v[196:199], a[212:215], v[132:135]
  ds_read_b128 a[228:231], v7 offset:4352
  v_mfma_f32_16x16x32_bf16 v[128:131], v[192:195], a[212:215], v[128:131]
  v_mfma_f32_16x16x32_bf16 v[96:99], v[192:195], a[208:211], v[96:99]
  ds_write_b128 v236, a[8:11] offset:2048
  v_mfma_f32_16x16x32_bf16 v[100:103], v[196:199], a[208:211], v[100:103]
  ds_read_b64_tr_b16 v[208:209], v6 offset:768
  v_mfma_f32_16x16x32_bf16 v[68:71], v[196:199], a[204:207], v[68:71]
  ds_read_b64_tr_b16 v[210:211], v6 offset:1792
  v_mfma_f32_16x16x32_bf16 v[64:67], v[192:195], a[204:207], v[64:67]
  ds_read_b128 a[232:235], v7 offset:6400
  v_mfma_f32_16x16x32_bf16 v[32:35], v[192:195], a[200:203], v[32:35]
  buffer_load_dwordx4 v10, s[20:23], s40 offen offset:3072 nt lds
  v_mfma_f32_16x16x32_bf16 v[36:39], v[196:199], a[200:203], v[36:39]
  ds_write_b128 v236, a[12:15] offset:3072
  s_waitcnt lgkmcnt(6)
  v_mfma_f32_16x16x32_bf16 v[40:43], v[200:203], a[200:203], v[40:43]
  ds_read_b64_tr_b16 v[212:213], v6 offset:776
  v_mfma_f32_16x16x32_bf16 v[44:47], v[204:207], a[200:203], v[44:47]
  ds_read_b64_tr_b16 v[214:215], v6 offset:1800
  v_mfma_f32_16x16x32_bf16 v[76:79], v[204:207], a[204:207], v[76:79]
  ds_read_b128 a[236:239], v7 offset:8448
  v_mfma_f32_16x16x32_bf16 v[72:75], v[200:203], a[204:207], v[72:75]
  s_add_u32 s39, s33, s34
  s_add_u32 s34, s34, 0x2000
  s_and_b32 s34, s34, 0x1ffff
  v_mfma_f32_16x16x32_bf16 v[104:107], v[200:203], a[208:211], v[104:107]
  ds_write_b128 v236, a[16:19] offset:4096
  s_mov_b32 m0, s30
  v_mfma_f32_16x16x32_bf16 v[108:111], v[204:207], a[208:211], v[108:111]
  ds_read_b64_tr_b16 v[184:185], v6 offset:16384
  v_mfma_f32_16x16x32_bf16 v[140:143], v[204:207], a[212:215], v[140:143]
  ds_read_b64_tr_b16 v[186:187], v6 offset:17408
  v_mfma_f32_16x16x32_bf16 v[136:139], v[200:203], a[212:215], v[136:139]
  v_mfma_f32_16x16x32_bf16 v[168:171], v[200:203], a[216:219], v[168:171]
  buffer_load_dwordx4 v9, s[16:19], s39 offen offset:0 nt lds
  v_mfma_f32_16x16x32_bf16 v[172:175], v[204:207], a[216:219], v[172:175]
  s_waitcnt lgkmcnt(4)
  v_mfma_f32_16x16x32_bf16 v[176:179], v[208:211], a[216:219], v[176:179]
  ds_read_b64_tr_b16 v[188:189], v6 offset:16392
  v_mfma_f32_16x16x32_bf16 v[180:183], v[212:215], a[216:219], v[180:183]
  ds_read_b64_tr_b16 v[190:191], v6 offset:17416
  v_mfma_f32_16x16x32_bf16 v[148:151], v[212:215], a[212:215], v[148:151]
  v_mfma_f32_16x16x32_bf16 v[144:147], v[208:211], a[212:215], v[144:147]
  v_mfma_f32_16x16x32_bf16 v[112:115], v[208:211], a[208:211], v[112:115]
  v_mfma_f32_16x16x32_bf16 v[116:119], v[212:215], a[208:211], v[116:119]
  ds_read_b64_tr_b16 v[192:193], v6 offset:16640
  v_mfma_f32_16x16x32_bf16 v[84:87], v[212:215], a[204:207], v[84:87]
  ds_read_b64_tr_b16 v[194:195], v6 offset:17664
  v_mfma_f32_16x16x32_bf16 v[80:83], v[208:211], a[204:207], v[80:83]
  v_mfma_f32_16x16x32_bf16 v[48:51], v[208:211], a[200:203], v[48:51]
  buffer_load_dwordx4 v10, s[16:19], s39 offen offset:1024 nt lds
  v_mfma_f32_16x16x32_bf16 v[52:55], v[212:215], a[200:203], v[52:55]
  s_waitcnt lgkmcnt(7)
  s_waitcnt lgkmcnt(2)
  v_mfma_f32_16x16x32_bf16 v[24:27], v[184:187], a[220:223], v[24:27]
  ds_read_b64_tr_b16 v[196:197], v6 offset:16648
  v_mfma_f32_16x16x32_bf16 v[28:31], v[188:191], a[220:223], v[28:31]
  ds_read_b64_tr_b16 v[198:199], v6 offset:17672
  v_mfma_f32_16x16x32_bf16 v[60:63], v[188:191], a[224:227], v[60:63]
  v_mfma_f32_16x16x32_bf16 v[56:59], v[184:187], a[224:227], v[56:59]
  v_mfma_f32_16x16x32_bf16 v[88:91], v[184:187], a[228:231], v[88:91]
  v_mfma_f32_16x16x32_bf16 v[92:95], v[188:191], a[228:231], v[92:95]
  ds_read_b64_tr_b16 v[200:201], v6 offset:16896
  v_mfma_f32_16x16x32_bf16 v[124:127], v[188:191], a[232:235], v[124:127]
  ds_read_b64_tr_b16 v[202:203], v6 offset:17920
  v_mfma_f32_16x16x32_bf16 v[120:123], v[184:187], a[232:235], v[120:123]
  v_mfma_f32_16x16x32_bf16 v[152:155], v[184:187], a[236:239], v[152:155]
  buffer_load_dwordx4 v9, s[16:19], s39 offen offset:2048 nt lds
  v_mfma_f32_16x16x32_bf16 v[156:159], v[188:191], a[236:239], v[156:159]
  s_waitcnt lgkmcnt(2)
  v_mul_f32 v24, s41, v24
  v_mfma_f32_16x16x32_bf16 v[160:163], v[192:195], a[236:239], v[160:163]
  ds_read_b64_tr_b16 v[204:205], v6 offset:16904
  v_mul_f32 v25, s41, v25
  v_mfma_f32_16x16x32_bf16 v[164:167], v[196:199], a[236:239], v[164:167]
  ds_read_b64_tr_b16 v[206:207], v6 offset:17928
  v_mul_f32 v26, s41, v26
  v_mfma_f32_16x16x32_bf16 v[132:135], v[196:199], a[232:235], v[132:135]
  ds_read_b64_tr_b16 v[208:209], v6 offset:17152
  v_mul_f32 v27, s41, v27
  v_mfma_f32_16x16x32_bf16 v[128:131], v[192:195], a[232:235], v[128:131]
  ds_read_b64_tr_b16 v[210:211], v6 offset:18176
  v_mul_f32 v28, s41, v28
  v_mfma_f32_16x16x32_bf16 v[96:99], v[192:195], a[228:231], v[96:99]
  v_mul_f32 v29, s41, v29
  v_mul_f32 v30, s41, v30
  v_mfma_f32_16x16x32_bf16 v[100:103], v[196:199], a[228:231], v[100:103]
  ds_read_b64_tr_b16 v[212:213], v6 offset:17160
  v_mul_f32 v31, s41, v31
  v_mfma_f32_16x16x32_bf16 v[68:71], v[196:199], a[224:227], v[68:71]
  ds_read_b64_tr_b16 v[214:215], v6 offset:18184
  v_cvt_pk_bf16_f32 v24, v24, v25
  v_cvt_pk_bf16_f32 v26, v26, v27
  v_cvt_pk_bf16_f32 v28, v28, v29
  v_cvt_pk_bf16_f32 v30, v30, v31
  v_accvgpr_write_b32 a160, v24
  v_mfma_f32_16x16x32_bf16 v[64:67], v[192:195], a[224:227], v[64:67]
  s_add_u32 s30, s29, s31
  v_accvgpr_write_b32 a161, v26
  v_accvgpr_write_b32 a162, v28
  v_accvgpr_write_b32 a163, v30
  v_mul_f32 v56, s41, v56
  v_mul_f32 v57, s41, v57
  v_mul_f32 v58, s41, v58
  v_mfma_f32_16x16x32_bf16 v[32:35], v[192:195], a[220:223], v[32:35]
  buffer_load_dwordx4 v10, s[16:19], s39 offen offset:3072 nt lds
  v_mul_f32 v59, s41, v59
  v_mul_f32 v60, s41, v60
  v_mul_f32 v61, s41, v61
  v_mul_f32 v62, s41, v62
  v_mul_f32 v63, s41, v63
  v_cvt_pk_bf16_f32 v56, v56, v57
  v_mfma_f32_16x16x32_bf16 v[36:39], v[196:199], a[220:223], v[36:39]
  s_waitcnt lgkmcnt(4)
  v_cvt_pk_bf16_f32 v58, v58, v59
  v_cvt_pk_bf16_f32 v60, v60, v61
  v_cvt_pk_bf16_f32 v62, v62, v63
  v_accvgpr_write_b32 a164, v56
  v_accvgpr_write_b32 a165, v58
  v_accvgpr_write_b32 a166, v60
  v_mfma_f32_16x16x32_bf16 v[40:43], v[200:203], a[220:223], v[40:43]
  v_accvgpr_write_b32 a167, v62
  v_mul_f32 v88, s41, v88
  v_mul_f32 v89, s41, v89
  v_mul_f32 v90, s41, v90
  v_mul_f32 v91, s41, v91
  v_mul_f32 v92, s41, v92
  v_mfma_f32_16x16x32_bf16 v[44:47], v[204:207], a[220:223], v[44:47]
  s_add_u32 s29, s29, 53248
  v_mul_f32 v93, s41, v93
  v_mul_f32 v94, s41, v94
  v_mul_f32 v95, s41, v95
  v_cvt_pk_bf16_f32 v88, v88, v89
  v_cvt_pk_bf16_f32 v90, v90, v91
  v_cvt_pk_bf16_f32 v92, v92, v93
  v_cvt_pk_bf16_f32 v94, v94, v95
  v_mfma_f32_16x16x32_bf16 v[76:79], v[204:207], a[224:227], v[76:79]
  s_cmp_eq_u32 s29, 159744
  v_accvgpr_write_b32 a168, v88
  v_accvgpr_write_b32 a169, v90
  v_accvgpr_write_b32 a170, v92
  v_accvgpr_write_b32 a171, v94
  v_mul_f32 v120, s41, v120
  v_mul_f32 v121, s41, v121
  v_mfma_f32_16x16x32_bf16 v[72:75], v[200:203], a[224:227], v[72:75]
  s_cselect_b32 s29, 0, s29
  v_mul_f32 v122, s41, v122
  v_mul_f32 v123, s41, v123
  v_mul_f32 v124, s41, v124
  v_mul_f32 v125, s41, v125
  v_mul_f32 v126, s41, v126
  v_mul_f32 v127, s41, v127
  v_mfma_f32_16x16x32_bf16 v[104:107], v[200:203], a[228:231], v[104:107]
  s_waitcnt vmcnt(8) lgkmcnt(0)
  s_barrier
  v_cvt_pk_bf16_f32 v120, v120, v121
  v_cvt_pk_bf16_f32 v122, v122, v123
  v_cvt_pk_bf16_f32 v124, v124, v125
  v_cvt_pk_bf16_f32 v126, v126, v127
  v_accvgpr_write_b32 a172, v120
  v_add_u32 v6, s29, v1
  v_accvgpr_write_b32 a173, v122
  v_mfma_f32_16x16x32_bf16 v[108:111], v[204:207], a[228:231], v[108:111]
  ds_read_b128 v[184:187], v6 offset:16384
  v_accvgpr_write_b32 a174, v124
  v_accvgpr_write_b32 a175, v126
  v_mul_f32 v152, s41, v152
  v_add_u32 v7, s29, v2
  v_mul_f32 v153, s41, v153
  v_mul_f32 v154, s41, v154
  v_mul_f32 v155, s41, v155
  v_mfma_f32_16x16x32_bf16 v[140:143], v[204:207], a[232:235], v[140:143]
  s_add_u32 s40, s33, s35
  v_mul_f32 v156, s41, v156
  v_add_u32 v8, s29, v3
  v_mul_f32 v157, s41, v157
  v_mul_f32 v158, s41, v158
  v_mul_f32 v159, s41, v159
  v_cvt_pk_bf16_f32 v152, v152, v153
  v_cvt_pk_bf16_f32 v154, v154, v155
  v_mfma_f32_16x16x32_bf16 v[136:139], v[200:203], a[232:235], v[136:139]
  s_add_u32 s35, s35, 0x2000
  v_cvt_pk_bf16_f32 v156, v156, v157
  v_cvt_pk_bf16_f32 v158, v158, v159
  v_accvgpr_write_b32 a176, v152
  v_accvgpr_write_b32 a177, v154
  v_accvgpr_write_b32 a178, v156
  v_accvgpr_write_b32 a179, v158
  v_mul_f32 v32, s41, v32
  v_mfma_f32_16x16x32_bf16 v[168:171], v[200:203], a[236:239], v[168:171]
  s_and_b32 s35, s35, 0x1ffff
  v_mul_f32 v33, s41, v33
  v_mul_f32 v34, s41, v34
  v_mul_f32 v35, s41, v35
  s_add_u32 m0, s30, 16384
  v_mul_f32 v36, s41, v36
  v_mul_f32 v37, s41, v37
  v_mfma_f32_16x16x32_bf16 v[172:175], v[204:207], a[236:239], v[172:175]
  buffer_load_dwordx4 v9, s[20:23], s40 offen offset:0 nt lds
  v_mul_f32 v38, s41, v38
  v_mul_f32 v39, s41, v39
  v_cvt_pk_bf16_f32 v32, v32, v33
  v_cvt_pk_bf16_f32 v34, v34, v35
  v_cvt_pk_bf16_f32 v36, v36, v37
  v_cvt_pk_bf16_f32 v38, v38, v39
  v_mfma_f32_16x16x32_bf16 v[176:179], v[208:211], a[236:239], v[176:179]
  ds_read_b128 v[188:191], v6 offset:20480
  v_accvgpr_write_b32 a180, v32
  v_accvgpr_write_b32 a181, v34
  v_accvgpr_write_b32 a182, v36
  v_accvgpr_write_b32 a183, v38
  v_mul_f32 v64, s41, v64
  v_mul_f32 v65, s41, v65
  v_mfma_f32_16x16x32_bf16 v[180:183], v[212:215], a[236:239], v[180:183]
  v_mul_f32 v66, s41, v66
  v_mul_f32 v67, s41, v67
  v_mul_f32 v68, s41, v68
  v_mul_f32 v69, s41, v69
  v_mul_f32 v70, s41, v70
  v_mfma_f32_16x16x32_bf16 v[148:151], v[212:215], a[232:235], v[148:151]
  v_mul_f32 v71, s41, v71
  v_cvt_pk_bf16_f32 v64, v64, v65
  v_cvt_pk_bf16_f32 v66, v66, v67
  v_cvt_pk_bf16_f32 v68, v68, v69
  v_cvt_pk_bf16_f32 v70, v70, v71
  v_accvgpr_write_b32 a184, v64
  v_mfma_f32_16x16x32_bf16 v[144:147], v[208:211], a[232:235], v[144:147]
  buffer_load_dwordx4 v10, s[20:23], s40 offen offset:1024 nt lds
  v_accvgpr_write_b32 a185, v66
  v_accvgpr_write_b32 a186, v68
  v_accvgpr_write_b32 a187, v70
  v_mul_f32 v96, s41, v96
  v_mul_f32 v97, s41, v97
  v_mul_f32 v98, s41, v98
  v_mfma_f32_16x16x32_bf16 v[112:115], v[208:211], a[228:231], v[112:115]
  v_mul_f32 v99, s41, v99
  v_mul_f32 v100, s41, v100
  v_mul_f32 v101, s41, v101
  v_mul_f32 v102, s41, v102
  v_mul_f32 v103, s41, v103
  v_cvt_pk_bf16_f32 v96, v96, v97
  v_mfma_f32_16x16x32_bf16 v[116:119], v[212:215], a[228:231], v[116:119]
  ds_read_b128 v[192:195], v6 offset:16640
  v_cvt_pk_bf16_f32 v98, v98, v99
  v_cvt_pk_bf16_f32 v100, v100, v101
  v_cvt_pk_bf16_f32 v102, v102, v103
  v_accvgpr_write_b32 a188, v96
  v_accvgpr_write_b32 a189, v98
  v_mfma_f32_16x16x32_bf16 v[84:87], v[212:215], a[224:227], v[84:87]
  v_accvgpr_write_b32 a190, v100
  v_accvgpr_write_b32 a191, v102
  v_mul_f32 v128, s41, v128
  v_mul_f32 v129, s41, v129
  v_mul_f32 v130, s41, v130
  v_mul_f32 v131, s41, v131
  v_mfma_f32_16x16x32_bf16 v[80:83], v[208:211], a[224:227], v[80:83]
  v_mul_f32 v132, s41, v132
  v_mul_f32 v133, s41, v133
  v_mul_f32 v134, s41, v134
  v_mul_f32 v135, s41, v135
  v_cvt_pk_bf16_f32 v128, v128, v129
  v_cvt_pk_bf16_f32 v130, v130, v131
  v_mfma_f32_16x16x32_bf16 v[48:51], v[208:211], a[220:223], v[48:51]
  buffer_load_dwordx4 v9, s[20:23], s40 offen offset:2048 nt lds
  v_cvt_pk_bf16_f32 v132, v132, v133
  v_cvt_pk_bf16_f32 v134, v134, v135
  v_accvgpr_write_b32 a192, v128
  v_accvgpr_write_b32 a193, v130
  v_accvgpr_write_b32 a194, v132
  v_mfma_f32_16x16x32_bf16 v[52:55], v[212:215], a[220:223], v[52:55]
  s_waitcnt lgkmcnt(2)
  v_accvgpr_write_b32 a195, v134
  v_mul_f32 v160, s41, v160
  v_mul_f32 v161, s41, v161
  v_mul_f32 v162, s41, v162
  v_mul_f32 v163, s41, v163
  v_mul_f32 v164, s41, v164
  v_mfma_f32_16x16x32_bf16 v[24:27], v[184:187], a[160:163], 0
  ds_read_b128 v[196:199], v6 offset:20736
  v_mul_f32 v165, s41, v165
  v_mul_f32 v166, s41, v166
  v_mul_f32 v167, s41, v167
  v_cvt_pk_bf16_f32 v160, v160, v161
  v_cvt_pk_bf16_f32 v162, v162, v163
  v_cvt_pk_bf16_f32 v164, v164, v165
  v_mfma_f32_16x16x32_bf16 v[56:59], v[184:187], a[164:167], 0
  v_cvt_pk_bf16_f32 v166, v166, v167
  v_accvgpr_write_b32 a196, v160
  v_accvgpr_write_b32 a197, v162
  v_accvgpr_write_b32 a198, v164
  v_accvgpr_write_b32 a199, v166
  v_mfma_f32_16x16x32_bf16 v[88:91], v[184:187], a[168:171], 0
  v_mul_f32 v40, s41, v40
  v_mul_f32 v41, s41, v41
  v_mul_f32 v42, s41, v42
  v_mfma_f32_16x16x32_bf16 v[120:123], v[184:187], a[172:175], 0
  buffer_load_dwordx4 v10, s[20:23], s40 offen offset:3072 nt lds
  v_mul_f32 v43, s41, v43
  v_mul_f32 v44, s41, v44
  v_mul_f32 v45, s41, v45
  v_mul_f32 v46, s41, v46
  v_mfma_f32_16x16x32_bf16 v[152:155], v[184:187], a[176:179], 0
  ds_write_b128 v236, a[40:43] offset:53248
  v_mul_f32 v47, s41, v47
  v_cvt_pk_bf16_f32 v40, v40, v41
  v_cvt_pk_bf16_f32 v42, v42, v43
  v_cvt_pk_bf16_f32 v44, v44, v45
  s_waitcnt lgkmcnt(3)
  v_mfma_f32_16x16x32_bf16 v[28:31], v[188:191], a[160:163], 0
  ds_read_b128 v[200:203], v6 offset:16896
  v_cvt_pk_bf16_f32 v46, v46, v47
  v_accvgpr_write_b32 a200, v40
  v_accvgpr_write_b32 a201, v42
  v_accvgpr_write_b32 a202, v44
  v_mfma_f32_16x16x32_bf16 v[60:63], v[188:191], a[164:167], 0
  v_accvgpr_write_b32 a203, v46
  v_mul_f32 v72, s41, v72
  v_mul_f32 v73, s41, v73
  v_mul_f32 v74, s41, v74
  v_mfma_f32_16x16x32_bf16 v[92:95], v[188:191], a[168:171], 0
  v_mul_f32 v75, s41, v75
  v_mul_f32 v76, s41, v76
  v_mul_f32 v77, s41, v77
  v_mul_f32 v78, s41, v78
  v_mul_f32 v79, s41, v79
  v_mfma_f32_16x16x32_bf16 v[124:127], v[188:191], a[172:175], 0
  s_add_u32 s39, s33, s34
  v_cvt_pk_bf16_f32 v72, v72, v73
  v_cvt_pk_bf16_f32 v74, v74, v75
  v_cvt_pk_bf16_f32 v76, v76, v77
  v_cvt_pk_bf16_f32 v78, v78, v79
  v_mfma_f32_16x16x32_bf16 v[156:159], v[188:191], a[176:179], 0
  ds_write_b128 v236, a[44:47] offset:54272
  v_accvgpr_write_b32 a204, v72
  v_accvgpr_write_b32 a205, v74
  v_accvgpr_write_b32 a206, v76
  v_accvgpr_write_b32 a207, v78
  s_waitcnt lgkmcnt(4)
  v_mfma_f32_16x16x32_bf16 v[24:27], v[192:195], a[180:183], v[24:27]
  ds_read_b128 v[204:207], v6 offset:20992
  v_mul_f32 v104, s41, v104
  v_mul_f32 v105, s41, v105
  v_mul_f32 v106, s41, v106
  v_mul_f32 v107, s41, v107
  v_mfma_f32_16x16x32_bf16 v[56:59], v[192:195], a[184:187], v[56:59]
  v_mul_f32 v108, s41, v108
  v_mul_f32 v109, s41, v109
  v_mul_f32 v110, s41, v110
  v_mul_f32 v111, s41, v111
  v_cvt_pk_bf16_f32 v104, v104, v105
  v_mfma_f32_16x16x32_bf16 v[88:91], v[192:195], a[188:191], v[88:91]
  s_add_u32 s34, s34, 0x2000
  v_cvt_pk_bf16_f32 v106, v106, v107
  v_cvt_pk_bf16_f32 v108, v108, v109
  v_cvt_pk_bf16_f32 v110, v110, v111
  v_accvgpr_write_b32 a208, v104
  v_mfma_f32_16x16x32_bf16 v[120:123], v[192:195], a[192:195], v[120:123]
  s_and_b32 s34, s34, 0x1ffff
  v_accvgpr_write_b32 a209, v106
  v_accvgpr_write_b32 a210, v108
  s_mov_b32 m0, s30
  v_accvgpr_write_b32 a211, v110
  v_mul_f32 v136, s41, v136
  v_mfma_f32_16x16x32_bf16 v[152:155], v[192:195], a[196:199], v[152:155]
  buffer_load_dwordx4 v9, s[16:19], s39 offen offset:0 nt lds
  v_mul_f32 v137, s41, v137
  v_mul_f32 v138, s41, v138
  v_mul_f32 v139, s41, v139
  v_mul_f32 v140, s41, v140
  s_waitcnt lgkmcnt(4)
  v_mfma_f32_16x16x32_bf16 v[28:31], v[196:199], a[180:183], v[28:31]
  ds_write_b128 v236, a[48:51] offset:55296
  v_mul_f32 v141, s41, v141
  v_mul_f32 v142, s41, v142
  v_mul_f32 v143, s41, v143
  v_cvt_pk_bf16_f32 v136, v136, v137
  v_mfma_f32_16x16x32_bf16 v[60:63], v[196:199], a[184:187], v[60:63]
  v_cvt_pk_bf16_f32 v138, v138, v139
  v_cvt_pk_bf16_f32 v140, v140, v141
  v_cvt_pk_bf16_f32 v142, v142, v143
  v_accvgpr_write_b32 a212, v136
  v_accvgpr_write_b32 a213, v138
  v_mfma_f32_16x16x32_bf16 v[92:95], v[196:199], a[188:191], v[92:95]
  ds_read_b128 v[208:211], v6 offset:17152
  v_accvgpr_write_b32 a214, v140
  v_accvgpr_write_b32 a215, v142
  v_mul_f32 v168, s41, v168
  v_mul_f32 v169, s41, v169
  v_mfma_f32_16x16x32_bf16 v[124:127], v[196:199], a[192:195], v[124:127]
  buffer_load_dwordx4 v10, s[16:19], s39 offen offset:1024 nt lds
  v_mul_f32 v170, s41, v170
  v_mul_f32 v171, s41, v171
  v_mul_f32 v172, s41, v172
  v_mul_f32 v173, s41, v173
  v_mfma_f32_16x16x32_bf16 v[156:159], v[196:199], a[196:199], v[156:159]
  ds_write_b128 v236, a[52:55] offset:56320
  v_mul_f32 v174, s41, v174
  v_mul_f32 v175, s41, v175
  v_cvt_pk_bf16_f32 v168, v168, v169
  v_cvt_pk_bf16_f32 v170, v170, v171
  s_waitcnt lgkmcnt(5)
  v_mfma_f32_16x16x32_bf16 v[24:27], v[200:203], a[200:203], v[24:27]
  ds_read_b128 v[212:215], v6 offset:21248
  v_cvt_pk_bf16_f32 v172, v172, v173
  v_cvt_pk_bf16_f32 v174, v174, v175
  v_accvgpr_write_b32 a216, v168
  v_accvgpr_write_b32 a217, v170
  v_mfma_f32_16x16x32_bf16 v[56:59], v[200:203], a[204:207], v[56:59]
  v_accvgpr_write_b32 a218, v172
  v_accvgpr_write_b32 a219, v174
  v_mul_f32 v48, s41, v48
  v_mul_f32 v49, s41, v49
  v_mul_f32 v50, s41, v50
  v_mul_f32 v51, s41, v51
  v_mfma_f32_16x16x32_bf16 v[88:91], v[200:203], a[208:211], v[88:91]
  v_mul_f32 v52, s41, v52
  v_mul_f32 v53, s41, v53
  v_mul_f32 v54, s41, v54
  v_mul_f32 v55, s41, v55
  v_cvt_pk_bf16_f32 v48, v48, v49
  v_cvt_pk_bf16_f32 v50, v50, v51
  v_cvt_pk_bf16_f32 v52, v52, v53
  v_cvt_pk_bf16_f32 v54, v54, v55
  v_mfma_f32_16x16x32_bf16 v[120:123], v[200:203], a[212:215], v[120:123]
  buffer_load_dwordx4 v9, s[16:19], s39 offen offset:2048 nt lds
  v_accvgpr_write_b32 a220, v48
  v_accvgpr_write_b32 a221, v50
  v_accvgpr_write_b32 a222, v52
  v_accvgpr_write_b32 a223, v54
  v_mul_f32 v80, s41, v80
  v_mul_f32 v81, s41, v81
  v_mul_f32 v82, s41, v82
  v_mul_f32 v83, s41, v83
  v_mfma_f32_16x16x32_bf16 v[152:155], v[200:203], a[216:219], v[152:155]
  ds_write_b128 v236, a[56:59] offset:57344
  v_mul_f32 v84, s41, v84
  v_mul_f32 v85, s41, v85
  v_mul_f32 v86, s41, v86
  v_mul_f32 v87, s41, v87
  v_cvt_pk_bf16_f32 v80, v80, v81
  v_cvt_pk_bf16_f32 v82, v82, v83
  v_cvt_pk_bf16_f32 v84, v84, v85
  v_cvt_pk_bf16_f32 v86, v86, v87
  s_waitcnt lgkmcnt(5)
  v_mfma_f32_16x16x32_bf16 v[28:31], v[204:207], a[200:203], v[28:31]
  ds_read_b128 v[184:187], v6 offset:0
  v_accvgpr_write_b32 a224, v80
  v_accvgpr_write_b32 a225, v82
  v_accvgpr_write_b32 a226, v84
  v_accvgpr_write_b32 a227, v86
  v_mul_f32 v112, s41, v112
  v_mul_f32 v113, s41, v113
  v_mul_f32 v114, s41, v114
  v_mul_f32 v115, s41, v115
  v_mfma_f32_16x16x32_bf16 v[60:63], v[204:207], a[204:207], v[60:63]
  v_mul_f32 v116, s41, v116
  v_mul_f32 v117, s41, v117
  v_mul_f32 v118, s41, v118
  v_mul_f32 v119, s41, v119
  v_cvt_pk_bf16_f32 v112, v112, v113
  v_cvt_pk_bf16_f32 v114, v114, v115
  v_cvt_pk_bf16_f32 v116, v116, v117
  v_cvt_pk_bf16_f32 v118, v118, v119
  v_mfma_f32_16x16x32_bf16 v[92:95], v[204:207], a[208:211], v[92:95]
  v_accvgpr_write_b32 a228, v112
  v_accvgpr_write_b32 a229, v114
  v_accvgpr_write_b32 a230, v116
  v_accvgpr_write_b32 a231, v118
  v_mul_f32 v144, s41, v144
  v_mul_f32 v145, s41, v145
  v_mul_f32 v146, s41, v146
  v_mul_f32 v147, s41, v147
  v_mfma_f32_16x16x32_bf16 v[124:127], v[204:207], a[212:215], v[124:127]
  buffer_load_dwordx4 v10, s[16:19], s39 offen offset:3072 nt lds
  v_mul_f32 v148, s41, v148
  v_mul_f32 v149, s41, v149
  v_mul_f32 v150, s41, v150
  v_mul_f32 v151, s41, v151
  v_cvt_pk_bf16_f32 v144, v144, v145
  v_cvt_pk_bf16_f32 v146, v146, v147
  v_cvt_pk_bf16_f32 v148, v148, v149
  v_cvt_pk_bf16_f32 v150, v150, v151
  v_mfma_f32_16x16x32_bf16 v[156:159], v[204:207], a[216:219], v[156:159]
  s_waitcnt lgkmcnt(4)
  v_accvgpr_write_b32 a232, v144
  v_accvgpr_write_b32 a233, v146
  v_accvgpr_write_b32 a234, v148
  v_accvgpr_write_b32 a235, v150
  v_mul_f32 v176, s41, v176
  v_mul_f32 v177, s41, v177
  v_mul_f32 v178, s41, v178
  v_mul_f32 v179, s41, v179
  v_mfma_f32_16x16x32_bf16 v[24:27], v[208:211], a[220:223], v[24:27]
  ds_read_b128 v[188:191], v6 offset:256
  v_mul_f32 v180, s41, v180
  v_mul_f32 v181, s41, v181
  v_mul_f32 v182, s41, v182
  v_mul_f32 v183, s41, v183
  v_cvt_pk_bf16_f32 v176, v176, v177
  v_cvt_pk_bf16_f32 v178, v178, v179
  v_cvt_pk_bf16_f32 v180, v180, v181
  v_cvt_pk_bf16_f32 v182, v182, v183
  v_mfma_f32_16x16x32_bf16 v[56:59], v[208:211], a[224:227], v[56:59]
  v_accvgpr_write_b32 a236, v176
  v_accvgpr_write_b32 a237, v178
  v_accvgpr_write_b32 a238, v180
  v_accvgpr_write_b32 a239, v182
  v_mfma_f32_16x16x32_bf16 v[88:91], v[208:211], a[228:231], v[88:91]
  v_mfma_f32_16x16x32_bf16 v[120:123], v[208:211], a[232:235], v[120:123]
  v_mfma_f32_16x16x32_bf16 v[152:155], v[208:211], a[236:239], v[152:155]
  s_waitcnt lgkmcnt(3)
  v_mfma_f32_16x16x32_bf16 v[28:31], v[212:215], a[220:223], v[28:31]
  ds_read_b128 v[192:195], v6 offset:512
  v_mfma_f32_16x16x32_bf16 v[60:63], v[212:215], a[224:227], v[60:63]
  v_max3_f32 v216, v24, v25, v26
  v_max3_f32 v218, v56, v57, v58
  v_mfma_f32_16x16x32_bf16 v[92:95], v[212:215], a[228:231], v[92:95]
  v_max3_f32 v220, v88, v89, v90
  v_max3_f32 v222, v120, v121, v122
  v_mfma_f32_16x16x32_bf16 v[124:127], v[212:215], a[232:235], v[124:127]
  ds_read_b128 v[196:199], v6 offset:768
  v_max3_f32 v224, v152, v153, v154
  v_mfma_f32_16x16x32_bf16 v[156:159], v[212:215], a[236:239], v[156:159]
  ds_read_b128 v[200:203], v6 offset:4096
  v_max3_f32 v217, v27, v28, v29
  v_max3_f32 v216, v216, v30, v31
  v_max_f32 v216, v216, v217
  v_mov_b32 v217, v216
  s_nop 1
  v_permlane16_swap_b32 v216, v217
  v_max_f32 v216, v216, v217
  v_mov_b32 v217, v216
  s_nop 1
  v_permlane32_swap_b32 v216, v217
  v_max_f32 v216, v216, v217
  v_sub_f32 v48, 0, v216
  v_sub_f32 v49, 0, v216
  v_sub_f32 v50, 0, v216
  v_sub_f32 v51, 0, v216
  s_waitcnt lgkmcnt(4)
  s_nop 0
  v_mfma_f32_16x16x32_bf16 v[32:35], v[184:187], a[160:163], v[48:51]
  ds_read_b128 v[204:207], v6 offset:4352
  v_max3_f32 v219, v59, v60, v61
  v_max3_f32 v218, v218, v62, v63
  v_max_f32 v218, v218, v219
  v_mov_b32 v219, v218
  s_nop 1
  v_permlane16_swap_b32 v218, v219
  v_max_f32 v218, v218, v219
  v_mov_b32 v219, v218
  s_nop 1
  v_permlane32_swap_b32 v218, v219
  v_max_f32 v218, v218, v219
  v_sub_f32 v80, 0, v218
  v_sub_f32 v81, 0, v218
  v_sub_f32 v82, 0, v218
  v_sub_f32 v83, 0, v218
  s_nop 1
  v_mfma_f32_16x16x32_bf16 v[64:67], v[184:187], a[164:167], v[80:83]
  v_max3_f32 v221, v91, v92, v93
  v_max3_f32 v220, v220, v94, v95
  v_max3_f32 v223, v123, v124, v125
  v_max3_f32 v225, v155, v156, v157
  v_max3_f32 v222, v222, v126, v127
  v_max3_f32 v224, v224, v158, v159
  v_max_f32 v220, v220, v221
  v_max_f32 v222, v222, v223
  v_max_f32 v224, v224, v225
  v_mov_b32 v221, v220
  v_mov_b32 v223, v222
  v_mov_b32 v225, v224
  v_permlane16_swap_b32 v220, v221
  v_permlane16_swap_b32 v222, v223
  v_permlane16_swap_b32 v224, v225
  v_max_f32 v220, v220, v221
  v_max_f32 v222, v222, v223
  v_max_f32 v224, v224, v225
  v_mov_b32 v221, v220
  v_mov_b32 v223, v222
  v_mov_b32 v225, v224
  v_permlane32_swap_b32 v220, v221
  v_permlane32_swap_b32 v222, v223
  v_permlane32_swap_b32 v224, v225
  v_max_f32 v220, v220, v221
  v_max_f32 v222, v222, v223
  v_max_f32 v224, v224, v225
  v_sub_f32 v112, 0, v220
  v_sub_f32 v144, 0, v222
  v_sub_f32 v176, 0, v224
  v_sub_f32 v113, 0, v220
  v_sub_f32 v145, 0, v222
  v_sub_f32 v177, 0, v224
  v_sub_f32 v114, 0, v220
  v_sub_f32 v146, 0, v222
  v_sub_f32 v178, 0, v224
  v_sub_f32 v115, 0, v220
  v_sub_f32 v147, 0, v222
  v_sub_f32 v179, 0, v224
  v_mfma_f32_16x16x32_bf16 v[96:99], v[184:187], a[168:171], v[112:115]
  ds_read_b128 v[208:211], v6 offset:4608
  v_add_f32 v24, v24, v48
  v_add_f32 v25, v25, v48
  v_add_f32 v26, v26, v48
  v_mfma_f32_16x16x32_bf16 v[128:131], v[184:187], a[172:175], v[144:147]
  ds_read_b128 v[212:215], v6 offset:4864
  v_add_f32 v27, v27, v48
  v_add_f32 v56, v56, v80
  v_add_f32 v57, v57, v80
  v_add_f32 v58, v58, v80
  v_mfma_f32_16x16x32_bf16 v[160:163], v[184:187], a[176:179], v[176:179]
  s_waitcnt lgkmcnt(6)
  v_add_f32 v59, v59, v80
  v_add_f32 v88, v88, v112
  v_add_f32 v89, v89, v112
  v_add_f32 v90, v90, v112
  v_add_f32 v91, v91, v112
  v_mfma_f32_16x16x32_bf16 v[32:35], v[188:191], a[180:183], v[32:35]
  s_add_u32 s30, s29, s31
  v_add_f32 v120, v120, v144
  v_add_f32 v121, v121, v144
  v_add_f32 v122, v122, v144
  v_add_f32 v123, v123, v144
  v_mfma_f32_16x16x32_bf16 v[64:67], v[188:191], a[184:187], v[64:67]
  s_add_u32 s29, s29, 53248
  v_add_f32 v152, v152, v176
  v_add_f32 v153, v153, v176
  v_add_f32 v154, v154, v176
  v_add_f32 v155, v155, v176
  v_add_f32 v28, v28, v48
  v_mfma_f32_16x16x32_bf16 v[96:99], v[188:191], a[188:191], v[96:99]
  s_cmp_eq_u32 s29, 159744
  v_add_f32 v29, v29, v48
  v_add_f32 v30, v30, v48
  v_add_f32 v31, v31, v48
  v_add_f32 v60, v60, v80
  v_add_f32 v61, v61, v80
  v_mfma_f32_16x16x32_bf16 v[128:131], v[188:191], a[192:195], v[128:131]
  s_cselect_b32 s29, 0, s29
  v_add_f32 v62, v62, v80
  v_add_f32 v63, v63, v80
  v_add_f32 v92, v92, v112
  v_add_f32 v93, v93, v112
  v_mfma_f32_16x16x32_bf16 v[160:163], v[188:191], a[196:199], v[160:163]
  s_waitcnt lgkmcnt(5)
  v_add_f32 v94, v94, v112
  v_add_f32 v95, v95, v112
  v_add_f32 v124, v124, v144
  v_add_f32 v125, v125, v144
  v_add_u32 v6, s29, v1
  v_add_f32 v126, v126, v144
  v_mfma_f32_16x16x32_bf16 v[32:35], v[192:195], a[200:203], v[32:35]
  s_waitcnt vmcnt(8) lgkmcnt(0)
  s_barrier
  v_exp_f32 v216, v24
  v_add_f32 v127, v127, v144
  v_add_f32 v156, v156, v176
  v_add_u32 v7, s29, v2
  v_add_f32 v157, v157, v176
  v_add_f32 v158, v158, v176
  v_mfma_f32_16x16x32_bf16 v[64:67], v[192:195], a[204:207], v[64:67]
  s_add_u32 s40, s33, s35
  v_exp_f32 v217, v25
  v_add_f32 v159, v159, v176
  v_add_u32 v8, s29, v3
  v_mfma_f32_16x16x32_bf16 v[96:99], v[192:195], a[208:211], v[96:99]
  s_add_u32 s35, s35, 0x2000
  v_exp_f32 v218, v26
  v_cvt_pk_bf16_f32 v40, v216, v217
  v_exp_f32 v219, v27
  v_mfma_f32_16x16x32_bf16 v[128:131], v[192:195], a[212:215], v[128:131]
  s_and_b32 s35, s35, 0x1ffff
  v_exp_f32 v220, v56
  v_add_f32 v53, v216, v217
  s_add_u32 m0, s30, 16384
  v_cvt_pk_bf16_f32 v41, v218, v219
  v_mfma_f32_16x16x32_bf16 v[160:163], v[192:195], a[216:219], v[160:163]
  buffer_load_dwordx4 v9, s[20:23], s40 offen offset:0 nt lds
  v_exp_f32 v221, v57
  v_add_f32 v53, v53, v218
  v_add_f32 v53, v53, v219
  v_mfma_f32_16x16x32_bf16 v[32:35], v[196:199], a[220:223], v[32:35]
  v_exp_f32 v222, v58
  v_cvt_pk_bf16_f32 v72, v220, v221
  v_exp_f32 v223, v59
  v_mfma_f32_16x16x32_bf16 v[64:67], v[196:199], a[224:227], v[64:67]
  v_exp_f32 v224, v88
  v_add_f32 v85, v220, v221
  v_cvt_pk_bf16_f32 v73, v222, v223
  v_exp_f32 v225, v89
  v_mfma_f32_16x16x32_bf16 v[96:99], v[196:199], a[228:231], v[96:99]
  v_exp_f32 v226, v90
  v_add_f32 v85, v85, v222
  v_add_f32 v85, v85, v223
  v_mfma_f32_16x16x32_bf16 v[128:131], v[196:199], a[232:235], v[128:131]
  buffer_load_dwordx4 v10, s[20:23], s40 offen offset:1024 nt lds
  v_cvt_pk_bf16_f32 v104, v224, v225
  v_exp_f32 v227, v91
  v_add_f32 v117, v224, v225
  v_mfma_f32_16x16x32_bf16 v[160:163], v[196:199], a[236:239], v[160:163]
  v_exp_f32 v228, v120
  v_cvt_pk_bf16_f32 v105, v226, v227
  v_exp_f32 v229, v121
  v_mfma_f32_16x16x32_bf16 v[36:39], v[200:203], a[160:163], v[48:51]
  v_exp_f32 v230, v122
  v_add_f32 v117, v117, v226
  v_add_f32 v117, v117, v227
  v_mfma_f32_16x16x32_bf16 v[68:71], v[200:203], a[164:167], v[80:83]
  v_exp_f32 v231, v123
  v_cvt_pk_bf16_f32 v136, v228, v229
  v_add_f32 v149, v228, v229
  v_mfma_f32_16x16x32_bf16 v[100:103], v[200:203], a[168:171], v[112:115]
  v_exp_f32 v216, v152
  v_cvt_pk_bf16_f32 v137, v230, v231
  v_exp_f32 v217, v153
  v_mfma_f32_16x16x32_bf16 v[132:135], v[200:203], a[172:175], v[144:147]
  v_exp_f32 v218, v154
  v_add_f32 v149, v149, v230
  v_add_f32 v149, v149, v231
  v_mfma_f32_16x16x32_bf16 v[164:167], v[200:203], a[176:179], v[176:179]
  v_exp_f32 v219, v155
  v_cvt_pk_bf16_f32 v168, v216, v217
  v_add_f32 v181, v216, v217
  v_exp_f32 v220, v28
  v_mfma_f32_16x16x32_bf16 v[36:39], v[204:207], a[180:183], v[36:39]
  ds_read_b64_tr_b16 v[184:185], v7 offset:16384
  v_cvt_pk_bf16_f32 v169, v218, v219
  v_exp_f32 v221, v29
  v_add_f32 v181, v181, v218
  v_mfma_f32_16x16x32_bf16 v[68:71], v[204:207], a[184:187], v[68:71]
  ds_read_b64_tr_b16 v[186:187], v7 offset:20480
  v_add_f32 v181, v181, v219
  v_exp_f32 v222, v30
  v_cvt_pk_bf16_f32 v42, v220, v221
  v_mfma_f32_16x16x32_bf16 v[100:103], v[204:207], a[188:191], v[100:103]
  v_exp_f32 v223, v31
  v_add_f32 v53, v53, v220
  v_add_f32 v53, v53, v221
  v_exp_f32 v224, v60
  v_mfma_f32_16x16x32_bf16 v[132:135], v[204:207], a[192:195], v[132:135]
  buffer_load_dwordx4 v9, s[20:23], s40 offen offset:2048 nt lds
  v_cvt_pk_bf16_f32 v43, v222, v223
  v_exp_f32 v225, v61
  v_mfma_f32_16x16x32_bf16 v[164:167], v[204:207], a[196:199], v[164:167]
  v_exp_f32 v226, v62
  v_add_f32 v53, v53, v222
  v_add_f32 v53, v53, v223
  v_cvt_pk_bf16_f32 v74, v224, v225
  v_mfma_f32_16x16x32_bf16 v[36:39], v[208:211], a[200:203], v[36:39]
  ds_read_b64_tr_b16 v[188:189], v8 offset:16384
  v_add_f32 v85, v85, v224
  v_exp_f32 v227, v63
  v_add_f32 v85, v85, v225
  v_mfma_f32_16x16x32_bf16 v[68:71], v[208:211], a[204:207], v[68:71]
  ds_read_b64_tr_b16 v[190:191], v8 offset:20480
  v_cvt_pk_bf16_f32 v75, v226, v227
  v_exp_f32 v228, v92
  v_exp_f32 v229, v93
  v_mfma_f32_16x16x32_bf16 v[100:103], v[208:211], a[208:211], v[100:103]
  v_exp_f32 v230, v94
  v_add_f32 v85, v85, v226
  v_add_f32 v85, v85, v227
  v_mfma_f32_16x16x32_bf16 v[132:135], v[208:211], a[212:215], v[132:135]
  v_exp_f32 v231, v95
  v_cvt_pk_bf16_f32 v106, v228, v229
  v_add_f32 v117, v117, v228
  v_add_f32 v117, v117, v229
  v_mfma_f32_16x16x32_bf16 v[164:167], v[208:211], a[216:219], v[164:167]
  v_exp_f32 v216, v124
  v_cvt_pk_bf16_f32 v107, v230, v231
  v_exp_f32 v217, v125
  v_mfma_f32_16x16x32_bf16 v[36:39], v[212:215], a[220:223], v[36:39]
  ds_read_b128 v[192:195], v6 offset:0
  v_add_f32 v117, v117, v230
  v_add_f32 v117, v117, v231
  v_exp_f32 v218, v126
  v_mfma_f32_16x16x32_bf16 v[68:71], v[212:215], a[224:227], v[68:71]
  v_exp_f32 v219, v127
  v_cvt_pk_bf16_f32 v138, v216, v217
  v_add_f32 v149, v149, v216
  v_add_f32 v149, v149, v217
  v_mfma_f32_16x16x32_bf16 v[100:103], v[212:215], a[228:231], v[100:103]
  v_exp_f32 v220, v156
  v_cvt_pk_bf16_f32 v139, v218, v219
  v_exp_f32 v221, v157
  v_mfma_f32_16x16x32_bf16 v[132:135], v[212:215], a[232:235], v[132:135]
  buffer_load_dwordx4 v10, s[20:23], s40 offen offset:3072 nt lds
  v_add_f32 v149, v149, v218
  v_add_f32 v149, v149, v219
  v_exp_f32 v222, v158
  v_mfma_f32_16x16x32_bf16 v[164:167], v[212:215], a[236:239], v[164:167]
  s_waitcnt lgkmcnt(1)
  v_exp_f32 v223, v159
  v_cvt_pk_bf16_f32 v170, v220, v221
  v_add_f32 v181, v181, v220
  v_mfma_f32_16x16x32_bf16 a[0:3], v[184:187], v[40:43], 0
  ds_read_b128 v[196:199], v6 offset:256
  v_add_f32 v181, v181, v221
  v_cvt_pk_bf16_f32 v171, v222, v223
  v_add_f32 v181, v181, v222
  v_add_f32 v181, v181, v223
  v_mov_b32 v52, v53
  v_mfma_f32_16x16x32_bf16 a[20:23], v[188:191], v[40:43], 0
  v_mov_b32 v84, v85
  v_mov_b32 v116, v117
  v_mov_b32 v148, v149
  v_mov_b32 v180, v181
  v_mfma_f32_16x16x32_bf16 a[24:27], v[188:191], v[72:75], 0
  v_exp_f32 v216, v32
  v_mfma_f32_16x16x32_bf16 a[4:7], v[184:187], v[72:75], 0
  s_add_u32 s39, s33, s34
  v_exp_f32 v217, v33
  v_mfma_f32_16x16x32_bf16 a[8:11], v[184:187], v[104:107], 0
  s_add_u32 s34, s34, 0x2000
  v_exp_f32 v218, v34
  v_mfma_f32_16x16x32_bf16 a[28:31], v[188:191], v[104:107], 0
  ds_read_b64_tr_b16 v[200:201], v7 offset:16640
  v_cvt_pk_bf16_f32 v44, v216, v217
  v_mfma_f32_16x16x32_bf16 a[32:35], v[188:191], v[136:139], 0
  ds_read_b64_tr_b16 v[202:203], v7 offset:20736
  v_add_f32 v53, v216, v217
  v_mfma_f32_16x16x32_bf16 a[12:15], v[184:187], v[136:139], 0
  s_and_b32 s34, s34, 0x1ffff
  v_exp_f32 v219, v35
  v_mfma_f32_16x16x32_bf16 a[16:19], v[184:187], v[168:171], 0
  s_mov_b32 m0, s30
  v_exp_f32 v220, v64
  v_mfma_f32_16x16x32_bf16 a[36:39], v[188:191], v[168:171], 0
  buffer_load_dwordx4 v9, s[16:19], s39 offen offset:0 nt lds
  s_waitcnt lgkmcnt(3)
  v_mfma_f32_16x16x32_bf16 v[152:155], v[192:195], a[176:179], v[176:179]
  ds_read_b64_tr_b16 v[204:205], v8 offset:16640
  v_cvt_pk_bf16_f32 v45, v218, v219
  s_waitcnt lgkmcnt(3)
  v_mfma_f32_16x16x32_bf16 v[152:155], v[196:199], a[196:199], v[152:155]
  v_exp_f32 v221, v65
  v_mfma_f32_16x16x32_bf16 v[120:123], v[196:199], a[192:195], v[144:147]
  ds_read_b64_tr_b16 v[206:207], v8 offset:20736
  v_add_f32 v53, v53, v218
  v_mfma_f32_16x16x32_bf16 v[120:123], v[192:195], a[172:175], v[120:123]
  buffer_load_dwordx4 v10, s[16:19], s39 offen offset:1024 nt lds
  v_add_f32 v53, v53, v219
  v_mfma_f32_16x16x32_bf16 v[88:91], v[192:195], a[168:171], v[112:115]
  v_exp_f32 v222, v66
  v_mfma_f32_16x16x32_bf16 v[88:91], v[196:199], a[188:191], v[88:91]
  ds_read_b128 v[208:211], v6 offset:512
  v_cvt_pk_bf16_f32 v76, v220, v221
  v_exp_f32 v223, v67
  v_mfma_f32_16x16x32_bf16 v[56:59], v[196:199], a[184:187], v[80:83]
  v_exp_f32 v224, v96
  v_add_f32 v85, v220, v221
  v_mfma_f32_16x16x32_bf16 v[56:59], v[192:195], a[164:167], v[56:59]
  v_exp_f32 v225, v97
  v_mfma_f32_16x16x32_bf16 v[24:27], v[192:195], a[160:163], v[48:51]
  v_cvt_pk_bf16_f32 v77, v222, v223
  v_add_f32 v85, v85, v222
  v_mfma_f32_16x16x32_bf16 v[24:27], v[196:199], a[180:183], v[24:27]
  s_waitcnt lgkmcnt(1)
  v_exp_f32 v226, v98
  v_mfma_f32_16x16x32_bf16 a[40:43], v[200:203], v[40:43], 0
  ds_read_b128 v[212:215], v6 offset:768
  v_add_f32 v85, v85, v223
  v_mfma_f32_16x16x32_bf16 a[60:63], v[204:207], v[40:43], 0
  v_exp_f32 v227, v99
  v_mfma_f32_16x16x32_bf16 a[64:67], v[204:207], v[72:75], 0
  v_cvt_pk_bf16_f32 v108, v224, v225
  v_add_f32 v117, v224, v225
  v_mfma_f32_16x16x32_bf16 a[44:47], v[200:203], v[72:75], 0
  buffer_load_dwordx4 v9, s[16:19], s39 offen offset:2048 nt lds
  v_mfma_f32_16x16x32_bf16 a[48:51], v[200:203], v[104:107], 0
  v_exp_f32 v228, v128
  v_mfma_f32_16x16x32_bf16 a[68:71], v[204:207], v[104:107], 0
  ds_read_b64_tr_b16 v[184:185], v7 offset:16896
  v_cvt_pk_bf16_f32 v109, v226, v227
  v_mfma_f32_16x16x32_bf16 a[72:75], v[204:207], v[136:139], 0
  ds_read_b64_tr_b16 v[186:187], v7 offset:20992
  v_add_f32 v117, v117, v226
  v_exp_f32 v229, v129
  v_mfma_f32_16x16x32_bf16 a[52:55], v[200:203], v[136:139], 0
  v_exp_f32 v230, v130
  v_mfma_f32_16x16x32_bf16 a[56:59], v[200:203], v[168:171], 0
  v_add_f32 v117, v117, v227
  v_cvt_pk_bf16_f32 v140, v228, v229
  v_mfma_f32_16x16x32_bf16 a[76:79], v[204:207], v[168:171], 0
  s_waitcnt lgkmcnt(2)
  v_exp_f32 v231, v131
  v_mfma_f32_16x16x32_bf16 v[152:155], v[208:211], a[216:219], v[152:155]
  ds_read_b64_tr_b16 v[188:189], v8 offset:16896
  v_add_f32 v149, v228, v229
  v_mfma_f32_16x16x32_bf16 v[152:155], v[212:215], a[236:239], v[152:155]
  v_exp_f32 v216, v160
  v_mfma_f32_16x16x32_bf16 v[120:123], v[212:215], a[232:235], v[120:123]
  ds_read_b64_tr_b16 v[190:191], v8 offset:20992
  v_cvt_pk_bf16_f32 v141, v230, v231
  v_mfma_f32_16x16x32_bf16 v[120:123], v[208:211], a[212:215], v[120:123]
  buffer_load_dwordx4 v10, s[16:19], s39 offen offset:3072 nt lds
  v_exp_f32 v217, v161
  v_mfma_f32_16x16x32_bf16 v[88:91], v[208:211], a[208:211], v[88:91]
  v_exp_f32 v218, v162
  v_add_f32 v149, v149, v230
  v_mfma_f32_16x16x32_bf16 v[88:91], v[212:215], a[228:231], v[88:91]
  ds_read_b128 v[192:195], v6 offset:4096
  v_add_f32 v149, v149, v231
  v_mfma_f32_16x16x32_bf16 v[56:59], v[212:215], a[224:227], v[56:59]
  v_exp_f32 v219, v163
  v_mfma_f32_16x16x32_bf16 v[56:59], v[208:211], a[204:207], v[56:59]
  v_cvt_pk_bf16_f32 v172, v216, v217
  v_add_f32 v181, v216, v217
  v_mfma_f32_16x16x32_bf16 v[24:27], v[208:211], a[200:203], v[24:27]
  v_exp_f32 v220, v36
  v_mfma_f32_16x16x32_bf16 v[24:27], v[212:215], a[220:223], v[24:27]
  s_waitcnt lgkmcnt(1)
  v_exp_f32 v221, v37
  v_mfma_f32_16x16x32_bf16 a[80:83], v[184:187], v[40:43], 0
  ds_read_b128 v[196:199], v6 offset:4352
  v_cvt_pk_bf16_f32 v173, v218, v219
  v_mfma_f32_16x16x32_bf16 a[100:103], v[188:191], v[40:43], 0
  v_exp_f32 v222, v38
  v_mfma_f32_16x16x32_bf16 a[104:107], v[188:191], v[72:75], 0
  v_add_f32 v181, v181, v218
  v_add_f32 v181, v181, v219
  v_mfma_f32_16x16x32_bf16 a[84:87], v[184:187], v[72:75], 0
  ds_read_b64_tr_b16 v[200:201], v7 offset:17152
  v_cvt_pk_bf16_f32 v46, v220, v221
  v_mfma_f32_16x16x32_bf16 a[88:91], v[184:187], v[104:107], 0
  ds_read_b64_tr_b16 v[202:203], v7 offset:21248
  v_add_f32 v53, v53, v220
  v_mfma_f32_16x16x32_bf16 a[108:111], v[188:191], v[104:107], 0
  ds_read_b64_tr_b16 v[204:205], v8 offset:17152
  v_add_f32 v53, v53, v221
  v_exp_f32 v223, v39
  v_mfma_f32_16x16x32_bf16 a[112:115], v[188:191], v[136:139], 0
  ds_read_b64_tr_b16 v[206:207], v8 offset:21248
  v_cvt_pk_bf16_f32 v47, v222, v223
  v_mfma_f32_16x16x32_bf16 a[92:95], v[184:187], v[136:139], 0
  ds_read_b128 v[208:211], v6 offset:4608
  v_add_f32 v53, v53, v222
  v_exp_f32 v224, v68
  v_mfma_f32_16x16x32_bf16 a[96:99], v[184:187], v[168:171], 0
  ds_read_b128 v[212:215], v6 offset:4864
  v_add_f32 v53, v53, v223
  v_exp_f32 v225, v69
  v_mfma_f32_16x16x32_bf16 a[116:119], v[188:191], v[168:171], 0
  s_waitcnt lgkmcnt(6)
  v_exp_f32 v226, v70
  v_mfma_f32_16x16x32_bf16 v[156:159], v[192:195], a[176:179], v[176:179]
  v_exp_f32 v227, v71
  v_mfma_f32_16x16x32_bf16 v[156:159], v[196:199], a[196:199], v[156:159]
  s_add_u32 s30, s29, s31
  v_cvt_pk_bf16_f32 v78, v224, v225
  v_add_f32 v85, v85, v224
  v_mfma_f32_16x16x32_bf16 v[124:127], v[196:199], a[192:195], v[144:147]
  s_add_u32 s29, s29, 53248
  v_exp_f32 v228, v100
  v_mfma_f32_16x16x32_bf16 v[124:127], v[192:195], a[172:175], v[124:127]
  s_cmp_eq_u32 s29, 159744
  v_add_f32 v85, v85, v225
  v_cvt_pk_bf16_f32 v79, v226, v227
  v_mfma_f32_16x16x32_bf16 v[92:95], v[192:195], a[168:171], v[112:115]
  s_cselect_b32 s29, 0, s29
  v_exp_f32 v229, v101
  v_mfma_f32_16x16x32_bf16 v[92:95], v[196:199], a[188:191], v[92:95]
  s_add_u32 s44, s92, 1
  s_branch K1_OUTER
K1_G2:
  s_add_u32 s30, s29, s31
  s_add_u32 s29, s29, 53248
  s_cmp_eq_u32 s29, 159744
  s_cselect_b32 s29, 0, s29
  v_add_u32 v6, s29, v4
  v_add_u32 v7, s29, v5
  s_waitcnt vmcnt(13) lgkmcnt(0)
  s_barrier
  ds_read_b64_tr_b16 v[184:185], v6 offset:0
  s_mov_b32 m0, s30
  ds_read_b64_tr_b16 v[186:187], v6 offset:1024
  ds_read_b128 a[200:203], v7 offset:0
  ds_read_b128 a[204:207], v7 offset:2048
  buffer_load_dwordx4 v11, s[12:15], s36 offen offset:0 lds
  ds_read_b128 a[208:211], v7 offset:4096
  ds_read_b64_tr_b16 v[188:189], v6 offset:8
  ds_read_b64_tr_b16 v[190:191], v6 offset:1032
  ds_read_b128 a[212:215], v7 offset:6144
  ds_read_b128 a[216:219], v7 offset:8192
  buffer_load_dwordx4 v12, s[12:15], s36 offen offset:1024 lds
  ds_read_b64_tr_b16 v[192:193], v6 offset:256
  ds_read_b64_tr_b16 v[194:195], v6 offset:1280
  s_waitcnt lgkmcnt(8)
  v_mfma_f32_16x16x32_bf16 a[0:3], v[184:187], a[200:203], 0
  buffer_load_dwordx4 v13, s[12:15], s36 offen offset:2048 lds
  s_waitcnt lgkmcnt(4)
  v_mfma_f32_16x16x32_bf16 a[20:23], v[188:191], a[200:203], 0
  ds_read_b64_tr_b16 v[196:197], v6 offset:264
  s_waitcnt lgkmcnt(3)
  v_mfma_f32_16x16x32_bf16 a[24:27], v[188:191], a[204:207], 0
  ds_read_b64_tr_b16 v[198:199], v6 offset:1288
  v_mfma_f32_16x16x32_bf16 a[4:7], v[184:187], a[204:207], 0
  ds_read_b128 a[220:223], v7 offset:256
  v_mfma_f32_16x16x32_bf16 a[8:11], v[184:187], a[208:211], 0
  buffer_load_dwordx4 v14, s[12:15], s36 offen offset:3072 lds
  v_mfma_f32_16x16x32_bf16 a[28:31], v[188:191], a[208:211], 0
  ds_read_b64_tr_b16 v[200:201], v6 offset:512
  s_add_u32 s36, s36, 0x40000
  v_mfma_f32_16x16x32_bf16 a[32:35], v[188:191], a[212:215], 0
  ds_read_b64_tr_b16 v[202:203], v6 offset:1536
  s_add_u32 m0, s30, 16384
  v_mfma_f32_16x16x32_bf16 a[12:15], v[184:187], a[212:215], 0
  ds_read_b128 a[224:227], v7 offset:2304
  v_mfma_f32_16x16x32_bf16 a[16:19], v[184:187], a[216:219], 0
  buffer_load_dwordx4 v11, s[12:15], s36 offen offset:0 lds
  v_mfma_f32_16x16x32_bf16 a[36:39], v[188:191], a[216:219], 0
  s_waitcnt lgkmcnt(4)
  v_mfma_f32_16x16x32_bf16 a[56:59], v[192:195], a[216:219], 0
  ds_read_b64_tr_b16 v[204:205], v6 offset:520
  v_mfma_f32_16x16x32_bf16 a[76:79], v[196:199], a[216:219], 0
  ds_read_b64_tr_b16 v[206:207], v6 offset:1544
  v_mfma_f32_16x16x32_bf16 a[72:75], v[196:199], a[212:215], 0
  ds_read_b128 a[228:231], v7 offset:4352
  v_mfma_f32_16x16x32_bf16 a[52:55], v[192:195], a[212:215], 0
  buffer_load_dwordx4 v12, s[12:15], s36 offen offset:1024 lds
  v_mfma_f32_16x16x32_bf16 a[48:51], v[192:195], a[208:211], 0
  v_mfma_f32_16x16x32_bf16 a[68:71], v[196:199], a[208:211], 0
  ds_read_b64_tr_b16 v[208:209], v6 offset:768
  v_mfma_f32_16x16x32_bf16 a[64:67], v[196:199], a[204:207], 0
  ds_read_b64_tr_b16 v[210:211], v6 offset:1792
  v_mfma_f32_16x16x32_bf16 a[44:47], v[192:195], a[204:207], 0
  ds_read_b128 a[232:235], v7 offset:6400
  v_mfma_f32_16x16x32_bf16 a[40:43], v[192:195], a[200:203], 0
  buffer_load_dwordx4 v13, s[12:15], s36 offen offset:2048 lds
  v_mfma_f32_16x16x32_bf16 a[60:63], v[196:199], a[200:203], 0
  s_waitcnt lgkmcnt(4)
  v_mfma_f32_16x16x32_bf16 a[80:83], v[200:203], a[200:203], 0
  ds_read_b64_tr_b16 v[212:213], v6 offset:776
  v_mfma_f32_16x16x32_bf16 a[100:103], v[204:207], a[200:203], 0
  ds_read_b64_tr_b16 v[214:215], v6 offset:1800
  v_mfma_f32_16x16x32_bf16 a[104:107], v[204:207], a[204:207], 0
  ds_read_b128 a[236:239], v7 offset:8448
  v_mfma_f32_16x16x32_bf16 a[84:87], v[200:203], a[204:207], 0
  buffer_load_dwordx4 v14, s[12:15], s36 offen offset:3072 lds
  v_mfma_f32_16x16x32_bf16 a[88:91], v[200:203], a[208:211], 0
  s_add_u32 s36, s36, 0x40000
  s_and_b32 s36, s36, 0x3fffff
  s_add_u32 s37, s6, s7
  v_mfma_f32_16x16x32_bf16 a[108:111], v[204:207], a[208:211], 0
  ds_read_b64_tr_b16 v[184:185], v6 offset:16384
  s_add_u32 m0, s30, s32
  v_mfma_f32_16x16x32_bf16 a[112:115], v[204:207], a[212:215], 0
  ds_read_b64_tr_b16 v[186:187], v6 offset:17408
  v_mfma_f32_16x16x32_bf16 a[92:95], v[200:203], a[212:215], 0
  v_mfma_f32_16x16x32_bf16 a[96:99], v[200:203], a[216:219], 0
  buffer_load_dwordx4 v15, s[8:11], s37 offen offset:0 lds
  v_mfma_f32_16x16x32_bf16 a[116:119], v[204:207], a[216:219], 0
  s_waitcnt lgkmcnt(3)
  v_mfma_f32_16x16x32_bf16 a[136:139], v[208:211], a[216:219], 0
  ds_read_b64_tr_b16 v[188:189], v6 offset:16392
  v_mfma_f32_16x16x32_bf16 a[156:159], v[212:215], a[216:219], 0
  ds_read_b64_tr_b16 v[190:191], v6 offset:17416
  v_mfma_f32_16x16x32_bf16 a[152:155], v[212:215], a[212:215], 0
  v_mfma_f32_16x16x32_bf16 a[132:135], v[208:211], a[212:215], 0
  buffer_load_dwordx4 v16, s[8:11], s37 offen offset:1024 lds
  v_mfma_f32_16x16x32_bf16 a[128:131], v[208:211], a[208:211], 0
  v_mfma_f32_16x16x32_bf16 a[148:151], v[212:215], a[208:211], 0
  ds_read_b64_tr_b16 v[192:193], v6 offset:16640
  v_mfma_f32_16x16x32_bf16 a[144:147], v[212:215], a[204:207], 0
  ds_read_b64_tr_b16 v[194:195], v6 offset:17664
  v_mfma_f32_16x16x32_bf16 a[124:127], v[208:211], a[204:207], 0
  v_mfma_f32_16x16x32_bf16 a[120:123], v[208:211], a[200:203], 0
  buffer_load_dwordx4 v17, s[8:11], s37 offen offset:2048 lds
  v_mfma_f32_16x16x32_bf16 a[140:143], v[212:215], a[200:203], 0
  s_waitcnt lgkmcnt(6)
  s_waitcnt lgkmcnt(2)
  v_mfma_f32_16x16x32_bf16 a[0:3], v[184:187], a[220:223], a[0:3]
  ds_read_b64_tr_b16 v[196:197], v6 offset:16648
  v_mfma_f32_16x16x32_bf16 a[20:23], v[188:191], a[220:223], a[20:23]
  ds_read_b64_tr_b16 v[198:199], v6 offset:17672
  v_mfma_f32_16x16x32_bf16 a[24:27], v[188:191], a[224:227], a[24:27]
  v_mfma_f32_16x16x32_bf16 a[4:7], v[184:187], a[224:227], a[4:7]
  buffer_load_dwordx4 v18, s[8:11], s37 offen offset:3072 lds
  v_mfma_f32_16x16x32_bf16 a[8:11], v[184:187], a[228:231], a[8:11]
  s_add_u32 m0, m0, 0x1000
  s_add_u32 s39, s37, 0x8000
  v_mfma_f32_16x16x32_bf16 a[28:31], v[188:191], a[228:231], a[28:31]
  ds_read_b64_tr_b16 v[200:201], v6 offset:16896
  v_mfma_f32_16x16x32_bf16 a[32:35], v[188:191], a[232:235], a[32:35]
  ds_read_b64_tr_b16 v[202:203], v6 offset:17920
  s_add_u32 s7, s7, 128
  v_mfma_f32_16x16x32_bf16 a[12:15], v[184:187], a[232:235], a[12:15]
  s_and_b32 s7, s7, 0x3ff
  v_mfma_f32_16x16x32_bf16 a[16:19], v[184:187], a[236:239], a[16:19]
  buffer_load_dwordx4 v15, s[8:11], s39 offen lds
  v_mfma_f32_16x16x32_bf16 a[36:39], v[188:191], a[236:239], a[36:39]
  s_waitcnt lgkmcnt(2)
  v_mfma_f32_16x16x32_bf16 a[56:59], v[192:195], a[236:239], a[56:59]
  ds_read_b64_tr_b16 v[204:205], v6 offset:16904
  v_mfma_f32_16x16x32_bf16 a[76:79], v[196:199], a[236:239], a[76:79]
  ds_read_b64_tr_b16 v[206:207], v6 offset:17928
  v_mfma_f32_16x16x32_bf16 a[72:75], v[196:199], a[232:235], a[72:75]
  ds_read_b64_tr_b16 v[208:209], v6 offset:17152
  v_mfma_f32_16x16x32_bf16 a[52:55], v[192:195], a[232:235], a[52:55]
  ds_read_b64_tr_b16 v[210:211], v6 offset:18176
  v_mfma_f32_16x16x32_bf16 a[48:51], v[192:195], a[228:231], a[48:51]
  v_mfma_f32_16x16x32_bf16 a[68:71], v[196:199], a[228:231], a[68:71]
  ds_read_b64_tr_b16 v[212:213], v6 offset:17160
  v_mfma_f32_16x16x32_bf16 a[64:67], v[196:199], a[224:227], a[64:67]
  ds_read_b64_tr_b16 v[214:215], v6 offset:18184
  s_add_u32 s30, s29, s31
  v_mfma_f32_16x16x32_bf16 a[44:47], v[192:195], a[224:227], a[44:47]
  s_add_u32 s29, s29, 53248
  v_mfma_f32_16x16x32_bf16 a[40:43], v[192:195], a[220:223], a[40:43]
  s_cmp_eq_u32 s29, 159744
  s_cselect_b32 s29, 0, s29
  v_mfma_f32_16x16x32_bf16 a[60:63], v[196:199], a[220:223], a[60:63]
  s_waitcnt lgkmcnt(4)
  v_mfma_f32_16x16x32_bf16 a[80:83], v[200:203], a[220:223], a[80:83]
  v_add_u32 v6, s29, v4
  v_mfma_f32_16x16x32_bf16 a[100:103], v[204:207], a[220:223], a[100:103]
  v_add_u32 v7, s29, v5
  v_mfma_f32_16x16x32_bf16 a[104:107], v[204:207], a[224:227], a[104:107]
  v_mfma_f32_16x16x32_bf16 a[84:87], v[200:203], a[224:227], a[84:87]
  s_mov_b32 m0, s30
  v_mfma_f32_16x16x32_bf16 a[88:91], v[200:203], a[228:231], a[88:91]
  s_mov_b32 s43, 5
LP16:
  s_waitcnt vmcnt(13) lgkmcnt(0)
  s_barrier
  v_mfma_f32_16x16x32_bf16 a[108:111], v[204:207], a[228:231], a[108:111]
  ds_read_b64_tr_b16 v[184:185], v6 offset:0
  v_mfma_f32_16x16x32_bf16 a[112:115], v[204:207], a[232:235], a[112:115]
  ds_read_b64_tr_b16 v[186:187], v6 offset:1024
  v_mfma_f32_16x16x32_bf16 a[92:95], v[200:203], a[232:235], a[92:95]
  ds_read_b128 a[200:203], v7 offset:0
  v_mfma_f32_16x16x32_bf16 a[96:99], v[200:203], a[236:239], a[96:99]
  ds_read_b128 a[204:207], v7 offset:2048
  v_mfma_f32_16x16x32_bf16 a[116:119], v[204:207], a[236:239], a[116:119]
  buffer_load_dwordx4 v11, s[12:15], s36 offen offset:0 lds
  v_mfma_f32_16x16x32_bf16 a[136:139], v[208:211], a[236:239], a[136:139]
  ds_read_b128 a[208:211], v7 offset:4096
  v_mfma_f32_16x16x32_bf16 a[156:159], v[212:215], a[236:239], a[156:159]
  v_mfma_f32_16x16x32_bf16 a[152:155], v[212:215], a[232:235], a[152:155]
  ds_read_b64_tr_b16 v[188:189], v6 offset:8
  v_mfma_f32_16x16x32_bf16 a[132:135], v[208:211], a[232:235], a[132:135]
  ds_read_b64_tr_b16 v[190:191], v6 offset:1032
  v_mfma_f32_16x16x32_bf16 a[128:131], v[208:211], a[228:231], a[128:131]
  ds_read_b128 a[212:215], v7 offset:6144
  v_mfma_f32_16x16x32_bf16 a[148:151], v[212:215], a[228:231], a[148:151]
  ds_read_b128 a[216:219], v7 offset:8192
  buffer_load_dwordx4 v12, s[12:15], s36 offen offset:1024 lds
  v_mfma_f32_16x16x32_bf16 a[144:147], v[212:215], a[224:227], a[144:147]
  ds_read_b64_tr_b16 v[192:193], v6 offset:256
  v_mfma_f32_16x16x32_bf16 a[124:127], v[208:211], a[224:227], a[124:127]
  ds_read_b64_tr_b16 v[194:195], v6 offset:1280
  v_mfma_f32_16x16x32_bf16 a[120:123], v[208:211], a[220:223], a[120:123]
  buffer_load_dwordx4 v13, s[12:15], s36 offen offset:2048 lds
  v_mfma_f32_16x16x32_bf16 a[140:143], v[212:215], a[220:223], a[140:143]
  s_waitcnt lgkmcnt(4)
  v_mfma_f32_16x16x32_bf16 a[0:3], v[184:187], a[200:203], a[0:3]
  s_waitcnt lgkmcnt(2)
  v_mfma_f32_16x16x32_bf16 a[20:23], v[188:191], a[200:203], a[20:23]
  ds_read_b64_tr_b16 v[196:197], v6 offset:264
  v_mfma_f32_16x16x32_bf16 a[24:27], v[188:191], a[204:207], a[24:27]
  ds_read_b64_tr_b16 v[198:199], v6 offset:1288
  v_mfma_f32_16x16x32_bf16 a[4:7], v[184:187], a[204:207], a[4:7]
  ds_read_b128 a[220:223], v7 offset:256
  v_mfma_f32_16x16x32_bf16 a[8:11], v[184:187], a[208:211], a[8:11]
  buffer_load_dwordx4 v14, s[12:15], s36 offen offset:3072 lds
  v_mfma_f32_16x16x32_bf16 a[28:31], v[188:191], a[208:211], a[28:31]
  ds_read_b64_tr_b16 v[200:201], v6 offset:512
  s_add_u32 s36, s36, 0x40000
  v_mfma_f32_16x16x32_bf16 a[32:35], v[188:191], a[212:215], a[32:35]
  ds_read_b64_tr_b16 v[202:203], v6 offset:1536
  s_add_u32 m0, s30, 16384
  v_mfma_f32_16x16x32_bf16 a[12:15], v[184:187], a[212:215], a[12:15]
  ds_read_b128 a[224:227], v7 offset:2304
  v_mfma_f32_16x16x32_bf16 a[16:19], v[184:187], a[216:219], a[16:19]
  buffer_load_dwordx4 v11, s[12:15], s36 offen offset:0 lds
  v_mfma_f32_16x16x32_bf16 a[36:39], v[188:191], a[216:219], a[36:39]
  s_waitcnt lgkmcnt(4)
  v_mfma_f32_16x16x32_bf16 a[56:59], v[192:195], a[216:219], a[56:59]
  ds_read_b64_tr_b16 v[204:205], v6 offset:520
  v_mfma_f32_16x16x32_bf16 a[76:79], v[196:199], a[216:219], a[76:79]
  ds_read_b64_tr_b16 v[206:207], v6 offset:1544
  v_mfma_f32_16x16x32_bf16 a[72:75], v[196:199], a[212:215], a[72:75]
  ds_read_b128 a[228:231], v7 offset:4352
  v_mfma_f32_16x16x32_bf16 a[52:55], v[192:195], a[212:215], a[52:55]
  buffer_load_dwordx4 v12, s[12:15], s36 offen offset:1024 lds
  v_mfma_f32_16x16x32_bf16 a[48:51], v[192:195], a[208:211], a[48:51]
  v_mfma_f32_16x16x32_bf16 a[68:71], v[196:199], a[208:211], a[68:71]
  ds_read_b64_tr_b16 v[208:209], v6 offset:768
  v_mfma_f32_16x16x32_bf16 a[64:67], v[196:199], a[204:207], a[64:67]
  ds_read_b64_tr_b16 v[210:211], v6 offset:1792
  v_mfma_f32_16x16x32_bf16 a[44:47], v[192:195], a[204:207], a[44:47]
  ds_read_b128 a[232:235], v7 offset:6400
  v_mfma_f32_16x16x32_bf16 a[40:43], v[192:195], a[200:203], a[40:43]
  buffer_load_dwordx4 v13, s[12:15], s36 offen offset:2048 lds
  v_mfma_f32_16x16x32_bf16 a[60:63], v[196:199], a[200:203], a[60:63]
  s_waitcnt lgkmcnt(4)
  v_mfma_f32_16x16x32_bf16 a[80:83], v[200:203], a[200:203], a[80:83]
  ds_read_b64_tr_b16 v[212:213], v6 offset:776
  v_mfma_f32_16x16x32_bf16 a[100:103], v[204:207], a[200:203], a[100:103]
  ds_read_b64_tr_b16 v[214:215], v6 offset:1800
  v_mfma_f32_16x16x32_bf16 a[104:107], v[204:207], a[204:207], a[104:107]
  ds_read_b128 a[236:239], v7 offset:8448
  v_mfma_f32_16x16x32_bf16 a[84:87], v[200:203], a[204:207], a[84:87]
  buffer_load_dwordx4 v14, s[12:15], s36 offen offset:3072 lds
  v_mfma_f32_16x16x32_bf16 a[88:91], v[200:203], a[208:211], a[88:91]
  s_add_u32 s36, s36, 0x40000
  s_and_b32 s36, s36, 0x3fffff
  s_add_u32 s37, s6, s7
  v_mfma_f32_16x16x32_bf16 a[108:111], v[204:207], a[208:211], a[108:111]
  ds_read_b64_tr_b16 v[184:185], v6 offset:16384
  s_add_u32 m0, s30, s32
  v_mfma_f32_16x16x32_bf16 a[112:115], v[204:207], a[212:215], a[112:115]
  ds_read_b64_tr_b16 v[186:187], v6 offset:17408
  v_mfma_f32_16x16x32_bf16 a[92:95], v[200:203], a[212:215], a[92:95]
  v_mfma_f32_16x16x32_bf16 a[96:99], v[200:203], a[216:219], a[96:99]
  buffer_load_dwordx4 v15, s[8:11], s37 offen offset:0 lds
  v_mfma_f32_16x16x32_bf16 a[116:119], v[204:207], a[216:219], a[116:119]
  s_waitcnt lgkmcnt(3)
  v_mfma_f32_16x16x32_bf16 a[136:139], v[208:211], a[216:219], a[136:139]
  ds_read_b64_tr_b16 v[188:189], v6 offset:16392
  v_mfma_f32_16x16x32_bf16 a[156:159], v[212:215], a[216:219], a[156:159]
  ds_read_b64_tr_b16 v[190:191], v6 offset:17416
  v_mfma_f32_16x16x32_bf16 a[152:155], v[212:215], a[212:215], a[152:155]
  v_mfma_f32_16x16x32_bf16 a[132:135], v[208:211], a[212:215], a[132:135]
  buffer_load_dwordx4 v16, s[8:11], s37 offen offset:1024 lds
  v_mfma_f32_16x16x32_bf16 a[128:131], v[208:211], a[208:211], a[128:131]
  v_mfma_f32_16x16x32_bf16 a[148:151], v[212:215], a[208:211], a[148:151]
  ds_read_b64_tr_b16 v[192:193], v6 offset:16640
  v_mfma_f32_16x16x32_bf16 a[144:147], v[212:215], a[204:207], a[144:147]
  ds_read_b64_tr_b16 v[194:195], v6 offset:17664
  v_mfma_f32_16x16x32_bf16 a[124:127], v[208:211], a[204:207], a[124:127]
  v_mfma_f32_16x16x32_bf16 a[120:123], v[208:211], a[200:203], a[120:123]
  buffer_load_dwordx4 v17, s[8:11], s37 offen offset:2048 lds
  v_mfma_f32_16x16x32_bf16 a[140:143], v[212:215], a[200:203], a[140:143]
  s_waitcnt lgkmcnt(6)
  s_waitcnt lgkmcnt(2)
  v_mfma_f32_16x16x32_bf16 a[0:3], v[184:187], a[220:223], a[0:3]
  ds_read_b64_tr_b16 v[196:197], v6 offset:16648
  v_mfma_f32_16x16x32_bf16 a[20:23], v[188:191], a[220:223], a[20:23]
  ds_read_b64_tr_b16 v[198:199], v6 offset:17672
  v_mfma_f32_16x16x32_bf16 a[24:27], v[188:191], a[224:227], a[24:27]
  v_mfma_f32_16x16x32_bf16 a[4:7], v[184:187], a[224:227], a[4:7]
  buffer_load_dwordx4 v18, s[8:11], s37 offen offset:3072 lds
  v_mfma_f32_16x16x32_bf16 a[8:11], v[184:187], a[228:231], a[8:11]
  s_add_u32 m0, m0, 0x1000
  s_add_u32 s39, s37, 0x8000
  v_mfma_f32_16x16x32_bf16 a[28:31], v[188:191], a[228:231], a[28:31]
  ds_read_b64_tr_b16 v[200:201], v6 offset:16896
  v_mfma_f32_16x16x32_bf16 a[32:35], v[188:191], a[232:235], a[32:35]
  ds_read_b64_tr_b16 v[202:203], v6 offset:17920
  s_add_u32 s7, s7, 128
  v_mfma_f32_16x16x32_bf16 a[12:15], v[184:187], a[232:235], a[12:15]
  s_and_b32 s7, s7, 0x3ff
  v_mfma_f32_16x16x32_bf16 a[16:19], v[184:187], a[236:239], a[16:19]
  buffer_load_dwordx4 v15, s[8:11], s39 offen lds
  v_mfma_f32_16x16x32_bf16 a[36:39], v[188:191], a[236:239], a[36:39]
  s_waitcnt lgkmcnt(2)
  v_mfma_f32_16x16x32_bf16 a[56:59], v[192:195], a[236:239], a[56:59]
  ds_read_b64_tr_b16 v[204:205], v6 offset:16904
  v_mfma_f32_16x16x32_bf16 a[76:79], v[196:199], a[236:239], a[76:79]
  ds_read_b64_tr_b16 v[206:207], v6 offset:17928
  v_mfma_f32_16x16x32_bf16 a[72:75], v[196:199], a[232:235], a[72:75]
  ds_read_b64_tr_b16 v[208:209], v6 offset:17152
  v_mfma_f32_16x16x32_bf16 a[52:55], v[192:195], a[232:235], a[52:55]
  ds_read_b64_tr_b16 v[210:211], v6 offset:18176
  v_mfma_f32_16x16x32_bf16 a[48:51], v[192:195], a[228:231], a[48:51]
  v_mfma_f32_16x16x32_bf16 a[68:71], v[196:199], a[228:231], a[68:71]
  ds_read_b64_tr_b16 v[212:213], v6 offset:17160
  v_mfma_f32_16x16x32_bf16 a[64:67], v[196:199], a[224:227], a[64:67]
  ds_read_b64_tr_b16 v[214:215], v6 offset:18184
  s_add_u32 s30, s29, s31
  v_mfma_f32_16x16x32_bf16 a[44:47], v[192:195], a[224:227], a[44:47]
  s_add_u32 s29, s29, 53248
  v_mfma_f32_16x16x32_bf16 a[40:43], v[192:195], a[220:223], a[40:43]
  s_cmp_eq_u32 s29, 159744
  s_cselect_b32 s29, 0, s29
  v_mfma_f32_16x16x32_bf16 a[60:63], v[196:199], a[220:223], a[60:63]
  s_waitcnt lgkmcnt(4)
  v_mfma_f32_16x16x32_bf16 a[80:83], v[200:203], a[220:223], a[80:83]
  v_add_u32 v6, s29, v4
  v_mfma_f32_16x16x32_bf16 a[100:103], v[204:207], a[220:223], a[100:103]
  v_add_u32 v7, s29, v5
  v_mfma_f32_16x16x32_bf16 a[104:107], v[204:207], a[224:227], a[104:107]
  v_mfma_f32_16x16x32_bf16 a[84:87], v[200:203], a[224:227], a[84:87]
  s_mov_b32 m0, s30
  v_mfma_f32_16x16x32_bf16 a[88:91], v[200:203], a[228:231], a[88:91]
  s_sub_u32 s43, s43, 1
  s_cmp_lg_u32 s43, 0
  s_cbranch_scc1 LP16
  s_waitcnt vmcnt(13) lgkmcnt(0)
  s_barrier
  s_sub_u32 s36, s36, 2048
  v_mfma_f32_16x16x32_bf16 a[108:111], v[204:207], a[228:231], a[108:111]
  ds_read_b64_tr_b16 v[184:185], v6 offset:0
  v_mfma_f32_16x16x32_bf16 a[112:115], v[204:207], a[232:235], a[112:115]
  ds_read_b64_tr_b16 v[186:187], v6 offset:1024
  v_mfma_f32_16x16x32_bf16 a[92:95], v[200:203], a[232:235], a[92:95]
  ds_read_b128 a[200:203], v7 offset:0
  v_mfma_f32_16x16x32_bf16 a[96:99], v[200:203], a[236:239], a[96:99]
  ds_read_b128 a[204:207], v7 offset:2048
  v_mfma_f32_16x16x32_bf16 a[116:119], v[204:207], a[236:239], a[116:119]
  buffer_load_dwordx4 v11, s[12:15], s36 offen offset:0 lds
  v_mfma_f32_16x16x32_bf16 a[136:139], v[208:211], a[236:239], a[136:139]
  ds_read_b128 a[208:211], v7 offset:4096
  v_mfma_f32_16x16x32_bf16 a[156:159], v[212:215], a[236:239], a[156:159]
  v_mfma_f32_16x16x32_bf16 a[152:155], v[212:215], a[232:235], a[152:155]
  ds_read_b64_tr_b16 v[188:189], v6 offset:8
  v_mfma_f32_16x16x32_bf16 a[132:135], v[208:211], a[232:235], a[132:135]
  ds_read_b64_tr_b16 v[190:191], v6 offset:1032
  v_mfma_f32_16x16x32_bf16 a[128:131], v[208:211], a[228:231], a[128:131]
  ds_read_b128 a[212:215], v7 offset:6144
  v_mfma_f32_16x16x32_bf16 a[148:151], v[212:215], a[228:231], a[148:151]
  ds_read_b128 a[216:219], v7 offset:8192
  buffer_load_dwordx4 v12, s[12:15], s36 offen offset:1024 lds
  v_mfma_f32_16x16x32_bf16 a[144:147], v[212:215], a[224:227], a[144:147]
  ds_read_b64_tr_b16 v[192:193], v6 offset:256
  v_mfma_f32_16x16x32_bf16 a[124:127], v[208:211], a[224:227], a[124:127]
  ds_read_b64_tr_b16 v[194:195], v6 offset:1280
  v_mfma_f32_16x16x32_bf16 a[120:123], v[208:211], a[220:223], a[120:123]
  buffer_load_dwordx4 v13, s[12:15], s36 offen offset:2048 lds
  v_mfma_f32_16x16x32_bf16 a[140:143], v[212:215], a[220:223], a[140:143]
  s_waitcnt lgkmcnt(4)
  v_mfma_f32_16x16x32_bf16 a[0:3], v[184:187], a[200:203], a[0:3]
  s_waitcnt lgkmcnt(2)
  v_mfma_f32_16x16x32_bf16 a[20:23], v[188:191], a[200:203], a[20:23]
  ds_read_b64_tr_b16 v[196:197], v6 offset:264
  v_mfma_f32_16x16x32_bf16 a[24:27], v[188:191], a[204:207], a[24:27]
  ds_read_b64_tr_b16 v[198:199], v6 offset:1288
  v_mfma_f32_16x16x32_bf16 a[4:7], v[184:187], a[204:207], a[4:7]
  ds_read_b128 a[220:223], v7 offset:256
  v_mfma_f32_16x16x32_bf16 a[8:11], v[184:187], a[208:211], a[8:11]
  buffer_load_dwordx4 v14, s[12:15], s36 offen offset:3072 lds
  v_mfma_f32_16x16x32_bf16 a[28:31], v[188:191], a[208:211], a[28:31]
  ds_read_b64_tr_b16 v[200:201], v6 offset:512
  s_add_u32 s36, s36, 0x40000
  v_mfma_f32_16x16x32_bf16 a[32:35], v[188:191], a[212:215], a[32:35]
  ds_read_b64_tr_b16 v[202:203], v6 offset:1536
  s_add_u32 m0, s30, 16384
  v_mfma_f32_16x16x32_bf16 a[12:15], v[184:187], a[212:215], a[12:15]
  ds_read_b128 a[224:227], v7 offset:2304
  v_mfma_f32_16x16x32_bf16 a[16:19], v[184:187], a[216:219], a[16:19]
  buffer_load_dwordx4 v11, s[12:15], s36 offen offset:0 lds
  v_mfma_f32_16x16x32_bf16 a[36:39], v[188:191], a[216:219], a[36:39]
  s_waitcnt lgkmcnt(4)
  v_mfma_f32_16x16x32_bf16 a[56:59], v[192:195], a[216:219], a[56:59]
  ds_read_b64_tr_b16 v[204:205], v6 offset:520
  v_mfma_f32_16x16x32_bf16 a[76:79], v[196:199], a[216:219], a[76:79]
  ds_read_b64_tr_b16 v[206:207], v6 offset:1544
  v_mfma_f32_16x16x32_bf16 a[72:75], v[196:199], a[212:215], a[72:75]
  ds_read_b128 a[228:231], v7 offset:4352
  v_mfma_f32_16x16x32_bf16 a[52:55], v[192:195], a[212:215], a[52:55]
  buffer_load_dwordx4 v12, s[12:15], s36 offen offset:1024 lds
  v_mfma_f32_16x16x32_bf16 a[48:51], v[192:195], a[208:211], a[48:51]
  v_mfma_f32_16x16x32_bf16 a[68:71], v[196:199], a[208:211], a[68:71]
  ds_read_b64_tr_b16 v[208:209], v6 offset:768
  v_mfma_f32_16x16x32_bf16 a[64:67], v[196:199], a[204:207], a[64:67]
  ds_read_b64_tr_b16 v[210:211], v6 offset:1792
  v_mfma_f32_16x16x32_bf16 a[44:47], v[192:195], a[204:207], a[44:47]
  ds_read_b128 a[232:235], v7 offset:6400
  v_mfma_f32_16x16x32_bf16 a[40:43], v[192:195], a[200:203], a[40:43]
  buffer_load_dwordx4 v13, s[12:15], s36 offen offset:2048 lds
  v_mfma_f32_16x16x32_bf16 a[60:63], v[196:199], a[200:203], a[60:63]
  s_waitcnt lgkmcnt(4)
  v_mfma_f32_16x16x32_bf16 a[80:83], v[200:203], a[200:203], a[80:83]
  ds_read_b64_tr_b16 v[212:213], v6 offset:776
  v_mfma_f32_16x16x32_bf16 a[100:103], v[204:207], a[200:203], a[100:103]
  ds_read_b64_tr_b16 v[214:215], v6 offset:1800
  v_mfma_f32_16x16x32_bf16 a[104:107], v[204:207], a[204:207], a[104:107]
  ds_read_b128 a[236:239], v7 offset:8448
  v_mfma_f32_16x16x32_bf16 a[84:87], v[200:203], a[204:207], a[84:87]
  buffer_load_dwordx4 v14, s[12:15], s36 offen offset:3072 lds
  v_mfma_f32_16x16x32_bf16 a[88:91], v[200:203], a[208:211], a[88:91]
  s_add_u32 s36, s36, 0x40000
  s_and_b32 s36, s36, 0x3fffff
  s_add_u32 s37, s6, s7
  v_mfma_f32_16x16x32_bf16 a[108:111], v[204:207], a[208:211], a[108:111]
  ds_read_b64_tr_b16 v[184:185], v6 offset:16384
  s_add_u32 m0, s30, s32
  v_mfma_f32_16x16x32_bf16 a[112:115], v[204:207], a[212:215], a[112:115]
  ds_read_b64_tr_b16 v[186:187], v6 offset:17408
  v_mfma_f32_16x16x32_bf16 a[92:95], v[200:203], a[212:215], a[92:95]
  v_mfma_f32_16x16x32_bf16 a[96:99], v[200:203], a[216:219], a[96:99]
  buffer_load_dwordx4 v15, s[8:11], s37 offen offset:0 lds
  v_mfma_f32_16x16x32_bf16 a[116:119], v[204:207], a[216:219], a[116:119]
  s_waitcnt lgkmcnt(3)
  v_mfma_f32_16x16x32_bf16 a[136:139], v[208:211], a[216:219], a[136:139]
  ds_read_b64_tr_b16 v[188:189], v6 offset:16392
  v_mfma_f32_16x16x32_bf16 a[156:159], v[212:215], a[216:219], a[156:159]
  ds_read_b64_tr_b16 v[190:191], v6 offset:17416
  v_mfma_f32_16x16x32_bf16 a[152:155], v[212:215], a[212:215], a[152:155]
  v_mfma_f32_16x16x32_bf16 a[132:135], v[208:211], a[212:215], a[132:135]
  buffer_load_dwordx4 v16, s[8:11], s37 offen offset:1024 lds
  v_mfma_f32_16x16x32_bf16 a[128:131], v[208:211], a[208:211], a[128:131]
  v_mfma_f32_16x16x32_bf16 a[148:151], v[212:215], a[208:211], a[148:151]
  ds_read_b64_tr_b16 v[192:193], v6 offset:16640
  v_mfma_f32_16x16x32_bf16 a[144:147], v[212:215], a[204:207], a[144:147]
  ds_read_b64_tr_b16 v[194:195], v6 offset:17664
  v_mfma_f32_16x16x32_bf16 a[124:127], v[208:211], a[204:207], a[124:127]
  v_mfma_f32_16x16x32_bf16 a[120:123], v[208:211], a[200:203], a[120:123]
  buffer_load_dwordx4 v17, s[8:11], s37 offen offset:2048 lds
  v_mfma_f32_16x16x32_bf16 a[140:143], v[212:215], a[200:203], a[140:143]
  s_waitcnt lgkmcnt(6)
  s_waitcnt lgkmcnt(2)
  v_mfma_f32_16x16x32_bf16 a[0:3], v[184:187], a[220:223], a[0:3]
  ds_read_b64_tr_b16 v[196:197], v6 offset:16648
  v_mfma_f32_16x16x32_bf16 a[20:23], v[188:191], a[220:223], a[20:23]
  ds_read_b64_tr_b16 v[198:199], v6 offset:17672
  v_mfma_f32_16x16x32_bf16 a[24:27], v[188:191], a[224:227], a[24:27]
  v_mfma_f32_16x16x32_bf16 a[4:7], v[184:187], a[224:227], a[4:7]
  buffer_load_dwordx4 v18, s[8:11], s37 offen offset:3072 lds
  v_mfma_f32_16x16x32_bf16 a[8:11], v[184:187], a[228:231], a[8:11]
  s_add_u32 m0, m0, 0x1000
  s_add_u32 s39, s37, 0x8000
  v_mfma_f32_16x16x32_bf16 a[28:31], v[188:191], a[228:231], a[28:31]
  ds_read_b64_tr_b16 v[200:201], v6 offset:16896
  v_mfma_f32_16x16x32_bf16 a[32:35], v[188:191], a[232:235], a[32:35]
  ds_read_b64_tr_b16 v[202:203], v6 offset:17920
  s_add_u32 s7, s7, 128
  v_mfma_f32_16x16x32_bf16 a[12:15], v[184:187], a[232:235], a[12:15]
  s_and_b32 s7, s7, 0x3ff
  v_mfma_f32_16x16x32_bf16 a[16:19], v[184:187], a[236:239], a[16:19]
  buffer_load_dwordx4 v15, s[8:11], s39 offen lds
  v_mfma_f32_16x16x32_bf16 a[36:39], v[188:191], a[236:239], a[36:39]
  s_waitcnt lgkmcnt(2)
  v_mfma_f32_16x16x32_bf16 a[56:59], v[192:195], a[236:239], a[56:59]
  ds_read_b64_tr_b16 v[204:205], v6 offset:16904
  v_mfma_f32_16x16x32_bf16 a[76:79], v[196:199], a[236:239], a[76:79]
  ds_read_b64_tr_b16 v[206:207], v6 offset:17928
  v_mfma_f32_16x16x32_bf16 a[72:75], v[196:199], a[232:235], a[72:75]
  ds_read_b64_tr_b16 v[208:209], v6 offset:17152
  v_mfma_f32_16x16x32_bf16 a[52:55], v[192:195], a[232:235], a[52:55]
  ds_read_b64_tr_b16 v[210:211], v6 offset:18176
  v_mfma_f32_16x16x32_bf16 a[48:51], v[192:195], a[228:231], a[48:51]
  v_mfma_f32_16x16x32_bf16 a[68:71], v[196:199], a[228:231], a[68:71]
  ds_read_b64_tr_b16 v[212:213], v6 offset:17160
  v_mfma_f32_16x16x32_bf16 a[64:67], v[196:199], a[224:227], a[64:67]
  ds_read_b64_tr_b16 v[214:215], v6 offset:18184
  s_add_u32 s30, s29, s31
  v_mfma_f32_16x16x32_bf16 a[44:47], v[192:195], a[224:227], a[44:47]
  s_add_u32 s29, s29, 53248
  v_mfma_f32_16x16x32_bf16 a[40:43], v[192:195], a[220:223], a[40:43]
  s_cmp_eq_u32 s29, 159744
  s_cselect_b32 s29, 0, s29
  v_mfma_f32_16x16x32_bf16 a[60:63], v[196:199], a[220:223], a[60:63]
  s_waitcnt lgkmcnt(4)
  v_mfma_f32_16x16x32_bf16 a[80:83], v[200:203], a[220:223], a[80:83]
  v_add_u32 v6, s29, v4
  v_mfma_f32_16x16x32_bf16 a[100:103], v[204:207], a[220:223], a[100:103]
  v_add_u32 v7, s29, v5
  v_mfma_f32_16x16x32_bf16 a[104:107], v[204:207], a[224:227], a[104:107]
  v_mfma_f32_16x16x32_bf16 a[84:87], v[200:203], a[224:227], a[84:87]
  s_mov_b32 m0, s30
  v_mfma_f32_16x16x32_bf16 a[88:91], v[200:203], a[228:231], a[88:91]
  s_waitcnt vmcnt(13) lgkmcnt(0)
  s_barrier
  v_mfma_f32_16x16x32_bf16 a[108:111], v[204:207], a[228:231], a[108:111]
  ds_read_b64_tr_b16 v[184:185], v6 offset:0
  v_mfma_f32_16x16x32_bf16 a[112:115], v[204:207], a[232:235], a[112:115]
  ds_read_b64_tr_b16 v[186:187], v6 offset:1024
  v_mfma_f32_16x16x32_bf16 a[92:95], v[200:203], a[232:235], a[92:95]
  ds_read_b128 a[200:203], v7 offset:0
  v_mfma_f32_16x16x32_bf16 a[96:99], v[200:203], a[236:239], a[96:99]
  ds_read_b128 a[204:207], v7 offset:2048
  v_mfma_f32_16x16x32_bf16 a[116:119], v[204:207], a[236:239], a[116:119]
  buffer_load_dwordx4 v11, s[12:15], s36 offen offset:0 lds
  v_mfma_f32_16x16x32_bf16 a[136:139], v[208:211], a[236:239], a[136:139]
  ds_read_b128 a[208:211], v7 offset:4096
  v_mfma_f32_16x16x32_bf16 a[156:159], v[212:215], a[236:239], a[156:159]
  v_mfma_f32_16x16x32_bf16 a[152:155], v[212:215], a[232:235], a[152:155]
  ds_read_b64_tr_b16 v[188:189], v6 offset:8
  v_mfma_f32_16x16x32_bf16 a[132:135], v[208:211], a[232:235], a[132:135]
  ds_read_b64_tr_b16 v[190:191], v6 offset:1032
  v_mfma_f32_16x16x32_bf16 a[128:131], v[208:211], a[228:231], a[128:131]
  ds_read_b128 a[212:215], v7 offset:6144
  v_mfma_f32_16x16x32_bf16 a[148:151], v[212:215], a[228:231], a[148:151]
  ds_read_b128 a[216:219], v7 offset:8192
  buffer_load_dwordx4 v12, s[12:15], s36 offen offset:1024 lds
  v_mfma_f32_16x16x32_bf16 a[144:147], v[212:215], a[224:227], a[144:147]
  ds_read_b64_tr_b16 v[192:193], v6 offset:256
  v_mfma_f32_16x16x32_bf16 a[124:127], v[208:211], a[224:227], a[124:127]
  ds_read_b64_tr_b16 v[194:195], v6 offset:1280
  v_mfma_f32_16x16x32_bf16 a[120:123], v[208:211], a[220:223], a[120:123]
  buffer_load_dwordx4 v13, s[12:15], s36 offen offset:2048 lds
  v_mfma_f32_16x16x32_bf16 a[140:143], v[212:215], a[220:223], a[140:143]
  s_waitcnt lgkmcnt(4)
  v_mfma_f32_16x16x32_bf16 a[0:3], v[184:187], a[200:203], a[0:3]
  s_waitcnt lgkmcnt(2)
  v_mfma_f32_16x16x32_bf16 a[20:23], v[188:191], a[200:203], a[20:23]
  ds_read_b64_tr_b16 v[196:197], v6 offset:264
  v_mfma_f32_16x16x32_bf16 a[24:27], v[188:191], a[204:207], a[24:27]
  ds_read_b64_tr_b16 v[198:199], v6 offset:1288
  v_mfma_f32_16x16x32_bf16 a[4:7], v[184:187], a[204:207], a[4:7]
  ds_read_b128 a[220:223], v7 offset:256
  v_mfma_f32_16x16x32_bf16 a[8:11], v[184:187], a[208:211], a[8:11]
  buffer_load_dwordx4 v14, s[12:15], s36 offen offset:3072 lds
  v_mfma_f32_16x16x32_bf16 a[28:31], v[188:191], a[208:211], a[28:31]
  ds_read_b64_tr_b16 v[200:201], v6 offset:512
  s_add_u32 s36, s36, 0x40000
  v_mfma_f32_16x16x32_bf16 a[32:35], v[188:191], a[212:215], a[32:35]
  ds_read_b64_tr_b16 v[202:203], v6 offset:1536
  s_add_u32 m0, s30, 16384
  v_mfma_f32_16x16x32_bf16 a[12:15], v[184:187], a[212:215], a[12:15]
  ds_read_b128 a[224:227], v7 offset:2304
  v_mfma_f32_16x16x32_bf16 a[16:19], v[184:187], a[216:219], a[16:19]
  buffer_load_dwordx4 v11, s[12:15], s36 offen offset:0 lds
  v_mfma_f32_16x16x32_bf16 a[36:39], v[188:191], a[216:219], a[36:39]
  s_waitcnt lgkmcnt(4)
  v_mfma_f32_16x16x32_bf16 a[56:59], v[192:195], a[216:219], a[56:59]
  ds_read_b64_tr_b16 v[204:205], v6 offset:520
  v_mfma_f32_16x16x32_bf16 a[76:79], v[196:199], a[216:219], a[76:79]
  ds_read_b64_tr_b16 v[206:207], v6 offset:1544
  v_mfma_f32_16x16x32_bf16 a[72:75], v[196:199], a[212:215], a[72:75]
  ds_read_b128 a[228:231], v7 offset:4352
  v_mfma_f32_16x16x32_bf16 a[52:55], v[192:195], a[212:215], a[52:55]
  buffer_load_dwordx4 v12, s[12:15], s36 offen offset:1024 lds
  v_mfma_f32_16x16x32_bf16 a[48:51], v[192:195], a[208:211], a[48:51]
  v_mfma_f32_16x16x32_bf16 a[68:71], v[196:199], a[208:211], a[68:71]
  ds_read_b64_tr_b16 v[208:209], v6 offset:768
  v_mfma_f32_16x16x32_bf16 a[64:67], v[196:199], a[204:207], a[64:67]
  ds_read_b64_tr_b16 v[210:211], v6 offset:1792
  v_mov_b32 v20, s41
  v_mfma_f32_16x16x32_bf16 a[44:47], v[192:195], a[204:207], a[44:47]
  ds_read_b128 a[232:235], v7 offset:6400
  v_mfma_f32_16x16x32_bf16 a[40:43], v[192:195], a[200:203], a[40:43]
  buffer_load_dwordx4 v13, s[12:15], s36 offen offset:2048 lds
  v_mfma_f32_16x16x32_bf16 a[60:63], v[196:199], a[200:203], a[60:63]
  s_waitcnt lgkmcnt(4)
  v_mfma_f32_16x16x32_bf16 a[80:83], v[200:203], a[200:203], a[80:83]
  ds_read_b64_tr_b16 v[212:213], v6 offset:776
  v_mov_b32 v21, s41
  v_mfma_f32_16x16x32_bf16 a[100:103], v[204:207], a[200:203], a[100:103]
  ds_read_b64_tr_b16 v[214:215], v6 offset:1800
  v_mfma_f32_16x16x32_bf16 a[104:107], v[204:207], a[204:207], a[104:107]
  ds_read_b128 a[236:239], v7 offset:8448
  v_mfma_f32_16x16x32_bf16 a[84:87], v[200:203], a[204:207], a[84:87]
  buffer_load_dwordx4 v14, s[12:15], s36 offen offset:3072 lds
  v_mfma_f32_16x16x32_bf16 a[88:91], v[200:203], a[208:211], a[88:91]
  s_add_u32 s36, s36, 0x40000
  v_mov_b32 v22, s41
  s_and_b32 s36, s36, 0x3fffff
  v_mfma_f32_16x16x32_bf16 a[108:111], v[204:207], a[208:211], a[108:111]
  ds_read_b64_tr_b16 v[184:185], v6 offset:16384
  s_add_u32 s37, s6, s7
  v_mfma_f32_16x16x32_bf16 a[112:115], v[204:207], a[212:215], a[112:115]
  ds_read_b64_tr_b16 v[186:187], v6 offset:17408
  s_add_u32 m0, s30, s32
  v_mfma_f32_16x16x32_bf16 a[92:95], v[200:203], a[212:215], a[92:95]
  v_mfma_f32_16x16x32_bf16 a[96:99], v[200:203], a[216:219], a[96:99]
  buffer_load_dwordx4 v15, s[8:11], s37 offen offset:0 lds
  v_mfma_f32_16x16x32_bf16 a[116:119], v[204:207], a[216:219], a[116:119]
  s_waitcnt lgkmcnt(3)
  v_mov_b32 v23, s41
  v_mfma_f32_16x16x32_bf16 a[136:139], v[208:211], a[216:219], a[136:139]
  ds_read_b64_tr_b16 v[188:189], v6 offset:16392
  v_mfma_f32_16x16x32_bf16 a[156:159], v[212:215], a[216:219], a[156:159]
  ds_read_b64_tr_b16 v[190:191], v6 offset:17416
  v_mfma_f32_16x16x32_bf16 a[152:155], v[212:215], a[212:215], a[152:155]
  v_mov_b32 v0, s41
  v_mfma_f32_16x16x32_bf16 a[132:135], v[208:211], a[212:215], a[132:135]
  buffer_load_dwordx4 v16, s[8:11], s37 offen offset:1024 lds
  v_mfma_f32_16x16x32_bf16 a[128:131], v[208:211], a[208:211], a[128:131]
  v_mfma_f32_16x16x32_bf16 a[148:151], v[212:215], a[208:211], a[148:151]
  ds_read_b64_tr_b16 v[192:193], v6 offset:16640
  v_mfma_f32_16x16x32_bf16 a[144:147], v[212:215], a[204:207], a[144:147]
  ds_read_b64_tr_b16 v[194:195], v6 offset:17664
  v_mfma_f32_16x16x32_bf16 a[124:127], v[208:211], a[204:207], a[124:127]
  v_mfma_f32_16x16x32_bf16 a[120:123], v[208:211], a[200:203], a[120:123]
  buffer_load_dwordx4 v17, s[8:11], s37 offen offset:2048 lds
  v_mfma_f32_16x16x32_bf16 a[140:143], v[212:215], a[200:203], a[140:143]
  s_waitcnt lgkmcnt(6)
  s_waitcnt lgkmcnt(2)
  v_mfma_f32_16x16x32_bf16 a[0:3], v[184:187], a[220:223], a[0:3]
  ds_read_b64_tr_b16 v[196:197], v6 offset:16648
  v_mfma_f32_16x16x32_bf16 a[20:23], v[188:191], a[220:223], a[20:23]
  ds_read_b64_tr_b16 v[198:199], v6 offset:17672
  v_mfma_f32_16x16x32_bf16 a[24:27], v[188:191], a[224:227], a[24:27]
  v_mfma_f32_16x16x32_bf16 a[4:7], v[184:187], a[224:227], a[4:7]
  buffer_load_dwordx4 v18, s[8:11], s37 offen offset:3072 lds
  v_mfma_f32_16x16x32_bf16 a[8:11], v[184:187], a[228:231], a[8:11]
  s_add_u32 m0, m0, 0x1000
  s_add_u32 s39, s37, 0x8000
  v_mfma_f32_16x16x32_bf16 a[28:31], v[188:191], a[228:231], a[28:31]
  ds_read_b64_tr_b16 v[200:201], v6 offset:16896
  v_mfma_f32_16x16x32_bf16 a[32:35], v[188:191], a[232:235], a[32:35]
  ds_read_b64_tr_b16 v[202:203], v6 offset:17920
  s_add_u32 s7, s7, 128
  v_mfma_f32_16x16x32_bf16 a[12:15], v[184:187], a[232:235], a[12:15]
  s_and_b32 s7, s7, 0x3ff
  v_mfma_f32_16x16x32_bf16 a[16:19], v[184:187], a[236:239], a[16:19]
  buffer_load_dwordx4 v15, s[8:11], s39 offen lds
  v_mfma_f32_16x16x32_bf16 a[36:39], v[188:191], a[236:239], a[36:39]
  s_waitcnt lgkmcnt(2)
  v_mfma_f32_16x16x32_bf16 a[56:59], v[192:195], a[236:239], a[56:59]
  ds_read_b64_tr_b16 v[204:205], v6 offset:16904
  v_mfma_f32_16x16x32_bf16 a[76:79], v[196:199], a[236:239], a[76:79]
  ds_read_b64_tr_b16 v[206:207], v6 offset:17928
  v_mfma_f32_16x16x32_bf16 a[72:75], v[196:199], a[232:235], a[72:75]
  ds_read_b64_tr_b16 v[208:209], v6 offset:17152
  v_mfma_f32_16x16x32_bf16 a[52:55], v[192:195], a[232:235], a[52:55]
  ds_read_b64_tr_b16 v[210:211], v6 offset:18176
  v_mfma_f32_16x16x32_bf16 a[48:51], v[192:195], a[228:231], a[48:51]
  v_mfma_f32_16x16x32_bf16 a[68:71], v[196:199], a[228:231], a[68:71]
  ds_read_b64_tr_b16 v[212:213], v6 offset:17160
  v_mfma_f32_16x16x32_bf16 a[64:67], v[196:199], a[224:227], a[64:67]
  ds_read_b64_tr_b16 v[214:215], v6 offset:18184
  s_add_u32 s30, s29, s31
  v_mfma_f32_16x16x32_bf16 a[44:47], v[192:195], a[224:227], a[44:47]
  s_add_u32 s29, s29, 53248
  v_mfma_f32_16x16x32_bf16 a[40:43], v[192:195], a[220:223], a[40:43]
  s_cmp_eq_u32 s29, 159744
  s_cselect_b32 s29, 0, s29
  v_mfma_f32_16x16x32_bf16 a[60:63], v[196:199], a[220:223], a[60:63]
  s_waitcnt lgkmcnt(4)
  v_mfma_f32_16x16x32_bf16 a[80:83], v[200:203], a[220:223], a[80:83]
  v_add_u32 v6, s29, v4
  v_mfma_f32_16x16x32_bf16 a[100:103], v[204:207], a[220:223], a[100:103]
  v_add_u32 v7, s29, v5
  v_mfma_f32_16x16x32_bf16 a[104:107], v[204:207], a[224:227], a[104:107]
  v_mfma_f32_16x16x32_bf16 a[84:87], v[200:203], a[224:227], a[84:87]
  s_mov_b32 m0, s30
  v_mfma_f32_16x16x32_bf16 a[88:91], v[200:203], a[228:231], a[88:91]
  s_waitcnt vmcnt(13) lgkmcnt(0)
  s_barrier
  v_mfma_f32_16x16x32_bf16 a[108:111], v[204:207], a[228:231], a[108:111]
  ds_read_b64_tr_b16 v[184:185], v6 offset:0
  v_mfma_f32_16x16x32_bf16 a[112:115], v[204:207], a[232:235], a[112:115]
  ds_read_b64_tr_b16 v[186:187], v6 offset:1024
  v_mfma_f32_16x16x32_bf16 a[92:95], v[200:203], a[232:235], a[92:95]
  ds_read_b128 a[200:203], v7 offset:0
  v_mfma_f32_16x16x32_bf16 a[96:99], v[200:203], a[236:239], a[96:99]
  ds_read_b128 a[204:207], v7 offset:2048
  v_mfma_f32_16x16x32_bf16 a[116:119], v[204:207], a[236:239], a[116:119]
  buffer_load_dwordx4 v11, s[12:15], s36 offen offset:0 lds
  v_mfma_f32_16x16x32_bf16 a[136:139], v[208:211], a[236:239], a[136:139]
  ds_read_b128 a[208:211], v7 offset:4096
  v_mfma_f32_16x16x32_bf16 a[156:159], v[212:215], a[236:239], a[156:159]
  v_mfma_f32_16x16x32_bf16 a[152:155], v[212:215], a[232:235], a[152:155]
  ds_read_b64_tr_b16 v[188:189], v6 offset:8
  v_mfma_f32_16x16x32_bf16 a[132:135], v[208:211], a[232:235], a[132:135]
  ds_read_b64_tr_b16 v[190:191], v6 offset:1032
  v_mfma_f32_16x16x32_bf16 a[128:131], v[208:211], a[228:231], a[128:131]
  ds_read_b128 a[212:215], v7 offset:6144
  v_mfma_f32_16x16x32_bf16 a[148:151], v[212:215], a[228:231], a[148:151]
  ds_read_b128 a[216:219], v7 offset:8192
  buffer_load_dwordx4 v12, s[12:15], s36 offen offset:1024 lds
  v_mfma_f32_16x16x32_bf16 a[144:147], v[212:215], a[224:227], a[144:147]
  ds_read_b64_tr_b16 v[192:193], v6 offset:256
  v_mfma_f32_16x16x32_bf16 a[124:127], v[208:211], a[224:227], a[124:127]
  ds_read_b64_tr_b16 v[194:195], v6 offset:1280
  v_mfma_f32_16x16x32_bf16 a[120:123], v[208:211], a[220:223], a[120:123]
  buffer_load_dwordx4 v13, s[12:15], s36 offen offset:2048 lds
  v_mfma_f32_16x16x32_bf16 a[140:143], v[212:215], a[220:223], a[140:143]
  s_waitcnt lgkmcnt(4)
  v_mfma_f32_16x16x32_bf16 v[24:27], v[184:187], a[200:203], 0
  s_waitcnt lgkmcnt(2)
  v_mfma_f32_16x16x32_bf16 v[28:31], v[188:191], a[200:203], 0
  ds_read_b64_tr_b16 v[196:197], v6 offset:264
  v_accvgpr_read_b32 v248, a80
  v_mfma_f32_16x16x32_bf16 v[60:63], v[188:191], a[204:207], 0
  ds_read_b64_tr_b16 v[198:199], v6 offset:1288
  v_accvgpr_read_b32 v249, a81
  v_mfma_f32_16x16x32_bf16 v[56:59], v[184:187], a[204:207], 0
  ds_read_b128 a[220:223], v7 offset:256
  v_accvgpr_read_b32 v250, a82
  v_mfma_f32_16x16x32_bf16 v[88:91], v[184:187], a[208:211], 0
  buffer_load_dwordx4 v14, s[12:15], s36 offen offset:3072 lds
  v_mfma_f32_16x16x32_bf16 v[92:95], v[188:191], a[208:211], 0
  ds_read_b64_tr_b16 v[200:201], v6 offset:512
  v_accvgpr_read_b32 v251, a83
  v_mfma_f32_16x16x32_bf16 v[124:127], v[188:191], a[212:215], 0
  ds_read_b64_tr_b16 v[202:203], v6 offset:1536
  v_accvgpr_read_b32 v252, a100
  v_mfma_f32_16x16x32_bf16 v[120:123], v[184:187], a[212:215], 0
  s_add_u32 s36, s36, 0x40000
  v_accvgpr_read_b32 v253, a101
  v_accvgpr_read_b32 v254, a102
  v_mfma_f32_16x16x32_bf16 v[152:155], v[184:187], a[216:219], 0
  s_add_u32 m0, s30, 16384
  v_accvgpr_read_b32 v255, a103
  v_mfma_f32_16x16x32_bf16 v[156:159], v[188:191], a[216:219], 0
  ds_read_b128 a[224:227], v7 offset:2304
  v_mul_f32 v248, v20, v248
  s_waitcnt lgkmcnt(6)
  v_mfma_f32_16x16x32_bf16 v[160:163], v[192:195], a[216:219], 0
  buffer_load_dwordx4 v11, s[12:15], s36 offen offset:0 lds
  s_waitcnt lgkmcnt(4)
  v_mfma_f32_16x16x32_bf16 v[164:167], v[196:199], a[216:219], 0
  v_mul_f32 v249, v20, v249
  v_mul_f32 v250, v20, v250
  v_mfma_f32_16x16x32_bf16 v[132:135], v[196:199], a[212:215], 0
  ds_read_b64_tr_b16 v[204:205], v6 offset:520
  v_mul_f32 v251, v20, v251
  v_mfma_f32_16x16x32_bf16 v[128:131], v[192:195], a[212:215], 0
  ds_read_b64_tr_b16 v[206:207], v6 offset:1544
  v_mul_f32 v252, v20, v252
  v_mfma_f32_16x16x32_bf16 v[96:99], v[192:195], a[208:211], 0
  ds_read_b128 a[228:231], v7 offset:4352
  v_mul_f32 v253, v20, v253
  v_mfma_f32_16x16x32_bf16 v[100:103], v[196:199], a[208:211], 0
  buffer_load_dwordx4 v12, s[12:15], s36 offen offset:1024 lds
  v_mfma_f32_16x16x32_bf16 v[68:71], v[196:199], a[204:207], 0
  ds_read_b64_tr_b16 v[208:209], v6 offset:768
  v_mul_f32 v254, v20, v254
  v_mfma_f32_16x16x32_bf16 v[64:67], v[192:195], a[204:207], 0
  ds_read_b64_tr_b16 v[210:211], v6 offset:1792
  v_mul_f32 v255, v20, v255
  v_mfma_f32_16x16x32_bf16 v[32:35], v[192:195], a[200:203], 0
  ds_read_b128 a[232:235], v7 offset:6400
  v_cvt_pk_bf16_f32 v224, v248, v249
  v_mfma_f32_16x16x32_bf16 v[36:39], v[196:199], a[200:203], 0
  buffer_load_dwordx4 v13, s[12:15], s36 offen offset:2048 lds
  s_waitcnt lgkmcnt(7)
  v_mfma_f32_16x16x32_bf16 v[40:43], v[200:203], a[200:203], 0
  ds_read_b64_tr_b16 v[212:213], v6 offset:776
  v_cvt_pk_bf16_f32 v225, v250, v251
  s_waitcnt lgkmcnt(5)
  v_mfma_f32_16x16x32_bf16 v[44:47], v[204:207], a[200:203], 0
  v_cvt_pk_bf16_f32 v226, v252, v253
  v_cvt_pk_bf16_f32 v227, v254, v255
  v_mfma_f32_16x16x32_bf16 v[76:79], v[204:207], a[204:207], 0
  ds_read_b64_tr_b16 v[214:215], v6 offset:1800
  v_accvgpr_write_b32 a80, v224
  v_mfma_f32_16x16x32_bf16 v[72:75], v[200:203], a[204:207], 0
  ds_read_b128 a[236:239], v7 offset:8448
  v_accvgpr_write_b32 a81, v225
  v_mfma_f32_16x16x32_bf16 v[104:107], v[200:203], a[208:211], 0
  buffer_load_dwordx4 v14, s[12:15], s36 offen offset:3072 lds
  v_mfma_f32_16x16x32_bf16 v[108:111], v[204:207], a[208:211], 0
  s_add_u32 s36, s36, 0x40000
  v_accvgpr_write_b32 a82, v226
  v_accvgpr_write_b32 a83, v227
  v_mfma_f32_16x16x32_bf16 v[140:143], v[204:207], a[212:215], 0
  s_and_b32 s36, s36, 0x3fffff
  v_accvgpr_read_b32 v248, a84
  v_accvgpr_read_b32 v249, a85
  v_mfma_f32_16x16x32_bf16 v[136:139], v[200:203], a[212:215], 0
  ds_read_b64_tr_b16 v[184:185], v6 offset:16384
  v_accvgpr_read_b32 v250, a86
  v_mfma_f32_16x16x32_bf16 v[168:171], v[200:203], a[216:219], 0
  s_add_u32 s37, s6, s7
  v_accvgpr_read_b32 v251, a87
  s_add_u32 m0, s30, s32
  ds_read_b64_tr_b16 v[186:187], v6 offset:17408
  v_mfma_f32_16x16x32_bf16 v[172:175], v[204:207], a[216:219], 0
  buffer_load_dwordx4 v15, s[8:11], s37 offen offset:0 lds
  s_waitcnt lgkmcnt(6)
  v_mfma_f32_16x16x32_bf16 v[176:179], v[208:211], a[216:219], 0
  ds_read_b64_tr_b16 v[188:189], v6 offset:16392
  v_accvgpr_read_b32 v252, a104
  s_waitcnt lgkmcnt(4)
  v_mfma_f32_16x16x32_bf16 v[180:183], v[212:215], a[216:219], 0
  v_accvgpr_read_b32 v253, a105
  v_accvgpr_read_b32 v254, a106
  v_mfma_f32_16x16x32_bf16 v[148:151], v[212:215], a[212:215], 0
  ds_read_b64_tr_b16 v[190:191], v6 offset:17416
  v_accvgpr_read_b32 v255, a107
  v_mfma_f32_16x16x32_bf16 v[144:147], v[208:211], a[212:215], 0
  buffer_load_dwordx4 v16, s[8:11], s37 offen offset:1024 lds
  v_mfma_f32_16x16x32_bf16 v[112:115], v[208:211], a[208:211], 0
  v_mul_f32 v248, v21, v248
  v_mul_f32 v249, v21, v249
  v_mfma_f32_16x16x32_bf16 v[116:119], v[212:215], a[208:211], 0
  ds_read_b64_tr_b16 v[192:193], v6 offset:16640
  v_mul_f32 v250, v21, v250
  v_mfma_f32_16x16x32_bf16 v[84:87], v[212:215], a[204:207], 0
  ds_read_b64_tr_b16 v[194:195], v6 offset:17664
  v_mul_f32 v251, v21, v251
  v_mfma_f32_16x16x32_bf16 v[80:83], v[208:211], a[204:207], 0
  v_mul_f32 v252, v21, v252
  v_mul_f32 v253, v21, v253
  v_mfma_f32_16x16x32_bf16 v[48:51], v[208:211], a[200:203], 0
  buffer_load_dwordx4 v17, s[8:11], s37 offen offset:2048 lds
  v_mfma_f32_16x16x32_bf16 v[52:55], v[212:215], a[200:203], 0
  s_waitcnt lgkmcnt(6)
  v_mul_f32 v254, v21, v254
  v_mul_f32 v255, v21, v255
  s_waitcnt lgkmcnt(4)
  v_mfma_f32_16x16x32_bf16 v[24:27], v[184:187], a[220:223], v[24:27]
  ds_read_b64_tr_b16 v[196:197], v6 offset:16648
  v_cvt_pk_bf16_f32 v228, v248, v249
  s_waitcnt lgkmcnt(3)
  v_mfma_f32_16x16x32_bf16 v[28:31], v[188:191], a[220:223], v[28:31]
  v_cvt_pk_bf16_f32 v229, v250, v251
  v_mfma_f32_16x16x32_bf16 v[60:63], v[188:191], a[224:227], v[60:63]
  ds_read_b64_tr_b16 v[198:199], v6 offset:17672
  v_cvt_pk_bf16_f32 v230, v252, v253
  v_mfma_f32_16x16x32_bf16 v[56:59], v[184:187], a[224:227], v[56:59]
  buffer_load_dwordx4 v18, s[8:11], s37 offen offset:3072 lds
  v_mfma_f32_16x16x32_bf16 v[88:91], v[184:187], a[228:231], v[88:91]
  s_add_u32 m0, m0, 0x1000
  v_cvt_pk_bf16_f32 v231, v254, v255
  v_accvgpr_write_b32 a84, v228
  v_mfma_f32_16x16x32_bf16 v[92:95], v[188:191], a[228:231], v[92:95]
  ds_read_b64_tr_b16 v[200:201], v6 offset:16896
  v_accvgpr_write_b32 a85, v229
  v_mfma_f32_16x16x32_bf16 v[124:127], v[188:191], a[232:235], v[124:127]
  ds_read_b64_tr_b16 v[202:203], v6 offset:17920
  v_accvgpr_write_b32 a86, v230
  v_mfma_f32_16x16x32_bf16 v[120:123], v[184:187], a[232:235], v[120:123]
  s_add_u32 s39, s37, 0x8000
  v_accvgpr_write_b32 a87, v231
  s_add_u32 s7, s7, 128
  v_mfma_f32_16x16x32_bf16 v[152:155], v[184:187], a[236:239], v[152:155]
  buffer_load_dwordx4 v15, s[8:11], s39 offen lds
  v_mfma_f32_16x16x32_bf16 v[156:159], v[188:191], a[236:239], v[156:159]
  s_and_b32 s7, s7, 0x3ff
  v_accvgpr_read_b32 v248, a88
  v_accvgpr_read_b32 v249, a89
  s_waitcnt lgkmcnt(4)
  v_mfma_f32_16x16x32_bf16 v[160:163], v[192:195], a[236:239], v[160:163]
  ds_read_b64_tr_b16 v[204:205], v6 offset:16904
  v_accvgpr_read_b32 v250, a90
  s_waitcnt lgkmcnt(3)
  v_mfma_f32_16x16x32_bf16 v[164:167], v[196:199], a[236:239], v[164:167]
  v_accvgpr_read_b32 v251, a91
  v_mfma_f32_16x16x32_bf16 v[132:135], v[196:199], a[232:235], v[132:135]
  ds_read_b64_tr_b16 v[206:207], v6 offset:17928
  v_accvgpr_read_b32 v252, a108
  v_mfma_f32_16x16x32_bf16 v[128:131], v[192:195], a[232:235], v[128:131]
  ds_read_b64_tr_b16 v[208:209], v6 offset:17152
  v_accvgpr_read_b32 v253, a109
  v_mfma_f32_16x16x32_bf16 v[96:99], v[192:195], a[228:231], v[96:99]
  ds_read_b64_tr_b16 v[210:211], v6 offset:18176
  v_accvgpr_read_b32 v254, a110
  v_mfma_f32_16x16x32_bf16 v[100:103], v[196:199], a[228:231], v[100:103]
  ds_read_b64_tr_b16 v[212:213], v6 offset:17160
  v_accvgpr_read_b32 v255, a111
  v_mfma_f32_16x16x32_bf16 v[68:71], v[196:199], a[224:227], v[68:71]
  ds_read_b64_tr_b16 v[214:215], v6 offset:18184
  v_mul_f32 v248, v22, v248
  v_mfma_f32_16x16x32_bf16 v[64:67], v[192:195], a[224:227], v[64:67]
  s_add_u32 s30, s29, s31
  v_mul_f32 v249, v22, v249
  s_add_u32 s29, s29, 53248
  v_mfma_f32_16x16x32_bf16 v[32:35], v[192:195], a[220:223], v[32:35]
  s_cmp_eq_u32 s29, 159744
  v_mul_f32 v250, v22, v250
  s_cselect_b32 s29, 0, s29
  v_mfma_f32_16x16x32_bf16 v[36:39], v[196:199], a[220:223], v[36:39]
  s_waitcnt lgkmcnt(4)
  v_mul_f32 v251, v22, v251
  v_mul_f32 v252, v22, v252
  v_mfma_f32_16x16x32_bf16 v[40:43], v[200:203], a[220:223], v[40:43]
  v_add_u32 v6, s29, v4
  v_mul_f32 v253, v22, v253
  v_mfma_f32_16x16x32_bf16 v[44:47], v[204:207], a[220:223], v[44:47]
  v_add_u32 v7, s29, v5
  v_mul_f32 v254, v22, v254
  v_mfma_f32_16x16x32_bf16 v[76:79], v[204:207], a[224:227], v[76:79]
  v_mul_f32 v255, v22, v255
  v_mfma_f32_16x16x32_bf16 v[72:75], v[200:203], a[224:227], v[72:75]
  s_mov_b32 m0, s30
  v_cvt_pk_bf16_f32 v216, v248, v249
  v_mfma_f32_16x16x32_bf16 v[104:107], v[200:203], a[228:231], v[104:107]
  s_branch K1_JOIN
K1_TRANS:
  s_waitcnt vmcnt(8) lgkmcnt(0)
  s_barrier
  v_add_u32 v6, s29, v1
  v_add_u32 v7, s29, v2
  v_mfma_f32_16x16x32_bf16 a[148:151], v[204:207], v[108:111], a[148:151]
  ds_read_b64_tr_b16 v[184:185], v7 offset:16384
  v_add_f32 v117, v117, v230
  v_mfma_f32_16x16x32_bf16 a[152:155], v[204:207], v[140:143], a[152:155]
  ds_read_b64_tr_b16 v[186:187], v7 offset:20480
  v_add_u32 v8, s29, v3
  v_add_f32 v117, v117, v231
  v_exp_f32 v218, v126
  v_mfma_f32_16x16x32_bf16 a[132:135], v[200:203], v[140:143], a[132:135]
  s_add_u32 s40, s33, s35
  v_exp_f32 v219, v127
  v_mfma_f32_16x16x32_bf16 a[136:139], v[200:203], v[172:175], a[136:139]
  s_add_u32 s35, s35, 0x2000
  v_cvt_pk_bf16_f32 v138, v216, v217
  v_add_f32 v149, v149, v216
  s_and_b32 s35, s35, 0x1ffff
  s_add_u32 m0, s30, 16384
  v_mfma_f32_16x16x32_bf16 a[156:159], v[204:207], v[172:175], a[156:159]
  s_waitcnt vmcnt(4)
  buffer_load_dwordx4 v9, s[20:23], s40 offen offset:0 nt lds
  v_mfma_f32_16x16x32_bf16 v[164:167], v[208:211], a[216:219], v[164:167]
  ds_read_b64_tr_b16 v[188:189], v8 offset:16384
  v_add_f32 v149, v149, v217
  v_exp_f32 v220, v156
  v_mfma_f32_16x16x32_bf16 v[164:167], v[212:215], a[236:239], v[164:167]
  v_exp_f32 v221, v157
  v_mfma_f32_16x16x32_bf16 v[132:135], v[212:215], a[232:235], v[132:135]
  ds_read_b64_tr_b16 v[190:191], v8 offset:20480
  v_cvt_pk_bf16_f32 v139, v218, v219
  v_mfma_f32_16x16x32_bf16 v[132:135], v[208:211], a[212:215], v[132:135]
  v_exp_f32 v222, v158
  v_add_f32 v149, v149, v218
  v_mfma_f32_16x16x32_bf16 v[100:103], v[208:211], a[208:211], v[100:103]
  v_add_f32 v149, v149, v219
  v_cvt_pk_bf16_f32 v170, v220, v221
  v_mfma_f32_16x16x32_bf16 v[100:103], v[212:215], a[228:231], v[100:103]
  ds_read_b128 v[192:195], v6 offset:0
  v_add_f32 v181, v181, v220
  v_mfma_f32_16x16x32_bf16 v[68:71], v[212:215], a[224:227], v[68:71]
  v_exp_f32 v223, v159
  v_mfma_f32_16x16x32_bf16 v[68:71], v[208:211], a[204:207], v[68:71]
  v_add_f32 v181, v181, v221
  v_cvt_pk_bf16_f32 v171, v222, v223
  v_mfma_f32_16x16x32_bf16 v[36:39], v[208:211], a[200:203], v[36:39]
  s_waitcnt vmcnt(5)
  buffer_load_dwordx4 v10, s[20:23], s40 offen offset:1024 nt lds
  v_mfma_f32_16x16x32_bf16 v[36:39], v[212:215], a[220:223], v[36:39]
  s_waitcnt lgkmcnt(1)
  v_add_f32 v181, v181, v222
  v_add_f32 v181, v181, v223
  v_max3_f32 v248, v53, v85, v117
  v_max3_f32 v248, v248, v149, v181
  v_cmp_nge_f32 vcc, s42, v248
  s_nop 0
  s_cbranch_vccnz RARE0_17
RET_17:
  v_mfma_f32_16x16x32_bf16 a[0:3], v[184:187], v[40:43], a[0:3]
  ds_read_b128 v[196:199], v6 offset:256
  v_add_f32 v52, v52, v53
  v_mfma_f32_16x16x32_bf16 a[20:23], v[188:191], v[40:43], a[20:23]
  v_exp_f32 v216, v32
  v_mfma_f32_16x16x32_bf16 a[24:27], v[188:191], v[72:75], a[24:27]
  v_add_f32 v84, v84, v85
  v_add_f32 v116, v116, v117
  v_mfma_f32_16x16x32_bf16 a[4:7], v[184:187], v[72:75], a[4:7]
  v_exp_f32 v217, v33
  v_add_f32 v148, v148, v149
  v_mfma_f32_16x16x32_bf16 a[8:11], v[184:187], v[104:107], a[8:11]
  v_add_f32 v180, v180, v181
  v_cvt_pk_bf16_f32 v44, v216, v217
  v_mfma_f32_16x16x32_bf16 a[28:31], v[188:191], v[104:107], a[28:31]
  ds_read_b64_tr_b16 v[200:201], v7 offset:16640
  v_add_f32 v53, v216, v217
  v_mfma_f32_16x16x32_bf16 a[32:35], v[188:191], v[136:139], a[32:35]
  ds_read_b64_tr_b16 v[202:203], v7 offset:20736
  v_exp_f32 v218, v34
  v_mfma_f32_16x16x32_bf16 a[12:15], v[184:187], v[136:139], a[12:15]
  v_exp_f32 v219, v35
  v_mfma_f32_16x16x32_bf16 a[16:19], v[184:187], v[168:171], a[16:19]
  s_waitcnt vmcnt(4)
  buffer_load_dwordx4 v9, s[20:23], s40 offen offset:2048 nt lds
  v_mfma_f32_16x16x32_bf16 a[36:39], v[188:191], v[168:171], a[36:39]
  s_waitcnt lgkmcnt(2)
  v_exp_f32 v220, v64
  v_mfma_f32_16x16x32_bf16 v[152:155], v[192:195], a[176:179], v[176:179]
  ds_read_b64_tr_b16 v[204:205], v8 offset:16640
  v_cvt_pk_bf16_f32 v45, v218, v219
  v_mfma_f32_16x16x32_bf16 v[152:155], v[196:199], a[196:199], v[152:155]
  v_exp_f32 v221, v65
  v_mfma_f32_16x16x32_bf16 v[120:123], v[196:199], a[192:195], v[144:147]
  ds_read_b64_tr_b16 v[206:207], v8 offset:20736
  v_add_f32 v53, v53, v218
  v_mfma_f32_16x16x32_bf16 v[120:123], v[192:195], a[172:175], v[120:123]
  v_exp_f32 v222, v66
  v_add_f32 v53, v53, v219
  v_mfma_f32_16x16x32_bf16 v[88:91], v[192:195], a[168:171], v[112:115]
  v_exp_f32 v223, v67
  v_mfma_f32_16x16x32_bf16 v[88:91], v[196:199], a[188:191], v[88:91]
  ds_read_b128 v[208:211], v6 offset:512
  v_cvt_pk_bf16_f32 v76, v220, v221
  v_mfma_f32_16x16x32_bf16 v[56:59], v[196:199], a[184:187], v[80:83]
  v_exp_f32 v224, v96
  v_add_f32 v85, v220, v221
  v_mfma_f32_16x16x32_bf16 v[56:59], v[192:195], a[164:167], v[56:59]
  v_exp_f32 v225, v97
  v_mfma_f32_16x16x32_bf16 v[24:27], v[192:195], a[160:163], v[48:51]
  s_waitcnt vmcnt(5)
  buffer_load_dwordx4 v10, s[20:23], s40 offen offset:3072 nt lds
  v_cvt_pk_bf16_f32 v77, v222, v223
  v_mfma_f32_16x16x32_bf16 v[24:27], v[196:199], a[180:183], v[24:27]
  s_waitcnt lgkmcnt(1)
  v_exp_f32 v226, v98
  v_mfma_f32_16x16x32_bf16 a[40:43], v[200:203], v[40:43], a[40:43]
  ds_read_b128 v[212:215], v6 offset:768
  v_add_f32 v85, v85, v222
  v_add_f32 v85, v85, v223
  v_mfma_f32_16x16x32_bf16 a[60:63], v[204:207], v[40:43], a[60:63]
  v_exp_f32 v227, v99
  v_mfma_f32_16x16x32_bf16 a[64:67], v[204:207], v[72:75], a[64:67]
  v_cvt_pk_bf16_f32 v108, v224, v225
  v_add_f32 v117, v224, v225
  v_mfma_f32_16x16x32_bf16 a[44:47], v[200:203], v[72:75], a[44:47]
  s_add_u32 s39, s33, s35
  v_exp_f32 v228, v128
  v_mfma_f32_16x16x32_bf16 a[48:51], v[200:203], v[104:107], a[48:51]
  s_add_u32 s35, s35, 0x2000
  v_exp_f32 v229, v129
  v_mfma_f32_16x16x32_bf16 a[68:71], v[204:207], v[104:107], a[68:71]
  ds_read_b64_tr_b16 v[184:185], v7 offset:16896
  v_cvt_pk_bf16_f32 v109, v226, v227
  v_mfma_f32_16x16x32_bf16 a[72:75], v[204:207], v[136:139], a[72:75]
  ds_read_b64_tr_b16 v[186:187], v7 offset:20992
  v_add_f32 v117, v117, v226
  v_mfma_f32_16x16x32_bf16 a[52:55], v[200:203], v[136:139], a[52:55]
  s_and_b32 s35, s35, 0x1ffff
  v_exp_f32 v230, v130
  v_mfma_f32_16x16x32_bf16 a[56:59], v[200:203], v[168:171], a[56:59]
  s_mov_b32 m0, s30
  v_add_f32 v117, v117, v227
  v_cvt_pk_bf16_f32 v140, v228, v229
  v_mfma_f32_16x16x32_bf16 a[76:79], v[204:207], v[168:171], a[76:79]
  s_waitcnt vmcnt(4)
  buffer_load_dwordx4 v9, s[20:23], s39 offen offset:0 nt lds
  s_waitcnt lgkmcnt(3)
  v_mfma_f32_16x16x32_bf16 v[152:155], v[208:211], a[216:219], v[152:155]
  ds_read_b64_tr_b16 v[188:189], v8 offset:16896
  v_add_f32 v149, v228, v229
  v_exp_f32 v231, v131
  s_waitcnt lgkmcnt(3)
  v_mfma_f32_16x16x32_bf16 v[152:155], v[212:215], a[236:239], v[152:155]
  v_exp_f32 v216, v160
  v_mfma_f32_16x16x32_bf16 v[120:123], v[212:215], a[232:235], v[120:123]
  ds_read_b64_tr_b16 v[190:191], v8 offset:20992
  v_cvt_pk_bf16_f32 v141, v230, v231
  v_mfma_f32_16x16x32_bf16 v[120:123], v[208:211], a[212:215], v[120:123]
  v_exp_f32 v217, v161
  v_mfma_f32_16x16x32_bf16 v[88:91], v[208:211], a[208:211], v[88:91]
  v_exp_f32 v218, v162
  v_add_f32 v149, v149, v230
  v_mfma_f32_16x16x32_bf16 v[88:91], v[212:215], a[228:231], v[88:91]
  ds_read_b128 v[192:195], v6 offset:4096
  v_add_f32 v149, v149, v231
  v_mfma_f32_16x16x32_bf16 v[56:59], v[212:215], a[224:227], v[56:59]
  v_exp_f32 v219, v163
  v_mfma_f32_16x16x32_bf16 v[56:59], v[208:211], a[204:207], v[56:59]
  v_cvt_pk_bf16_f32 v172, v216, v217
  v_add_f32 v181, v216, v217
  v_mfma_f32_16x16x32_bf16 v[24:27], v[208:211], a[200:203], v[24:27]
  s_waitcnt vmcnt(5)
  buffer_load_dwordx4 v10, s[20:23], s39 offen offset:1024 nt lds
  v_mfma_f32_16x16x32_bf16 v[24:27], v[212:215], a[220:223], v[24:27]
  s_waitcnt lgkmcnt(1)
  v_exp_f32 v220, v36
  v_mfma_f32_16x16x32_bf16 a[80:83], v[184:187], v[40:43], a[80:83]
  ds_read_b128 v[196:199], v6 offset:4352
  v_cvt_pk_bf16_f32 v173, v218, v219
  v_mfma_f32_16x16x32_bf16 a[100:103], v[188:191], v[40:43], a[100:103]
  v_exp_f32 v221, v37
  v_mfma_f32_16x16x32_bf16 a[104:107], v[188:191], v[72:75], a[104:107]
  v_exp_f32 v222, v38
  v_add_f32 v181, v181, v218
  v_add_f32 v181, v181, v219
  v_mfma_f32_16x16x32_bf16 a[84:87], v[184:187], v[72:75], a[84:87]
  v_exp_f32 v223, v39
  v_mfma_f32_16x16x32_bf16 a[88:91], v[184:187], v[104:107], a[88:91]
  v_cvt_pk_bf16_f32 v46, v220, v221
  v_add_f32 v53, v53, v220
  v_mfma_f32_16x16x32_bf16 a[108:111], v[188:191], v[104:107], a[108:111]
  ds_read_b64_tr_b16 v[200:201], v7 offset:17152
  v_add_f32 v53, v53, v221
  v_mfma_f32_16x16x32_bf16 a[112:115], v[188:191], v[136:139], a[112:115]
  ds_read_b64_tr_b16 v[202:203], v7 offset:21248
  v_cvt_pk_bf16_f32 v47, v222, v223
  v_mfma_f32_16x16x32_bf16 a[92:95], v[184:187], v[136:139], a[92:95]
  v_exp_f32 v224, v68
  v_mfma_f32_16x16x32_bf16 a[96:99], v[184:187], v[168:171], a[96:99]
  s_waitcnt vmcnt(4)
  buffer_load_dwordx4 v9, s[20:23], s39 offen offset:2048 nt lds
  v_exp_f32 v225, v69
  v_mfma_f32_16x16x32_bf16 a[116:119], v[188:191], v[168:171], a[116:119]
  s_waitcnt lgkmcnt(2)
  v_exp_f32 v226, v70
  v_mfma_f32_16x16x32_bf16 v[156:159], v[192:195], a[176:179], v[176:179]
  ds_read_b64_tr_b16 v[204:205], v8 offset:17152
  v_add_f32 v53, v53, v222
  v_add_f32 v53, v53, v223
  v_mfma_f32_16x16x32_bf16 v[156:159], v[196:199], a[196:199], v[156:159]
  v_exp_f32 v227, v71
  v_mfma_f32_16x16x32_bf16 v[124:127], v[196:199], a[192:195], v[144:147]
  ds_read_b64_tr_b16 v[206:207], v8 offset:21248
  v_cvt_pk_bf16_f32 v78, v224, v225
  v_mfma_f32_16x16x32_bf16 v[124:127], v[192:195], a[172:175], v[124:127]
  ds_read_b128 v[208:211], v6 offset:4608
  v_add_f32 v85, v85, v224
  v_mfma_f32_16x16x32_bf16 v[92:95], v[192:195], a[168:171], v[112:115]
  v_exp_f32 v228, v100
  v_add_f32 v85, v85, v225
  v_mfma_f32_16x16x32_bf16 v[92:95], v[196:199], a[188:191], v[92:95]
  ds_read_b128 v[212:215], v6 offset:4864
  v_cvt_pk_bf16_f32 v79, v226, v227
  v_mfma_f32_16x16x32_bf16 v[60:63], v[196:199], a[184:187], v[80:83]
  s_add_u32 s30, s29, s31
  v_exp_f32 v229, v101
  v_mfma_f32_16x16x32_bf16 v[60:63], v[192:195], a[164:167], v[60:63]
  s_add_u32 s29, s29, 53248
  v_exp_f32 v230, v102
  v_add_f32 v85, v85, v226
  v_mfma_f32_16x16x32_bf16 v[28:31], v[192:195], a[160:163], v[48:51]
  s_waitcnt vmcnt(5)
  buffer_load_dwordx4 v10, s[20:23], s39 offen offset:3072 nt lds
  v_add_f32 v85, v85, v227
  v_mfma_f32_16x16x32_bf16 v[28:31], v[196:199], a[180:183], v[28:31]
  s_waitcnt lgkmcnt(2)
  v_exp_f32 v231, v103
  v_mfma_f32_16x16x32_bf16 a[120:123], v[200:203], v[40:43], a[120:123]
  v_cvt_pk_bf16_f32 v110, v228, v229
  v_add_f32 v117, v117, v228
  v_mfma_f32_16x16x32_bf16 a[140:143], v[204:207], v[40:43], a[140:143]
  s_cmp_eq_u32 s29, 159744
  v_exp_f32 v216, v132
  v_mfma_f32_16x16x32_bf16 a[144:147], v[204:207], v[72:75], a[144:147]
  s_cselect_b32 s29, 0, s29
  v_add_f32 v117, v117, v229
  v_cvt_pk_bf16_f32 v111, v230, v231
  v_mfma_f32_16x16x32_bf16 a[124:127], v[200:203], v[72:75], a[124:127]
  v_exp_f32 v217, v133
  v_mfma_f32_16x16x32_bf16 a[128:131], v[200:203], v[104:107], a[128:131]
  s_waitcnt vmcnt(8) lgkmcnt(0)
  s_barrier
  v_add_u32 v6, s29, v1
  v_add_u32 v7, s29, v2
  v_mfma_f32_16x16x32_bf16 a[148:151], v[204:207], v[104:107], a[148:151]
  ds_read_b64_tr_b16 v[184:185], v7 offset:16384
  v_add_f32 v117, v117, v230
  v_mfma_f32_16x16x32_bf16 a[152:155], v[204:207], v[136:139], a[152:155]
  ds_read_b64_tr_b16 v[186:187], v7 offset:20480
  v_add_u32 v8, s29, v3
  v_add_f32 v117, v117, v231
  v_exp_f32 v218, v134
  v_mfma_f32_16x16x32_bf16 a[132:135], v[200:203], v[136:139], a[132:135]
  s_add_u32 s33, s33, 0x100000
  v_exp_f32 v219, v135
  v_mfma_f32_16x16x32_bf16 a[136:139], v[200:203], v[168:171], a[136:139]
  s_add_u32 s40, s33, s34
  v_cvt_pk_bf16_f32 v142, v216, v217
  v_add_f32 v149, v149, v216
  s_add_u32 s34, s34, 0x2000
  s_and_b32 s34, s34, 0x1ffff
  s_add_u32 m0, s30, 16384
  v_mfma_f32_16x16x32_bf16 a[156:159], v[204:207], v[168:171], a[156:159]
  buffer_load_dwordx4 v9, s[16:19], s40 offen offset:0 nt lds
  v_mfma_f32_16x16x32_bf16 v[156:159], v[208:211], a[216:219], v[156:159]
  ds_read_b64_tr_b16 v[188:189], v8 offset:16384
  v_add_f32 v149, v149, v217
  v_exp_f32 v220, v164
  v_mfma_f32_16x16x32_bf16 v[156:159], v[212:215], a[236:239], v[156:159]
  v_exp_f32 v221, v165
  v_mfma_f32_16x16x32_bf16 v[124:127], v[212:215], a[232:235], v[124:127]
  ds_read_b64_tr_b16 v[190:191], v8 offset:20480
  v_cvt_pk_bf16_f32 v143, v218, v219
  v_mfma_f32_16x16x32_bf16 v[124:127], v[208:211], a[212:215], v[124:127]
  v_exp_f32 v222, v166
  v_add_f32 v149, v149, v218
  v_mfma_f32_16x16x32_bf16 v[92:95], v[208:211], a[208:211], v[92:95]
  v_add_f32 v149, v149, v219
  v_cvt_pk_bf16_f32 v174, v220, v221
  v_mfma_f32_16x16x32_bf16 v[92:95], v[212:215], a[228:231], v[92:95]
  ds_read_b128 v[192:195], v6 offset:0
  v_add_f32 v181, v181, v220
  v_mfma_f32_16x16x32_bf16 v[60:63], v[212:215], a[224:227], v[60:63]
  v_exp_f32 v223, v167
  v_mfma_f32_16x16x32_bf16 v[60:63], v[208:211], a[204:207], v[60:63]
  v_add_f32 v181, v181, v221
  v_cvt_pk_bf16_f32 v175, v222, v223
  v_mfma_f32_16x16x32_bf16 v[28:31], v[208:211], a[200:203], v[28:31]
  buffer_load_dwordx4 v10, s[16:19], s40 offen offset:1024 nt lds
  v_mfma_f32_16x16x32_bf16 v[28:31], v[212:215], a[220:223], v[28:31]
  s_waitcnt lgkmcnt(1)
  v_add_f32 v181, v181, v222
  v_add_f32 v181, v181, v223
  v_max3_f32 v248, v53, v85, v117
  v_max3_f32 v248, v248, v149, v181
  v_cmp_nge_f32 vcc, s42, v248
  s_nop 0
  s_cbranch_vccnz RARE1_18
RET_18:
  v_mfma_f32_16x16x32_bf16 a[0:3], v[184:187], v[44:47], a[0:3]
  ds_read_b128 v[196:199], v6 offset:256
  v_add_f32 v52, v52, v53
  v_mfma_f32_16x16x32_bf16 a[20:23], v[188:191], v[44:47], a[20:23]
  v_exp_f32 v216, v24
  v_mfma_f32_16x16x32_bf16 a[24:27], v[188:191], v[76:79], a[24:27]
  v_add_f32 v84, v84, v85
  v_add_f32 v116, v116, v117
  v_mfma_f32_16x16x32_bf16 a[4:7], v[184:187], v[76:79], a[4:7]
  v_exp_f32 v217, v25
  v_add_f32 v148, v148, v149
  v_mfma_f32_16x16x32_bf16 a[8:11], v[184:187], v[108:111], a[8:11]
  v_add_f32 v180, v180, v181
  v_cvt_pk_bf16_f32 v40, v216, v217
  v_mfma_f32_16x16x32_bf16 a[28:31], v[188:191], v[108:111], a[28:31]
  ds_read_b64_tr_b16 v[200:201], v7 offset:16640
  v_add_f32 v53, v216, v217
  v_mfma_f32_16x16x32_bf16 a[32:35], v[188:191], v[140:143], a[32:35]
  ds_read_b64_tr_b16 v[202:203], v7 offset:20736
  v_exp_f32 v218, v26
  v_mfma_f32_16x16x32_bf16 a[12:15], v[184:187], v[140:143], a[12:15]
  v_exp_f32 v219, v27
  v_mfma_f32_16x16x32_bf16 a[16:19], v[184:187], v[172:175], a[16:19]
  buffer_load_dwordx4 v9, s[16:19], s40 offen offset:2048 nt lds
  v_mfma_f32_16x16x32_bf16 a[36:39], v[188:191], v[172:175], a[36:39]
  s_waitcnt lgkmcnt(2)
  v_exp_f32 v220, v56
  v_mfma_f32_16x16x32_bf16 v[160:163], v[192:195], a[176:179], v[176:179]
  ds_read_b64_tr_b16 v[204:205], v8 offset:16640
  v_cvt_pk_bf16_f32 v41, v218, v219
  v_mfma_f32_16x16x32_bf16 v[160:163], v[196:199], a[196:199], v[160:163]
  v_exp_f32 v221, v57
  v_mfma_f32_16x16x32_bf16 v[128:131], v[196:199], a[192:195], v[144:147]
  ds_read_b64_tr_b16 v[206:207], v8 offset:20736
  v_add_f32 v53, v53, v218
  v_mfma_f32_16x16x32_bf16 v[128:131], v[192:195], a[172:175], v[128:131]
  v_exp_f32 v222, v58
  v_add_f32 v53, v53, v219
  v_mfma_f32_16x16x32_bf16 v[96:99], v[192:195], a[168:171], v[112:115]
  v_exp_f32 v223, v59
  v_mfma_f32_16x16x32_bf16 v[96:99], v[196:199], a[188:191], v[96:99]
  ds_read_b128 v[208:211], v6 offset:512
  v_cvt_pk_bf16_f32 v72, v220, v221
  v_mfma_f32_16x16x32_bf16 v[64:67], v[196:199], a[184:187], v[80:83]
  v_exp_f32 v224, v88
  v_add_f32 v85, v220, v221
  v_mfma_f32_16x16x32_bf16 v[64:67], v[192:195], a[164:167], v[64:67]
  v_exp_f32 v225, v89
  v_mfma_f32_16x16x32_bf16 v[32:35], v[192:195], a[160:163], v[48:51]
  buffer_load_dwordx4 v10, s[16:19], s40 offen offset:3072 nt lds
  v_cvt_pk_bf16_f32 v73, v222, v223
  v_mfma_f32_16x16x32_bf16 v[32:35], v[196:199], a[180:183], v[32:35]
  s_waitcnt lgkmcnt(1)
  v_exp_f32 v226, v90
  v_mfma_f32_16x16x32_bf16 a[40:43], v[200:203], v[44:47], a[40:43]
  ds_read_b128 v[212:215], v6 offset:768
  v_add_f32 v85, v85, v222
  v_add_f32 v85, v85, v223
  v_mfma_f32_16x16x32_bf16 a[60:63], v[204:207], v[44:47], a[60:63]
  v_exp_f32 v227, v91
  v_mfma_f32_16x16x32_bf16 a[64:67], v[204:207], v[76:79], a[64:67]
  v_cvt_pk_bf16_f32 v104, v224, v225
  v_add_f32 v117, v224, v225
  v_mfma_f32_16x16x32_bf16 a[44:47], v[200:203], v[76:79], a[44:47]
  s_add_u32 s39, s33, s34
  v_exp_f32 v228, v120
  v_mfma_f32_16x16x32_bf16 a[48:51], v[200:203], v[108:111], a[48:51]
  s_add_u32 s34, s34, 0x2000
  v_exp_f32 v229, v121
  v_mfma_f32_16x16x32_bf16 a[68:71], v[204:207], v[108:111], a[68:71]
  ds_read_b64_tr_b16 v[184:185], v7 offset:16896
  v_cvt_pk_bf16_f32 v105, v226, v227
  v_mfma_f32_16x16x32_bf16 a[72:75], v[204:207], v[140:143], a[72:75]
  ds_read_b64_tr_b16 v[186:187], v7 offset:20992
  v_add_f32 v117, v117, v226
  v_mfma_f32_16x16x32_bf16 a[52:55], v[200:203], v[140:143], a[52:55]
  s_and_b32 s34, s34, 0x1ffff
  v_exp_f32 v230, v122
  v_mfma_f32_16x16x32_bf16 a[56:59], v[200:203], v[172:175], a[56:59]
  s_mov_b32 m0, s30
  v_add_f32 v117, v117, v227
  v_cvt_pk_bf16_f32 v136, v228, v229
  v_mfma_f32_16x16x32_bf16 a[76:79], v[204:207], v[172:175], a[76:79]
  buffer_load_dwordx4 v9, s[16:19], s39 offen offset:0 nt lds
  s_waitcnt lgkmcnt(3)
  v_mfma_f32_16x16x32_bf16 v[160:163], v[208:211], a[216:219], v[160:163]
  ds_read_b64_tr_b16 v[188:189], v8 offset:16896
  v_add_f32 v149, v228, v229
  v_exp_f32 v231, v123
  s_waitcnt lgkmcnt(3)
  v_mfma_f32_16x16x32_bf16 v[160:163], v[212:215], a[236:239], v[160:163]
  v_exp_f32 v216, v152
  v_mfma_f32_16x16x32_bf16 v[128:131], v[212:215], a[232:235], v[128:131]
  ds_read_b64_tr_b16 v[190:191], v8 offset:20992
  v_cvt_pk_bf16_f32 v137, v230, v231
  v_mfma_f32_16x16x32_bf16 v[128:131], v[208:211], a[212:215], v[128:131]
  v_exp_f32 v217, v153
  v_mfma_f32_16x16x32_bf16 v[96:99], v[208:211], a[208:211], v[96:99]
  v_exp_f32 v218, v154
  v_add_f32 v149, v149, v230
  v_mfma_f32_16x16x32_bf16 v[96:99], v[212:215], a[228:231], v[96:99]
  ds_read_b128 v[192:195], v6 offset:4096
  v_add_f32 v149, v149, v231
  v_mfma_f32_16x16x32_bf16 v[64:67], v[212:215], a[224:227], v[64:67]
  v_exp_f32 v219, v155
  v_mfma_f32_16x16x32_bf16 v[64:67], v[208:211], a[204:207], v[64:67]
  v_cvt_pk_bf16_f32 v168, v216, v217
  v_add_f32 v181, v216, v217
  v_mfma_f32_16x16x32_bf16 v[32:35], v[208:211], a[200:203], v[32:35]
  buffer_load_dwordx4 v10, s[16:19], s39 offen offset:1024 nt lds
  v_mfma_f32_16x16x32_bf16 v[32:35], v[212:215], a[220:223], v[32:35]
  s_waitcnt lgkmcnt(1)
  v_exp_f32 v220, v28
  v_mfma_f32_16x16x32_bf16 a[80:83], v[184:187], v[44:47], a[80:83]
  ds_read_b128 v[196:199], v6 offset:4352
  v_cvt_pk_bf16_f32 v169, v218, v219
  v_mfma_f32_16x16x32_bf16 a[100:103], v[188:191], v[44:47], a[100:103]
  v_exp_f32 v221, v29
  v_mfma_f32_16x16x32_bf16 a[104:107], v[188:191], v[76:79], a[104:107]
  v_exp_f32 v222, v30
  v_add_f32 v181, v181, v218
  v_add_f32 v181, v181, v219
  v_mfma_f32_16x16x32_bf16 a[84:87], v[184:187], v[76:79], a[84:87]
  v_exp_f32 v223, v31
  v_mfma_f32_16x16x32_bf16 a[88:91], v[184:187], v[108:111], a[88:91]
  v_cvt_pk_bf16_f32 v42, v220, v221
  v_add_f32 v53, v53, v220
  v_mfma_f32_16x16x32_bf16 a[108:111], v[188:191], v[108:111], a[108:111]
  ds_read_b64_tr_b16 v[200:201], v7 offset:17152
  v_add_f32 v53, v53, v221
  v_mfma_f32_16x16x32_bf16 a[112:115], v[188:191], v[140:143], a[112:115]
  ds_read_b64_tr_b16 v[202:203], v7 offset:21248
  v_cvt_pk_bf16_f32 v43, v222, v223
  v_mfma_f32_16x16x32_bf16 a[92:95], v[184:187], v[140:143], a[92:95]
  v_exp_f32 v224, v60
  v_mfma_f32_16x16x32_bf16 a[96:99], v[184:187], v[172:175], a[96:99]
  buffer_load_dwordx4 v9, s[16:19], s39 offen offset:2048 nt lds
  v_exp_f32 v225, v61
  v_mfma_f32_16x16x32_bf16 a[116:119], v[188:191], v[172:175], a[116:119]
  s_waitcnt lgkmcnt(2)
  v_exp_f32 v226, v62
  v_mfma_f32_16x16x32_bf16 v[164:167], v[192:195], a[176:179], v[176:179]
  ds_read_b64_tr_b16 v[204:205], v8 offset:17152
  v_add_f32 v53, v53, v222
  v_add_f32 v53, v53, v223
  v_mfma_f32_16x16x32_bf16 v[164:167], v[196:199], a[196:199], v[164:167]
  v_exp_f32 v227, v63
  v_mfma_f32_16x16x32_bf16 v[132:135], v[196:199], a[192:195], v[144:147]
  ds_read_b64_tr_b16 v[206:207], v8 offset:21248
  v_cvt_pk_bf16_f32 v74, v224, v225
  v_mfma_f32_16x16x32_bf16 v[132:135], v[192:195], a[172:175], v[132:135]
  ds_read_b128 v[208:211], v6 offset:4608
  v_add_f32 v85, v85, v224
  v_mfma_f32_16x16x32_bf16 v[100:103], v[192:195], a[168:171], v[112:115]
  v_exp_f32 v228, v92
  v_add_f32 v85, v85, v225
  v_mfma_f32_16x16x32_bf16 v[100:103], v[196:199], a[188:191], v[100:103]
  ds_read_b128 v[212:215], v6 offset:4864
  v_cvt_pk_bf16_f32 v75, v226, v227
  v_mfma_f32_16x16x32_bf16 v[68:71], v[196:199], a[184:187], v[80:83]
  s_add_u32 s30, s29, s31
  v_exp_f32 v229, v93
  v_mfma_f32_16x16x32_bf16 v[68:71], v[192:195], a[164:167], v[68:71]
  s_add_u32 s29, s29, 53248
  v_exp_f32 v230, v94
  v_add_f32 v85, v85, v226
  v_mfma_f32_16x16x32_bf16 v[36:39], v[192:195], a[160:163], v[48:51]
  buffer_load_dwordx4 v10, s[16:19], s39 offen offset:3072 nt lds
  v_add_f32 v85, v85, v227
  v_mfma_f32_16x16x32_bf16 v[36:39], v[196:199], a[180:183], v[36:39]
  s_waitcnt lgkmcnt(2)
  v_exp_f32 v231, v95
  v_mfma_f32_16x16x32_bf16 a[120:123], v[200:203], v[44:47], a[120:123]
  v_cvt_pk_bf16_f32 v106, v228, v229
  v_add_f32 v117, v117, v228
  v_mfma_f32_16x16x32_bf16 a[140:143], v[204:207], v[44:47], a[140:143]
  s_cmp_eq_u32 s29, 159744
  v_exp_f32 v216, v124
  v_mfma_f32_16x16x32_bf16 a[144:147], v[204:207], v[76:79], a[144:147]
  s_cselect_b32 s29, 0, s29
  v_add_f32 v117, v117, v229
  v_cvt_pk_bf16_f32 v107, v230, v231
  v_mfma_f32_16x16x32_bf16 a[124:127], v[200:203], v[76:79], a[124:127]
  v_exp_f32 v217, v125
  v_mfma_f32_16x16x32_bf16 a[128:131], v[200:203], v[108:111], a[128:131]
  s_waitcnt vmcnt(8) lgkmcnt(0)
  s_barrier
  v_add_u32 v6, s29, v1
  v_add_u32 v7, s29, v2
  v_mfma_f32_16x16x32_bf16 a[148:151], v[204:207], v[108:111], a[148:151]
  ds_read_b64_tr_b16 v[184:185], v7 offset:16384
  v_add_f32 v117, v117, v230
  v_mfma_f32_16x16x32_bf16 a[152:155], v[204:207], v[140:143], a[152:155]
  ds_read_b64_tr_b16 v[186:187], v7 offset:20480
  v_add_u32 v8, s29, v3
  v_add_f32 v117, v117, v231
  v_exp_f32 v218, v126
  v_mfma_f32_16x16x32_bf16 a[132:135], v[200:203], v[140:143], a[132:135]
  s_add_u32 s40, s33, s35
  v_exp_f32 v219, v127
  v_mfma_f32_16x16x32_bf16 a[136:139], v[200:203], v[172:175], a[136:139]
  s_add_u32 s35, s35, 0x2000
  v_cvt_pk_bf16_f32 v138, v216, v217
  v_add_f32 v149, v149, v216
  s_and_b32 s35, s35, 0x1ffff
  s_add_u32 m0, s30, 16384
  v_mfma_f32_16x16x32_bf16 a[156:159], v[204:207], v[172:175], a[156:159]
  buffer_load_dwordx4 v9, s[20:23], s40 offen offset:0 nt lds
  v_mfma_f32_16x16x32_bf16 v[164:167], v[208:211], a[216:219], v[164:167]
  ds_read_b64_tr_b16 v[188:189], v8 offset:16384
  v_add_f32 v149, v149, v217
  v_exp_f32 v220, v156
  v_mfma_f32_16x16x32_bf16 v[164:167], v[212:215], a[236:239], v[164:167]
  v_exp_f32 v221, v157
  v_mfma_f32_16x16x32_bf16 v[132:135], v[212:215], a[232:235], v[132:135]
  ds_read_b64_tr_b16 v[190:191], v8 offset:20480
  v_cvt_pk_bf16_f32 v139, v218, v219
  v_mfma_f32_16x16x32_bf16 v[132:135], v[208:211], a[212:215], v[132:135]
  v_exp_f32 v222, v158
  v_add_f32 v149, v149, v218
  v_mfma_f32_16x16x32_bf16 v[100:103], v[208:211], a[208:211], v[100:103]
  v_add_f32 v149, v149, v219
  v_cvt_pk_bf16_f32 v170, v220, v221
  v_mfma_f32_16x16x32_bf16 v[100:103], v[212:215], a[228:231], v[100:103]
  ds_read_b64_tr_b16 v[192:193], v7 offset:16640
  v_add_f32 v181, v181, v220
  v_mfma_f32_16x16x32_bf16 v[68:71], v[212:215], a[224:227], v[68:71]
  ds_read_b64_tr_b16 v[194:195], v7 offset:20736
  v_add_f32 v181, v181, v221
  v_exp_f32 v223, v159
  v_mfma_f32_16x16x32_bf16 v[68:71], v[208:211], a[204:207], v[68:71]
  v_cvt_pk_bf16_f32 v171, v222, v223
  v_add_f32 v181, v181, v222
  v_mfma_f32_16x16x32_bf16 v[36:39], v[208:211], a[200:203], v[36:39]
  buffer_load_dwordx4 v10, s[20:23], s40 offen offset:1024 nt lds
  v_mfma_f32_16x16x32_bf16 v[36:39], v[212:215], a[220:223], v[36:39]
  s_waitcnt lgkmcnt(4)
  v_add_f32 v181, v181, v223
  v_max3_f32 v248, v53, v85, v117
  v_max3_f32 v248, v248, v149, v181
  v_cmp_nge_f32 vcc, s42, v248
  s_nop 0
  s_cbranch_vccnz RARE0_19
RET_19:
  v_mfma_f32_16x16x32_bf16 a[0:3], v[184:187], v[40:43], a[0:3]
  ds_read_b64_tr_b16 v[196:197], v8 offset:16640
  v_add_f32 v52, v52, v53
  v_mfma_f32_16x16x32_bf16 a[4:7], v[184:187], v[72:75], a[4:7]
  ds_read_b64_tr_b16 v[198:199], v8 offset:20736
  v_add_f32 v84, v84, v85
  v_mfma_f32_16x16x32_bf16 a[8:11], v[184:187], v[104:107], a[8:11]
  ds_read_b128 a[160:163], v236 offset:0
  v_add_f32 v116, v116, v117
  v_mfma_f32_16x16x32_bf16 a[12:15], v[184:187], v[136:139], a[12:15]
  ds_read_b128 a[164:167], v236 offset:1024
  v_add_f32 v148, v148, v149
  v_mfma_f32_16x16x32_bf16 a[16:19], v[184:187], v[168:171], a[16:19]
  s_waitcnt lgkmcnt(6)
  v_exp_f32 v216, v32
  v_add_f32 v180, v180, v181
  v_mfma_f32_16x16x32_bf16 a[20:23], v[188:191], v[40:43], a[20:23]
  ds_read_b64_tr_b16 v[200:201], v7 offset:16896
  v_exp_f32 v217, v33
  v_exp_f32 v218, v34
  v_mfma_f32_16x16x32_bf16 a[24:27], v[188:191], v[72:75], a[24:27]
  ds_read_b64_tr_b16 v[202:203], v7 offset:20992
  v_cvt_pk_bf16_f32 v44, v216, v217
  v_exp_f32 v219, v35
  v_add_f32 v53, v216, v217
  v_mfma_f32_16x16x32_bf16 a[28:31], v[188:191], v[104:107], a[28:31]
  ds_read_b128 a[168:171], v236 offset:2048
  v_cvt_pk_bf16_f32 v45, v218, v219
  v_exp_f32 v220, v64
  v_mfma_f32_16x16x32_bf16 a[32:35], v[188:191], v[136:139], a[32:35]
  buffer_load_dwordx4 v9, s[20:23], s40 offen offset:2048 nt lds
  v_exp_f32 v221, v65
  v_add_f32 v53, v53, v218
  v_add_f32 v53, v53, v219
  v_mfma_f32_16x16x32_bf16 a[36:39], v[188:191], v[168:171], a[36:39]
  ds_read_b128 a[172:175], v236 offset:3072
  v_cvt_pk_bf16_f32 v76, v220, v221
  v_exp_f32 v222, v66
  v_exp_f32 v223, v67
  s_waitcnt lgkmcnt(8)
  v_mfma_f32_16x16x32_bf16 a[40:43], v[192:195], v[40:43], a[40:43]
  ds_read_b64_tr_b16 v[204:205], v8 offset:16896
  v_add_f32 v85, v220, v221
  v_exp_f32 v224, v96
  v_mfma_f32_16x16x32_bf16 a[44:47], v[192:195], v[72:75], a[44:47]
  v_exp_f32 v225, v97
  v_cvt_pk_bf16_f32 v77, v222, v223
  v_mfma_f32_16x16x32_bf16 a[48:51], v[192:195], v[104:107], a[48:51]
  ds_read_b64_tr_b16 v[206:207], v8 offset:20992
  v_add_f32 v85, v85, v222
  v_add_f32 v85, v85, v223
  v_exp_f32 v226, v98
  v_mfma_f32_16x16x32_bf16 a[52:55], v[192:195], v[136:139], a[52:55]
  ds_read_b128 a[176:179], v236 offset:4096
  v_cvt_pk_bf16_f32 v108, v224, v225
  v_exp_f32 v227, v99
  v_mfma_f32_16x16x32_bf16 a[56:59], v[192:195], v[168:171], a[56:59]
  ds_read_b128 a[180:183], v236 offset:53248
  v_add_f32 v117, v224, v225
  v_exp_f32 v228, v128
  v_cvt_pk_bf16_f32 v109, v226, v227
  s_waitcnt lgkmcnt(10)
  v_mfma_f32_16x16x32_bf16 a[60:63], v[196:199], v[40:43], a[60:63]
  ds_read_b64_tr_b16 v[208:209], v7 offset:17152
  v_add_f32 v117, v117, v226
  v_exp_f32 v229, v129
  v_mfma_f32_16x16x32_bf16 a[64:67], v[196:199], v[72:75], a[64:67]
  v_exp_f32 v230, v130
  v_add_f32 v117, v117, v227
  v_cvt_pk_bf16_f32 v140, v228, v229
  v_mfma_f32_16x16x32_bf16 a[68:71], v[196:199], v[104:107], a[68:71]
  ds_read_b64_tr_b16 v[210:211], v7 offset:21248
  v_add_f32 v149, v228, v229
  v_exp_f32 v231, v131
  v_exp_f32 v216, v160
  v_mfma_f32_16x16x32_bf16 a[72:75], v[196:199], v[136:139], a[72:75]
  ds_read_b128 a[184:187], v236 offset:54272
  v_cvt_pk_bf16_f32 v141, v230, v231
  v_exp_f32 v217, v161
  v_mfma_f32_16x16x32_bf16 a[76:79], v[196:199], v[168:171], a[76:79]
  buffer_load_dwordx4 v10, s[20:23], s40 offen offset:3072 nt lds
  v_add_f32 v149, v149, v230
  v_add_f32 v149, v149, v231
  v_exp_f32 v218, v162
  s_waitcnt lgkmcnt(9)
  v_mfma_f32_16x16x32_bf16 a[80:83], v[200:203], v[40:43], a[80:83]
  ds_read_b128 a[188:191], v236 offset:55296
  v_cvt_pk_bf16_f32 v172, v216, v217
  v_exp_f32 v219, v163
  v_mfma_f32_16x16x32_bf16 a[84:87], v[200:203], v[72:75], a[84:87]
  v_exp_f32 v220, v36
  v_add_f32 v181, v216, v217
  v_mfma_f32_16x16x32_bf16 a[88:91], v[200:203], v[104:107], a[88:91]
  ds_read_b64_tr_b16 v[212:213], v8 offset:17152
  v_cvt_pk_bf16_f32 v173, v218, v219
  v_exp_f32 v221, v37
  v_add_f32 v181, v181, v218
  v_mfma_f32_16x16x32_bf16 a[92:95], v[200:203], v[136:139], a[92:95]
  ds_read_b64_tr_b16 v[214:215], v8 offset:21248
  v_add_f32 v181, v181, v219
  v_exp_f32 v222, v38
  v_cvt_pk_bf16_f32 v46, v220, v221
  v_mfma_f32_16x16x32_bf16 a[96:99], v[200:203], v[168:171], a[96:99]
  ds_read_b128 a[192:195], v236 offset:56320
  v_add_f32 v53, v53, v220
  v_exp_f32 v223, v39
  s_waitcnt lgkmcnt(9)
  v_mfma_f32_16x16x32_bf16 a[100:103], v[204:207], v[40:43], a[100:103]
  ds_read_b128 a[196:199], v236 offset:57344
  v_add_f32 v53, v53, v221
  v_exp_f32 v224, v68
  v_cvt_pk_bf16_f32 v47, v222, v223
  v_mfma_f32_16x16x32_bf16 a[104:107], v[204:207], v[72:75], a[104:107]
  v_exp_f32 v225, v69
  v_add_f32 v53, v53, v222
  v_add_f32 v53, v53, v223
  v_mfma_f32_16x16x32_bf16 a[108:111], v[204:207], v[104:107], a[108:111]
  ds_read_b64_tr_b16 v[184:185], v7 offset:0
  v_cvt_pk_bf16_f32 v78, v224, v225
  v_exp_f32 v226, v70
  v_mfma_f32_16x16x32_bf16 a[112:115], v[204:207], v[136:139], a[112:115]
  s_add_u32 s39, s33, s34
  v_exp_f32 v227, v71
  s_add_u32 s34, s34, 0x2000
  s_and_b32 s34, s34, 0x1ffff
  s_mov_b32 m0, s30
  v_add_f32 v85, v85, v224
  v_add_f32 v85, v85, v225
  ds_read_b64_tr_b16 v[186:187], v7 offset:4096
  v_mfma_f32_16x16x32_bf16 a[116:119], v[204:207], v[168:171], a[116:119]
  ds_read_b128 a[200:203], v237 offset:0
  v_cvt_pk_bf16_f32 v79, v226, v227
  v_exp_f32 v228, v100
  v_exp_f32 v229, v101
  s_waitcnt lgkmcnt(9)
  v_mfma_f32_16x16x32_bf16 a[120:123], v[208:211], v[40:43], a[120:123]
  buffer_load_dwordx4 v9, s[16:19], s39 offen offset:0 nt lds
  v_add_f32 v85, v85, v226
  v_add_f32 v85, v85, v227
  ds_read_b128 a[204:207], v237 offset:1024
  v_mfma_f32_16x16x32_bf16 a[124:127], v[208:211], v[72:75], a[124:127]
  v_exp_f32 v230, v102
  v_cvt_pk_bf16_f32 v110, v228, v229
  v_exp_f32 v231, v103
  v_mfma_f32_16x16x32_bf16 a[128:131], v[208:211], v[104:107], a[128:131]
  ds_read_b64_tr_b16 v[188:189], v8 offset:0
  v_add_f32 v117, v117, v228
  v_add_f32 v117, v117, v229
  v_mfma_f32_16x16x32_bf16 a[132:135], v[208:211], v[136:139], a[132:135]
  ds_read_b64_tr_b16 v[190:191], v8 offset:4096
  v_cvt_pk_bf16_f32 v111, v230, v231
  v_exp_f32 v216, v132
  v_exp_f32 v217, v133
  v_mfma_f32_16x16x32_bf16 a[136:139], v[208:211], v[168:171], a[136:139]
  ds_read_b128 a[208:211], v237 offset:2048
  v_add_f32 v117, v117, v230
  v_add_f32 v117, v117, v231
  v_exp_f32 v218, v134
  s_waitcnt lgkmcnt(9)
  v_mfma_f32_16x16x32_bf16 a[140:143], v[212:215], v[40:43], a[140:143]
  ds_read_b128 a[212:215], v237 offset:3072
  v_cvt_pk_bf16_f32 v142, v216, v217
  v_exp_f32 v219, v135
  v_mfma_f32_16x16x32_bf16 a[144:147], v[212:215], v[72:75], a[144:147]
  v_exp_f32 v220, v164
  v_add_f32 v149, v149, v216
  v_add_f32 v149, v149, v217
  v_mfma_f32_16x16x32_bf16 a[148:151], v[212:215], v[104:107], a[148:151]
  ds_read_b64_tr_b16 v[192:193], v7 offset:256
  v_cvt_pk_bf16_f32 v143, v218, v219
  v_exp_f32 v221, v165
  v_mfma_f32_16x16x32_bf16 a[152:155], v[212:215], v[136:139], a[152:155]
  ds_read_b64_tr_b16 v[194:195], v7 offset:4352
  v_add_f32 v149, v149, v218
  v_add_f32 v149, v149, v219
  v_exp_f32 v222, v166
  v_mfma_f32_16x16x32_bf16 a[156:159], v[212:215], v[168:171], a[156:159]
  ds_read_b128 a[216:219], v237 offset:4096
  v_cvt_pk_bf16_f32 v174, v220, v221
  v_exp_f32 v223, v167
  v_add_f32 v181, v181, v220
  v_add_f32 v181, v181, v221
  v_cvt_pk_bf16_f32 v175, v222, v223
  v_add_f32 v181, v181, v222
  v_add_f32 v181, v181, v223
  v_max3_f32 v248, v53, v85, v117
  v_max3_f32 v248, v248, v149, v181
  v_cmp_nge_f32 vcc, s42, v248
  s_nop 0
  s_cbranch_vccnz RARE1_20
RET_20:
  s_waitcnt lgkmcnt(9)
  v_mfma_f32_16x16x32_bf16 a[0:3], v[184:187], v[44:47], a[0:3]
  buffer_load_dwordx4 v10, s[16:19], s39 offen offset:1024 nt lds
  v_mfma_f32_16x16x32_bf16 a[4:7], v[184:187], v[76:79], a[4:7]
  v_add_f32 v52, v52, v53
  v_add_f32 v84, v84, v85
  v_mfma_f32_16x16x32_bf16 a[8:11], v[184:187], v[108:111], a[8:11]
  ds_read_b64_tr_b16 v[196:197], v8 offset:256
  v_accvgpr_mov_b32 a220, a240
  v_mfma_f32_16x16x32_bf16 a[12:15], v[184:187], v[140:143], a[12:15]
  ds_read_b64_tr_b16 v[198:199], v8 offset:4352
  v_add_f32 v116, v116, v117
  v_add_f32 v148, v148, v149
  v_mfma_f32_16x16x32_bf16 a[16:19], v[184:187], v[172:175], a[16:19]
  s_waitcnt lgkmcnt(7)
  v_accvgpr_mov_b32 a221, a241
  v_add_f32 v180, v180, v181
  v_mov_b32 v53, v52
  v_mfma_f32_16x16x32_bf16 a[20:23], v[188:191], v[44:47], a[20:23]
  ds_read_b64_tr_b16 v[200:201], v7 offset:512
  v_accvgpr_mov_b32 a222, a242
  v_mov_b32 v85, v84
  v_mov_b32 v117, v116
  v_mfma_f32_16x16x32_bf16 a[24:27], v[188:191], v[76:79], a[24:27]
  ds_read_b64_tr_b16 v[202:203], v7 offset:4608
  v_accvgpr_mov_b32 a223, a243
  v_mov_b32 v149, v148
  v_mov_b32 v181, v180
  v_mfma_f32_16x16x32_bf16 a[28:31], v[188:191], v[108:111], a[28:31]
  v_accvgpr_mov_b32 a224, a244
  v_permlane16_swap_b32 v52, v53
  v_permlane16_swap_b32 v84, v85
  v_mfma_f32_16x16x32_bf16 a[32:35], v[188:191], v[140:143], a[32:35]
  buffer_load_dwordx4 v9, s[16:19], s39 offen offset:2048 nt lds
  v_permlane16_swap_b32 v116, v117
  v_accvgpr_mov_b32 a225, a245
  v_permlane16_swap_b32 v148, v149
  v_mfma_f32_16x16x32_bf16 a[36:39], v[188:191], v[172:175], a[36:39]
  s_waitcnt lgkmcnt(5)
  v_permlane16_swap_b32 v180, v181
  v_accvgpr_mov_b32 a226, a246
  v_add_f32 v52, v52, v53
  v_mfma_f32_16x16x32_bf16 a[40:43], v[192:195], v[44:47], a[40:43]
  ds_read_b64_tr_b16 v[204:205], v8 offset:512
  v_add_f32 v84, v84, v85
  v_accvgpr_mov_b32 a227, a247
  v_add_f32 v116, v116, v117
  v_mfma_f32_16x16x32_bf16 a[44:47], v[192:195], v[76:79], a[44:47]
  ds_read_b64_tr_b16 v[206:207], v8 offset:4608
  v_add_f32 v148, v148, v149
  v_accvgpr_mov_b32 a228, a248
  v_add_f32 v180, v180, v181
  v_mfma_f32_16x16x32_bf16 a[48:51], v[192:195], v[108:111], a[48:51]
  ds_read_b64_tr_b16 v[208:209], v7 offset:768
  v_mov_b32 v53, v52
  v_accvgpr_mov_b32 a229, a249
  v_mov_b32 v85, v84
  v_mfma_f32_16x16x32_bf16 a[52:55], v[192:195], v[140:143], a[52:55]
  ds_read_b64_tr_b16 v[210:211], v7 offset:4864
  v_mov_b32 v117, v116
  v_mov_b32 v149, v148
  v_accvgpr_mov_b32 a230, a250
  v_mov_b32 v181, v180
  v_mfma_f32_16x16x32_bf16 a[56:59], v[192:195], v[172:175], a[56:59]
  s_waitcnt lgkmcnt(6)
  v_permlane32_swap_b32 v52, v53
  v_accvgpr_mov_b32 a231, a251
  v_permlane32_swap_b32 v84, v85
  v_mfma_f32_16x16x32_bf16 a[60:63], v[196:199], v[44:47], a[60:63]
  ds_read_b64_tr_b16 v[212:213], v8 offset:768
  v_permlane32_swap_b32 v116, v117
  v_accvgpr_mov_b32 a232, a252
  v_permlane32_swap_b32 v148, v149
  v_mfma_f32_16x16x32_bf16 a[64:67], v[196:199], v[76:79], a[64:67]
  ds_read_b64_tr_b16 v[214:215], v8 offset:4864
  v_permlane32_swap_b32 v180, v181
  v_accvgpr_mov_b32 a233, a253
  v_add_f32 v52, v52, v53
  v_mfma_f32_16x16x32_bf16 a[68:71], v[196:199], v[108:111], a[68:71]
  s_add_u32 s30, s29, s31
  v_rcp_f32 v20, v52
  v_add_f32 v84, v84, v85
  v_accvgpr_mov_b32 a234, a254
  v_add_f32 v116, v116, v117
  v_mfma_f32_16x16x32_bf16 a[72:75], v[196:199], v[140:143], a[72:75]
  buffer_load_dwordx4 v10, s[16:19], s39 offen offset:3072 nt lds
  v_add_f32 v148, v148, v149
  v_add_f32 v180, v180, v181
  v_accvgpr_mov_b32 a235, a255
  v_mfma_f32_16x16x32_bf16 a[76:79], v[196:199], v[172:175], a[76:79]
  s_waitcnt lgkmcnt(6)
  v_rcp_f32 v21, v84
  v_accvgpr_write_b32 a236, v240
  v_mfma_f32_16x16x32_bf16 a[80:83], v[200:203], v[44:47], a[80:83]
  s_add_u32 s29, s29, 53248
  v_rcp_f32 v22, v116
  v_accvgpr_write_b32 a237, v241
  v_mfma_f32_16x16x32_bf16 a[84:87], v[200:203], v[76:79], a[84:87]
  s_cmp_eq_u32 s29, 159744
  v_rcp_f32 v23, v148
  v_accvgpr_write_b32 a238, v242
  v_mfma_f32_16x16x32_bf16 a[88:91], v[200:203], v[108:111], a[88:91]
  s_cselect_b32 s29, 0, s29
  v_rcp_f32 v0, v180
  v_accvgpr_write_b32 a239, v243
  v_mfma_f32_16x16x32_bf16 a[92:95], v[200:203], v[140:143], a[92:95]
  v_add_u32 v6, s29, v1
  v_accvgpr_read_b32 v248, a0
  v_mfma_f32_16x16x32_bf16 a[96:99], v[200:203], v[172:175], a[96:99]
  s_waitcnt lgkmcnt(4)
  v_accvgpr_read_b32 v249, a1
  v_accvgpr_read_b32 v250, a2
  v_mfma_f32_16x16x32_bf16 a[100:103], v[204:207], v[44:47], a[100:103]
  s_waitcnt vmcnt(8) lgkmcnt(0)
  s_barrier
  v_add_u32 v7, s29, v2
  v_accvgpr_read_b32 v251, a3
  v_accvgpr_read_b32 v252, a20
  v_mfma_f32_16x16x32_bf16 a[104:107], v[204:207], v[76:79], a[104:107]
  ds_read_b128 v[184:187], v6 offset:16384
  v_accvgpr_read_b32 v253, a21
  v_add_u32 v8, s29, v3
  v_accvgpr_read_b32 v254, a22
  v_accvgpr_read_b32 v255, a23
  v_mul_f32 v248, v20, v248
  v_mul_f32 v249, v20, v249
  v_mfma_f32_16x16x32_bf16 a[108:111], v[204:207], v[108:111], a[108:111]
  s_add_u32 s40, s33, s35
  v_mul_f32 v250, v20, v250
  v_mul_f32 v251, v20, v251
  v_mul_f32 v252, v20, v252
  v_mul_f32 v253, v20, v253
  v_mul_f32 v254, v20, v254
  v_mfma_f32_16x16x32_bf16 a[112:115], v[204:207], v[140:143], a[112:115]
  s_add_u32 s35, s35, 0x2000
  v_mul_f32 v255, v20, v255
  v_cvt_pk_bf16_f32 v40, v248, v249
  s_and_b32 s35, s35, 0x1ffff
  s_add_u32 m0, s30, 16384
  v_cvt_pk_bf16_f32 v41, v250, v251
  v_cvt_pk_bf16_f32 v42, v252, v253
  v_cvt_pk_bf16_f32 v43, v254, v255
  v_mfma_f32_16x16x32_bf16 a[116:119], v[204:207], v[172:175], a[116:119]
  ds_write_b128 v236, v[40:43] offset:0
  v_accvgpr_read_b32 v248, a4
  v_accvgpr_read_b32 v249, a5
  v_accvgpr_read_b32 v250, a6
  v_mfma_f32_16x16x32_bf16 a[120:123], v[208:211], v[44:47], a[120:123]
  buffer_load_dwordx4 v9, s[20:23], s40 offen offset:0 nt lds
  v_accvgpr_read_b32 v251, a7
  v_accvgpr_read_b32 v252, a24
  v_accvgpr_read_b32 v253, a25
  v_accvgpr_read_b32 v254, a26
  v_accvgpr_read_b32 v255, a27
  v_mfma_f32_16x16x32_bf16 a[124:127], v[208:211], v[76:79], a[124:127]
  v_mul_f32 v248, v21, v248
  v_mul_f32 v249, v21, v249
  v_mul_f32 v250, v21, v250
  v_mul_f32 v251, v21, v251
  v_mul_f32 v252, v21, v252
  v_mfma_f32_16x16x32_bf16 a[128:131], v[208:211], v[108:111], a[128:131]
  ds_read_b128 v[188:191], v6 offset:20480
  v_mul_f32 v253, v21, v253
  v_mul_f32 v254, v21, v254
  v_mul_f32 v255, v21, v255
  v_cvt_pk_bf16_f32 v72, v248, v249
  v_cvt_pk_bf16_f32 v73, v250, v251
  v_mfma_f32_16x16x32_bf16 a[132:135], v[208:211], v[140:143], a[132:135]
  buffer_load_dwordx4 v10, s[20:23], s40 offen offset:1024 nt lds
  v_cvt_pk_bf16_f32 v74, v252, v253
  v_cvt_pk_bf16_f32 v75, v254, v255
  ds_write_b128 v236, v[72:75] offset:1024
  v_accvgpr_read_b32 v248, a8
  v_mfma_f32_16x16x32_bf16 a[136:139], v[208:211], v[172:175], a[136:139]
  v_accvgpr_read_b32 v249, a9
  v_accvgpr_read_b32 v250, a10
  v_accvgpr_read_b32 v251, a11
  v_accvgpr_read_b32 v252, a28
  v_accvgpr_read_b32 v253, a29
  v_mfma_f32_16x16x32_bf16 a[140:143], v[212:215], v[44:47], a[140:143]
  v_accvgpr_read_b32 v254, a30
  v_accvgpr_read_b32 v255, a31
  v_mul_f32 v248, v22, v248
  v_mul_f32 v249, v22, v249
  v_mul_f32 v250, v22, v250
  v_mfma_f32_16x16x32_bf16 a[144:147], v[212:215], v[76:79], a[144:147]
  v_mul_f32 v251, v22, v251
  v_mul_f32 v252, v22, v252
  v_mul_f32 v253, v22, v253
  v_mul_f32 v254, v22, v254
  v_mul_f32 v255, v22, v255
  v_mfma_f32_16x16x32_bf16 a[148:151], v[212:215], v[108:111], a[148:151]
  v_cvt_pk_bf16_f32 v104, v248, v249
  v_cvt_pk_bf16_f32 v105, v250, v251
  v_cvt_pk_bf16_f32 v106, v252, v253
  v_cvt_pk_bf16_f32 v107, v254, v255
  ds_write_b128 v236, v[104:107] offset:2048
  ds_read_b128 v[192:195], v6 offset:16640
  v_mfma_f32_16x16x32_bf16 a[152:155], v[212:215], v[140:143], a[152:155]
  buffer_load_dwordx4 v9, s[20:23], s40 offen offset:2048 nt lds
  v_accvgpr_read_b32 v248, a12
  v_accvgpr_read_b32 v249, a13
  v_accvgpr_read_b32 v250, a14
  v_accvgpr_read_b32 v251, a15
  v_mfma_f32_16x16x32_bf16 a[156:159], v[212:215], v[172:175], a[156:159]
  s_waitcnt lgkmcnt(5)
  v_accvgpr_read_b32 v252, a32
  v_accvgpr_read_b32 v253, a33
  v_accvgpr_read_b32 v254, a34
  v_accvgpr_read_b32 v255, a35
  v_mul_f32 v248, v23, v248
  v_mfma_f32_16x16x32_bf16 v[24:27], v[184:187], a[160:163], 0
  v_mul_f32 v249, v23, v249
  v_mul_f32 v250, v23, v250
  v_mul_f32 v251, v23, v251
  v_mul_f32 v252, v23, v252
  v_mul_f32 v253, v23, v253
  v_mfma_f32_16x16x32_bf16 v[56:59], v[184:187], a[164:167], 0
  v_mul_f32 v254, v23, v254
  v_mul_f32 v255, v23, v255
  v_cvt_pk_bf16_f32 v136, v248, v249
  v_cvt_pk_bf16_f32 v137, v250, v251
  v_cvt_pk_bf16_f32 v138, v252, v253
  v_mfma_f32_16x16x32_bf16 v[88:91], v[184:187], a[168:171], 0
  v_cvt_pk_bf16_f32 v139, v254, v255
  v_accvgpr_read_b32 v248, a16
  ds_write_b128 v236, v[136:139] offset:3072
  v_accvgpr_read_b32 v249, a17
  ds_read_b128 v[196:199], v6 offset:20736
  v_mfma_f32_16x16x32_bf16 v[120:123], v[184:187], a[172:175], 0
  buffer_load_dwordx4 v10, s[20:23], s40 offen offset:3072 nt lds
  v_accvgpr_read_b32 v250, a18
  v_accvgpr_read_b32 v251, a19
  v_accvgpr_read_b32 v252, a36
  v_accvgpr_read_b32 v253, a37
  v_accvgpr_read_b32 v254, a38
  v_mfma_f32_16x16x32_bf16 v[152:155], v[184:187], a[176:179], 0
  s_waitcnt lgkmcnt(5)
  v_accvgpr_read_b32 v255, a39
  v_mul_f32 v248, v0, v248
  v_mul_f32 v249, v0, v249
  v_mul_f32 v250, v0, v250
  v_mul_f32 v251, v0, v251
  v_mfma_f32_16x16x32_bf16 v[28:31], v[188:191], a[160:163], 0
  v_mul_f32 v252, v0, v252
  v_mul_f32 v253, v0, v253
  v_mul_f32 v254, v0, v254
  v_mul_f32 v255, v0, v255
  v_cvt_pk_bf16_f32 v168, v248, v249
  v_mfma_f32_16x16x32_bf16 v[60:63], v[188:191], a[164:167], 0
  v_cvt_pk_bf16_f32 v169, v250, v251
  v_cvt_pk_bf16_f32 v170, v252, v253
  v_cvt_pk_bf16_f32 v171, v254, v255
  ds_write_b128 v236, v[168:171] offset:4096
  v_accvgpr_read_b32 v248, a40
  v_mfma_f32_16x16x32_bf16 v[92:95], v[188:191], a[168:171], 0
  ds_read_b128 v[200:203], v6 offset:16896
  v_accvgpr_read_b32 v249, a41
  v_accvgpr_read_b32 v250, a42
  v_accvgpr_read_b32 v251, a43
  v_accvgpr_read_b32 v252, a60
  v_accvgpr_read_b32 v253, a61
  v_accvgpr_read_b32 v254, a62
  v_mfma_f32_16x16x32_bf16 v[124:127], v[188:191], a[172:175], 0
  s_add_u32 s39, s33, s34
  v_accvgpr_read_b32 v255, a63
  v_mul_f32 v248, v20, v248
  v_mul_f32 v249, v20, v249
  v_mul_f32 v250, v20, v250
  v_mul_f32 v251, v20, v251
  v_mul_f32 v252, v20, v252
  v_mfma_f32_16x16x32_bf16 v[156:159], v[188:191], a[176:179], 0
  s_waitcnt lgkmcnt(4)
  v_mul_f32 v253, v20, v253
  v_mul_f32 v254, v20, v254
  v_mul_f32 v255, v20, v255
  v_cvt_pk_bf16_f32 v40, v248, v249
  v_cvt_pk_bf16_f32 v41, v250, v251
  v_cvt_pk_bf16_f32 v42, v252, v253
  v_mfma_f32_16x16x32_bf16 v[24:27], v[192:195], a[180:183], v[24:27]
  s_add_u32 s34, s34, 0x2000
  v_cvt_pk_bf16_f32 v43, v254, v255
  v_accvgpr_read_b32 v248, a44
  ds_write_b128 v236, v[40:43] offset:53248
  v_accvgpr_read_b32 v249, a45
  v_accvgpr_read_b32 v250, a46
  v_accvgpr_read_b32 v251, a47
  v_mfma_f32_16x16x32_bf16 v[56:59], v[192:195], a[184:187], v[56:59]
  ds_read_b128 v[204:207], v6 offset:20992
  v_accvgpr_read_b32 v252, a64
  v_accvgpr_read_b32 v253, a65
  v_accvgpr_read_b32 v254, a66
  v_accvgpr_read_b32 v255, a67
  v_mul_f32 v248, v21, v248
  v_mul_f32 v249, v21, v249
  v_mfma_f32_16x16x32_bf16 v[88:91], v[192:195], a[188:191], v[88:91]
  s_and_b32 s34, s34, 0x1ffff
  v_mul_f32 v250, v21, v250
  v_mul_f32 v251, v21, v251
  v_mul_f32 v252, v21, v252
  v_mul_f32 v253, v21, v253
  v_mul_f32 v254, v21, v254
  v_mul_f32 v255, v21, v255
  v_cvt_pk_bf16_f32 v72, v248, v249
  v_mfma_f32_16x16x32_bf16 v[120:123], v[192:195], a[192:195], v[120:123]
  s_mov_b32 m0, s30
  v_cvt_pk_bf16_f32 v73, v250, v251
  v_cvt_pk_bf16_f32 v74, v252, v253
  v_cvt_pk_bf16_f32 v75, v254, v255
  ds_write_b128 v236, v[72:75] offset:54272
  v_accvgpr_read_b32 v248, a48
  v_accvgpr_read_b32 v249, a49
  v_mfma_f32_16x16x32_bf16 v[152:155], v[192:195], a[196:199], v[152:155]
  buffer_load_dwordx4 v9, s[16:19], s39 offen offset:0 nt lds
  v_accvgpr_read_b32 v250, a50
  v_accvgpr_read_b32 v251, a51
  v_accvgpr_read_b32 v252, a68
  v_accvgpr_read_b32 v253, a69
  v_accvgpr_read_b32 v254, a70
  v_accvgpr_read_b32 v255, a71
  s_waitcnt lgkmcnt(5)
  v_mfma_f32_16x16x32_bf16 v[28:31], v[196:199], a[180:183], v[28:31]
  v_mul_f32 v248, v22, v248
  v_mul_f32 v249, v22, v249
  v_mul_f32 v250, v22, v250
  v_mul_f32 v251, v22, v251
  v_mul_f32 v252, v22, v252
  v_mul_f32 v253, v22, v253
  v_mfma_f32_16x16x32_bf16 v[60:63], v[196:199], a[184:187], v[60:63]
  v_mul_f32 v254, v22, v254
  v_mul_f32 v255, v22, v255
  v_cvt_pk_bf16_f32 v104, v248, v249
  v_cvt_pk_bf16_f32 v105, v250, v251
  v_cvt_pk_bf16_f32 v106, v252, v253
  v_cvt_pk_bf16_f32 v107, v254, v255
  v_mfma_f32_16x16x32_bf16 v[92:95], v[196:199], a[188:191], v[92:95]
  ds_write_b128 v236, v[104:107] offset:55296
  v_accvgpr_read_b32 v248, a52
  v_accvgpr_read_b32 v249, a53
  v_accvgpr_read_b32 v250, a54
  v_accvgpr_read_b32 v251, a55
  v_accvgpr_read_b32 v252, a72
  ds_read_b128 v[208:211], v6 offset:17152
  v_mfma_f32_16x16x32_bf16 v[124:127], v[196:199], a[192:195], v[124:127]
  buffer_load_dwordx4 v10, s[16:19], s39 offen offset:1024 nt lds
  v_accvgpr_read_b32 v253, a73
  v_accvgpr_read_b32 v254, a74
  v_accvgpr_read_b32 v255, a75
  v_mul_f32 v248, v23, v248
  v_mul_f32 v249, v23, v249
  v_mul_f32 v250, v23, v250
  v_mul_f32 v251, v23, v251
  v_mfma_f32_16x16x32_bf16 v[156:159], v[196:199], a[196:199], v[156:159]
  s_waitcnt lgkmcnt(5)
  v_mul_f32 v252, v23, v252
  v_mul_f32 v253, v23, v253
  v_mul_f32 v254, v23, v254
  v_mul_f32 v255, v23, v255
  v_cvt_pk_bf16_f32 v136, v248, v249
  v_cvt_pk_bf16_f32 v137, v250, v251
  v_mfma_f32_16x16x32_bf16 v[24:27], v[200:203], a[200:203], v[24:27]
  v_cvt_pk_bf16_f32 v138, v252, v253
  v_cvt_pk_bf16_f32 v139, v254, v255
  ds_write_b128 v236, v[136:139] offset:56320
  v_accvgpr_read_b32 v248, a56
  v_accvgpr_read_b32 v249, a57
  v_accvgpr_read_b32 v250, a58
  v_mfma_f32_16x16x32_bf16 v[56:59], v[200:203], a[204:207], v[56:59]
  ds_read_b128 v[212:215], v6 offset:21248
  v_accvgpr_read_b32 v251, a59
  v_accvgpr_read_b32 v252, a76
  v_accvgpr_read_b32 v253, a77
  v_accvgpr_read_b32 v254, a78
  v_accvgpr_read_b32 v255, a79
  v_mul_f32 v248, v0, v248
  v_mfma_f32_16x16x32_bf16 v[88:91], v[200:203], a[208:211], v[88:91]
  v_mul_f32 v249, v0, v249
  v_mul_f32 v250, v0, v250
  v_mul_f32 v251, v0, v251
  v_mul_f32 v252, v0, v252
  v_mul_f32 v253, v0, v253
  v_mul_f32 v254, v0, v254
  v_mfma_f32_16x16x32_bf16 v[120:123], v[200:203], a[212:215], v[120:123]
  buffer_load_dwordx4 v9, s[16:19], s39 offen offset:2048 nt lds
  v_mul_f32 v255, v0, v255
  v_cvt_pk_bf16_f32 v168, v248, v249
  v_cvt_pk_bf16_f32 v169, v250, v251
  v_cvt_pk_bf16_f32 v170, v252, v253
  v_cvt_pk_bf16_f32 v171, v254, v255
  ds_write_b128 v236, v[168:171] offset:57344
  v_accvgpr_read_b32 v248, a80
  v_mfma_f32_16x16x32_bf16 v[152:155], v[200:203], a[216:219], v[152:155]
  s_waitcnt lgkmcnt(6)
  v_accvgpr_read_b32 v249, a81
  v_accvgpr_read_b32 v250, a82
  v_accvgpr_read_b32 v251, a83
  v_accvgpr_read_b32 v252, a100
  v_accvgpr_read_b32 v253, a101
  v_accvgpr_read_b32 v254, a102
  v_mfma_f32_16x16x32_bf16 v[28:31], v[204:207], a[200:203], v[28:31]
  v_accvgpr_read_b32 v255, a103
  v_mul_f32 v248, v20, v248
  v_mul_f32 v249, v20, v249
  v_mul_f32 v250, v20, v250
  v_mul_f32 v251, v20, v251
  v_mul_f32 v252, v20, v252
  v_mfma_f32_16x16x32_bf16 v[60:63], v[204:207], a[204:207], v[60:63]
  v_mul_f32 v253, v20, v253
  v_mul_f32 v254, v20, v254
  v_mul_f32 v255, v20, v255
  v_cvt_pk_bf16_f32 v40, v248, v249
  v_cvt_pk_bf16_f32 v41, v250, v251
  v_cvt_pk_bf16_f32 v42, v252, v253
  v_mfma_f32_16x16x32_bf16 v[92:95], v[204:207], a[208:211], v[92:95]
  v_cvt_pk_bf16_f32 v43, v254, v255
  v_accvgpr_read_b32 v248, a84
  ds_write_b128 v237, v[40:43] offset:0
  v_accvgpr_read_b32 v249, a85
  v_accvgpr_read_b32 v250, a86
  ds_read_b128 v[184:187], v6 offset:0
  v_accvgpr_read_b32 v251, a87
  v_mfma_f32_16x16x32_bf16 v[124:127], v[204:207], a[212:215], v[124:127]
  buffer_load_dwordx4 v10, s[16:19], s39 offen offset:3072 nt lds
  v_accvgpr_read_b32 v252, a104
  v_accvgpr_read_b32 v253, a105
  v_accvgpr_read_b32 v254, a106
  v_accvgpr_read_b32 v255, a107
  v_mul_f32 v248, v21, v248
  v_mul_f32 v249, v21, v249
  v_mfma_f32_16x16x32_bf16 v[156:159], v[204:207], a[216:219], v[156:159]
  s_waitcnt lgkmcnt(5)
  v_mul_f32 v250, v21, v250
  v_mul_f32 v251, v21, v251
  v_mul_f32 v252, v21, v252
  v_mul_f32 v253, v21, v253
  v_mul_f32 v254, v21, v254
  v_mul_f32 v255, v21, v255
  v_mfma_f32_16x16x32_bf16 v[24:27], v[208:211], a[220:223], v[24:27]
  v_cvt_pk_bf16_f32 v72, v248, v249
  v_cvt_pk_bf16_f32 v73, v250, v251
  v_cvt_pk_bf16_f32 v74, v252, v253
  v_cvt_pk_bf16_f32 v75, v254, v255
  ds_write_b128 v237, v[72:75] offset:1024
  v_accvgpr_read_b32 v248, a88
  v_mfma_f32_16x16x32_bf16 v[56:59], v[208:211], a[224:227], v[56:59]
  ds_read_b128 v[188:191], v6 offset:256
  v_accvgpr_read_b32 v249, a89
  v_accvgpr_read_b32 v250, a90
  v_accvgpr_read_b32 v251, a91
  v_accvgpr_read_b32 v252, a108
  v_accvgpr_read_b32 v253, a109
  v_accvgpr_read_b32 v254, a110
  v_mfma_f32_16x16x32_bf16 v[88:91], v[208:211], a[228:231], v[88:91]
  v_accvgpr_read_b32 v255, a111
  v_mul_f32 v248, v22, v248
  v_mul_f32 v249, v22, v249
  v_mul_f32 v250, v22, v250
  v_mul_f32 v251, v22, v251
  v_mul_f32 v252, v22, v252
  v_mfma_f32_16x16x32_bf16 v[120:123], v[208:211], a[232:235], v[120:123]
  v_mul_f32 v253, v22, v253
  v_mul_f32 v254, v22, v254
  v_mul_f32 v255, v22, v255
  v_cvt_pk_bf16_f32 v104, v248, v249
  v_cvt_pk_bf16_f32 v105, v250, v251
  v_cvt_pk_bf16_f32 v106, v252, v253
  v_mfma_f32_16x16x32_bf16 v[152:155], v[208:211], a[236:239], v[152:155]
  s_waitcnt lgkmcnt(5)
  v_cvt_pk_bf16_f32 v107, v254, v255
  v_accvgpr_read_b32 v248, a92
  ds_write_b128 v237, v[104:107] offset:2048
  v_accvgpr_read_b32 v249, a93
  v_accvgpr_read_b32 v250, a94
  v_accvgpr_read_b32 v251, a95
  v_mfma_f32_16x16x32_bf16 v[28:31], v[212:215], a[220:223], v[28:31]
  v_accvgpr_read_b32 v252, a112
  v_accvgpr_read_b32 v253, a113
  v_accvgpr_read_b32 v254, a114
  v_accvgpr_read_b32 v255, a115
  v_mul_f32 v248, v23, v248
  v_mul_f32 v249, v23, v249
  v_mfma_f32_16x16x32_bf16 v[60:63], v[212:215], a[224:227], v[60:63]
  v_mul_f32 v250, v23, v250
  v_mul_f32 v251, v23, v251
  v_mul_f32 v252, v23, v252
  v_mul_f32 v253, v23, v253
  v_mul_f32 v254, v23, v254
  v_mul_f32 v255, v23, v255
  v_mfma_f32_16x16x32_bf16 v[92:95], v[212:215], a[228:231], v[92:95]
  v_cvt_pk_bf16_f32 v136, v248, v249
  v_cvt_pk_bf16_f32 v137, v250, v251
  v_cvt_pk_bf16_f32 v138, v252, v253
  v_cvt_pk_bf16_f32 v139, v254, v255
  ds_write_b128 v237, v[136:139] offset:3072
  ds_read_b128 v[192:195], v6 offset:512
  v_accvgpr_read_b32 v248, a96
  v_mfma_f32_16x16x32_bf16 v[124:127], v[212:215], a[232:235], v[124:127]
  ds_read_b128 v[196:199], v6 offset:768
  v_accvgpr_read_b32 v249, a97
  v_accvgpr_read_b32 v250, a98
  v_accvgpr_read_b32 v251, a99
  v_accvgpr_read_b32 v252, a116
  v_accvgpr_read_b32 v253, a117
  v_accvgpr_read_b32 v254, a118
  v_mfma_f32_16x16x32_bf16 v[156:159], v[212:215], a[236:239], v[156:159]
  s_waitcnt lgkmcnt(6)
  v_accvgpr_read_b32 v255, a119
  v_mul_f32 v248, v0, v248
  v_mul_f32 v249, v0, v249
  v_mul_f32 v250, v0, v250
  v_mul_f32 v251, v0, v251
  v_mul_f32 v252, v0, v252
  v_max3_f32 v216, v24, v25, v26
  v_max3_f32 v217, v27, v28, v29
  v_max3_f32 v216, v216, v30, v31
  v_max_f32 v216, v216, v217
  v_mov_b32 v217, v216
  s_nop 1
  v_permlane16_swap_b32 v216, v217
  v_max_f32 v216, v216, v217
  v_mov_b32 v217, v216
  s_nop 1
  v_permlane32_swap_b32 v216, v217
  v_max_f32 v216, v216, v217
  v_sub_f32 v48, 0, v216
  v_sub_f32 v49, 0, v216
  v_sub_f32 v50, 0, v216
  v_sub_f32 v51, 0, v216
  s_nop 1
  v_mfma_f32_16x16x32_bf16 v[32:35], v[184:187], a[160:163], v[48:51]
  v_mul_f32 v253, v0, v253
  v_mul_f32 v254, v0, v254
  v_mul_f32 v255, v0, v255
  v_cvt_pk_bf16_f32 v168, v248, v249
  v_cvt_pk_bf16_f32 v169, v250, v251
  v_cvt_pk_bf16_f32 v170, v252, v253
  v_max3_f32 v218, v56, v57, v58
  v_max3_f32 v219, v59, v60, v61
  v_max3_f32 v218, v218, v62, v63
  v_max_f32 v218, v218, v219
  v_mov_b32 v219, v218
  s_nop 1
  v_permlane16_swap_b32 v218, v219
  v_max_f32 v218, v218, v219
  v_mov_b32 v219, v218
  s_nop 1
  v_permlane32_swap_b32 v218, v219
  v_max_f32 v218, v218, v219
  v_sub_f32 v80, 0, v218
  v_sub_f32 v81, 0, v218
  v_sub_f32 v82, 0, v218
  v_sub_f32 v83, 0, v218
  s_nop 1
  v_mfma_f32_16x16x32_bf16 v[64:67], v[184:187], a[164:167], v[80:83]
  s_add_u32 s30, s29, s31
  v_cvt_pk_bf16_f32 v171, v254, v255
  v_max3_f32 v220, v88, v89, v90
  ds_write_b128 v237, v[168:171] offset:4096
  v_max3_f32 v222, v120, v121, v122
  v_max3_f32 v224, v152, v153, v154
  v_max3_f32 v221, v91, v92, v93
  v_max3_f32 v223, v123, v124, v125
  v_max3_f32 v225, v155, v156, v157
  v_max3_f32 v220, v220, v94, v95
  v_max3_f32 v222, v222, v126, v127
  v_max3_f32 v224, v224, v158, v159
  v_max_f32 v220, v220, v221
  v_max_f32 v222, v222, v223
  v_max_f32 v224, v224, v225
  v_mov_b32 v221, v220
  v_mov_b32 v223, v222
  v_mov_b32 v225, v224
  v_permlane16_swap_b32 v220, v221
  v_permlane16_swap_b32 v222, v223
  v_permlane16_swap_b32 v224, v225
  v_max_f32 v220, v220, v221
  v_max_f32 v222, v222, v223
  v_max_f32 v224, v224, v225
  v_mov_b32 v221, v220
  v_mov_b32 v223, v222
  v_mov_b32 v225, v224
  v_permlane32_swap_b32 v220, v221
  v_permlane32_swap_b32 v222, v223
  v_permlane32_swap_b32 v224, v225
  v_max_f32 v220, v220, v221
  v_max_f32 v222, v222, v223
  v_max_f32 v224, v224, v225
  v_sub_f32 v112, 0, v220
  v_sub_f32 v144, 0, v222
  v_sub_f32 v176, 0, v224
  v_sub_f32 v113, 0, v220
  v_sub_f32 v145, 0, v222
  v_sub_f32 v177, 0, v224
  v_sub_f32 v114, 0, v220
  v_sub_f32 v146, 0, v222
  v_sub_f32 v178, 0, v224
  v_sub_f32 v115, 0, v220
  v_sub_f32 v147, 0, v222
  v_sub_f32 v179, 0, v224
  ds_read_b128 v[200:203], v6 offset:4096
  v_mfma_f32_16x16x32_bf16 v[96:99], v[184:187], a[168:171], v[112:115]
  ds_read_b128 v[204:207], v6 offset:4352
  v_add_f32 v24, v24, v48
  v_add_f32 v25, v25, v48
  v_add_f32 v26, v26, v48
  v_accvgpr_read_b32 v248, a120
  v_mfma_f32_16x16x32_bf16 v[128:131], v[184:187], a[172:175], v[144:147]
  ds_read_b128 v[208:211], v6 offset:4608
  v_add_f32 v27, v27, v48
  v_accvgpr_read_b32 v249, a121
  v_accvgpr_read_b32 v250, a122
  v_add_f32 v56, v56, v80
  v_accvgpr_read_b32 v251, a123
  v_add_f32 v57, v57, v80
  v_accvgpr_read_b32 v252, a140
  v_add_f32 v58, v58, v80
  v_accvgpr_read_b32 v253, a141
  v_mfma_f32_16x16x32_bf16 v[160:163], v[184:187], a[176:179], v[176:179]
  ds_read_b128 v[212:215], v6 offset:4864
  v_add_f32 v59, v59, v80
  v_accvgpr_read_b32 v254, a142
  v_add_f32 v88, v88, v112
  v_accvgpr_read_b32 v255, a143
  v_mul_f32 v248, v20, v248
  v_add_f32 v89, v89, v112
  v_mul_f32 v249, v20, v249
  v_add_f32 v90, v90, v112
  v_mul_f32 v250, v20, v250
  v_add_f32 v91, v91, v112
  v_mul_f32 v251, v20, v251
  s_waitcnt lgkmcnt(9)
  v_mfma_f32_16x16x32_bf16 v[32:35], v[188:191], a[180:183], v[32:35]
  v_add_f32 v120, v120, v144
  v_mul_f32 v252, v20, v252
  v_add_f32 v121, v121, v144
  v_mul_f32 v253, v20, v253
  v_mul_f32 v254, v20, v254
  v_add_f32 v122, v122, v144
  v_mul_f32 v255, v20, v255
  v_add_f32 v123, v123, v144
  v_cvt_pk_bf16_f32 v44, v248, v249
  v_mfma_f32_16x16x32_bf16 v[64:67], v[188:191], a[184:187], v[64:67]
  s_add_u32 s29, s29, 53248
  v_add_f32 v152, v152, v176
  v_cvt_pk_bf16_f32 v45, v250, v251
  v_add_f32 v153, v153, v176
  v_cvt_pk_bf16_f32 v46, v252, v253
  v_cvt_pk_bf16_f32 v47, v254, v255
  v_add_f32 v154, v154, v176
  v_accvgpr_write_b32 a240, v44
  v_add_f32 v155, v155, v176
  v_accvgpr_write_b32 a241, v45
  v_add_f32 v28, v28, v48
  v_accvgpr_write_b32 a242, v46
  v_mfma_f32_16x16x32_bf16 v[96:99], v[188:191], a[188:191], v[96:99]
  s_cmp_eq_u32 s29, 159744
  v_add_f32 v29, v29, v48
  v_accvgpr_write_b32 a243, v47
  v_add_f32 v30, v30, v48
  v_accvgpr_read_b32 v248, a124
  v_accvgpr_read_b32 v249, a125
  v_add_f32 v31, v31, v48
  v_accvgpr_read_b32 v250, a126
  v_add_f32 v60, v60, v80
  v_accvgpr_read_b32 v251, a127
  v_add_f32 v61, v61, v80
  v_mfma_f32_16x16x32_bf16 v[128:131], v[188:191], a[192:195], v[128:131]
  s_cselect_b32 s29, 0, s29
  v_accvgpr_read_b32 v252, a144
  v_add_f32 v62, v62, v80
  v_accvgpr_read_b32 v253, a145
  v_add_f32 v63, v63, v80
  v_accvgpr_read_b32 v254, a146
  v_accvgpr_read_b32 v255, a147
  v_add_f32 v92, v92, v112
  v_mul_f32 v248, v21, v248
  v_add_f32 v93, v93, v112
  v_mul_f32 v249, v21, v249
  v_mfma_f32_16x16x32_bf16 v[160:163], v[188:191], a[196:199], v[160:163]
  s_waitcnt lgkmcnt(6)
  v_add_f32 v94, v94, v112
  v_mul_f32 v250, v21, v250
  v_add_f32 v95, v95, v112
  v_mul_f32 v251, v21, v251
  v_mul_f32 v252, v21, v252
  v_add_f32 v124, v124, v144
  v_mul_f32 v253, v21, v253
  v_add_f32 v125, v125, v144
  v_add_u32 v6, s29, v1
  v_mul_f32 v254, v21, v254
  v_add_f32 v126, v126, v144
  v_mfma_f32_16x16x32_bf16 v[32:35], v[192:195], a[200:203], v[32:35]
  s_waitcnt vmcnt(8) lgkmcnt(0)
  s_barrier
  v_exp_f32 v216, v24
  v_mul_f32 v255, v21, v255
  v_add_f32 v127, v127, v144
  v_cvt_pk_bf16_f32 v76, v248, v249
  v_add_f32 v156, v156, v176
  v_cvt_pk_bf16_f32 v77, v250, v251
  v_add_u32 v7, s29, v2
  v_cvt_pk_bf16_f32 v78, v252, v253
  v_add_f32 v157, v157, v176
  v_cvt_pk_bf16_f32 v79, v254, v255
  v_add_f32 v158, v158, v176
  v_accvgpr_write_b32 a244, v76
  v_mfma_f32_16x16x32_bf16 v[64:67], v[192:195], a[204:207], v[64:67]
  s_add_u32 s40, s33, s35
  v_exp_f32 v217, v25
  v_add_f32 v159, v159, v176
  v_accvgpr_write_b32 a245, v77
  v_add_u32 v8, s29, v3
  v_accvgpr_write_b32 a246, v78
  v_accvgpr_write_b32 a247, v79
  v_accvgpr_read_b32 v248, a128
  v_accvgpr_read_b32 v249, a129
  v_mfma_f32_16x16x32_bf16 v[96:99], v[192:195], a[208:211], v[96:99]
  s_add_u32 s35, s35, 0x2000
  v_exp_f32 v218, v26
  v_accvgpr_read_b32 v250, a130
  v_accvgpr_read_b32 v251, a131
  v_accvgpr_read_b32 v252, a148
  v_cvt_pk_bf16_f32 v40, v216, v217
  v_accvgpr_read_b32 v253, a149
  v_accvgpr_read_b32 v254, a150
  v_exp_f32 v219, v27
  v_accvgpr_read_b32 v255, a151
  v_mfma_f32_16x16x32_bf16 v[128:131], v[192:195], a[212:215], v[128:131]
  s_and_b32 s35, s35, 0x1ffff
  v_exp_f32 v220, v56
  v_mul_f32 v248, v22, v248
  v_add_f32 v53, v216, v217
  v_mul_f32 v249, v22, v249
  v_mul_f32 v250, v22, v250
  s_add_u32 m0, s30, 16384
  v_mul_f32 v251, v22, v251
  v_mul_f32 v252, v22, v252
  v_cvt_pk_bf16_f32 v41, v218, v219
  v_mfma_f32_16x16x32_bf16 v[160:163], v[192:195], a[216:219], v[160:163]
  buffer_load_dwordx4 v9, s[20:23], s40 offen offset:0 nt lds
  v_mul_f32 v253, v22, v253
  v_exp_f32 v221, v57
  v_mul_f32 v254, v22, v254
  v_mul_f32 v255, v22, v255
  v_add_f32 v53, v53, v218
  v_cvt_pk_bf16_f32 v108, v248, v249
  v_cvt_pk_bf16_f32 v109, v250, v251
  v_add_f32 v53, v53, v219
  v_cvt_pk_bf16_f32 v110, v252, v253
  v_mfma_f32_16x16x32_bf16 v[32:35], v[196:199], a[220:223], v[32:35]
  v_exp_f32 v222, v58
  v_cvt_pk_bf16_f32 v111, v254, v255
  v_accvgpr_write_b32 a248, v108
  v_cvt_pk_bf16_f32 v72, v220, v221
  v_accvgpr_write_b32 a249, v109
  v_exp_f32 v223, v59
  v_accvgpr_write_b32 a250, v110
  v_accvgpr_write_b32 a251, v111
  v_mfma_f32_16x16x32_bf16 v[64:67], v[196:199], a[224:227], v[64:67]
  v_exp_f32 v224, v88
  v_accvgpr_read_b32 v248, a132
  v_add_f32 v85, v220, v221
  v_accvgpr_read_b32 v249, a133
  v_accvgpr_read_b32 v250, a134
  v_accvgpr_read_b32 v251, a135
  v_accvgpr_read_b32 v252, a152
  v_cvt_pk_bf16_f32 v73, v222, v223
  v_accvgpr_read_b32 v253, a153
  v_exp_f32 v225, v89
  v_mfma_f32_16x16x32_bf16 v[96:99], v[196:199], a[228:231], v[96:99]
  v_exp_f32 v226, v90
  v_accvgpr_read_b32 v254, a154
  v_accvgpr_read_b32 v255, a155
  v_add_f32 v85, v85, v222
  v_mul_f32 v248, v23, v248
  v_add_f32 v85, v85, v223
  v_mul_f32 v249, v23, v249
  v_mul_f32 v250, v23, v250
  v_mfma_f32_16x16x32_bf16 v[128:131], v[196:199], a[232:235], v[128:131]
  buffer_load_dwordx4 v10, s[20:23], s40 offen offset:1024 nt lds
  v_mul_f32 v251, v23, v251
  v_mul_f32 v252, v23, v252
  v_cvt_pk_bf16_f32 v104, v224, v225
  v_mul_f32 v253, v23, v253
  v_exp_f32 v227, v91
  v_mul_f32 v254, v23, v254
  v_mul_f32 v255, v23, v255
  v_cvt_pk_bf16_f32 v140, v248, v249
  v_add_f32 v117, v224, v225
  v_mfma_f32_16x16x32_bf16 v[160:163], v[196:199], a[236:239], v[160:163]
  v_exp_f32 v228, v120
  v_cvt_pk_bf16_f32 v141, v250, v251
  v_cvt_pk_bf16_f32 v142, v252, v253
  v_cvt_pk_bf16_f32 v143, v254, v255
  v_cvt_pk_bf16_f32 v105, v226, v227
  v_accvgpr_write_b32 a252, v140
  v_exp_f32 v229, v121
  v_accvgpr_write_b32 a253, v141
  v_mfma_f32_16x16x32_bf16 v[36:39], v[200:203], a[160:163], v[48:51]
  v_exp_f32 v230, v122
  v_accvgpr_write_b32 a254, v142
  v_accvgpr_write_b32 a255, v143
  v_add_f32 v117, v117, v226
  v_accvgpr_read_b32 v248, a136
  v_add_f32 v117, v117, v227
  v_accvgpr_read_b32 v249, a137
  v_accvgpr_read_b32 v250, a138
  v_accvgpr_read_b32 v251, a139
  v_mfma_f32_16x16x32_bf16 v[68:71], v[200:203], a[164:167], v[80:83]
  v_exp_f32 v231, v123
  v_accvgpr_read_b32 v252, a156
  v_cvt_pk_bf16_f32 v136, v228, v229
  v_accvgpr_read_b32 v253, a157
  v_accvgpr_read_b32 v254, a158
  v_accvgpr_read_b32 v255, a159
  v_add_f32 v149, v228, v229
  v_mul_f32 v248, v0, v248
  v_mfma_f32_16x16x32_bf16 v[100:103], v[200:203], a[168:171], v[112:115]
  v_exp_f32 v216, v152
  v_mul_f32 v249, v0, v249
  v_mul_f32 v250, v0, v250
  v_mul_f32 v251, v0, v251
  v_cvt_pk_bf16_f32 v137, v230, v231
  v_mul_f32 v252, v0, v252
  v_exp_f32 v217, v153
  v_mul_f32 v253, v0, v253
  v_mul_f32 v254, v0, v254
  v_mfma_f32_16x16x32_bf16 v[132:135], v[200:203], a[172:175], v[144:147]
  v_exp_f32 v218, v154
  v_mul_f32 v255, v0, v255
  v_add_f32 v149, v149, v230
  v_cvt_pk_bf16_f32 v240, v248, v249
  v_add_f32 v149, v149, v231
  v_cvt_pk_bf16_f32 v241, v250, v251
  v_cvt_pk_bf16_f32 v242, v252, v253
  v_cvt_pk_bf16_f32 v243, v254, v255
  v_mfma_f32_16x16x32_bf16 v[164:167], v[200:203], a[176:179], v[176:179]
  v_exp_f32 v219, v155
  v_cvt_pk_bf16_f32 v168, v216, v217
  v_add_f32 v181, v216, v217
  v_exp_f32 v220, v28
  v_mfma_f32_16x16x32_bf16 v[36:39], v[204:207], a[180:183], v[36:39]
  ds_read_b64_tr_b16 v[184:185], v7 offset:16384
  v_cvt_pk_bf16_f32 v169, v218, v219
  v_exp_f32 v221, v29
  v_add_f32 v181, v181, v218
  v_mfma_f32_16x16x32_bf16 v[68:71], v[204:207], a[184:187], v[68:71]
  ds_read_b64_tr_b16 v[186:187], v7 offset:20480
  v_add_f32 v181, v181, v219
  v_exp_f32 v222, v30
  v_cvt_pk_bf16_f32 v42, v220, v221
  v_mfma_f32_16x16x32_bf16 v[100:103], v[204:207], a[188:191], v[100:103]
  v_exp_f32 v223, v31
  v_add_f32 v53, v53, v220
  v_add_f32 v53, v53, v221
  v_exp_f32 v224, v60
  v_mfma_f32_16x16x32_bf16 v[132:135], v[204:207], a[192:195], v[132:135]
  buffer_load_dwordx4 v9, s[20:23], s40 offen offset:2048 nt lds
  v_cvt_pk_bf16_f32 v43, v222, v223
  v_exp_f32 v225, v61
  v_mfma_f32_16x16x32_bf16 v[164:167], v[204:207], a[196:199], v[164:167]
  v_exp_f32 v226, v62
  v_add_f32 v53, v53, v222
  v_add_f32 v53, v53, v223
  v_cvt_pk_bf16_f32 v74, v224, v225
  v_mfma_f32_16x16x32_bf16 v[36:39], v[208:211], a[200:203], v[36:39]
  ds_read_b64_tr_b16 v[188:189], v8 offset:16384
  v_add_f32 v85, v85, v224
  v_exp_f32 v227, v63
  v_add_f32 v85, v85, v225
  v_mfma_f32_16x16x32_bf16 v[68:71], v[208:211], a[204:207], v[68:71]
  ds_read_b64_tr_b16 v[190:191], v8 offset:20480
  v_cvt_pk_bf16_f32 v75, v226, v227
  v_exp_f32 v228, v92
  v_exp_f32 v229, v93
  v_mfma_f32_16x16x32_bf16 v[100:103], v[208:211], a[208:211], v[100:103]
  v_exp_f32 v230, v94
  v_add_f32 v85, v85, v226
  v_add_f32 v85, v85, v227
  v_mfma_f32_16x16x32_bf16 v[132:135], v[208:211], a[212:215], v[132:135]
  v_exp_f32 v231, v95
  v_cvt_pk_bf16_f32 v106, v228, v229
  v_add_f32 v117, v117, v228
  v_add_f32 v117, v117, v229
  v_mfma_f32_16x16x32_bf16 v[164:167], v[208:211], a[216:219], v[164:167]
  v_exp_f32 v216, v124
  v_cvt_pk_bf16_f32 v107, v230, v231
  v_exp_f32 v217, v125
  v_mfma_f32_16x16x32_bf16 v[36:39], v[212:215], a[220:223], v[36:39]
  ds_read_b128 v[192:195], v6 offset:0
  v_add_f32 v117, v117, v230
  v_add_f32 v117, v117, v231
  v_exp_f32 v218, v126
  v_mfma_f32_16x16x32_bf16 v[68:71], v[212:215], a[224:227], v[68:71]
  v_exp_f32 v219, v127
  v_cvt_pk_bf16_f32 v138, v216, v217
  v_add_f32 v149, v149, v216
  v_add_f32 v149, v149, v217
  v_mfma_f32_16x16x32_bf16 v[100:103], v[212:215], a[228:231], v[100:103]
  v_exp_f32 v220, v156
  v_cvt_pk_bf16_f32 v139, v218, v219
  v_exp_f32 v221, v157
  v_mfma_f32_16x16x32_bf16 v[132:135], v[212:215], a[232:235], v[132:135]
  buffer_load_dwordx4 v10, s[20:23], s40 offen offset:3072 nt lds
  v_add_f32 v149, v149, v218
  v_add_f32 v149, v149, v219
  v_exp_f32 v222, v158
  v_mfma_f32_16x16x32_bf16 v[164:167], v[212:215], a[236:239], v[164:167]
  s_waitcnt lgkmcnt(1)
  v_exp_f32 v223, v159
  v_cvt_pk_bf16_f32 v170, v220, v221
  v_add_f32 v181, v181, v220
  v_mfma_f32_16x16x32_bf16 a[0:3], v[184:187], v[40:43], 0
  ds_read_b128 v[196:199], v6 offset:256
  v_add_f32 v181, v181, v221
  v_cvt_pk_bf16_f32 v171, v222, v223
  v_add_f32 v181, v181, v222
  v_add_f32 v181, v181, v223
  v_mov_b32 v52, v53
  v_mfma_f32_16x16x32_bf16 a[20:23], v[188:191], v[40:43], 0
  v_mov_b32 v84, v85
  v_mov_b32 v116, v117
  v_mov_b32 v148, v149
  v_mov_b32 v180, v181
  v_mfma_f32_16x16x32_bf16 a[24:27], v[188:191], v[72:75], 0
  v_exp_f32 v216, v32
  v_mfma_f32_16x16x32_bf16 a[4:7], v[184:187], v[72:75], 0
  s_add_u32 s39, s33, s34
  v_exp_f32 v217, v33
  v_mfma_f32_16x16x32_bf16 a[8:11], v[184:187], v[104:107], 0
  s_add_u32 s34, s34, 0x2000
  v_exp_f32 v218, v34
  v_mfma_f32_16x16x32_bf16 a[28:31], v[188:191], v[104:107], 0
  ds_read_b64_tr_b16 v[200:201], v7 offset:16640
  v_cvt_pk_bf16_f32 v44, v216, v217
  v_mfma_f32_16x16x32_bf16 a[32:35], v[188:191], v[136:139], 0
  ds_read_b64_tr_b16 v[202:203], v7 offset:20736
  v_add_f32 v53, v216, v217
  v_mfma_f32_16x16x32_bf16 a[12:15], v[184:187], v[136:139], 0
  s_and_b32 s34, s34, 0x1ffff
  v_exp_f32 v219, v35
  v_mfma_f32_16x16x32_bf16 a[16:19], v[184:187], v[168:171], 0
  s_mov_b32 m0, s30
  v_exp_f32 v220, v64
  v_mfma_f32_16x16x32_bf16 a[36:39], v[188:191], v[168:171], 0
  buffer_load_dwordx4 v9, s[16:19], s39 offen offset:0 nt lds
  s_waitcnt lgkmcnt(3)
  v_mfma_f32_16x16x32_bf16 v[152:155], v[192:195], a[176:179], v[176:179]
  ds_read_b64_tr_b16 v[204:205], v8 offset:16640
  v_cvt_pk_bf16_f32 v45, v218, v219
  s_waitcnt lgkmcnt(3)
  v_mfma_f32_16x16x32_bf16 v[152:155], v[196:199], a[196:199], v[152:155]
  v_exp_f32 v221, v65
  v_mfma_f32_16x16x32_bf16 v[120:123], v[196:199], a[192:195], v[144:147]
  ds_read_b64_tr_b16 v[206:207], v8 offset:20736
  v_add_f32 v53, v53, v218
  v_mfma_f32_16x16x32_bf16 v[120:123], v[192:195], a[172:175], v[120:123]
  buffer_load_dwordx4 v10, s[16:19], s39 offen offset:1024 nt lds
  v_add_f32 v53, v53, v219
  v_mfma_f32_16x16x32_bf16 v[88:91], v[192:195], a[168:171], v[112:115]
  v_exp_f32 v222, v66
  v_mfma_f32_16x16x32_bf16 v[88:91], v[196:199], a[188:191], v[88:91]
  ds_read_b128 v[208:211], v6 offset:512
  v_cvt_pk_bf16_f32 v76, v220, v221
  v_exp_f32 v223, v67
  v_mfma_f32_16x16x32_bf16 v[56:59], v[196:199], a[184:187], v[80:83]
  v_exp_f32 v224, v96
  v_add_f32 v85, v220, v221
  v_mfma_f32_16x16x32_bf16 v[56:59], v[192:195], a[164:167], v[56:59]
  v_exp_f32 v225, v97
  v_mfma_f32_16x16x32_bf16 v[24:27], v[192:195], a[160:163], v[48:51]
  v_cvt_pk_bf16_f32 v77, v222, v223
  v_add_f32 v85, v85, v222
  v_mfma_f32_16x16x32_bf16 v[24:27], v[196:199], a[180:183], v[24:27]
  s_waitcnt lgkmcnt(1)
  v_exp_f32 v226, v98
  v_mfma_f32_16x16x32_bf16 a[40:43], v[200:203], v[40:43], 0
  ds_read_b128 v[212:215], v6 offset:768
  v_add_f32 v85, v85, v223
  v_mfma_f32_16x16x32_bf16 a[60:63], v[204:207], v[40:43], 0
  v_exp_f32 v227, v99
  v_mfma_f32_16x16x32_bf16 a[64:67], v[204:207], v[72:75], 0
  v_cvt_pk_bf16_f32 v108, v224, v225
  v_add_f32 v117, v224, v225
  v_mfma_f32_16x16x32_bf16 a[44:47], v[200:203], v[72:75], 0
  buffer_load_dwordx4 v9, s[16:19], s39 offen offset:2048 nt lds
  v_mfma_f32_16x16x32_bf16 a[48:51], v[200:203], v[104:107], 0
  v_exp_f32 v228, v128
  v_mfma_f32_16x16x32_bf16 a[68:71], v[204:207], v[104:107], 0
  ds_read_b64_tr_b16 v[184:185], v7 offset:16896
  v_cvt_pk_bf16_f32 v109, v226, v227
  v_mfma_f32_16x16x32_bf16 a[72:75], v[204:207], v[136:139], 0
  ds_read_b64_tr_b16 v[186:187], v7 offset:20992
  v_add_f32 v117, v117, v226
  v_exp_f32 v229, v129
  v_mfma_f32_16x16x32_bf16 a[52:55], v[200:203], v[136:139], 0
  v_exp_f32 v230, v130
  v_mfma_f32_16x16x32_bf16 a[56:59], v[200:203], v[168:171], 0
  v_add_f32 v117, v117, v227
  v_cvt_pk_bf16_f32 v140, v228, v229
  v_mfma_f32_16x16x32_bf16 a[76:79], v[204:207], v[168:171], 0
  s_waitcnt lgkmcnt(2)
  v_exp_f32 v231, v131
  v_mfma_f32_16x16x32_bf16 v[152:155], v[208:211], a[216:219], v[152:155]
  ds_read_b64_tr_b16 v[188:189], v8 offset:16896
  v_add_f32 v149, v228, v229
  v_mfma_f32_16x16x32_bf16 v[152:155], v[212:215], a[236:239], v[152:155]
  v_exp_f32 v216, v160
  v_mfma_f32_16x16x32_bf16 v[120:123], v[212:215], a[232:235], v[120:123]
  ds_read_b64_tr_b16 v[190:191], v8 offset:20992
  v_cvt_pk_bf16_f32 v141, v230, v231
  v_mfma_f32_16x16x32_bf16 v[120:123], v[208:211], a[212:215], v[120:123]
  buffer_load_dwordx4 v10, s[16:19], s39 offen offset:3072 nt lds
  v_exp_f32 v217, v161
  v_mfma_f32_16x16x32_bf16 v[88:91], v[208:211], a[208:211], v[88:91]
  v_exp_f32 v218, v162
  v_add_f32 v149, v149, v230
  v_mfma_f32_16x16x32_bf16 v[88:91], v[212:215], a[228:231], v[88:91]
  ds_read_b128 v[192:195], v6 offset:4096
  v_add_f32 v149, v149, v231
  v_mfma_f32_16x16x32_bf16 v[56:59], v[212:215], a[224:227], v[56:59]
  v_exp_f32 v219, v163
  v_mfma_f32_16x16x32_bf16 v[56:59], v[208:211], a[204:207], v[56:59]
  v_cvt_pk_bf16_f32 v172, v216, v217
  v_add_f32 v181, v216, v217
  v_mfma_f32_16x16x32_bf16 v[24:27], v[208:211], a[200:203], v[24:27]
  v_exp_f32 v220, v36
  v_mfma_f32_16x16x32_bf16 v[24:27], v[212:215], a[220:223], v[24:27]
  s_waitcnt lgkmcnt(1)
  v_exp_f32 v221, v37
  v_mfma_f32_16x16x32_bf16 a[80:83], v[184:187], v[40:43], 0
  ds_read_b128 v[196:199], v6 offset:4352
  v_cvt_pk_bf16_f32 v173, v218, v219
  v_mfma_f32_16x16x32_bf16 a[100:103], v[188:191], v[40:43], 0
  v_exp_f32 v222, v38
  v_mfma_f32_16x16x32_bf16 a[104:107], v[188:191], v[72:75], 0
  v_add_f32 v181, v181, v218
  v_add_f32 v181, v181, v219
  v_mfma_f32_16x16x32_bf16 a[84:87], v[184:187], v[72:75], 0
  ds_read_b64_tr_b16 v[200:201], v7 offset:17152
  v_cvt_pk_bf16_f32 v46, v220, v221
  v_mfma_f32_16x16x32_bf16 a[88:91], v[184:187], v[104:107], 0
  ds_read_b64_tr_b16 v[202:203], v7 offset:21248
  v_add_f32 v53, v53, v220
  v_mfma_f32_16x16x32_bf16 a[108:111], v[188:191], v[104:107], 0
  ds_read_b64_tr_b16 v[204:205], v8 offset:17152
  v_add_f32 v53, v53, v221
  v_exp_f32 v223, v39
  v_mfma_f32_16x16x32_bf16 a[112:115], v[188:191], v[136:139], 0
  ds_read_b64_tr_b16 v[206:207], v8 offset:21248
  v_cvt_pk_bf16_f32 v47, v222, v223
  v_mfma_f32_16x16x32_bf16 a[92:95], v[184:187], v[136:139], 0
  ds_read_b128 v[208:211], v6 offset:4608
  v_add_f32 v53, v53, v222
  v_exp_f32 v224, v68
  v_mfma_f32_16x16x32_bf16 a[96:99], v[184:187], v[168:171], 0
  ds_read_b128 v[212:215], v6 offset:4864
  v_add_f32 v53, v53, v223
  v_exp_f32 v225, v69
  v_mfma_f32_16x16x32_bf16 a[116:119], v[188:191], v[168:171], 0
  s_waitcnt lgkmcnt(6)
  v_exp_f32 v226, v70
  v_mfma_f32_16x16x32_bf16 v[156:159], v[192:195], a[176:179], v[176:179]
  v_exp_f32 v227, v71
  v_mfma_f32_16x16x32_bf16 v[156:159], v[196:199], a[196:199], v[156:159]
  s_add_u32 s30, s29, s31
  v_cvt_pk_bf16_f32 v78, v224, v225
  v_add_f32 v85, v85, v224
  v_mfma_f32_16x16x32_bf16 v[124:127], v[196:199], a[192:195], v[144:147]
  s_add_u32 s29, s29, 53248
  v_exp_f32 v228, v100
  v_mfma_f32_16x16x32_bf16 v[124:127], v[192:195], a[172:175], v[124:127]
  s_cmp_eq_u32 s29, 159744
  v_add_f32 v85, v85, v225
  v_cvt_pk_bf16_f32 v79, v226, v227
  v_mfma_f32_16x16x32_bf16 v[92:95], v[192:195], a[168:171], v[112:115]
  s_cselect_b32 s29, 0, s29
  v_exp_f32 v229, v101
  v_mfma_f32_16x16x32_bf16 v[92:95], v[196:199], a[188:191], v[92:95]
  s_mov_b32 s44, 1
  s_branch K1_OUTER
K1_FINAL:
  s_waitcnt vmcnt(8) lgkmcnt(0)
  s_barrier
  v_add_u32 v6, s29, v1
  v_add_u32 v7, s29, v2
  v_mfma_f32_16x16x32_bf16 a[148:151], v[204:207], v[108:111], a[148:151]
  ds_read_b64_tr_b16 v[184:185], v7 offset:16384
  v_add_f32 v117, v117, v230
  v_mfma_f32_16x16x32_bf16 a[152:155], v[204:207], v[140:143], a[152:155]
  ds_read_b64_tr_b16 v[186:187], v7 offset:20480
  v_add_u32 v8, s29, v3
  v_add_f32 v117, v117, v231
  v_exp_f32 v218, v126
  v_mfma_f32_16x16x32_bf16 a[132:135], v[200:203], v[140:143], a[132:135]
  s_add_u32 s40, s33, s35
  v_exp_f32 v219, v127
  v_mfma_f32_16x16x32_bf16 a[136:139], v[200:203], v[172:175], a[136:139]
  s_add_u32 s35, s35, 0x2000
  v_cvt_pk_bf16_f32 v138, v216, v217
  v_add_f32 v149, v149, v216
  s_and_b32 s35, s35, 0x1ffff
  s_add_u32 m0, s30, 16384
  v_mfma_f32_16x16x32_bf16 a[156:159], v[204:207], v[172:175], a[156:159]
  s_waitcnt vmcnt(4)
  buffer_load_dwordx4 v9, s[20:23], s40 offen offset:0 nt lds
  v_mfma_f32_16x16x32_bf16 v[164:167], v[208:211], a[216:219], v[164:167]
  ds_read_b64_tr_b16 v[188:189], v8 offset:16384
  v_add_f32 v149, v149, v217
  v_exp_f32 v220, v156
  v_mfma_f32_16x16x32_bf16 v[164:167], v[212:215], a[236:239], v[164:167]
  v_exp_f32 v221, v157
  v_mfma_f32_16x16x32_bf16 v[132:135], v[212:215], a[232:235], v[132:135]
  ds_read_b64_tr_b16 v[190:191], v8 offset:20480
  v_cvt_pk_bf16_f32 v139, v218, v219
  v_mfma_f32_16x16x32_bf16 v[132:135], v[208:211], a[212:215], v[132:135]
  v_exp_f32 v222, v158
  v_add_f32 v149, v149, v218
  v_mfma_f32_16x16x32_bf16 v[100:103], v[208:211], a[208:211], v[100:103]
  v_add_f32 v149, v149, v219
  v_cvt_pk_bf16_f32 v170, v220, v221
  v_mfma_f32_16x16x32_bf16 v[100:103], v[212:215], a[228:231], v[100:103]
  ds_read_b128 v[192:195], v6 offset:0
  v_add_f32 v181, v181, v220
  v_mfma_f32_16x16x32_bf16 v[68:71], v[212:215], a[224:227], v[68:71]
  v_exp_f32 v223, v159
  v_mfma_f32_16x16x32_bf16 v[68:71], v[208:211], a[204:207], v[68:71]
  v_add_f32 v181, v181, v221
  v_cvt_pk_bf16_f32 v171, v222, v223
  v_mfma_f32_16x16x32_bf16 v[36:39], v[208:211], a[200:203], v[36:39]
  s_waitcnt vmcnt(5)
  buffer_load_dwordx4 v10, s[20:23], s40 offen offset:1024 nt lds
  v_mfma_f32_16x16x32_bf16 v[36:39], v[212:215], a[220:223], v[36:39]
  s_waitcnt lgkmcnt(1)
  v_add_f32 v181, v181, v222
  v_add_f32 v181, v181, v223
  v_max3_f32 v248, v53, v85, v117
  v_max3_f32 v248, v248, v149, v181
  v_cmp_nge_f32 vcc, s42, v248
  s_nop 0
  s_cbranch_vccnz RARE0_12
RET_12:
  v_mfma_f32_16x16x32_bf16 a[0:3], v[184:187], v[40:43], a[0:3]
  ds_read_b128 v[196:199], v6 offset:256
  v_add_f32 v52, v52, v53
  v_mfma_f32_16x16x32_bf16 a[20:23], v[188:191], v[40:43], a[20:23]
  v_exp_f32 v216, v32
  v_mfma_f32_16x16x32_bf16 a[24:27], v[188:191], v[72:75], a[24:27]
  v_add_f32 v84, v84, v85
  v_add_f32 v116, v116, v117
  v_mfma_f32_16x16x32_bf16 a[4:7], v[184:187], v[72:75], a[4:7]
  v_exp_f32 v217, v33
  v_add_f32 v148, v148, v149
  v_mfma_f32_16x16x32_bf16 a[8:11], v[184:187], v[104:107], a[8:11]
  v_add_f32 v180, v180, v181
  v_cvt_pk_bf16_f32 v44, v216, v217
  v_mfma_f32_16x16x32_bf16 a[28:31], v[188:191], v[104:107], a[28:31]
  ds_read_b64_tr_b16 v[200:201], v7 offset:16640
  v_add_f32 v53, v216, v217
  v_mfma_f32_16x16x32_bf16 a[32:35], v[188:191], v[136:139], a[32:35]
  ds_read_b64_tr_b16 v[202:203], v7 offset:20736
  v_exp_f32 v218, v34
  v_mfma_f32_16x16x32_bf16 a[12:15], v[184:187], v[136:139], a[12:15]
  v_exp_f32 v219, v35
  v_mfma_f32_16x16x32_bf16 a[16:19], v[184:187], v[168:171], a[16:19]
  s_waitcnt vmcnt(4)
  buffer_load_dwordx4 v9, s[20:23], s40 offen offset:2048 nt lds
  v_mfma_f32_16x16x32_bf16 a[36:39], v[188:191], v[168:171], a[36:39]
  s_waitcnt lgkmcnt(2)
  v_exp_f32 v220, v64
  v_mfma_f32_16x16x32_bf16 v[152:155], v[192:195], a[176:179], v[176:179]
  ds_read_b64_tr_b16 v[204:205], v8 offset:16640
  v_cvt_pk_bf16_f32 v45, v218, v219
  v_mfma_f32_16x16x32_bf16 v[152:155], v[196:199], a[196:199], v[152:155]
  v_exp_f32 v221, v65
  v_mfma_f32_16x16x32_bf16 v[120:123], v[196:199], a[192:195], v[144:147]
  ds_read_b64_tr_b16 v[206:207], v8 offset:20736
  v_add_f32 v53, v53, v218
  v_mfma_f32_16x16x32_bf16 v[120:123], v[192:195], a[172:175], v[120:123]
  v_exp_f32 v222, v66
  v_add_f32 v53, v53, v219
  v_mfma_f32_16x16x32_bf16 v[88:91], v[192:195], a[168:171], v[112:115]
  v_exp_f32 v223, v67
  v_mfma_f32_16x16x32_bf16 v[88:91], v[196:199], a[188:191], v[88:91]
  ds_read_b128 v[208:211], v6 offset:512
  v_cvt_pk_bf16_f32 v76, v220, v221
  v_mfma_f32_16x16x32_bf16 v[56:59], v[196:199], a[184:187], v[80:83]
  v_exp_f32 v224, v96
  v_add_f32 v85, v220, v221
  v_mfma_f32_16x16x32_bf16 v[56:59], v[192:195], a[164:167], v[56:59]
  v_exp_f32 v225, v97
  v_mfma_f32_16x16x32_bf16 v[24:27], v[192:195], a[160:163], v[48:51]
  s_waitcnt vmcnt(5)
  buffer_load_dwordx4 v10, s[20:23], s40 offen offset:3072 nt lds
  v_cvt_pk_bf16_f32 v77, v222, v223
  v_mfma_f32_16x16x32_bf16 v[24:27], v[196:199], a[180:183], v[24:27]
  s_waitcnt lgkmcnt(1)
  v_exp_f32 v226, v98
  v_mfma_f32_16x16x32_bf16 a[40:43], v[200:203], v[40:43], a[40:43]
  ds_read_b128 v[212:215], v6 offset:768
  v_add_f32 v85, v85, v222
  v_add_f32 v85, v85, v223
  v_mfma_f32_16x16x32_bf16 a[60:63], v[204:207], v[40:43], a[60:63]
  v_exp_f32 v227, v99
  v_mfma_f32_16x16x32_bf16 a[64:67], v[204:207], v[72:75], a[64:67]
  v_cvt_pk_bf16_f32 v108, v224, v225
  v_add_f32 v117, v224, v225
  v_mfma_f32_16x16x32_bf16 a[44:47], v[200:203], v[72:75], a[44:47]
  s_add_u32 s39, s33, s35
  v_exp_f32 v228, v128
  v_mfma_f32_16x16x32_bf16 a[48:51], v[200:203], v[104:107], a[48:51]
  s_add_u32 s35, s35, 0x2000
  v_exp_f32 v229, v129
  v_mfma_f32_16x16x32_bf16 a[68:71], v[204:207], v[104:107], a[68:71]
  ds_read_b64_tr_b16 v[184:185], v7 offset:16896
  v_cvt_pk_bf16_f32 v109, v226, v227
  v_mfma_f32_16x16x32_bf16 a[72:75], v[204:207], v[136:139], a[72:75]
  ds_read_b64_tr_b16 v[186:187], v7 offset:20992
  v_add_f32 v117, v117, v226
  v_mfma_f32_16x16x32_bf16 a[52:55], v[200:203], v[136:139], a[52:55]
  s_and_b32 s35, s35, 0x1ffff
  v_exp_f32 v230, v130
  v_mfma_f32_16x16x32_bf16 a[56:59], v[200:203], v[168:171], a[56:59]
  s_mov_b32 m0, s30
  v_add_f32 v117, v117, v227
  v_cvt_pk_bf16_f32 v140, v228, v229
  v_mfma_f32_16x16x32_bf16 a[76:79], v[204:207], v[168:171], a[76:79]
  s_waitcnt vmcnt(4)
  buffer_load_dwordx4 v9, s[20:23], s39 offen offset:0 nt lds
  s_waitcnt lgkmcnt(3)
  v_mfma_f32_16x16x32_bf16 v[152:155], v[208:211], a[216:219], v[152:155]
  ds_read_b64_tr_b16 v[188:189], v8 offset:16896
  v_add_f32 v149, v228, v229
  v_exp_f32 v231, v131
  s_waitcnt lgkmcnt(3)
  v_mfma_f32_16x16x32_bf16 v[152:155], v[212:215], a[236:239], v[152:155]
  v_exp_f32 v216, v160
  v_mfma_f32_16x16x32_bf16 v[120:123], v[212:215], a[232:235], v[120:123]
  ds_read_b64_tr_b16 v[190:191], v8 offset:20992
  v_cvt_pk_bf16_f32 v141, v230, v231
  v_mfma_f32_16x16x32_bf16 v[120:123], v[208:211], a[212:215], v[120:123]
  v_exp_f32 v217, v161
  v_mfma_f32_16x16x32_bf16 v[88:91], v[208:211], a[208:211], v[88:91]
  v_exp_f32 v218, v162
  v_add_f32 v149, v149, v230
  v_mfma_f32_16x16x32_bf16 v[88:91], v[212:215], a[228:231], v[88:91]
  ds_read_b128 v[192:195], v6 offset:4096
  v_add_f32 v149, v149, v231
  v_mfma_f32_16x16x32_bf16 v[56:59], v[212:215], a[224:227], v[56:59]
  v_exp_f32 v219, v163
  v_mfma_f32_16x16x32_bf16 v[56:59], v[208:211], a[204:207], v[56:59]
  v_cvt_pk_bf16_f32 v172, v216, v217
  v_add_f32 v181, v216, v217
  v_mfma_f32_16x16x32_bf16 v[24:27], v[208:211], a[200:203], v[24:27]
  s_waitcnt vmcnt(5)
  buffer_load_dwordx4 v10, s[20:23], s39 offen offset:1024 nt lds
  v_mfma_f32_16x16x32_bf16 v[24:27], v[212:215], a[220:223], v[24:27]
  s_waitcnt lgkmcnt(1)
  v_exp_f32 v220, v36
  v_mfma_f32_16x16x32_bf16 a[80:83], v[184:187], v[40:43], a[80:83]
  ds_read_b128 v[196:199], v6 offset:4352
  v_cvt_pk_bf16_f32 v173, v218, v219
  v_mfma_f32_16x16x32_bf16 a[100:103], v[188:191], v[40:43], a[100:103]
  v_exp_f32 v221, v37
  v_mfma_f32_16x16x32_bf16 a[104:107], v[188:191], v[72:75], a[104:107]
  v_exp_f32 v222, v38
  v_add_f32 v181, v181, v218
  v_add_f32 v181, v181, v219
  v_mfma_f32_16x16x32_bf16 a[84:87], v[184:187], v[72:75], a[84:87]
  v_exp_f32 v223, v39
  v_mfma_f32_16x16x32_bf16 a[88:91], v[184:187], v[104:107], a[88:91]
  v_cvt_pk_bf16_f32 v46, v220, v221
  v_add_f32 v53, v53, v220
  v_mfma_f32_16x16x32_bf16 a[108:111], v[188:191], v[104:107], a[108:111]
  ds_read_b64_tr_b16 v[200:201], v7 offset:17152
  v_add_f32 v53, v53, v221
  v_mfma_f32_16x16x32_bf16 a[112:115], v[188:191], v[136:139], a[112:115]
  ds_read_b64_tr_b16 v[202:203], v7 offset:21248
  v_cvt_pk_bf16_f32 v47, v222, v223
  v_mfma_f32_16x16x32_bf16 a[92:95], v[184:187], v[136:139], a[92:95]
  v_exp_f32 v224, v68
  v_mfma_f32_16x16x32_bf16 a[96:99], v[184:187], v[168:171], a[96:99]
  s_waitcnt vmcnt(4)
  buffer_load_dwordx4 v9, s[20:23], s39 offen offset:2048 nt lds
  v_exp_f32 v225, v69
  v_mfma_f32_16x16x32_bf16 a[116:119], v[188:191], v[168:171], a[116:119]
  s_waitcnt lgkmcnt(2)
  v_exp_f32 v226, v70
  v_mfma_f32_16x16x32_bf16 v[156:159], v[192:195], a[176:179], v[176:179]
  ds_read_b64_tr_b16 v[204:205], v8 offset:17152
  v_add_f32 v53, v53, v222
  v_add_f32 v53, v53, v223
  v_mfma_f32_16x16x32_bf16 v[156:159], v[196:199], a[196:199], v[156:159]
  v_exp_f32 v227, v71
  v_mfma_f32_16x16x32_bf16 v[124:127], v[196:199], a[192:195], v[144:147]
  ds_read_b64_tr_b16 v[206:207], v8 offset:21248
  v_cvt_pk_bf16_f32 v78, v224, v225
  v_mfma_f32_16x16x32_bf16 v[124:127], v[192:195], a[172:175], v[124:127]
  ds_read_b128 v[208:211], v6 offset:4608
  v_add_f32 v85, v85, v224
  v_mfma_f32_16x16x32_bf16 v[92:95], v[192:195], a[168:171], v[112:115]
  v_exp_f32 v228, v100
  v_add_f32 v85, v85, v225
  v_mfma_f32_16x16x32_bf16 v[92:95], v[196:199], a[188:191], v[92:95]
  ds_read_b128 v[212:215], v6 offset:4864
  v_cvt_pk_bf16_f32 v79, v226, v227
  v_mfma_f32_16x16x32_bf16 v[60:63], v[196:199], a[184:187], v[80:83]
  s_add_u32 s30, s29, s31
  v_exp_f32 v229, v101
  v_mfma_f32_16x16x32_bf16 v[60:63], v[192:195], a[164:167], v[60:63]
  s_add_u32 s29, s29, 53248
  v_exp_f32 v230, v102
  v_add_f32 v85, v85, v226
  v_mfma_f32_16x16x32_bf16 v[28:31], v[192:195], a[160:163], v[48:51]
  s_waitcnt vmcnt(5)
  buffer_load_dwordx4 v10, s[20:23], s39 offen offset:3072 nt lds
  v_add_f32 v85, v85, v227
  v_mfma_f32_16x16x32_bf16 v[28:31], v[196:199], a[180:183], v[28:31]
  s_waitcnt lgkmcnt(2)
  v_exp_f32 v231, v103
  v_mfma_f32_16x16x32_bf16 a[120:123], v[200:203], v[40:43], a[120:123]
  v_cvt_pk_bf16_f32 v110, v228, v229
  v_add_f32 v117, v117, v228
  v_mfma_f32_16x16x32_bf16 a[140:143], v[204:207], v[40:43], a[140:143]
  s_cmp_eq_u32 s29, 159744
  v_exp_f32 v216, v132
  v_mfma_f32_16x16x32_bf16 a[144:147], v[204:207], v[72:75], a[144:147]
  s_cselect_b32 s29, 0, s29
  v_add_f32 v117, v117, v229
  v_cvt_pk_bf16_f32 v111, v230, v231
  v_mfma_f32_16x16x32_bf16 a[124:127], v[200:203], v[72:75], a[124:127]
  v_exp_f32 v217, v133
  v_mfma_f32_16x16x32_bf16 a[128:131], v[200:203], v[104:107], a[128:131]
  s_waitcnt vmcnt(8) lgkmcnt(0)
  s_barrier
  v_add_u32 v6, s29, v1
  v_add_u32 v7, s29, v2
  v_mfma_f32_16x16x32_bf16 a[148:151], v[204:207], v[104:107], a[148:151]
  ds_read_b64_tr_b16 v[184:185], v7 offset:16384
  v_add_f32 v117, v117, v230
  v_mfma_f32_16x16x32_bf16 a[152:155], v[204:207], v[136:139], a[152:155]
  ds_read_b64_tr_b16 v[186:187], v7 offset:20480
  v_add_u32 v8, s29, v3
  v_add_f32 v117, v117, v231
  v_exp_f32 v218, v134
  v_mfma_f32_16x16x32_bf16 a[132:135], v[200:203], v[136:139], a[132:135]
  s_add_u32 m0, s30, s31
  v_exp_f32 v219, v135
  v_mfma_f32_16x16x32_bf16 a[136:139], v[200:203], v[168:171], a[136:139]
  buffer_load_dwordx4 v15, s[68:71], s94 offen offset:0 lds
  v_cvt_pk_bf16_f32 v142, v216, v217
  v_mfma_f32_16x16x32_bf16 a[156:159], v[204:207], v[168:171], a[156:159]
  v_exp_f32 v220, v164
  v_add_f32 v149, v149, v216
  v_mfma_f32_16x16x32_bf16 v[156:159], v[208:211], a[216:219], v[156:159]
  ds_read_b64_tr_b16 v[188:189], v8 offset:16384
  v_add_f32 v149, v149, v217
  v_mfma_f32_16x16x32_bf16 v[156:159], v[212:215], a[236:239], v[156:159]
  v_exp_f32 v221, v165
  v_mfma_f32_16x16x32_bf16 v[124:127], v[212:215], a[232:235], v[124:127]
  ds_read_b64_tr_b16 v[190:191], v8 offset:20480
  v_cvt_pk_bf16_f32 v143, v218, v219
  v_mfma_f32_16x16x32_bf16 v[124:127], v[208:211], a[212:215], v[124:127]
  buffer_load_dwordx4 v16, s[68:71], s94 offen offset:1024 lds
  v_add_f32 v149, v149, v218
  v_mfma_f32_16x16x32_bf16 v[92:95], v[208:211], a[208:211], v[92:95]
  v_exp_f32 v222, v166
  v_add_f32 v149, v149, v219
  v_mfma_f32_16x16x32_bf16 v[92:95], v[212:215], a[228:231], v[92:95]
  ds_read_b128 v[192:195], v6 offset:0
  v_cvt_pk_bf16_f32 v174, v220, v221
  v_mfma_f32_16x16x32_bf16 v[60:63], v[212:215], a[224:227], v[60:63]
  v_exp_f32 v223, v167
  v_mfma_f32_16x16x32_bf16 v[60:63], v[208:211], a[204:207], v[60:63]
  v_add_f32 v181, v181, v220
  v_add_f32 v181, v181, v221
  v_mfma_f32_16x16x32_bf16 v[28:31], v[208:211], a[200:203], v[28:31]
  v_cvt_pk_bf16_f32 v175, v222, v223
  v_add_f32 v181, v181, v222
  v_mfma_f32_16x16x32_bf16 v[28:31], v[212:215], a[220:223], v[28:31]
  s_waitcnt lgkmcnt(1)
  v_add_f32 v181, v181, v223
  v_max3_f32 v248, v53, v85, v117
  v_max3_f32 v248, v248, v149, v181
  v_cmp_nge_f32 vcc, s42, v248
  s_nop 0
  s_cbranch_vccnz RARE1_13
RET_13:
  v_mfma_f32_16x16x32_bf16 a[0:3], v[184:187], v[44:47], a[0:3]
  ds_read_b128 v[196:199], v6 offset:256
  v_add_f32 v52, v52, v53
  v_mfma_f32_16x16x32_bf16 a[20:23], v[188:191], v[44:47], a[20:23]
  v_exp_f32 v216, v24
  v_mfma_f32_16x16x32_bf16 a[24:27], v[188:191], v[76:79], a[24:27]
  v_add_f32 v84, v84, v85
  v_add_f32 v116, v116, v117
  v_mfma_f32_16x16x32_bf16 a[4:7], v[184:187], v[76:79], a[4:7]
  buffer_load_dwordx4 v17, s[68:71], s94 offen offset:2048 lds
  v_add_f32 v148, v148, v149
  v_mfma_f32_16x16x32_bf16 a[8:11], v[184:187], v[108:111], a[8:11]
  v_exp_f32 v217, v25
  v_add_f32 v180, v180, v181
  v_mfma_f32_16x16x32_bf16 a[28:31], v[188:191], v[108:111], a[28:31]
  ds_read_b64_tr_b16 v[200:201], v7 offset:16640
  v_cvt_pk_bf16_f32 v40, v216, v217
  v_mfma_f32_16x16x32_bf16 a[32:35], v[188:191], v[140:143], a[32:35]
  ds_read_b64_tr_b16 v[202:203], v7 offset:20736
  v_add_f32 v53, v216, v217
  v_exp_f32 v218, v26
  v_mfma_f32_16x16x32_bf16 a[12:15], v[184:187], v[140:143], a[12:15]
  v_exp_f32 v219, v27
  v_mfma_f32_16x16x32_bf16 a[16:19], v[184:187], v[172:175], a[16:19]
  buffer_load_dwordx4 v18, s[68:71], s94 offen offset:3072 lds
  v_mfma_f32_16x16x32_bf16 a[36:39], v[188:191], v[172:175], a[36:39]
  s_waitcnt lgkmcnt(2)
  v_exp_f32 v220, v56
  v_mfma_f32_16x16x32_bf16 v[160:163], v[192:195], a[176:179], v[176:179]
  ds_read_b64_tr_b16 v[204:205], v8 offset:16640
  v_cvt_pk_bf16_f32 v41, v218, v219
  v_mfma_f32_16x16x32_bf16 v[160:163], v[196:199], a[196:199], v[160:163]
  v_exp_f32 v221, v57
  v_mfma_f32_16x16x32_bf16 v[128:131], v[196:199], a[192:195], v[144:147]
  ds_read_b64_tr_b16 v[206:207], v8 offset:20736
  v_add_f32 v53, v53, v218
  v_mfma_f32_16x16x32_bf16 v[128:131], v[192:195], a[172:175], v[128:131]
  s_add_u32 m0, m0, 0x1000
  v_exp_f32 v222, v58
  v_add_f32 v53, v53, v219
  v_mfma_f32_16x16x32_bf16 v[96:99], v[192:195], a[168:171], v[112:115]
  s_add_u32 s39, s94, 0x8000
  v_exp_f32 v223, v59
  v_mfma_f32_16x16x32_bf16 v[96:99], v[196:199], a[188:191], v[96:99]
  ds_read_b128 v[208:211], v6 offset:512
  v_cvt_pk_bf16_f32 v72, v220, v221
  v_mfma_f32_16x16x32_bf16 v[64:67], v[196:199], a[184:187], v[80:83]
  v_exp_f32 v224, v88
  v_add_f32 v85, v220, v221
  v_mfma_f32_16x16x32_bf16 v[64:67], v[192:195], a[164:167], v[64:67]
  v_exp_f32 v225, v89
  v_mfma_f32_16x16x32_bf16 v[32:35], v[192:195], a[160:163], v[48:51]
  buffer_load_dwordx4 v15, s[68:71], s39 offen offset:0 lds
  v_cvt_pk_bf16_f32 v73, v222, v223
  v_mfma_f32_16x16x32_bf16 v[32:35], v[196:199], a[180:183], v[32:35]
  s_waitcnt lgkmcnt(1)
  v_exp_f32 v226, v90
  v_mfma_f32_16x16x32_bf16 a[40:43], v[200:203], v[44:47], a[40:43]
  ds_read_b128 v[212:215], v6 offset:768
  v_add_f32 v85, v85, v222
  v_add_f32 v85, v85, v223
  v_mfma_f32_16x16x32_bf16 a[60:63], v[204:207], v[44:47], a[60:63]
  v_exp_f32 v227, v91
  v_mfma_f32_16x16x32_bf16 a[64:67], v[204:207], v[76:79], a[64:67]
  v_cvt_pk_bf16_f32 v104, v224, v225
  v_add_f32 v117, v224, v225
  v_mfma_f32_16x16x32_bf16 a[44:47], v[200:203], v[76:79], a[44:47]
  v_exp_f32 v228, v120
  v_mfma_f32_16x16x32_bf16 a[48:51], v[200:203], v[108:111], a[48:51]
  v_exp_f32 v229, v121
  v_mfma_f32_16x16x32_bf16 a[68:71], v[204:207], v[108:111], a[68:71]
  ds_read_b64_tr_b16 v[184:185], v7 offset:16896
  v_cvt_pk_bf16_f32 v105, v226, v227
  v_mfma_f32_16x16x32_bf16 a[72:75], v[204:207], v[140:143], a[72:75]
  ds_read_b64_tr_b16 v[186:187], v7 offset:20992
  v_add_f32 v117, v117, v226
  v_mfma_f32_16x16x32_bf16 a[52:55], v[200:203], v[140:143], a[52:55]
  v_exp_f32 v230, v122
  v_mfma_f32_16x16x32_bf16 a[56:59], v[200:203], v[172:175], a[56:59]
  buffer_load_dwordx4 v16, s[68:71], s39 offen offset:1024 lds
  v_add_f32 v117, v117, v227
  v_mfma_f32_16x16x32_bf16 a[76:79], v[204:207], v[172:175], a[76:79]
  buffer_load_dword v232, off, s[84:87], s99 sc1
  v_cvt_pk_bf16_f32 v136, v228, v229
  s_waitcnt lgkmcnt(3)
  v_mfma_f32_16x16x32_bf16 v[160:163], v[208:211], a[216:219], v[160:163]
  ds_read_b64_tr_b16 v[188:189], v8 offset:16896
  v_add_f32 v149, v228, v229
  v_exp_f32 v231, v123
  s_waitcnt lgkmcnt(3)
  v_mfma_f32_16x16x32_bf16 v[160:163], v[212:215], a[236:239], v[160:163]
  v_exp_f32 v216, v152
  v_mfma_f32_16x16x32_bf16 v[128:131], v[212:215], a[232:235], v[128:131]
  ds_read_b64_tr_b16 v[190:191], v8 offset:20992
  v_cvt_pk_bf16_f32 v137, v230, v231
  v_mfma_f32_16x16x32_bf16 v[128:131], v[208:211], a[212:215], v[128:131]
  buffer_load_dwordx4 v17, s[68:71], s39 offen offset:2048 lds
  v_exp_f32 v217, v153
  v_mfma_f32_16x16x32_bf16 v[96:99], v[208:211], a[208:211], v[96:99]
  v_exp_f32 v218, v154
  v_add_f32 v149, v149, v230
  v_mfma_f32_16x16x32_bf16 v[96:99], v[212:215], a[228:231], v[96:99]
  ds_read_b128 v[192:195], v6 offset:4096
  v_add_f32 v149, v149, v231
  v_mfma_f32_16x16x32_bf16 v[64:67], v[212:215], a[224:227], v[64:67]
  v_exp_f32 v219, v155
  v_mfma_f32_16x16x32_bf16 v[64:67], v[208:211], a[204:207], v[64:67]
  v_cvt_pk_bf16_f32 v168, v216, v217
  v_add_f32 v181, v216, v217
  v_mfma_f32_16x16x32_bf16 v[32:35], v[208:211], a[200:203], v[32:35]
  v_exp_f32 v220, v28
  v_mfma_f32_16x16x32_bf16 v[32:35], v[212:215], a[220:223], v[32:35]
  s_waitcnt lgkmcnt(1)
  v_exp_f32 v221, v29
  v_mfma_f32_16x16x32_bf16 a[80:83], v[184:187], v[44:47], a[80:83]
  ds_read_b128 v[196:199], v6 offset:4352
  v_cvt_pk_bf16_f32 v169, v218, v219
  v_mfma_f32_16x16x32_bf16 a[100:103], v[188:191], v[44:47], a[100:103]
  v_exp_f32 v222, v30
  v_mfma_f32_16x16x32_bf16 a[104:107], v[188:191], v[76:79], a[104:107]
  s_add_u32 s94, s94, s95
  v_add_f32 v181, v181, v218
  v_add_f32 v181, v181, v219
  v_mfma_f32_16x16x32_bf16 a[84:87], v[184:187], v[76:79], a[84:87]
  buffer_load_dwordx4 v18, s[68:71], s39 offen offset:3072 lds
  v_mfma_f32_16x16x32_bf16 a[88:91], v[184:187], v[108:111], a[88:91]
  v_exp_f32 v223, v31
  v_cvt_pk_bf16_f32 v42, v220, v221
  v_mfma_f32_16x16x32_bf16 a[108:111], v[188:191], v[108:111], a[108:111]
  ds_read_b64_tr_b16 v[200:201], v7 offset:17152
  v_add_f32 v53, v53, v220
  v_mfma_f32_16x16x32_bf16 a[112:115], v[188:191], v[140:143], a[112:115]
  ds_read_b64_tr_b16 v[202:203], v7 offset:21248
  v_add_f32 v53, v53, v221
  v_mfma_f32_16x16x32_bf16 a[92:95], v[184:187], v[140:143], a[92:95]
  v_exp_f32 v224, v60
  v_mfma_f32_16x16x32_bf16 a[96:99], v[184:187], v[172:175], a[96:99]
  v_exp_f32 v225, v61
  v_cvt_pk_bf16_f32 v43, v222, v223
  v_mfma_f32_16x16x32_bf16 a[116:119], v[188:191], v[172:175], a[116:119]
  s_waitcnt lgkmcnt(2)
  v_exp_f32 v226, v62
  v_mfma_f32_16x16x32_bf16 v[164:167], v[192:195], a[176:179], v[176:179]
  ds_read_b64_tr_b16 v[204:205], v8 offset:17152
  v_add_f32 v53, v53, v222
  v_add_f32 v53, v53, v223
  v_mfma_f32_16x16x32_bf16 v[164:167], v[196:199], a[196:199], v[164:167]
  v_exp_f32 v227, v63
  v_mfma_f32_16x16x32_bf16 v[132:135], v[196:199], a[192:195], v[144:147]
  ds_read_b64_tr_b16 v[206:207], v8 offset:21248
  v_cvt_pk_bf16_f32 v74, v224, v225
  v_mfma_f32_16x16x32_bf16 v[132:135], v[192:195], a[172:175], v[132:135]
  ds_read_b128 v[208:211], v6 offset:4608
  v_add_f32 v85, v85, v224
  v_mfma_f32_16x16x32_bf16 v[100:103], v[192:195], a[168:171], v[112:115]
  v_exp_f32 v228, v92
  v_add_f32 v85, v85, v225
  v_mfma_f32_16x16x32_bf16 v[100:103], v[196:199], a[188:191], v[100:103]
  ds_read_b128 v[212:215], v6 offset:4864
  v_cvt_pk_bf16_f32 v75, v226, v227
  v_mfma_f32_16x16x32_bf16 v[68:71], v[196:199], a[184:187], v[80:83]
  s_add_u32 s30, s29, s31
  v_exp_f32 v229, v93
  v_mfma_f32_16x16x32_bf16 v[68:71], v[192:195], a[164:167], v[68:71]
  s_add_u32 s29, s29, 53248
  v_exp_f32 v230, v94
  v_add_f32 v85, v85, v226
  v_mfma_f32_16x16x32_bf16 v[36:39], v[192:195], a[160:163], v[48:51]
  s_cmp_eq_u32 s29, 159744
  v_add_f32 v85, v85, v227
  v_cvt_pk_bf16_f32 v106, v228, v229
  v_mfma_f32_16x16x32_bf16 v[36:39], v[196:199], a[180:183], v[36:39]
  s_waitcnt lgkmcnt(2)
  v_exp_f32 v231, v95
  v_mfma_f32_16x16x32_bf16 a[120:123], v[200:203], v[44:47], a[120:123]
  v_exp_f32 v216, v124
  v_mfma_f32_16x16x32_bf16 a[140:143], v[204:207], v[44:47], a[140:143]
  s_cselect_b32 s29, 0, s29
  v_add_f32 v117, v117, v228
  v_add_f32 v117, v117, v229
  v_mfma_f32_16x16x32_bf16 a[144:147], v[204:207], v[76:79], a[144:147]
  v_exp_f32 v217, v125
  v_mfma_f32_16x16x32_bf16 a[124:127], v[200:203], v[76:79], a[124:127]
  v_cvt_pk_bf16_f32 v107, v230, v231
  v_add_u32 v6, s29, v1
  v_mfma_f32_16x16x32_bf16 a[128:131], v[200:203], v[108:111], a[128:131]
  s_waitcnt vmcnt(9) lgkmcnt(0)
  s_barrier
  v_exp_f32 v218, v126
  v_mfma_f32_16x16x32_bf16 a[148:151], v[204:207], v[108:111], a[148:151]
  s_add_u32 m0, s30, s31
  v_add_u32 v7, s29, v2
  v_add_f32 v117, v117, v230
  v_mfma_f32_16x16x32_bf16 a[152:155], v[204:207], v[140:143], a[152:155]
  ds_read_b64_tr_b16 v[184:185], v7 offset:16384
  v_add_u32 v8, s29, v3
  v_add_f32 v117, v117, v231
  v_mfma_f32_16x16x32_bf16 a[132:135], v[200:203], v[140:143], a[132:135]
  ds_read_b64_tr_b16 v[186:187], v7 offset:20480
  v_cvt_pk_bf16_f32 v138, v216, v217
  v_mfma_f32_16x16x32_bf16 a[136:139], v[200:203], v[172:175], a[136:139]
  buffer_load_dwordx4 v15, s[68:71], s94 offen offset:0 lds
  v_exp_f32 v219, v127
  v_mfma_f32_16x16x32_bf16 a[156:159], v[204:207], v[172:175], a[156:159]
  v_exp_f32 v220, v156
  v_add_f32 v149, v149, v216
  v_mfma_f32_16x16x32_bf16 v[164:167], v[208:211], a[216:219], v[164:167]
  ds_read_b64_tr_b16 v[188:189], v8 offset:16384
  v_add_f32 v149, v149, v217
  v_mfma_f32_16x16x32_bf16 v[164:167], v[212:215], a[236:239], v[164:167]
  v_exp_f32 v221, v157
  v_mfma_f32_16x16x32_bf16 v[132:135], v[212:215], a[232:235], v[132:135]
  ds_read_b64_tr_b16 v[190:191], v8 offset:20480
  v_cvt_pk_bf16_f32 v139, v218, v219
  v_mfma_f32_16x16x32_bf16 v[132:135], v[208:211], a[212:215], v[132:135]
  buffer_load_dwordx4 v16, s[68:71], s94 offen offset:1024 lds
  v_add_f32 v149, v149, v218
  v_mfma_f32_16x16x32_bf16 v[100:103], v[208:211], a[208:211], v[100:103]
  v_exp_f32 v222, v158
  v_add_f32 v149, v149, v219
  v_mfma_f32_16x16x32_bf16 v[100:103], v[212:215], a[228:231], v[100:103]
  ds_read_b64_tr_b16 v[192:193], v7 offset:16640
  v_cvt_pk_bf16_f32 v170, v220, v221
  v_mfma_f32_16x16x32_bf16 v[68:71], v[212:215], a[224:227], v[68:71]
  ds_read_b64_tr_b16 v[194:195], v7 offset:20736
  v_add_f32 v181, v181, v220
  v_exp_f32 v223, v159
  v_mfma_f32_16x16x32_bf16 v[68:71], v[208:211], a[204:207], v[68:71]
  v_add_f32 v181, v181, v221
  v_cvt_pk_bf16_f32 v171, v222, v223
  v_mfma_f32_16x16x32_bf16 v[36:39], v[208:211], a[200:203], v[36:39]
  v_add_f32 v181, v181, v222
  v_add_f32 v181, v181, v223
  v_mfma_f32_16x16x32_bf16 v[36:39], v[212:215], a[220:223], v[36:39]
  s_waitcnt lgkmcnt(4)
  v_max3_f32 v248, v53, v85, v117
  v_max3_f32 v248, v248, v149, v181
  v_cmp_nge_f32 vcc, s42, v248
  s_nop 0
  s_cbranch_vccnz RARE0_14
RET_14:
  v_mfma_f32_16x16x32_bf16 a[0:3], v[184:187], v[40:43], a[0:3]
  ds_read_b64_tr_b16 v[196:197], v8 offset:16640
  v_add_f32 v52, v52, v53
  v_mfma_f32_16x16x32_bf16 a[4:7], v[184:187], v[72:75], a[4:7]
  ds_read_b64_tr_b16 v[198:199], v8 offset:20736
  v_add_f32 v84, v84, v85
  v_mfma_f32_16x16x32_bf16 a[8:11], v[184:187], v[104:107], a[8:11]
  ds_read_b128 a[160:163], v236 offset:0
  v_add_f32 v116, v116, v117
  v_mfma_f32_16x16x32_bf16 a[12:15], v[184:187], v[136:139], a[12:15]
  buffer_load_dwordx4 v17, s[68:71], s94 offen offset:2048 lds
  v_add_f32 v148, v148, v149
  v_mfma_f32_16x16x32_bf16 a[16:19], v[184:187], v[168:171], a[16:19]
  ds_read_b128 a[164:167], v236 offset:1024
  v_add_f32 v180, v180, v181
  v_exp_f32 v216, v32
  s_waitcnt lgkmcnt(6)
  v_mfma_f32_16x16x32_bf16 a[20:23], v[188:191], v[40:43], a[20:23]
  ds_read_b64_tr_b16 v[200:201], v7 offset:16896
  v_exp_f32 v217, v33
  v_exp_f32 v218, v34
  v_mfma_f32_16x16x32_bf16 a[24:27], v[188:191], v[72:75], a[24:27]
  ds_read_b64_tr_b16 v[202:203], v7 offset:20992
  v_cvt_pk_bf16_f32 v44, v216, v217
  v_exp_f32 v219, v35
  v_add_f32 v53, v216, v217
  v_mfma_f32_16x16x32_bf16 a[28:31], v[188:191], v[104:107], a[28:31]
  ds_read_b128 a[168:171], v236 offset:2048
  v_cvt_pk_bf16_f32 v45, v218, v219
  v_exp_f32 v220, v64
  v_mfma_f32_16x16x32_bf16 a[32:35], v[188:191], v[136:139], a[32:35]
  buffer_load_dwordx4 v18, s[68:71], s94 offen offset:3072 lds
  v_exp_f32 v221, v65
  v_add_f32 v53, v53, v218
  v_add_f32 v53, v53, v219
  v_mfma_f32_16x16x32_bf16 a[36:39], v[188:191], v[168:171], a[36:39]
  ds_read_b128 a[172:175], v236 offset:3072
  v_cvt_pk_bf16_f32 v76, v220, v221
  v_exp_f32 v222, v66
  v_exp_f32 v223, v67
  s_waitcnt lgkmcnt(8)
  v_mfma_f32_16x16x32_bf16 a[40:43], v[192:195], v[40:43], a[40:43]
  ds_read_b64_tr_b16 v[204:205], v8 offset:16896
  v_add_f32 v85, v220, v221
  v_exp_f32 v224, v96
  v_mfma_f32_16x16x32_bf16 a[44:47], v[192:195], v[72:75], a[44:47]
  v_exp_f32 v225, v97
  v_cvt_pk_bf16_f32 v77, v222, v223
  v_mfma_f32_16x16x32_bf16 a[48:51], v[192:195], v[104:107], a[48:51]
  ds_read_b64_tr_b16 v[206:207], v8 offset:20992
  v_add_f32 v85, v85, v222
  v_add_f32 v85, v85, v223
  v_exp_f32 v226, v98
  v_mfma_f32_16x16x32_bf16 a[52:55], v[192:195], v[136:139], a[52:55]
  ds_read_b128 a[176:179], v236 offset:4096
  v_cvt_pk_bf16_f32 v108, v224, v225
  v_exp_f32 v227, v99
  v_mfma_f32_16x16x32_bf16 a[56:59], v[192:195], v[168:171], a[56:59]
  ds_read_b128 a[180:183], v236 offset:53248
  v_add_f32 v117, v224, v225
  v_exp_f32 v228, v128
  v_cvt_pk_bf16_f32 v109, v226, v227
  s_waitcnt lgkmcnt(10)
  v_mfma_f32_16x16x32_bf16 a[60:63], v[196:199], v[40:43], a[60:63]
  ds_read_b64_tr_b16 v[208:209], v7 offset:17152
  v_add_f32 v117, v117, v226
  v_exp_f32 v229, v129
  v_mfma_f32_16x16x32_bf16 a[64:67], v[196:199], v[72:75], a[64:67]
  v_exp_f32 v230, v130
  v_add_f32 v117, v117, v227
  v_cvt_pk_bf16_f32 v140, v228, v229
  v_mfma_f32_16x16x32_bf16 a[68:71], v[196:199], v[104:107], a[68:71]
  s_add_u32 m0, m0, 0x1000
  v_exp_f32 v231, v131
  v_add_f32 v149, v228, v229
  v_exp_f32 v216, v160
  v_mfma_f32_16x16x32_bf16 a[72:75], v[196:199], v[136:139], a[72:75]
  s_add_u32 s39, s94, 0x8000
  v_exp_f32 v217, v161
  v_cvt_pk_bf16_f32 v141, v230, v231
  ds_read_b64_tr_b16 v[210:211], v7 offset:21248
  v_mfma_f32_16x16x32_bf16 a[76:79], v[196:199], v[168:171], a[76:79]
  ds_read_b128 a[184:187], v236 offset:54272
  v_add_f32 v149, v149, v230
  v_add_f32 v149, v149, v231
  v_exp_f32 v218, v162
  s_waitcnt lgkmcnt(9)
  v_mfma_f32_16x16x32_bf16 a[80:83], v[200:203], v[40:43], a[80:83]
  buffer_load_dwordx4 v15, s[68:71], s39 offen offset:0 lds
  v_cvt_pk_bf16_f32 v172, v216, v217
  v_exp_f32 v219, v163
  ds_read_b128 a[188:191], v236 offset:55296
  v_mfma_f32_16x16x32_bf16 a[84:87], v[200:203], v[72:75], a[84:87]
  v_exp_f32 v220, v36
  v_add_f32 v181, v216, v217
  v_mfma_f32_16x16x32_bf16 a[88:91], v[200:203], v[104:107], a[88:91]
  ds_read_b64_tr_b16 v[212:213], v8 offset:17152
  v_cvt_pk_bf16_f32 v173, v218, v219
  v_exp_f32 v221, v37
  v_add_f32 v181, v181, v218
  v_mfma_f32_16x16x32_bf16 a[92:95], v[200:203], v[136:139], a[92:95]
  ds_read_b64_tr_b16 v[214:215], v8 offset:21248
  v_add_f32 v181, v181, v219
  v_exp_f32 v222, v38
  v_cvt_pk_bf16_f32 v46, v220, v221
  v_mfma_f32_16x16x32_bf16 a[96:99], v[200:203], v[168:171], a[96:99]
  ds_read_b128 a[192:195], v236 offset:56320
  v_add_f32 v53, v53, v220
  v_exp_f32 v223, v39
  s_waitcnt lgkmcnt(9)
  v_mfma_f32_16x16x32_bf16 a[100:103], v[204:207], v[40:43], a[100:103]
  ds_read_b128 a[196:199], v236 offset:57344
  v_add_f32 v53, v53, v221
  v_exp_f32 v224, v68
  v_cvt_pk_bf16_f32 v47, v222, v223
  v_mfma_f32_16x16x32_bf16 a[104:107], v[204:207], v[72:75], a[104:107]
  v_exp_f32 v225, v69
  v_add_f32 v53, v53, v222
  v_add_f32 v53, v53, v223
  v_mfma_f32_16x16x32_bf16 a[108:111], v[204:207], v[104:107], a[108:111]
  ds_read_b64_tr_b16 v[184:185], v7 offset:0
  v_cvt_pk_bf16_f32 v78, v224, v225
  v_exp_f32 v226, v70
  v_mfma_f32_16x16x32_bf16 a[112:115], v[204:207], v[136:139], a[112:115]
  ds_read_b64_tr_b16 v[186:187], v7 offset:4096
  v_add_f32 v85, v85, v224
  v_exp_f32 v227, v71
  v_add_f32 v85, v85, v225
  v_mfma_f32_16x16x32_bf16 a[116:119], v[204:207], v[168:171], a[116:119]
  ds_read_b128 a[200:203], v237 offset:0
  v_cvt_pk_bf16_f32 v79, v226, v227
  v_exp_f32 v228, v100
  v_exp_f32 v229, v101
  s_waitcnt lgkmcnt(9)
  v_mfma_f32_16x16x32_bf16 a[120:123], v[208:211], v[40:43], a[120:123]
  buffer_load_dwordx4 v16, s[68:71], s39 offen offset:1024 lds
  v_add_f32 v85, v85, v226
  v_add_f32 v85, v85, v227
  ds_read_b128 a[204:207], v237 offset:1024
  v_mfma_f32_16x16x32_bf16 a[124:127], v[208:211], v[72:75], a[124:127]
  v_exp_f32 v230, v102
  v_cvt_pk_bf16_f32 v110, v228, v229
  v_exp_f32 v231, v103
  v_mfma_f32_16x16x32_bf16 a[128:131], v[208:211], v[104:107], a[128:131]
  ds_read_b64_tr_b16 v[188:189], v8 offset:0
  v_add_f32 v117, v117, v228
  v_add_f32 v117, v117, v229
  v_mfma_f32_16x16x32_bf16 a[132:135], v[208:211], v[136:139], a[132:135]
  ds_read_b64_tr_b16 v[190:191], v8 offset:4096
  v_cvt_pk_bf16_f32 v111, v230, v231
  v_exp_f32 v216, v132
  v_exp_f32 v217, v133
  v_mfma_f32_16x16x32_bf16 a[136:139], v[208:211], v[168:171], a[136:139]
  ds_read_b128 a[208:211], v237 offset:2048
  v_add_f32 v117, v117, v230
  v_add_f32 v117, v117, v231
  v_exp_f32 v218, v134
  s_waitcnt lgkmcnt(9)
  v_mfma_f32_16x16x32_bf16 a[140:143], v[212:215], v[40:43], a[140:143]
  buffer_load_dwordx4 v17, s[68:71], s39 offen offset:2048 lds
  v_cvt_pk_bf16_f32 v142, v216, v217
  v_exp_f32 v219, v135
  ds_read_b128 a[212:215], v237 offset:3072
  v_mfma_f32_16x16x32_bf16 a[144:147], v[212:215], v[72:75], a[144:147]
  v_exp_f32 v220, v164
  v_add_f32 v149, v149, v216
  v_add_f32 v149, v149, v217
  v_mfma_f32_16x16x32_bf16 a[148:151], v[212:215], v[104:107], a[148:151]
  ds_read_b64_tr_b16 v[192:193], v7 offset:256
  v_cvt_pk_bf16_f32 v143, v218, v219
  v_exp_f32 v221, v165
  v_mfma_f32_16x16x32_bf16 a[152:155], v[212:215], v[136:139], a[152:155]
  ds_read_b64_tr_b16 v[194:195], v7 offset:4352
  v_add_f32 v149, v149, v218
  v_add_f32 v149, v149, v219
  v_exp_f32 v222, v166
  v_mfma_f32_16x16x32_bf16 a[156:159], v[212:215], v[168:171], a[156:159]
  ds_read_b128 a[216:219], v237 offset:4096
  v_cvt_pk_bf16_f32 v174, v220, v221
  v_exp_f32 v223, v167
  v_add_f32 v181, v181, v220
  v_add_f32 v181, v181, v221
  v_cvt_pk_bf16_f32 v175, v222, v223
  v_add_f32 v181, v181, v222
  v_add_f32 v181, v181, v223
  v_max3_f32 v248, v53, v85, v117
  v_max3_f32 v248, v248, v149, v181
  v_cmp_nge_f32 vcc, s42, v248
  s_nop 0
  s_cbranch_vccnz RARE1_15
RET_15:
  s_waitcnt lgkmcnt(9)
  v_mfma_f32_16x16x32_bf16 a[0:3], v[184:187], v[44:47], a[0:3]
  ds_read_b64_tr_b16 v[196:197], v8 offset:256
  v_add_f32 v52, v52, v53
  v_mfma_f32_16x16x32_bf16 a[4:7], v[184:187], v[76:79], a[4:7]
  v_add_f32 v84, v84, v85
  v_add_f32 v116, v116, v117
  v_mfma_f32_16x16x32_bf16 a[8:11], v[184:187], v[108:111], a[8:11]
  ds_read_b64_tr_b16 v[198:199], v8 offset:4352
  v_add_f32 v148, v148, v149
  v_mfma_f32_16x16x32_bf16 a[12:15], v[184:187], v[140:143], a[12:15]
  ds_read_b128 v[48:51], v239 offset:0
  v_add_f32 v180, v180, v181
  v_mfma_f32_16x16x32_bf16 a[16:19], v[184:187], v[172:175], a[16:19]
  buffer_load_dwordx4 v18, s[68:71], s39 offen offset:3072 lds
  v_mov_b32 v53, v52
  s_waitcnt lgkmcnt(8)
  v_mfma_f32_16x16x32_bf16 a[20:23], v[188:191], v[44:47], a[20:23]
  ds_read_b128 v[80:83], v239 offset:1024
  v_mov_b32 v85, v84
  v_mov_b32 v117, v116
  v_mfma_f32_16x16x32_bf16 a[24:27], v[188:191], v[76:79], a[24:27]
  s_sub_u32 s94, s94, s95
  v_mov_b32 v149, v148
  v_mov_b32 v181, v180
  s_add_u32 s94, s94, 0x100000
  ds_read_b128 v[112:115], v239 offset:2048
  v_mfma_f32_16x16x32_bf16 a[28:31], v[188:191], v[108:111], a[28:31]
  ds_read_b64_tr_b16 v[200:201], v7 offset:512
  v_permlane16_swap_b32 v52, v53
  v_permlane16_swap_b32 v84, v85
  v_mfma_f32_16x16x32_bf16 a[32:35], v[188:191], v[140:143], a[32:35]
  ds_read_b64_tr_b16 v[202:203], v7 offset:4608
  v_permlane16_swap_b32 v116, v117
  v_permlane16_swap_b32 v148, v149
  v_mfma_f32_16x16x32_bf16 a[36:39], v[188:191], v[172:175], a[36:39]
  ds_read_b128 v[144:147], v239 offset:3072
  v_permlane16_swap_b32 v180, v181
  v_add_f32 v52, v52, v53
  s_waitcnt lgkmcnt(9)
  v_mfma_f32_16x16x32_bf16 a[40:43], v[192:195], v[44:47], a[40:43]
  ds_read_b128 v[176:179], v239 offset:4096
  v_add_f32 v84, v84, v85
  v_add_f32 v116, v116, v117
  v_mfma_f32_16x16x32_bf16 a[44:47], v[192:195], v[76:79], a[44:47]
  v_add_f32 v148, v148, v149
  v_add_f32 v180, v180, v181
  ds_read_b128 v[40:43], v238 offset:0
  v_mfma_f32_16x16x32_bf16 a[48:51], v[192:195], v[108:111], a[48:51]
  ds_read_b64_tr_b16 v[204:205], v8 offset:512
  v_mov_b32 v53, v52
  v_mov_b32 v85, v84
  v_mfma_f32_16x16x32_bf16 a[52:55], v[192:195], v[140:143], a[52:55]
  ds_read_b64_tr_b16 v[206:207], v8 offset:4608
  v_mov_b32 v117, v116
  v_mov_b32 v149, v148
  v_mov_b32 v181, v180
  v_mfma_f32_16x16x32_bf16 a[56:59], v[192:195], v[172:175], a[56:59]
  ds_read_b64_tr_b16 v[208:209], v7 offset:768
  v_permlane32_swap_b32 v52, v53
  v_permlane32_swap_b32 v84, v85
  ds_read_b128 v[72:75], v238 offset:1024
  s_waitcnt lgkmcnt(12)
  v_mfma_f32_16x16x32_bf16 a[60:63], v[196:199], v[44:47], a[60:63]
  ds_read_b64_tr_b16 v[210:211], v7 offset:4864
  v_permlane32_swap_b32 v116, v117
  v_permlane32_swap_b32 v148, v149
  ds_read_b128 v[104:107], v238 offset:2048
  v_mfma_f32_16x16x32_bf16 a[64:67], v[196:199], v[76:79], a[64:67]
  v_permlane32_swap_b32 v180, v181
  v_add_f32 v52, v52, v53
  ds_read_b128 v[136:139], v238 offset:3072
  v_mfma_f32_16x16x32_bf16 a[68:71], v[196:199], v[108:111], a[68:71]
  ds_read_b64_tr_b16 v[212:213], v8 offset:768
  v_add_f32 v84, v84, v85
  v_add_f32 v116, v116, v117
  v_mfma_f32_16x16x32_bf16 a[72:75], v[196:199], v[140:143], a[72:75]
  ds_read_b64_tr_b16 v[214:215], v8 offset:4864
  v_add_f32 v148, v148, v149
  v_add_f32 v180, v180, v181
  v_mfma_f32_16x16x32_bf16 a[76:79], v[196:199], v[172:175], a[76:79]
  ds_read_b128 v[168:171], v238 offset:4096
  v_accvgpr_read_b32 v248, a0
  v_rcp_f32 v20, v52
  s_waitcnt lgkmcnt(13)
  v_mfma_f32_16x16x32_bf16 a[80:83], v[200:203], v[44:47], a[80:83]
  v_rcp_f32 v21, v84
  v_mfma_f32_16x16x32_bf16 a[84:87], v[200:203], v[76:79], a[84:87]
  s_add_u32 s30, s29, s31
  v_rcp_f32 v22, v116
  v_mfma_f32_16x16x32_bf16 a[88:91], v[200:203], v[108:111], a[88:91]
  s_add_u32 s29, s29, 53248
  v_rcp_f32 v23, v148
  v_mfma_f32_16x16x32_bf16 a[92:95], v[200:203], v[140:143], a[92:95]
  s_cmp_eq_u32 s29, 159744
  v_rcp_f32 v0, v180
  s_cselect_b32 s29, 0, s29
  v_mfma_f32_16x16x32_bf16 a[96:99], v[200:203], v[172:175], a[96:99]
  s_waitcnt lgkmcnt(8)
  v_accvgpr_read_b32 v249, a1
  v_accvgpr_read_b32 v250, a2
  v_mfma_f32_16x16x32_bf16 a[100:103], v[204:207], v[44:47], a[100:103]
  s_waitcnt vmcnt(8) lgkmcnt(0)
  s_barrier
  v_add_u32 v6, s29, v244
  v_accvgpr_read_b32 v251, a3
  v_mfma_f32_16x16x32_bf16 a[104:107], v[204:207], v[76:79], a[104:107]
  ds_read_b64_tr_b16 v[184:185], v6 offset:0
  v_accvgpr_read_b32 v252, a20
  v_mfma_f32_16x16x32_bf16 a[108:111], v[204:207], v[108:111], a[108:111]
  s_add_u32 m0, s30, s31
  v_accvgpr_read_b32 v253, a21
  v_accvgpr_read_b32 v254, a22
  v_mfma_f32_16x16x32_bf16 a[112:115], v[204:207], v[140:143], a[112:115]
  ds_read_b64_tr_b16 v[186:187], v6 offset:2048
  v_accvgpr_read_b32 v255, a23
  v_mul_f32 v248, v20, v248
  v_mul_f32 v249, v20, v249
  v_mfma_f32_16x16x32_bf16 a[116:119], v[204:207], v[172:175], a[116:119]
  buffer_load_dwordx4 v15, s[68:71], s94 offen offset:0 lds
  v_mul_f32 v250, v20, v250
  v_mul_f32 v251, v20, v251
  v_readfirstlane_b32 s98, v232
  v_mul_f32 v252, v20, v252
  v_mul_f32 v253, v20, v253
  v_mul_f32 v254, v20, v254
  v_mul_f32 v255, v20, v255
  v_cvt_pk_bf16_f32 v216, v248, v249
  s_cmp_lg_u32 s98, 0
  s_cbranch_scc0 SPIN0
SRET0:
  v_mfma_f32_16x16x32_bf16 a[120:123], v[208:211], v[44:47], a[120:123]
  ds_write_b128 v236, a[240:243] offset:0
  v_cvt_pk_bf16_f32 v217, v250, v251
  v_mfma_f32_16x16x32_bf16 a[124:127], v[208:211], v[76:79], a[124:127]
  v_cvt_pk_bf16_f32 v218, v252, v253
  v_cvt_pk_bf16_f32 v219, v254, v255
  v_mfma_f32_16x16x32_bf16 a[128:131], v[208:211], v[108:111], a[128:131]
  s_mov_b32 s96, s98
  v_accvgpr_write_b32 a0, v216
  v_accvgpr_write_b32 a1, v217
  ds_read_b64_tr_b16 v[188:189], v6 offset:4096
  v_mfma_f32_16x16x32_bf16 a[132:135], v[208:211], v[140:143], a[132:135]
  s_mov_b32 s41, 0xffff0000
  v_accvgpr_write_b32 a2, v218
  v_accvgpr_write_b32 a3, v219
  ds_read_b64_tr_b16 v[190:191], v6 offset:6144
  v_mfma_f32_16x16x32_bf16 a[136:139], v[208:211], v[172:175], a[136:139]
  buffer_load_dwordx4 v16, s[68:71], s94 offen offset:1024 lds
  v_mfma_f32_16x16x32_bf16 a[140:143], v[212:215], v[44:47], a[140:143]
  ds_write_b128 v236, a[244:247] offset:1024
  v_accvgpr_read_b32 v248, a4
  v_accvgpr_read_b32 v249, a5
  v_mfma_f32_16x16x32_bf16 a[144:147], v[212:215], v[76:79], a[144:147]
  v_accvgpr_read_b32 v250, a6
  v_accvgpr_read_b32 v251, a7
  v_mfma_f32_16x16x32_bf16 a[148:151], v[212:215], v[108:111], a[148:151]
  ds_read_b64_tr_b16 v[192:193], v6 offset:8
  v_accvgpr_read_b32 v252, a24
  v_accvgpr_read_b32 v253, a25
  v_accvgpr_read_b32 v254, a26
  v_mfma_f32_16x16x32_bf16 a[152:155], v[212:215], v[140:143], a[152:155]
  ds_read_b64_tr_b16 v[194:195], v6 offset:2056
  v_accvgpr_read_b32 v255, a27
  v_mul_f32 v248, v21, v248
  v_mfma_f32_16x16x32_bf16 a[156:159], v[212:215], v[172:175], a[156:159]
  ds_write_b128 v236, a[248:251] offset:2048
  v_mul_f32 v249, v21, v249
  v_mul_f32 v250, v21, v250
  s_waitcnt lgkmcnt(7)
  v_mfma_f32_16x16x32_bf16 v[24:27], v[184:187], a[160:163], 0
  v_mul_f32 v251, v21, v251
  v_mul_f32 v252, v21, v252
  s_waitcnt lgkmcnt(4)
  v_mfma_f32_16x16x32_bf16 v[24:27], v[188:191], a[180:183], v[24:27]
  v_mul_f32 v253, v21, v253
  v_mul_f32 v254, v21, v254
  v_mul_f32 v255, v21, v255
  v_mfma_f32_16x16x32_bf16 v[56:59], v[188:191], a[184:187], 0
  ds_read_b64_tr_b16 v[196:197], v6 offset:4104
  v_cvt_pk_bf16_f32 v220, v248, v249
  v_cvt_pk_bf16_f32 v221, v250, v251
  v_mfma_f32_16x16x32_bf16 v[56:59], v[184:187], a[164:167], v[56:59]
  ds_read_b64_tr_b16 v[198:199], v6 offset:6152
  v_cvt_pk_bf16_f32 v222, v252, v253
  v_cvt_pk_bf16_f32 v223, v254, v255
  v_mfma_f32_16x16x32_bf16 v[88:91], v[184:187], a[168:171], 0
  buffer_load_dwordx4 v17, s[68:71], s94 offen offset:2048 lds
  v_accvgpr_write_b32 a4, v220
  v_accvgpr_write_b32 a5, v221
  v_accvgpr_write_b32 a6, v222
  v_mfma_f32_16x16x32_bf16 v[88:91], v[188:191], a[188:191], v[88:91]
  ds_read_b128 v[44:47], v238 offset:53248
  v_accvgpr_write_b32 a7, v223
  v_accvgpr_read_b32 v248, a8
  v_mfma_f32_16x16x32_bf16 v[120:123], v[188:191], a[192:195], 0
  ds_write_b128 v236, a[252:255] offset:3072
  v_accvgpr_read_b32 v249, a9
  v_accvgpr_read_b32 v250, a10
  v_mfma_f32_16x16x32_bf16 v[120:123], v[184:187], a[172:175], v[120:123]
  ds_read_b64_tr_b16 v[200:201], v6 offset:8192
  v_accvgpr_read_b32 v251, a11
  v_accvgpr_read_b32 v252, a28
  v_accvgpr_read_b32 v253, a29
  v_mfma_f32_16x16x32_bf16 v[152:155], v[184:187], a[176:179], 0
  ds_read_b64_tr_b16 v[202:203], v6 offset:10240
  v_accvgpr_read_b32 v254, a30
  v_accvgpr_read_b32 v255, a31
  v_mfma_f32_16x16x32_bf16 v[152:155], v[188:191], a[196:199], v[152:155]
  buffer_load_dwordx4 v18, s[68:71], s94 offen offset:3072 lds
  v_mul_f32 v248, v22, v248
  v_mul_f32 v249, v22, v249
  s_waitcnt lgkmcnt(7)
  v_mfma_f32_16x16x32_bf16 v[156:159], v[192:195], a[176:179], 0
  ds_read_b128 v[76:79], v238 offset:54272
  v_mul_f32 v250, v22, v250
  v_mul_f32 v251, v22, v251
  v_mul_f32 v252, v22, v252
  s_waitcnt lgkmcnt(5)
  v_mfma_f32_16x16x32_bf16 v[156:159], v[196:199], a[196:199], v[156:159]
  v_mul_f32 v253, v22, v253
  v_mul_f32 v254, v22, v254
  ds_write_b128 v236, v[240:243] offset:4096
  v_mfma_f32_16x16x32_bf16 v[124:127], v[196:199], a[192:195], 0
  ds_read_b64_tr_b16 v[204:205], v6 offset:12288
  v_mul_f32 v255, v22, v255
  v_cvt_pk_bf16_f32 v224, v248, v249
  v_mfma_f32_16x16x32_bf16 v[124:127], v[192:195], a[172:175], v[124:127]
  ds_read_b64_tr_b16 v[206:207], v6 offset:14336
  v_cvt_pk_bf16_f32 v225, v250, v251
  v_cvt_pk_bf16_f32 v226, v252, v253
  v_mfma_f32_16x16x32_bf16 v[92:95], v[192:195], a[168:171], 0
  ds_read_b128 v[108:111], v238 offset:55296
  v_cvt_pk_bf16_f32 v227, v254, v255
  v_accvgpr_write_b32 a8, v224
  v_accvgpr_write_b32 a9, v225
  v_mfma_f32_16x16x32_bf16 v[92:95], v[196:199], a[188:191], v[92:95]
  ds_read_b64_tr_b16 v[184:185], v6 offset:8200
  v_accvgpr_write_b32 a10, v226
  v_accvgpr_write_b32 a11, v227
  v_mfma_f32_16x16x32_bf16 v[60:63], v[196:199], a[184:187], 0
  ds_read_b64_tr_b16 v[186:187], v6 offset:10248
  v_accvgpr_read_b32 v248, a12
  v_accvgpr_read_b32 v249, a13
  v_mfma_f32_16x16x32_bf16 v[60:63], v[192:195], a[164:167], v[60:63]
  s_add_u32 m0, m0, 0x1000
  v_accvgpr_read_b32 v250, a14
  v_accvgpr_read_b32 v251, a15
  v_accvgpr_read_b32 v252, a32
  v_mfma_f32_16x16x32_bf16 v[28:31], v[192:195], a[160:163], 0
  s_add_u32 s39, s94, 0x8000
  v_accvgpr_read_b32 v253, a33
  v_accvgpr_read_b32 v254, a34
  v_mfma_f32_16x16x32_bf16 v[28:31], v[196:199], a[180:183], v[28:31]
  buffer_load_dwordx4 v15, s[68:71], s39 offen offset:0 lds
  v_accvgpr_read_b32 v255, a35
  v_mul_f32 v248, v23, v248
  s_waitcnt lgkmcnt(7)
  v_mfma_f32_16x16x32_bf16 v[24:27], v[200:203], a[200:203], v[24:27]
  ds_read_b128 v[140:143], v238 offset:56320
  v_mul_f32 v249, v23, v249
  v_mul_f32 v250, v23, v250
  v_mul_f32 v251, v23, v251
  s_waitcnt lgkmcnt(4)
  v_mfma_f32_16x16x32_bf16 v[24:27], v[204:207], a[240:243], v[24:27]
  v_mul_f32 v252, v23, v252
  v_mul_f32 v253, v23, v253
  v_mfma_f32_16x16x32_bf16 v[56:59], v[204:207], a[244:247], v[56:59]
  ds_read_b64_tr_b16 v[188:189], v6 offset:12296
  v_mul_f32 v254, v23, v254
  v_mul_f32 v255, v23, v255
  v_mfma_f32_16x16x32_bf16 v[56:59], v[200:203], a[204:207], v[56:59]
  ds_read_b64_tr_b16 v[190:191], v6 offset:14344
  v_cvt_pk_bf16_f32 v228, v248, v249
  v_cvt_pk_bf16_f32 v229, v250, v251
  v_cvt_pk_bf16_f32 v230, v252, v253
  v_mfma_f32_16x16x32_bf16 v[88:91], v[200:203], a[208:211], v[88:91]
  ds_read_b128 v[172:175], v238 offset:57344
  v_cvt_pk_bf16_f32 v231, v254, v255
  v_accvgpr_write_b32 a12, v228
  v_mfma_f32_16x16x32_bf16 v[88:91], v[204:207], a[248:251], v[88:91]
  ds_read_b64_tr_b16 v[192:193], v6 offset:256
  v_accvgpr_write_b32 a13, v229
  v_accvgpr_write_b32 a14, v230
  v_mfma_f32_16x16x32_bf16 v[120:123], v[204:207], a[252:255], v[120:123]
  ds_read_b64_tr_b16 v[194:195], v6 offset:2304
  v_accvgpr_write_b32 a15, v231
  v_accvgpr_read_b32 v248, a16
  v_mfma_f32_16x16x32_bf16 v[120:123], v[200:203], a[212:215], v[120:123]
  v_accvgpr_read_b32 v249, a17
  v_accvgpr_read_b32 v250, a18
  v_accvgpr_read_b32 v251, a19
  v_mfma_f32_16x16x32_bf16 v[152:155], v[200:203], a[216:219], v[152:155]
  buffer_load_dwordx4 v16, s[68:71], s39 offen offset:1024 lds
  v_accvgpr_read_b32 v252, a36
  v_accvgpr_read_b32 v253, a37
  v_mfma_f32_16x16x32_bf16 v[152:155], v[204:207], v[240:243], v[152:155]
  s_waitcnt lgkmcnt(3)
  v_accvgpr_read_b32 v254, a38
  v_accvgpr_read_b32 v255, a39
  v_mfma_f32_16x16x32_bf16 v[156:159], v[184:187], a[216:219], v[156:159]
  ds_read_b64_tr_b16 v[196:197], v6 offset:4352
  v_mul_f32 v248, v0, v248
  v_mul_f32 v249, v0, v249
  v_mul_f32 v250, v0, v250
  v_mfma_f32_16x16x32_bf16 v[156:159], v[188:191], v[240:243], v[156:159]
  v_mul_f32 v251, v0, v251
  v_mul_f32 v252, v0, v252
  v_mfma_f32_16x16x32_bf16 v[124:127], v[188:191], a[252:255], v[124:127]
  ds_read_b64_tr_b16 v[198:199], v6 offset:6400
  v_mul_f32 v253, v0, v253
  v_mul_f32 v254, v0, v254
  v_mfma_f32_16x16x32_bf16 v[124:127], v[184:187], a[212:215], v[124:127]
  buffer_load_dwordx4 v17, s[68:71], s39 offen offset:2048 lds
  v_mul_f32 v255, v0, v255
  v_cvt_pk_bf16_f32 v216, v248, v249
  v_cvt_pk_bf16_f32 v217, v250, v251
  v_mfma_f32_16x16x32_bf16 v[92:95], v[184:187], a[208:211], v[92:95]
  v_cvt_pk_bf16_f32 v218, v252, v253
  v_cvt_pk_bf16_f32 v219, v254, v255
  v_mfma_f32_16x16x32_bf16 v[92:95], v[188:191], a[248:251], v[92:95]
  ds_read_b64_tr_b16 v[200:201], v6 offset:264
  v_accvgpr_write_b32 a16, v216
  v_accvgpr_write_b32 a17, v217
  v_mfma_f32_16x16x32_bf16 v[60:63], v[188:191], a[244:247], v[60:63]
  ds_read_b64_tr_b16 v[202:203], v6 offset:2312
  v_accvgpr_write_b32 a18, v218
  v_accvgpr_write_b32 a19, v219
  v_accvgpr_read_b32 v248, a40
  v_mfma_f32_16x16x32_bf16 v[60:63], v[184:187], a[204:207], v[60:63]
  ds_write_b128 v237, a[0:3] offset:0
  v_accvgpr_read_b32 v249, a41
  v_accvgpr_read_b32 v250, a42
  v_mfma_f32_16x16x32_bf16 v[28:31], v[184:187], a[200:203], v[28:31]
  v_accvgpr_read_b32 v251, a43
  v_accvgpr_read_b32 v252, a60
  v_mfma_f32_16x16x32_bf16 v[28:31], v[188:191], a[240:243], v[28:31]
  s_waitcnt lgkmcnt(3)
  v_accvgpr_read_b32 v253, a61
  v_accvgpr_read_b32 v254, a62
  v_mfma_f32_16x16x32_bf16 v[32:35], v[192:195], a[160:163], 0
  ds_read_b64_tr_b16 v[204:205], v6 offset:4360
  v_accvgpr_read_b32 v255, a63
  v_mul_f32 v248, v20, v248
  v_mfma_f32_16x16x32_bf16 v[32:35], v[196:199], a[180:183], v[32:35]
  v_mul_f32 v249, v20, v249
  v_mul_f32 v250, v20, v250
  v_mfma_f32_16x16x32_bf16 v[64:67], v[196:199], a[184:187], 0
  ds_read_b64_tr_b16 v[206:207], v6 offset:6408
  v_mul_f32 v251, v20, v251
  v_mul_f32 v252, v20, v252
  v_mul_f32 v253, v20, v253
  v_mfma_f32_16x16x32_bf16 v[64:67], v[192:195], a[164:167], v[64:67]
  ds_write_b128 v237, a[4:7] offset:1024
  v_mul_f32 v254, v20, v254
  v_mul_f32 v255, v20, v255
  v_mfma_f32_16x16x32_bf16 v[96:99], v[192:195], a[168:171], 0
  buffer_load_dwordx4 v18, s[68:71], s39 offen offset:3072 lds
  v_cvt_pk_bf16_f32 v220, v248, v249
  v_cvt_pk_bf16_f32 v221, v250, v251
  v_mfma_f32_16x16x32_bf16 v[96:99], v[196:199], a[188:191], v[96:99]
  s_add_u32 s94, s94, s95
  v_cvt_pk_bf16_f32 v222, v252, v253
  v_cvt_pk_bf16_f32 v223, v254, v255
  v_mfma_f32_16x16x32_bf16 v[128:131], v[196:199], a[192:195], 0
  ds_read_b64_tr_b16 v[184:185], v6 offset:8448
  v_accvgpr_write_b32 a40, v220
  v_accvgpr_write_b32 a41, v221
  v_mfma_f32_16x16x32_bf16 v[128:131], v[192:195], a[172:175], v[128:131]
  ds_write_b128 v237, a[8:11] offset:2048
  v_accvgpr_write_b32 a42, v222
  v_accvgpr_write_b32 a43, v223
  v_accvgpr_read_b32 v248, a44
  v_mfma_f32_16x16x32_bf16 v[160:163], v[192:195], a[176:179], 0
  ds_read_b64_tr_b16 v[186:187], v6 offset:10496
  v_accvgpr_read_b32 v249, a45
  v_accvgpr_read_b32 v250, a46
  v_mfma_f32_16x16x32_bf16 v[160:163], v[196:199], a[196:199], v[160:163]
  ds_write_b128 v237, a[12:15] offset:3072
  v_accvgpr_read_b32 v251, a47
  v_accvgpr_read_b32 v252, a64
  s_waitcnt lgkmcnt(8)
  v_mfma_f32_16x16x32_bf16 v[164:167], v[200:203], a[176:179], 0
  ds_read_b64_tr_b16 v[188:189], v6 offset:12544
  v_accvgpr_read_b32 v253, a65
  v_accvgpr_read_b32 v254, a66
  s_waitcnt lgkmcnt(6)
  v_mfma_f32_16x16x32_bf16 v[164:167], v[204:207], a[196:199], v[164:167]
  v_accvgpr_read_b32 v255, a67
  v_mul_f32 v248, v21, v248
  v_mfma_f32_16x16x32_bf16 v[132:135], v[204:207], a[192:195], 0
  ds_read_b64_tr_b16 v[190:191], v6 offset:14592
  v_mul_f32 v249, v21, v249
  v_mul_f32 v250, v21, v250
  v_mfma_f32_16x16x32_bf16 v[132:135], v[200:203], a[172:175], v[132:135]
  ds_read_b64_tr_b16 v[192:193], v6 offset:8456
  v_mul_f32 v251, v21, v251
  v_mul_f32 v252, v21, v252
  v_mul_f32 v253, v21, v253
  v_mfma_f32_16x16x32_bf16 v[100:103], v[200:203], a[168:171], 0
  ds_read_b64_tr_b16 v[194:195], v6 offset:10504
  v_mul_f32 v254, v21, v254
  v_mul_f32 v255, v21, v255
  v_mfma_f32_16x16x32_bf16 v[100:103], v[204:207], a[188:191], v[100:103]
  ds_write_b128 v237, a[16:19] offset:4096
  v_cvt_pk_bf16_f32 v224, v248, v249
  v_cvt_pk_bf16_f32 v225, v250, v251
  v_mfma_f32_16x16x32_bf16 v[68:71], v[204:207], a[184:187], 0
  ds_read_b64_tr_b16 v[196:197], v6 offset:12552
  v_cvt_pk_bf16_f32 v226, v252, v253
  v_cvt_pk_bf16_f32 v227, v254, v255
  v_mfma_f32_16x16x32_bf16 v[68:71], v[200:203], a[164:167], v[68:71]
  ds_read_b64_tr_b16 v[198:199], v6 offset:14600
  v_accvgpr_write_b32 a44, v224
  v_accvgpr_write_b32 a45, v225
  v_mfma_f32_16x16x32_bf16 v[36:39], v[200:203], a[160:163], 0
  s_add_u32 s30, s29, s31
  v_accvgpr_write_b32 a46, v226
  v_accvgpr_write_b32 a47, v227
  v_accvgpr_read_b32 v248, a48
  v_mfma_f32_16x16x32_bf16 v[36:39], v[204:207], a[180:183], v[36:39]
  s_waitcnt lgkmcnt(5)
  v_accvgpr_read_b32 v249, a49
  v_accvgpr_read_b32 v250, a50
  v_mfma_f32_16x16x32_bf16 v[32:35], v[184:187], a[200:203], v[32:35]
  v_accvgpr_read_b32 v251, a51
  v_accvgpr_read_b32 v252, a68
  v_mfma_f32_16x16x32_bf16 v[32:35], v[188:191], a[240:243], v[32:35]
  s_add_u32 s29, s29, 53248
  v_accvgpr_read_b32 v253, a69
  v_accvgpr_read_b32 v254, a70
  v_mfma_f32_16x16x32_bf16 v[64:67], v[188:191], a[244:247], v[64:67]
  s_cmp_eq_u32 s29, 159744
  v_accvgpr_read_b32 v255, a71
  v_mul_f32 v248, v22, v248
  v_mfma_f32_16x16x32_bf16 v[64:67], v[184:187], a[204:207], v[64:67]
  s_cselect_b32 s29, 0, s29
  v_mul_f32 v249, v22, v249
  v_mul_f32 v250, v22, v250
  v_mfma_f32_16x16x32_bf16 v[96:99], v[184:187], a[208:211], v[96:99]
  s_waitcnt vmcnt(8) lgkmcnt(0)
  s_barrier
  v_mul_f32 v251, v22, v251
  v_mul_f32 v252, v22, v252
  v_mul_f32 v253, v22, v253
  v_mfma_f32_16x16x32_bf16 v[96:99], v[188:191], a[248:251], v[96:99]
  s_add_u32 m0, s30, s31
  v_mul_f32 v254, v22, v254
  v_mul_f32 v255, v22, v255
  v_add_u32 v6, s29, v244
  v_mfma_f32_16x16x32_bf16 v[128:131], v[188:191], a[252:255], v[128:131]
  ds_read_b64_tr_b16 v[200:201], v6 offset:0
  v_cvt_pk_bf16_f32 v228, v248, v249
  v_cvt_pk_bf16_f32 v229, v250, v251
  v_mfma_f32_16x16x32_bf16 v[128:131], v[184:187], a[212:215], v[128:131]
  ds_read_b64_tr_b16 v[202:203], v6 offset:2048
  v_cvt_pk_bf16_f32 v230, v252, v253
  v_cvt_pk_bf16_f32 v231, v254, v255
  v_mfma_f32_16x16x32_bf16 v[160:163], v[184:187], a[216:219], v[160:163]
  buffer_load_dwordx4 v15, s[68:71], s94 offen offset:0 lds
  v_accvgpr_write_b32 a48, v228
  v_accvgpr_write_b32 a49, v229
  v_mfma_f32_16x16x32_bf16 v[160:163], v[188:191], v[240:243], v[160:163]
  ds_read_b128 a[220:223], v238 offset:0
  v_accvgpr_write_b32 a50, v230
  v_accvgpr_write_b32 a51, v231
  v_accvgpr_read_b32 v248, a52
  v_mfma_f32_16x16x32_bf16 v[164:167], v[192:195], a[216:219], v[164:167]
  ds_read_b64_tr_b16 v[204:205], v6 offset:8
  v_accvgpr_read_b32 v249, a53
  v_accvgpr_read_b32 v250, a54
  v_mfma_f32_16x16x32_bf16 v[164:167], v[196:199], v[240:243], v[164:167]
  v_accvgpr_read_b32 v251, a55
  v_accvgpr_read_b32 v252, a72
  v_mfma_f32_16x16x32_bf16 v[132:135], v[196:199], a[252:255], v[132:135]
  ds_read_b64_tr_b16 v[206:207], v6 offset:2056
  v_accvgpr_read_b32 v253, a73
  v_accvgpr_read_b32 v254, a74
  v_mfma_f32_16x16x32_bf16 v[132:135], v[192:195], a[212:215], v[132:135]
  buffer_load_dwordx4 v16, s[68:71], s94 offen offset:1024 lds
  v_accvgpr_read_b32 v255, a75
  v_mul_f32 v248, v23, v248
  v_mfma_f32_16x16x32_bf16 v[100:103], v[192:195], a[208:211], v[100:103]
  ds_read_b128 a[224:227], v238 offset:1024
  v_mul_f32 v249, v23, v249
  v_mul_f32 v250, v23, v250
  v_mfma_f32_16x16x32_bf16 v[100:103], v[196:199], a[248:251], v[100:103]
  ds_read_b64_tr_b16 v[184:185], v6 offset:256
  v_mul_f32 v251, v23, v251
  v_mul_f32 v252, v23, v252
  v_mul_f32 v253, v23, v253
  v_mfma_f32_16x16x32_bf16 v[68:71], v[196:199], a[244:247], v[68:71]
  ds_read_b64_tr_b16 v[186:187], v6 offset:2304
  v_mul_f32 v254, v23, v254
  v_mul_f32 v255, v23, v255
  v_mfma_f32_16x16x32_bf16 v[68:71], v[192:195], a[204:207], v[68:71]
  v_cvt_pk_bf16_f32 v216, v248, v249
  v_cvt_pk_bf16_f32 v217, v250, v251
  v_mfma_f32_16x16x32_bf16 v[36:39], v[192:195], a[200:203], v[36:39]
  v_cvt_pk_bf16_f32 v218, v252, v253
  v_cvt_pk_bf16_f32 v219, v254, v255
  v_mfma_f32_16x16x32_bf16 v[36:39], v[196:199], a[240:243], v[36:39]
  ds_read_b128 a[228:231], v238 offset:2048
  v_accvgpr_write_b32 a52, v216
  v_accvgpr_write_b32 a53, v217
  s_waitcnt lgkmcnt(7)
  v_mfma_f32_16x16x32_bf16 v[24:27], v[200:203], v[40:43], v[24:27]
  ds_read_b64_tr_b16 v[188:189], v6 offset:264
  v_accvgpr_write_b32 a54, v218
  v_accvgpr_write_b32 a55, v219
  v_accvgpr_read_b32 v248, a56
  s_waitcnt lgkmcnt(5)
  v_mfma_f32_16x16x32_bf16 v[28:31], v[204:207], v[40:43], v[28:31]
  v_accvgpr_read_b32 v249, a57
  v_accvgpr_read_b32 v250, a58
  v_mfma_f32_16x16x32_bf16 v[60:63], v[204:207], v[72:75], v[60:63]
  ds_read_b64_tr_b16 v[190:191], v6 offset:2312
  v_accvgpr_read_b32 v251, a59
  v_accvgpr_read_b32 v252, a76
  v_mfma_f32_16x16x32_bf16 v[56:59], v[200:203], v[72:75], v[56:59]
  buffer_load_dwordx4 v17, s[68:71], s94 offen offset:2048 lds
  v_accvgpr_read_b32 v253, a77
  v_accvgpr_read_b32 v254, a78
  v_mfma_f32_16x16x32_bf16 v[88:91], v[200:203], v[104:107], v[88:91]
  ds_read_b128 a[232:235], v238 offset:3072
  v_accvgpr_read_b32 v255, a79
  v_mul_f32 v248, v0, v248
  v_mfma_f32_16x16x32_bf16 v[92:95], v[204:207], v[104:107], v[92:95]
  ds_read_b64_tr_b16 v[192:193], v6 offset:4096
  v_mul_f32 v249, v0, v249
  v_mul_f32 v250, v0, v250
  v_mfma_f32_16x16x32_bf16 v[124:127], v[204:207], v[136:139], v[124:127]
  ds_read_b64_tr_b16 v[194:195], v6 offset:6144
  v_mul_f32 v251, v0, v251
  v_mul_f32 v252, v0, v252
  v_mul_f32 v253, v0, v253
  v_mfma_f32_16x16x32_bf16 v[120:123], v[200:203], v[136:139], v[120:123]
  v_mul_f32 v254, v0, v254
  v_mul_f32 v255, v0, v255
  v_mfma_f32_16x16x32_bf16 v[152:155], v[200:203], v[168:171], v[152:155]
  buffer_load_dwordx4 v18, s[68:71], s94 offen offset:3072 lds
  v_cvt_pk_bf16_f32 v220, v248, v249
  v_cvt_pk_bf16_f32 v221, v250, v251
  v_mfma_f32_16x16x32_bf16 v[156:159], v[204:207], v[168:171], v[156:159]
  ds_read_b128 a[236:239], v238 offset:4096
  v_cvt_pk_bf16_f32 v222, v252, v253
  v_cvt_pk_bf16_f32 v223, v254, v255
  s_waitcnt lgkmcnt(7)
  v_mfma_f32_16x16x32_bf16 v[160:163], v[184:187], v[168:171], v[160:163]
  ds_read_b64_tr_b16 v[196:197], v6 offset:4104
  v_accvgpr_write_b32 a56, v220
  v_accvgpr_write_b32 a57, v221
  s_waitcnt lgkmcnt(5)
  v_mfma_f32_16x16x32_bf16 v[164:167], v[188:191], v[168:171], v[164:167]
  v_accvgpr_write_b32 a58, v222
  v_accvgpr_write_b32 a59, v223
  v_accvgpr_read_b32 v248, a80
  v_mfma_f32_16x16x32_bf16 v[132:135], v[188:191], v[136:139], v[132:135]
  ds_read_b64_tr_b16 v[198:199], v6 offset:6152
  v_accvgpr_read_b32 v249, a81
  v_accvgpr_read_b32 v250, a82
  v_mfma_f32_16x16x32_bf16 v[128:131], v[184:187], v[136:139], v[128:131]
  s_add_u32 m0, m0, 0x1000
  v_accvgpr_read_b32 v251, a83
  v_accvgpr_read_b32 v252, a100
  v_mfma_f32_16x16x32_bf16 v[96:99], v[184:187], v[104:107], v[96:99]
  ds_read_b128 a[20:23], v239 offset:0
  v_accvgpr_read_b32 v253, a101
  v_accvgpr_read_b32 v254, a102
  v_accvgpr_read_b32 v255, a103
  v_mfma_f32_16x16x32_bf16 v[100:103], v[188:191], v[104:107], v[100:103]
  ds_read_b64_tr_b16 v[200:201], v6 offset:4352
  v_mul_f32 v248, v20, v248
  v_mul_f32 v249, v20, v249
  v_mfma_f32_16x16x32_bf16 v[68:71], v[188:191], v[72:75], v[68:71]
  ds_read_b64_tr_b16 v[202:203], v6 offset:6400
  v_mul_f32 v250, v20, v250
  v_mul_f32 v251, v20, v251
  v_mul_f32 v252, v20, v252
  v_mfma_f32_16x16x32_bf16 v[64:67], v[184:187], v[72:75], v[64:67]
  s_add_u32 s39, s94, 0x8000
  v_mul_f32 v253, v20, v253
  v_mul_f32 v254, v20, v254
  v_mfma_f32_16x16x32_bf16 v[32:35], v[184:187], v[40:43], v[32:35]
  buffer_load_dwordx4 v15, s[68:71], s39 offen offset:0 lds
  v_mul_f32 v255, v20, v255
  v_cvt_pk_bf16_f32 v224, v248, v249
  v_mfma_f32_16x16x32_bf16 v[36:39], v[188:191], v[40:43], v[36:39]
  ds_read_b128 a[24:27], v239 offset:1024
  v_cvt_pk_bf16_f32 v225, v250, v251
  v_cvt_pk_bf16_f32 v226, v252, v253
  v_cvt_pk_bf16_f32 v227, v254, v255
  s_waitcnt lgkmcnt(7)
  v_mfma_f32_16x16x32_bf16 v[24:27], v[192:195], v[44:47], v[24:27]
  ds_read_b64_tr_b16 v[204:205], v6 offset:4360
  v_accvgpr_write_b32 a80, v224
  v_accvgpr_write_b32 a81, v225
  s_waitcnt lgkmcnt(5)
  v_mfma_f32_16x16x32_bf16 v[28:31], v[196:199], v[44:47], v[28:31]
  v_accvgpr_write_b32 a82, v226
  v_accvgpr_write_b32 a83, v227
  v_accvgpr_read_b32 v248, a84
  v_mfma_f32_16x16x32_bf16 v[60:63], v[196:199], v[76:79], v[60:63]
  ds_read_b64_tr_b16 v[206:207], v6 offset:6408
  v_accvgpr_read_b32 v249, a85
  v_accvgpr_read_b32 v250, a86
  v_mfma_f32_16x16x32_bf16 v[56:59], v[192:195], v[76:79], v[56:59]
  v_accvgpr_read_b32 v251, a87
  v_accvgpr_read_b32 v252, a104
  v_mfma_f32_16x16x32_bf16 v[88:91], v[192:195], v[108:111], v[88:91]
  ds_read_b128 a[28:31], v239 offset:2048
  v_accvgpr_read_b32 v253, a105
  v_accvgpr_read_b32 v254, a106
  v_accvgpr_read_b32 v255, a107
  v_mfma_f32_16x16x32_bf16 v[92:95], v[196:199], v[108:111], v[92:95]
  ds_read_b64_tr_b16 v[184:185], v6 offset:8192
  v_mul_f32 v248, v21, v248
  v_mul_f32 v249, v21, v249
  v_mfma_f32_16x16x32_bf16 v[124:127], v[196:199], v[140:143], v[124:127]
  ds_read_b64_tr_b16 v[186:187], v6 offset:10240
  v_mul_f32 v250, v21, v250
  v_mul_f32 v251, v21, v251
  v_mul_f32 v252, v21, v252
  v_mfma_f32_16x16x32_bf16 v[120:123], v[192:195], v[140:143], v[120:123]
  v_mul_f32 v253, v21, v253
  v_mul_f32 v254, v21, v254
  v_mfma_f32_16x16x32_bf16 v[152:155], v[192:195], v[172:175], v[152:155]
  buffer_load_dwordx4 v16, s[68:71], s39 offen offset:1024 lds
  v_mul_f32 v255, v21, v255
  v_cvt_pk_bf16_f32 v228, v248, v249
  v_mfma_f32_16x16x32_bf16 v[156:159], v[196:199], v[172:175], v[156:159]
  ds_read_b128 a[32:35], v239 offset:3072
  v_cvt_pk_bf16_f32 v229, v250, v251
  v_cvt_pk_bf16_f32 v230, v252, v253
  v_cvt_pk_bf16_f32 v231, v254, v255
  s_waitcnt lgkmcnt(7)
  v_mfma_f32_16x16x32_bf16 v[160:163], v[200:203], v[172:175], v[160:163]
  ds_read_b64_tr_b16 v[188:189], v6 offset:8200
  v_accvgpr_write_b32 a84, v228
  v_accvgpr_write_b32 a85, v229
  s_waitcnt lgkmcnt(5)
  v_mfma_f32_16x16x32_bf16 v[164:167], v[204:207], v[172:175], v[164:167]
  v_accvgpr_write_b32 a86, v230
  v_accvgpr_write_b32 a87, v231
  v_accvgpr_read_b32 v248, a88
  v_mfma_f32_16x16x32_bf16 v[132:135], v[204:207], v[140:143], v[132:135]
  ds_read_b64_tr_b16 v[190:191], v6 offset:10248
  v_accvgpr_read_b32 v249, a89
  v_accvgpr_read_b32 v250, a90
  v_mfma_f32_16x16x32_bf16 v[128:131], v[200:203], v[140:143], v[128:131]
  buffer_load_dwordx4 v17, s[68:71], s39 offen offset:2048 lds
  v_accvgpr_read_b32 v251, a91
  v_accvgpr_read_b32 v252, a108
  v_mfma_f32_16x16x32_bf16 v[96:99], v[200:203], v[108:111], v[96:99]
  ds_read_b128 a[36:39], v239 offset:4096
  v_accvgpr_read_b32 v253, a109
  v_accvgpr_read_b32 v254, a110
  v_accvgpr_read_b32 v255, a111
  v_mfma_f32_16x16x32_bf16 v[100:103], v[204:207], v[108:111], v[100:103]
  ds_read_b64_tr_b16 v[192:193], v6 offset:8448
  v_mul_f32 v248, v22, v248
  v_mul_f32 v249, v22, v249
  v_mfma_f32_16x16x32_bf16 v[68:71], v[204:207], v[76:79], v[68:71]
  ds_read_b64_tr_b16 v[194:195], v6 offset:10496
  v_mul_f32 v250, v22, v250
  v_mul_f32 v251, v22, v251
  v_mul_f32 v252, v22, v252
  v_mfma_f32_16x16x32_bf16 v[64:67], v[200:203], v[76:79], v[64:67]
  ds_write_b128 v236, a[40:43] offset:53248
  v_mul_f32 v253, v22, v253
  v_mul_f32 v254, v22, v254
  v_mfma_f32_16x16x32_bf16 v[32:35], v[200:203], v[44:47], v[32:35]
  v_mul_f32 v255, v22, v255
  v_cvt_pk_bf16_f32 v216, v248, v249
  v_mfma_f32_16x16x32_bf16 v[36:39], v[204:207], v[44:47], v[36:39]
  s_waitcnt lgkmcnt(4)
  v_cvt_pk_bf16_f32 v217, v250, v251
  v_cvt_pk_bf16_f32 v218, v252, v253
  v_cvt_pk_bf16_f32 v219, v254, v255
  v_mfma_f32_16x16x32_bf16 v[24:27], v[184:187], v[48:51], v[24:27]
  ds_read_b64_tr_b16 v[196:197], v6 offset:8456
  v_accvgpr_write_b32 a88, v216
  v_accvgpr_write_b32 a89, v217
  v_mfma_f32_16x16x32_bf16 v[28:31], v[188:191], v[48:51], v[28:31]
  v_accvgpr_write_b32 a90, v218
  v_accvgpr_write_b32 a91, v219
  v_accvgpr_read_b32 v248, a92
  v_mfma_f32_16x16x32_bf16 v[60:63], v[188:191], v[80:83], v[60:63]
  ds_read_b64_tr_b16 v[198:199], v6 offset:10504
  v_accvgpr_read_b32 v249, a93
  v_accvgpr_read_b32 v250, a94
  v_mfma_f32_16x16x32_bf16 v[56:59], v[184:187], v[80:83], v[56:59]
  ds_write_b128 v236, a[44:47] offset:54272
  v_accvgpr_read_b32 v251, a95
  v_accvgpr_read_b32 v252, a112
  v_mfma_f32_16x16x32_bf16 v[88:91], v[184:187], v[112:115], v[88:91]
  buffer_load_dwordx4 v18, s[68:71], s39 offen offset:3072 lds
  v_accvgpr_read_b32 v253, a113
  v_accvgpr_read_b32 v254, a114
  v_accvgpr_read_b32 v255, a115
  v_mfma_f32_16x16x32_bf16 v[92:95], v[188:191], v[112:115], v[92:95]
  s_add_u32 s94, s88, 3
  v_mul_f32 v248, v23, v248
  v_mul_f32 v249, v23, v249
  v_mfma_f32_16x16x32_bf16 v[124:127], v[188:191], v[144:147], v[124:127]
  s_and_b32 s94, s94, 7
  v_mul_f32 v250, v23, v250
  v_mul_f32 v251, v23, v251
  s_lshl_b32 s94, s94, 7
  s_add_u32 s94, s94, s100
  v_mul_f32 v252, v23, v252
  v_mfma_f32_16x16x32_bf16 v[120:123], v[184:187], v[144:147], v[120:123]
  ds_read_b64_tr_b16 v[200:201], v6 offset:12288
  v_mul_f32 v253, v23, v253
  v_mul_f32 v254, v23, v254
  ds_write_b128 v236, a[48:51] offset:55296
  v_mfma_f32_16x16x32_bf16 v[152:155], v[184:187], v[176:179], v[152:155]
  ds_read_b64_tr_b16 v[202:203], v6 offset:14336
  v_mul_f32 v255, v23, v255
  v_cvt_pk_bf16_f32 v220, v248, v249
  v_mfma_f32_16x16x32_bf16 v[156:159], v[188:191], v[176:179], v[156:159]
  ds_write_b128 v236, a[52:55] offset:56320
  v_cvt_pk_bf16_f32 v221, v250, v251
  v_cvt_pk_bf16_f32 v222, v252, v253
  v_cvt_pk_bf16_f32 v223, v254, v255
  s_waitcnt lgkmcnt(8)
  v_mfma_f32_16x16x32_bf16 v[160:163], v[192:195], v[176:179], v[160:163]
  ds_read_b64_tr_b16 v[204:205], v6 offset:12296
  v_accvgpr_write_b32 a92, v220
  v_accvgpr_write_b32 a93, v221
  s_waitcnt lgkmcnt(6)
  v_mfma_f32_16x16x32_bf16 v[164:167], v[196:199], v[176:179], v[164:167]
  v_accvgpr_write_b32 a94, v222
  v_accvgpr_write_b32 a95, v223
  v_accvgpr_read_b32 v248, a96
  v_mfma_f32_16x16x32_bf16 v[132:135], v[196:199], v[144:147], v[132:135]
  ds_read_b64_tr_b16 v[206:207], v6 offset:14344
  v_accvgpr_read_b32 v249, a97
  v_accvgpr_read_b32 v250, a98
  v_mfma_f32_16x16x32_bf16 v[128:131], v[192:195], v[144:147], v[128:131]
  ds_read_b64_tr_b16 v[184:185], v6 offset:12544
  v_accvgpr_read_b32 v251, a99
  v_accvgpr_read_b32 v252, a116
  v_mfma_f32_16x16x32_bf16 v[96:99], v[192:195], v[112:115], v[96:99]
  ds_read_b64_tr_b16 v[186:187], v6 offset:14592
  v_accvgpr_read_b32 v253, a117
  v_accvgpr_read_b32 v254, a118
  v_accvgpr_read_b32 v255, a119
  v_mfma_f32_16x16x32_bf16 v[100:103], v[196:199], v[112:115], v[100:103]
  ds_write_b128 v236, a[56:59] offset:57344
  v_mul_f32 v248, v0, v248
  v_mul_f32 v249, v0, v249
  v_mfma_f32_16x16x32_bf16 v[68:71], v[196:199], v[80:83], v[68:71]
  ds_read_b64_tr_b16 v[188:189], v6 offset:12552
  v_mul_f32 v250, v0, v250
  v_mul_f32 v251, v0, v251
  v_mul_f32 v252, v0, v252
  v_mfma_f32_16x16x32_bf16 v[64:67], v[192:195], v[80:83], v[64:67]
  ds_read_b64_tr_b16 v[190:191], v6 offset:14600
  v_mul_f32 v253, v0, v253
  v_mul_f32 v254, v0, v254
  v_mfma_f32_16x16x32_bf16 v[32:35], v[192:195], v[48:51], v[32:35]
  s_add_u32 s30, s29, s31
  v_mul_f32 v255, v0, v255
  v_cvt_pk_bf16_f32 v224, v248, v249
  v_mfma_f32_16x16x32_bf16 v[36:39], v[196:199], v[48:51], v[36:39]
  s_waitcnt lgkmcnt(5)
  v_cvt_pk_bf16_f32 v225, v250, v251
  v_cvt_pk_bf16_f32 v226, v252, v253
  v_cvt_pk_bf16_f32 v227, v254, v255
  v_mfma_f32_16x16x32_bf16 v[24:27], v[200:203], a[220:223], v[24:27]
  v_accvgpr_write_b32 a96, v224
  v_accvgpr_write_b32 a97, v225
  v_mfma_f32_16x16x32_bf16 v[28:31], v[204:207], a[220:223], v[28:31]
  s_add_u32 s29, s29, 53248
  v_accvgpr_write_b32 a98, v226
  v_accvgpr_write_b32 a99, v227
  v_accvgpr_read_b32 v248, a120
  v_mfma_f32_16x16x32_bf16 v[60:63], v[204:207], a[224:227], v[60:63]
  s_cmp_eq_u32 s29, 159744
  v_accvgpr_read_b32 v249, a121
  v_accvgpr_read_b32 v250, a122
  v_mfma_f32_16x16x32_bf16 v[56:59], v[200:203], a[224:227], v[56:59]
  s_cselect_b32 s29, 0, s29
  v_accvgpr_read_b32 v251, a123
  v_accvgpr_read_b32 v252, a140
  v_mfma_f32_16x16x32_bf16 v[88:91], v[200:203], a[228:231], v[88:91]
  s_waitcnt vmcnt(8) lgkmcnt(0)
  s_barrier
  v_accvgpr_read_b32 v253, a141
  v_accvgpr_read_b32 v254, a142
  v_mfma_f32_16x16x32_bf16 v[92:95], v[204:207], a[228:231], v[92:95]
  s_add_u32 m0, s30, s31
  v_accvgpr_read_b32 v255, a143
  v_mul_f32 v248, v20, v248
  v_add_u32 v6, s29, v244
  v_mfma_f32_16x16x32_bf16 v[124:127], v[204:207], a[232:235], v[124:127]
  ds_read_b64_tr_b16 v[192:193], v6 offset:0
  v_mul_f32 v249, v20, v249
  v_mul_f32 v250, v20, v250
  v_mfma_f32_16x16x32_bf16 v[120:123], v[200:203], a[232:235], v[120:123]
  ds_read_b64_tr_b16 v[194:195], v6 offset:2048
  v_mul_f32 v251, v20, v251
  v_mul_f32 v252, v20, v252
  v_mul_f32 v253, v20, v253
  v_mfma_f32_16x16x32_bf16 v[152:155], v[200:203], a[236:239], v[152:155]
  buffer_load_dwordx4 v15, s[68:71], s94 offen offset:0 lds
  v_mul_f32 v254, v20, v254
  v_mul_f32 v255, v20, v255
  v_mfma_f32_16x16x32_bf16 v[156:159], v[204:207], a[236:239], v[156:159]
  ds_read_b128 a[60:63], v238 offset:53248
  v_cvt_pk_bf16_f32 v228, v248, v249
  v_cvt_pk_bf16_f32 v229, v250, v251
  v_mfma_f32_16x16x32_bf16 v[160:163], v[184:187], a[236:239], v[160:163]
  ds_read_b64_tr_b16 v[196:197], v6 offset:8
  v_cvt_pk_bf16_f32 v230, v252, v253
  v_cvt_pk_bf16_f32 v231, v254, v255
  v_mfma_f32_16x16x32_bf16 v[164:167], v[188:191], a[236:239], v[164:167]
  v_accvgpr_write_b32 a120, v228
  v_accvgpr_write_b32 a121, v229
  v_mfma_f32_16x16x32_bf16 v[132:135], v[188:191], a[232:235], v[132:135]
  ds_read_b64_tr_b16 v[198:199], v6 offset:2056
  v_accvgpr_write_b32 a122, v230
  v_accvgpr_write_b32 a123, v231
  v_accvgpr_read_b32 v248, a124
  v_mfma_f32_16x16x32_bf16 v[128:131], v[184:187], a[232:235], v[128:131]
  buffer_load_dwordx4 v16, s[68:71], s94 offen offset:1024 lds
  v_accvgpr_read_b32 v249, a125
  v_accvgpr_read_b32 v250, a126
  v_mfma_f32_16x16x32_bf16 v[96:99], v[184:187], a[228:231], v[96:99]
  ds_read_b128 a[64:67], v238 offset:54272
  v_accvgpr_read_b32 v251, a127
  v_accvgpr_read_b32 v252, a144
  v_mfma_f32_16x16x32_bf16 v[100:103], v[188:191], a[228:231], v[100:103]
  ds_read_b64_tr_b16 v[200:201], v6 offset:256
  v_accvgpr_read_b32 v253, a145
  v_accvgpr_read_b32 v254, a146
  v_mfma_f32_16x16x32_bf16 v[68:71], v[188:191], a[224:227], v[68:71]
  ds_read_b64_tr_b16 v[202:203], v6 offset:2304
  v_accvgpr_read_b32 v255, a147
  v_mul_f32 v248, v21, v248
  v_mfma_f32_16x16x32_bf16 v[64:67], v[184:187], a[224:227], v[64:67]
  v_mul_f32 v249, v21, v249
  v_mul_f32 v250, v21, v250
  v_mfma_f32_16x16x32_bf16 v[32:35], v[184:187], a[220:223], v[32:35]
  v_mul_f32 v251, v21, v251
  v_mul_f32 v252, v21, v252
  v_mul_f32 v253, v21, v253
  v_mfma_f32_16x16x32_bf16 v[36:39], v[188:191], a[220:223], v[36:39]
  ds_read_b128 a[68:71], v238 offset:55296
  v_mul_f32 v254, v21, v254
  v_mul_f32 v255, v21, v255
  s_waitcnt lgkmcnt(7)
  v_mfma_f32_16x16x32_bf16 v[24:27], v[192:195], a[0:3], v[24:27]
  ds_read_b64_tr_b16 v[204:205], v6 offset:264
  v_cvt_pk_bf16_f32 v216, v248, v249
  v_cvt_pk_bf16_f32 v217, v250, v251
  s_waitcnt lgkmcnt(5)
  v_mfma_f32_16x16x32_bf16 v[28:31], v[196:199], a[0:3], v[28:31]
  v_cvt_pk_bf16_f32 v218, v252, v253
  v_cvt_pk_bf16_f32 v219, v254, v255
  v_mfma_f32_16x16x32_bf16 v[60:63], v[196:199], a[4:7], v[60:63]
  ds_read_b64_tr_b16 v[206:207], v6 offset:2312
  v_accvgpr_write_b32 a124, v216
  v_accvgpr_write_b32 a125, v217
  v_mfma_f32_16x16x32_bf16 v[56:59], v[192:195], a[4:7], v[56:59]
  buffer_load_dwordx4 v17, s[68:71], s94 offen offset:2048 lds
  v_accvgpr_write_b32 a126, v218
  v_accvgpr_write_b32 a127, v219
  v_accvgpr_read_b32 v248, a128
  v_mfma_f32_16x16x32_bf16 v[88:91], v[192:195], a[8:11], v[88:91]
  ds_read_b128 a[72:75], v238 offset:56320
  v_accvgpr_read_b32 v249, a129
  v_accvgpr_read_b32 v250, a130
  v_mfma_f32_16x16x32_bf16 v[92:95], v[196:199], a[8:11], v[92:95]
  ds_read_b64_tr_b16 v[184:185], v6 offset:4096
  v_accvgpr_read_b32 v251, a131
  v_accvgpr_read_b32 v252, a148
  v_mfma_f32_16x16x32_bf16 v[124:127], v[196:199], a[12:15], v[124:127]
  ds_read_b64_tr_b16 v[186:187], v6 offset:6144
  v_accvgpr_read_b32 v253, a149
  v_accvgpr_read_b32 v254, a150
  v_mfma_f32_16x16x32_bf16 v[120:123], v[192:195], a[12:15], v[120:123]
  v_accvgpr_read_b32 v255, a151
  v_mul_f32 v248, v22, v248
  v_mfma_f32_16x16x32_bf16 v[152:155], v[192:195], a[16:19], v[152:155]
  buffer_load_dwordx4 v18, s[68:71], s94 offen offset:3072 lds
  v_mul_f32 v249, v22, v249
  v_mul_f32 v250, v22, v250
  v_mfma_f32_16x16x32_bf16 v[156:159], v[196:199], a[16:19], v[156:159]
  ds_read_b128 a[76:79], v238 offset:57344
  v_mul_f32 v251, v22, v251
  v_mul_f32 v252, v22, v252
  v_mul_f32 v253, v22, v253
  s_waitcnt lgkmcnt(7)
  v_mfma_f32_16x16x32_bf16 v[160:163], v[200:203], a[16:19], v[160:163]
  ds_read_b64_tr_b16 v[188:189], v6 offset:4104
  v_mul_f32 v254, v22, v254
  v_mul_f32 v255, v22, v255
  s_waitcnt lgkmcnt(5)
  v_mfma_f32_16x16x32_bf16 v[164:167], v[204:207], a[16:19], v[164:167]
  v_cvt_pk_bf16_f32 v220, v248, v249
  v_cvt_pk_bf16_f32 v221, v250, v251
  v_mfma_f32_16x16x32_bf16 v[132:135], v[204:207], a[12:15], v[132:135]
  ds_read_b64_tr_b16 v[190:191], v6 offset:6152
  v_cvt_pk_bf16_f32 v222, v252, v253
  v_cvt_pk_bf16_f32 v223, v254, v255
  v_mfma_f32_16x16x32_bf16 v[128:131], v[200:203], a[12:15], v[128:131]
  s_add_u32 m0, m0, 0x1000
  v_accvgpr_write_b32 a128, v220
  v_accvgpr_write_b32 a129, v221
  v_mfma_f32_16x16x32_bf16 v[96:99], v[200:203], a[8:11], v[96:99]
  ds_write_b128 v236, a[80:83] offset:0
  v_accvgpr_write_b32 a130, v222
  v_accvgpr_write_b32 a131, v223
  v_accvgpr_read_b32 v248, a132
  v_mfma_f32_16x16x32_bf16 v[100:103], v[204:207], a[8:11], v[100:103]
  ds_read_b64_tr_b16 v[192:193], v6 offset:4352
  v_accvgpr_read_b32 v249, a133
  v_accvgpr_read_b32 v250, a134
  v_mfma_f32_16x16x32_bf16 v[68:71], v[204:207], a[4:7], v[68:71]
  ds_read_b64_tr_b16 v[194:195], v6 offset:6400
  v_accvgpr_read_b32 v251, a135
  v_accvgpr_read_b32 v252, a152
  v_mfma_f32_16x16x32_bf16 v[64:67], v[200:203], a[4:7], v[64:67]
  s_add_u32 s39, s94, 0x8000
  v_accvgpr_read_b32 v253, a153
  v_accvgpr_read_b32 v254, a154
  v_mfma_f32_16x16x32_bf16 v[32:35], v[200:203], a[0:3], v[32:35]
  buffer_load_dwordx4 v15, s[68:71], s39 offen offset:0 lds
  v_accvgpr_read_b32 v255, a155
  v_mul_f32 v248, v23, v248
  v_mfma_f32_16x16x32_bf16 v[36:39], v[204:207], a[0:3], v[36:39]
  ds_write_b128 v236, a[84:87] offset:1024
  v_mul_f32 v249, v23, v249
  v_mul_f32 v250, v23, v250
  s_waitcnt lgkmcnt(7)
  v_mfma_f32_16x16x32_bf16 v[24:27], v[184:187], a[40:43], v[24:27]
  ds_read_b64_tr_b16 v[196:197], v6 offset:4360
  v_mul_f32 v251, v23, v251
  v_mul_f32 v252, v23, v252
  v_mul_f32 v253, v23, v253
  s_waitcnt lgkmcnt(5)
  v_mfma_f32_16x16x32_bf16 v[28:31], v[188:191], a[40:43], v[28:31]
  v_mul_f32 v254, v23, v254
  v_mul_f32 v255, v23, v255
  v_mfma_f32_16x16x32_bf16 v[60:63], v[188:191], a[44:47], v[60:63]
  ds_read_b64_tr_b16 v[198:199], v6 offset:6408
  v_cvt_pk_bf16_f32 v224, v248, v249
  v_cvt_pk_bf16_f32 v225, v250, v251
  v_mfma_f32_16x16x32_bf16 v[56:59], v[184:187], a[44:47], v[56:59]
  v_cvt_pk_bf16_f32 v226, v252, v253
  v_cvt_pk_bf16_f32 v227, v254, v255
  v_mfma_f32_16x16x32_bf16 v[88:91], v[184:187], a[48:51], v[88:91]
  ds_write_b128 v236, a[88:91] offset:2048
  v_accvgpr_write_b32 a132, v224
  v_accvgpr_write_b32 a133, v225
  v_mfma_f32_16x16x32_bf16 v[92:95], v[188:191], a[48:51], v[92:95]
  ds_read_b64_tr_b16 v[200:201], v6 offset:8192
  v_accvgpr_write_b32 a134, v226
  v_accvgpr_write_b32 a135, v227
  v_accvgpr_read_b32 v248, a136
  v_mfma_f32_16x16x32_bf16 v[124:127], v[188:191], a[52:55], v[124:127]
  ds_read_b64_tr_b16 v[202:203], v6 offset:10240
  v_accvgpr_read_b32 v249, a137
  v_accvgpr_read_b32 v250, a138
  v_mfma_f32_16x16x32_bf16 v[120:123], v[184:187], a[52:55], v[120:123]
  v_accvgpr_read_b32 v251, a139
  v_accvgpr_read_b32 v252, a156
  v_mfma_f32_16x16x32_bf16 v[152:155], v[184:187], a[56:59], v[152:155]
  buffer_load_dwordx4 v16, s[68:71], s39 offen offset:1024 lds
  v_accvgpr_read_b32 v253, a157
  v_accvgpr_read_b32 v254, a158
  v_mfma_f32_16x16x32_bf16 v[156:159], v[188:191], a[56:59], v[156:159]
  ds_write_b128 v236, a[92:95] offset:3072
  v_accvgpr_read_b32 v255, a159
  v_mul_f32 v248, v0, v248
  s_waitcnt lgkmcnt(7)
  v_mfma_f32_16x16x32_bf16 v[160:163], v[192:195], a[56:59], v[160:163]
  ds_read_b64_tr_b16 v[204:205], v6 offset:8200
  v_mul_f32 v249, v0, v249
  v_mul_f32 v250, v0, v250
  s_waitcnt lgkmcnt(5)
  v_mfma_f32_16x16x32_bf16 v[164:167], v[196:199], a[56:59], v[164:167]
  v_mul_f32 v251, v0, v251
  v_mul_f32 v252, v0, v252
  v_mul_f32 v253, v0, v253
  v_mfma_f32_16x16x32_bf16 v[132:135], v[196:199], a[52:55], v[132:135]
  ds_read_b64_tr_b16 v[206:207], v6 offset:10248
  v_mul_f32 v254, v0, v254
  v_mul_f32 v255, v0, v255
  v_mfma_f32_16x16x32_bf16 v[128:131], v[192:195], a[52:55], v[128:131]
  buffer_load_dwordx4 v17, s[68:71], s39 offen offset:2048 lds
  v_cvt_pk_bf16_f32 v228, v248, v249
  v_cvt_pk_bf16_f32 v229, v250, v251
  v_mfma_f32_16x16x32_bf16 v[96:99], v[192:195], a[48:51], v[96:99]
  ds_write_b128 v236, a[96:99] offset:4096
  v_cvt_pk_bf16_f32 v230, v252, v253
  v_cvt_pk_bf16_f32 v231, v254, v255
  v_mfma_f32_16x16x32_bf16 v[100:103], v[196:199], a[48:51], v[100:103]
  ds_read_b64_tr_b16 v[184:185], v6 offset:8448
  v_accvgpr_write_b32 a136, v228
  v_accvgpr_write_b32 a137, v229
  v_mfma_f32_16x16x32_bf16 v[68:71], v[196:199], a[44:47], v[68:71]
  ds_read_b64_tr_b16 v[186:187], v6 offset:10496
  v_accvgpr_write_b32 a138, v230
  v_accvgpr_write_b32 a139, v231
  v_mfma_f32_16x16x32_bf16 v[64:67], v[192:195], a[44:47], v[64:67]
  ds_write_b128 v237, a[120:123] offset:0
  v_mov_b32 v208, s96
  v_mfma_f32_16x16x32_bf16 v[32:35], v[192:195], a[40:43], v[32:35]
  v_mfma_f32_16x16x32_bf16 v[36:39], v[196:199], a[40:43], v[36:39]
  s_waitcnt lgkmcnt(4)
  v_mfma_f32_16x16x32_bf16 v[24:27], v[200:203], a[80:83], v[24:27]
  ds_read_b64_tr_b16 v[188:189], v6 offset:8456
  v_mfma_f32_16x16x32_bf16 v[28:31], v[204:207], a[80:83], v[28:31]
  ds_read_b64_tr_b16 v[190:191], v6 offset:10504
  v_mov_b32 v209, s96
  v_mfma_f32_16x16x32_bf16 v[60:63], v[204:207], a[84:87], v[60:63]
  ds_write_b128 v237, a[124:127] offset:1024
  s_add_u32 s94, s94, 0x100000
  v_mfma_f32_16x16x32_bf16 v[56:59], v[200:203], a[84:87], v[56:59]
  buffer_load_dwordx4 v18, s[68:71], s39 offen offset:3072 lds
  v_mfma_f32_16x16x32_bf16 v[88:91], v[200:203], a[88:91], v[88:91]
  v_mfma_f32_16x16x32_bf16 v[92:95], v[204:207], a[88:91], v[92:95]
  ds_read_b64_tr_b16 v[192:193], v6 offset:12288
  v_mfma_f32_16x16x32_bf16 v[124:127], v[204:207], a[92:95], v[124:127]
  ds_write_b128 v237, a[128:131] offset:2048
  v_min_u32 v211, 16, v19
  v_mfma_f32_16x16x32_bf16 v[120:123], v[200:203], a[92:95], v[120:123]
  ds_read_b64_tr_b16 v[194:195], v6 offset:14336
  v_mfma_f32_16x16x32_bf16 v[152:155], v[200:203], a[96:99], v[152:155]
  v_mfma_f32_16x16x32_bf16 v[156:159], v[204:207], a[96:99], v[156:159]
  ds_write_b128 v237, a[132:135] offset:3072
  s_waitcnt lgkmcnt(5)
  v_mfma_f32_16x16x32_bf16 v[160:163], v[184:187], a[96:99], v[160:163]
  ds_read_b64_tr_b16 v[196:197], v6 offset:12296
  v_mfma_f32_16x16x32_bf16 v[164:167], v[188:191], a[96:99], v[164:167]
  ds_read_b64_tr_b16 v[198:199], v6 offset:14344
  v_lshlrev_b32 v211, 26, v211
  v_mfma_f32_16x16x32_bf16 v[132:135], v[188:191], a[92:95], v[132:135]
  ds_read_b64_tr_b16 v[200:201], v6 offset:12544
  v_mfma_f32_16x16x32_bf16 v[128:131], v[184:187], a[92:95], v[128:131]
  ds_read_b64_tr_b16 v[202:203], v6 offset:14592
  v_mfma_f32_16x16x32_bf16 v[96:99], v[184:187], a[88:91], v[96:99]
  ds_write_b128 v237, a[136:139] offset:4096
  v_mfma_f32_16x16x32_bf16 v[100:103], v[188:191], a[88:91], v[100:103]
  ds_read_b64_tr_b16 v[204:205], v6 offset:12552
  v_mfma_f32_16x16x32_bf16 v[68:71], v[188:191], a[84:87], v[68:71]
  ds_read_b64_tr_b16 v[206:207], v6 offset:14600
  s_add_u32 s30, s29, s31
  v_mfma_f32_16x16x32_bf16 v[64:67], v[184:187], a[84:87], v[64:67]
  s_add_u32 s29, s29, 53248
  v_mfma_f32_16x16x32_bf16 v[32:35], v[184:187], a[80:83], v[32:35]
  s_cmp_eq_u32 s29, 159744
  s_cselect_b32 s29, 0, s29
  v_mfma_f32_16x16x32_bf16 v[36:39], v[188:191], a[80:83], v[36:39]
  s_waitcnt lgkmcnt(5)
  v_mfma_f32_16x16x32_bf16 v[24:27], v[192:195], a[120:123], v[24:27]
  v_add_u32 v6, s29, v244
  v_mfma_f32_16x16x32_bf16 v[28:31], v[196:199], a[120:123], v[28:31]
  v_mfma_f32_16x16x32_bf16 v[60:63], v[196:199], a[124:127], v[60:63]
  v_mfma_f32_16x16x32_bf16 v[56:59], v[192:195], a[124:127], v[56:59]
  v_mfma_f32_16x16x32_bf16 v[88:91], v[192:195], a[128:131], v[88:91]
  s_waitcnt vmcnt(8) lgkmcnt(0)
  s_barrier
  s_add_u32 m0, s30, s31
  v_mfma_f32_16x16x32_bf16 v[92:95], v[196:199], a[128:131], v[92:95]
  ds_read_b64_tr_b16 v[184:185], v6 offset:0
  v_mfma_f32_16x16x32_bf16 v[124:127], v[196:199], a[132:135], v[124:127]
  ds_read_b64_tr_b16 v[186:187], v6 offset:2048
  v_mfma_f32_16x16x32_bf16 v[120:123], v[192:195], a[132:135], v[120:123]
  ds_read_b128 a[100:103], v238 offset:0
  v_mfma_f32_16x16x32_bf16 v[152:155], v[192:195], a[136:139], v[152:155]
  buffer_load_dwordx4 v15, s[68:71], s94 offen offset:0 lds
  v_mfma_f32_16x16x32_bf16 v[156:159], v[196:199], a[136:139], v[156:159]
  ds_read_b128 a[104:107], v238 offset:1024
  v_mfma_f32_16x16x32_bf16 v[160:163], v[200:203], a[136:139], v[160:163]
  ds_read_b128 a[108:111], v238 offset:2048
  v_mfma_f32_16x16x32_bf16 v[164:167], v[204:207], a[136:139], v[164:167]
  ds_read_b64_tr_b16 v[188:189], v6 offset:4096
  v_mfma_f32_16x16x32_bf16 v[132:135], v[204:207], a[132:135], v[132:135]
  ds_read_b64_tr_b16 v[190:191], v6 offset:6144
  v_mfma_f32_16x16x32_bf16 v[128:131], v[200:203], a[132:135], v[128:131]
  ds_read_b128 a[112:115], v238 offset:3072
  v_mfma_f32_16x16x32_bf16 v[96:99], v[200:203], a[128:131], v[96:99]
  buffer_load_dwordx4 v16, s[68:71], s94 offen offset:1024 lds
  v_mfma_f32_16x16x32_bf16 v[100:103], v[204:207], a[128:131], v[100:103]
  ds_read_b128 a[116:119], v238 offset:4096
  v_mfma_f32_16x16x32_bf16 v[68:71], v[204:207], a[124:127], v[68:71]
  ds_read_b128 a[140:143], v239 offset:0
  v_mfma_f32_16x16x32_bf16 v[64:67], v[200:203], a[124:127], v[64:67]
  ds_read_b64_tr_b16 v[192:193], v6 offset:8
  v_mfma_f32_16x16x32_bf16 v[32:35], v[200:203], a[120:123], v[32:35]
  ds_read_b64_tr_b16 v[194:195], v6 offset:2056
  s_lshr_b32 s40, s28, 1
  v_mfma_f32_16x16x32_bf16 v[36:39], v[204:207], a[120:123], v[36:39]
  ds_read_b128 a[144:147], v239 offset:1024
  s_waitcnt lgkmcnt(6)
  v_mfma_f32_16x16x32_bf16 v[24:27], v[184:187], a[20:23], v[24:27]
  ds_read_b128 a[148:151], v239 offset:2048
  v_mfma_f32_16x16x32_bf16 v[24:27], v[188:191], a[60:63], v[24:27]
  ds_read_b128 a[152:155], v239 offset:3072
  s_lshl_b32 s40, s40, 8
  v_mfma_f32_16x16x32_bf16 v[56:59], v[188:191], a[64:67], v[56:59]
  ds_read_b64_tr_b16 v[196:197], v6 offset:4104
  v_mfma_f32_16x16x32_bf16 v[56:59], v[184:187], a[24:27], v[56:59]
  ds_read_b64_tr_b16 v[198:199], v6 offset:6152
  v_mfma_f32_16x16x32_bf16 v[88:91], v[184:187], a[28:31], v[88:91]
  ds_read_b128 a[156:159], v239 offset:4096
  v_add_u32 v244, s40, v244
  v_mfma_f32_16x16x32_bf16 v[88:91], v[188:191], a[68:71], v[88:91]
  buffer_load_dwordx4 v17, s[68:71], s94 offen offset:2048 lds
  v_mfma_f32_16x16x32_bf16 v[120:123], v[188:191], a[72:75], v[120:123]
  ds_read_b64_tr_b16 v[200:201], v6 offset:8192
  v_mfma_f32_16x16x32_bf16 v[120:123], v[184:187], a[32:35], v[120:123]
  ds_read_b64_tr_b16 v[202:203], v6 offset:10240
  v_mfma_f32_16x16x32_bf16 v[152:155], v[184:187], a[36:39], v[152:155]
  buffer_load_dwordx4 v18, s[68:71], s94 offen offset:3072 lds
  v_mfma_f32_16x16x32_bf16 v[152:155], v[188:191], a[76:79], v[152:155]
  s_waitcnt lgkmcnt(3)
  v_mfma_f32_16x16x32_bf16 v[156:159], v[192:195], a[36:39], v[156:159]
  ds_read_b64_tr_b16 v[204:205], v6 offset:12288
  v_mfma_f32_16x16x32_bf16 v[156:159], v[196:199], a[76:79], v[156:159]
  ds_read_b64_tr_b16 v[206:207], v6 offset:14336
  v_mfma_f32_16x16x32_bf16 v[124:127], v[196:199], a[72:75], v[124:127]
  v_mfma_f32_16x16x32_bf16 v[124:127], v[192:195], a[32:35], v[124:127]
  s_add_u32 m0, m0, 0x1000
  s_add_u32 s39, s94, 0x8000
  v_mfma_f32_16x16x32_bf16 v[92:95], v[192:195], a[28:31], v[92:95]
  v_mfma_f32_16x16x32_bf16 v[92:95], v[196:199], a[68:71], v[92:95]
  ds_read_b64_tr_b16 v[184:185], v6 offset:8200
  v_mfma_f32_16x16x32_bf16 v[60:63], v[196:199], a[64:67], v[60:63]
  ds_read_b64_tr_b16 v[186:187], v6 offset:10248
  s_lshr_b32 s40, s28, 1
  v_mfma_f32_16x16x32_bf16 v[60:63], v[192:195], a[24:27], v[60:63]
  v_mfma_f32_16x16x32_bf16 v[28:31], v[192:195], a[20:23], v[28:31]
  buffer_load_dwordx4 v15, s[68:71], s39 offen offset:0 lds
  v_mfma_f32_16x16x32_bf16 v[28:31], v[196:199], a[60:63], v[28:31]
  s_waitcnt lgkmcnt(2)
  s_add_u32 s91, s88, s40
  v_mfma_f32_16x16x32_bf16 v[24:27], v[200:203], a[100:103], v[24:27]
  ds_read_b64_tr_b16 v[188:189], v6 offset:12296
  s_add_u32 s91, s91, 1
  v_mfma_f32_16x16x32_bf16 v[24:27], v[204:207], a[140:143], v[24:27]
  ds_read_b64_tr_b16 v[190:191], v6 offset:14344
  s_and_b32 s91, s91, 7
  v_mfma_f32_16x16x32_bf16 v[56:59], v[204:207], a[144:147], v[56:59]
  v_mfma_f32_16x16x32_bf16 v[56:59], v[200:203], a[104:107], v[56:59]
  s_mul_i32 s38, s91, 163840
  v_mfma_f32_16x16x32_bf16 v[88:91], v[200:203], a[108:111], v[88:91]
  v_mfma_f32_16x16x32_bf16 v[88:91], v[204:207], a[148:151], v[88:91]
  ds_read_b64_tr_b16 v[192:193], v6 offset:256
  s_add_u32 s38, s38, s89
  v_mfma_f32_16x16x32_bf16 v[120:123], v[204:207], a[152:155], v[120:123]
  ds_read_b64_tr_b16 v[194:195], v6 offset:2304
  s_lshl_b32 s91, s91, 11
  v_mfma_f32_16x16x32_bf16 v[120:123], v[200:203], a[112:115], v[120:123]
  v_mfma_f32_16x16x32_bf16 v[152:155], v[200:203], a[116:119], v[152:155]
  buffer_load_dwordx4 v16, s[68:71], s39 offen offset:1024 lds
  v_mfma_f32_16x16x32_bf16 v[152:155], v[204:207], a[156:159], v[152:155]
  s_waitcnt lgkmcnt(2)
  s_add_u32 s91, s91, s90
  v_mfma_f32_16x16x32_bf16 v[156:159], v[184:187], a[116:119], v[156:159]
  ds_read_b64_tr_b16 v[196:197], v6 offset:4352
  s_lshl_b32 s4, s40, 8
  v_mfma_f32_16x16x32_bf16 v[156:159], v[188:191], a[156:159], v[156:159]
  ds_read_b64_tr_b16 v[198:199], v6 offset:6400
  s_add_u32 s91, s91, s4
  v_mfma_f32_16x16x32_bf16 v[124:127], v[188:191], a[152:155], v[124:127]
  v_mfma_f32_16x16x32_bf16 v[124:127], v[184:187], a[112:115], v[124:127]
  buffer_load_dwordx4 v17, s[68:71], s39 offen offset:2048 lds
  v_mfma_f32_16x16x32_bf16 v[92:95], v[184:187], a[108:111], v[92:95]
  s_mul_i32 s40, s40, 20480
  v_mfma_f32_16x16x32_bf16 v[92:95], v[188:191], a[148:151], v[92:95]
  ds_read_b64_tr_b16 v[200:201], v6 offset:264
  s_add_u32 s38, s38, s40
  v_mfma_f32_16x16x32_bf16 v[60:63], v[188:191], a[144:147], v[60:63]
  ds_read_b64_tr_b16 v[202:203], v6 offset:2312
  v_mfma_f32_16x16x32_bf16 v[60:63], v[184:187], a[104:107], v[60:63]
  v_mfma_f32_16x16x32_bf16 v[28:31], v[184:187], a[100:103], v[28:31]
  v_mfma_f32_16x16x32_bf16 v[28:31], v[188:191], a[140:143], v[28:31]
  s_waitcnt lgkmcnt(2)
  v_mfma_f32_16x16x32_bf16 v[32:35], v[192:195], a[20:23], v[32:35]
  ds_read_b64_tr_b16 v[204:205], v6 offset:4360
  v_mfma_f32_16x16x32_bf16 v[32:35], v[196:199], a[60:63], v[32:35]
  ds_read_b64_tr_b16 v[206:207], v6 offset:6408
  v_cvt_pk_bf16_f32 v52, v24, v25
  v_mfma_f32_16x16x32_bf16 v[64:67], v[196:199], a[64:67], v[64:67]
  s_add_u32 s94, s88, 4
  s_and_b32 s94, s94, 7
  s_lshl_b32 s94, s94, 7
  v_mfma_f32_16x16x32_bf16 v[64:67], v[192:195], a[24:27], v[64:67]
  buffer_load_dwordx4 v18, s[68:71], s39 offen offset:3072 lds
  v_mfma_f32_16x16x32_bf16 v[96:99], v[192:195], a[28:31], v[96:99]
  s_add_u32 s94, s94, s100
  v_cvt_pk_bf16_f32 v53, v26, v27
  v_cvt_pk_bf16_f32 v54, v28, v29
  v_mfma_f32_16x16x32_bf16 v[96:99], v[196:199], a[68:71], v[96:99]
  ds_read_b64_tr_b16 v[184:185], v6 offset:8448
  v_mfma_f32_16x16x32_bf16 v[128:131], v[196:199], a[72:75], v[128:131]
  ds_read_b64_tr_b16 v[186:187], v6 offset:10496
  v_cvt_pk_bf16_f32 v55, v30, v31
  v_mfma_f32_16x16x32_bf16 v[128:131], v[192:195], a[32:35], v[128:131]
  v_cvt_pk_bf16_f32 v84, v56, v57
  v_mfma_f32_16x16x32_bf16 v[160:163], v[192:195], a[36:39], v[160:163]
  v_mfma_f32_16x16x32_bf16 v[160:163], v[196:199], a[76:79], v[160:163]
  s_waitcnt lgkmcnt(2)
  v_cvt_pk_bf16_f32 v85, v58, v59
  v_mfma_f32_16x16x32_bf16 v[164:167], v[200:203], a[36:39], v[164:167]
  ds_read_b64_tr_b16 v[188:189], v6 offset:12544
  v_cvt_pk_bf16_f32 v86, v60, v61
  v_mfma_f32_16x16x32_bf16 v[164:167], v[204:207], a[76:79], v[164:167]
  ds_read_b64_tr_b16 v[190:191], v6 offset:14592
  v_mfma_f32_16x16x32_bf16 v[132:135], v[204:207], a[72:75], v[132:135]
  ds_read_b64_tr_b16 v[192:193], v6 offset:8456
  v_cvt_pk_bf16_f32 v87, v62, v63
  v_mfma_f32_16x16x32_bf16 v[132:135], v[200:203], a[32:35], v[132:135]
  buffer_store_dwordx4 v[52:55], v19, s[24:27], s38 offen offset:0 sc1
  v_mfma_f32_16x16x32_bf16 v[100:103], v[200:203], a[28:31], v[100:103]
  ds_read_b64_tr_b16 v[194:195], v6 offset:10504
  v_cvt_pk_bf16_f32 v116, v88, v89
  v_mfma_f32_16x16x32_bf16 v[100:103], v[204:207], a[68:71], v[100:103]
  ds_read_b64_tr_b16 v[196:197], v6 offset:12552
  v_cvt_pk_bf16_f32 v117, v90, v91
  v_mfma_f32_16x16x32_bf16 v[68:71], v[204:207], a[64:67], v[68:71]
  ds_read_b64_tr_b16 v[198:199], v6 offset:14600
  v_cvt_pk_bf16_f32 v118, v92, v93
  v_mfma_f32_16x16x32_bf16 v[68:71], v[200:203], a[24:27], v[68:71]
  s_add_u32 s30, s29, s31
  s_add_u32 s29, s29, 53248
  v_mfma_f32_16x16x32_bf16 v[36:39], v[200:203], a[20:23], v[36:39]
  s_cmp_eq_u32 s29, 159744
  v_cvt_pk_bf16_f32 v119, v94, v95
  s_cselect_b32 s29, 0, s29
  v_mfma_f32_16x16x32_bf16 v[36:39], v[204:207], a[60:63], v[36:39]
  s_waitcnt lgkmcnt(4)
  v_cvt_pk_bf16_f32 v148, v120, v121
  v_mfma_f32_16x16x32_bf16 v[32:35], v[184:187], a[100:103], v[32:35]
  v_add_u32 v6, s29, v244
  v_mfma_f32_16x16x32_bf16 v[32:35], v[188:191], a[140:143], v[32:35]
  v_add_u32 v7, s101, v6
  v_cvt_pk_bf16_f32 v149, v122, v123
  v_mfma_f32_16x16x32_bf16 v[64:67], v[188:191], a[144:147], v[64:67]
  v_cvt_pk_bf16_f32 v150, v124, v125
  v_mfma_f32_16x16x32_bf16 v[64:67], v[184:187], a[104:107], v[64:67]
  v_mfma_f32_16x16x32_bf16 v[96:99], v[184:187], a[108:111], v[96:99]
  buffer_store_dwordx4 v[84:87], v19, s[24:27], s38 offen offset:1024 sc1
  v_mfma_f32_16x16x32_bf16 v[96:99], v[188:191], a[148:151], v[96:99]
  s_waitcnt vmcnt(10) lgkmcnt(0)
  s_barrier
  v_cvt_pk_bf16_f32 v151, v126, v127
  v_cvt_pk_bf16_f32 v180, v152, v153
  v_mfma_f32_16x16x32_bf16 v[128:131], v[188:191], a[152:155], v[128:131]
  ds_read_b64_tr_b16 v[200:201], v6 offset:0
  s_add_u32 m0, s30, s31
  v_mfma_f32_16x16x32_bf16 v[128:131], v[184:187], a[112:115], v[128:131]
  ds_read_b64_tr_b16 v[202:203], v6 offset:2048
  v_cvt_pk_bf16_f32 v181, v154, v155
  v_mfma_f32_16x16x32_bf16 v[160:163], v[184:187], a[116:119], v[160:163]
  buffer_load_dwordx4 v15, s[68:71], s94 offen offset:0 lds
  v_mfma_f32_16x16x32_bf16 v[160:163], v[188:191], a[156:159], v[160:163]
  v_cvt_pk_bf16_f32 v182, v156, v157
  v_mfma_f32_16x16x32_bf16 v[164:167], v[192:195], a[116:119], v[164:167]
  ds_read_b64_tr_b16 v[204:205], v6 offset:4096
  v_cvt_pk_bf16_f32 v183, v158, v159
  v_mfma_f32_16x16x32_bf16 v[164:167], v[196:199], a[156:159], v[164:167]
  ds_read_b64_tr_b16 v[206:207], v6 offset:6144
  v_mfma_f32_16x16x32_bf16 v[132:135], v[196:199], a[152:155], v[132:135]
  v_mfma_f32_16x16x32_bf16 v[132:135], v[192:195], a[112:115], v[132:135]
  buffer_load_dwordx4 v16, s[68:71], s94 offen offset:1024 lds
  v_mfma_f32_16x16x32_bf16 v[100:103], v[192:195], a[108:111], v[100:103]
  v_mfma_f32_16x16x32_bf16 v[100:103], v[196:199], a[148:151], v[100:103]
  ds_read_b64_tr_b16 v[184:185], v6 offset:8
  v_mfma_f32_16x16x32_bf16 v[68:71], v[196:199], a[144:147], v[68:71]
  buffer_store_dwordx4 v[116:119], v19, s[24:27], s38 offen offset:2048 sc1
  v_mfma_f32_16x16x32_bf16 v[68:71], v[192:195], a[104:107], v[68:71]
  ds_read_b64_tr_b16 v[186:187], v6 offset:2056
  v_mfma_f32_16x16x32_bf16 v[36:39], v[192:195], a[100:103], v[36:39]
  v_mfma_f32_16x16x32_bf16 v[36:39], v[196:199], a[140:143], v[36:39]
  s_waitcnt lgkmcnt(2)
  v_mfma_f32_16x16x32_bf16 v[24:27], v[200:203], a[160:163], 0
  ds_read_b64_tr_b16 v[188:189], v6 offset:4104
  v_mfma_f32_16x16x32_bf16 v[24:27], v[204:207], a[180:183], v[24:27]
  ds_read_b64_tr_b16 v[190:191], v6 offset:6152
  v_mfma_f32_16x16x32_bf16 v[56:59], v[204:207], a[184:187], 0
  v_mfma_f32_16x16x32_bf16 v[56:59], v[200:203], a[164:167], v[56:59]
  buffer_load_dwordx4 v17, s[68:71], s94 offen offset:2048 lds
  v_mfma_f32_16x16x32_bf16 v[88:91], v[200:203], a[168:171], 0
  v_mfma_f32_16x16x32_bf16 v[88:91], v[204:207], a[188:191], v[88:91]
  ds_read_b64_tr_b16 v[192:193], v6 offset:8192
  v_mfma_f32_16x16x32_bf16 v[120:123], v[204:207], a[192:195], 0
  ds_read_b64_tr_b16 v[194:195], v6 offset:10240
  v_mfma_f32_16x16x32_bf16 v[120:123], v[200:203], a[172:175], v[120:123]
  buffer_store_dwordx4 v[148:151], v19, s[24:27], s38 offen offset:3072 sc1
  v_mfma_f32_16x16x32_bf16 v[152:155], v[200:203], a[176:179], 0
  buffer_load_dwordx4 v18, s[68:71], s94 offen offset:3072 lds
  v_mfma_f32_16x16x32_bf16 v[152:155], v[204:207], a[196:199], v[152:155]
  s_waitcnt lgkmcnt(2)
  v_mfma_f32_16x16x32_bf16 v[156:159], v[184:187], a[176:179], 0
  ds_read_b64_tr_b16 v[196:197], v6 offset:12288
  v_mfma_f32_16x16x32_bf16 v[156:159], v[188:191], a[196:199], v[156:159]
  ds_read_b64_tr_b16 v[198:199], v6 offset:14336
  v_mfma_f32_16x16x32_bf16 v[124:127], v[188:191], a[192:195], 0
  v_mfma_f32_16x16x32_bf16 v[124:127], v[184:187], a[172:175], v[124:127]
  s_add_u32 m0, m0, 0x1000
  s_add_u32 s39, s94, 0x8000
  v_mfma_f32_16x16x32_bf16 v[92:95], v[184:187], a[168:171], 0
  v_mfma_f32_16x16x32_bf16 v[92:95], v[188:191], a[188:191], v[92:95]
  ds_read_b64_tr_b16 v[200:201], v6 offset:8200
  s_add_u32 s38, s38, 4096
  v_mfma_f32_16x16x32_bf16 v[60:63], v[188:191], a[184:187], 0
  ds_read_b64_tr_b16 v[202:203], v6 offset:10248
  v_mfma_f32_16x16x32_bf16 v[60:63], v[184:187], a[164:167], v[60:63]
  v_mfma_f32_16x16x32_bf16 v[28:31], v[184:187], a[160:163], 0
  buffer_load_dwordx4 v15, s[68:71], s39 offen offset:0 lds
  v_mfma_f32_16x16x32_bf16 v[28:31], v[188:191], a[180:183], v[28:31]
  s_waitcnt lgkmcnt(2)
  v_mfma_f32_16x16x32_bf16 v[24:27], v[192:195], a[200:203], v[24:27]
  buffer_store_dwordx4 v[180:183], v19, s[24:27], s38 offen offset:0 sc1
  v_mfma_f32_16x16x32_bf16 v[24:27], v[196:199], a[240:243], v[24:27]
  ds_read_b64_tr_b16 v[204:205], v6 offset:12296
  v_cvt_pk_bf16_f32 v224, v32, v33
  v_mfma_f32_16x16x32_bf16 v[56:59], v[196:199], a[244:247], v[56:59]
  ds_read_b64_tr_b16 v[206:207], v6 offset:14344
  s_add_u32 s38, s38, 1024
  v_mfma_f32_16x16x32_bf16 v[56:59], v[192:195], a[204:207], v[56:59]
  v_mfma_f32_16x16x32_bf16 v[88:91], v[192:195], a[208:211], v[88:91]
  v_cvt_pk_bf16_f32 v225, v34, v35
  v_mfma_f32_16x16x32_bf16 v[88:91], v[196:199], a[248:251], v[88:91]
  ds_read_b64_tr_b16 v[184:185], v7 offset:0
  v_mfma_f32_16x16x32_bf16 v[120:123], v[196:199], a[252:255], v[120:123]
  ds_read_b64_tr_b16 v[186:187], v7 offset:2048
  v_cvt_pk_bf16_f32 v226, v36, v37
  v_mfma_f32_16x16x32_bf16 v[120:123], v[192:195], a[212:215], v[120:123]
  v_mfma_f32_16x16x32_bf16 v[152:155], v[192:195], a[216:219], v[152:155]
  buffer_load_dwordx4 v16, s[68:71], s39 offen offset:1024 lds
  v_mfma_f32_16x16x32_bf16 v[152:155], v[196:199], v[240:243], v[152:155]
  s_waitcnt lgkmcnt(2)
  v_cvt_pk_bf16_f32 v227, v38, v39
  v_mfma_f32_16x16x32_bf16 v[156:159], v[200:203], a[216:219], v[156:159]
  ds_read_b64_tr_b16 v[188:189], v7 offset:4096
  v_mfma_f32_16x16x32_bf16 v[156:159], v[204:207], v[240:243], v[156:159]
  ds_read_b64_tr_b16 v[190:191], v7 offset:6144
  v_mfma_f32_16x16x32_bf16 v[124:127], v[204:207], a[252:255], v[124:127]
  v_mfma_f32_16x16x32_bf16 v[124:127], v[200:203], a[212:215], v[124:127]
  buffer_store_dwordx4 v[224:227], v19, s[24:27], s38 offen offset:0 sc1
  v_mfma_f32_16x16x32_bf16 v[92:95], v[200:203], a[208:211], v[92:95]
  buffer_load_dwordx4 v17, s[68:71], s39 offen offset:2048 lds
  v_mfma_f32_16x16x32_bf16 v[92:95], v[204:207], a[248:251], v[92:95]
  ds_read_b64_tr_b16 v[192:193], v7 offset:8
  v_cvt_pk_bf16_f32 v216, v64, v65
  v_mfma_f32_16x16x32_bf16 v[60:63], v[204:207], a[244:247], v[60:63]
  ds_read_b64_tr_b16 v[194:195], v7 offset:2056
  v_cvt_pk_bf16_f32 v217, v66, v67
  v_mfma_f32_16x16x32_bf16 v[60:63], v[200:203], a[204:207], v[60:63]
  v_cvt_pk_bf16_f32 v218, v68, v69
  v_mfma_f32_16x16x32_bf16 v[28:31], v[200:203], a[200:203], v[28:31]
  v_mfma_f32_16x16x32_bf16 v[28:31], v[204:207], a[240:243], v[28:31]
  s_waitcnt lgkmcnt(2)
  v_cvt_pk_bf16_f32 v219, v70, v71
  v_mfma_f32_16x16x32_bf16 v[24:27], v[184:187], v[40:43], v[24:27]
  ds_read_b64_tr_b16 v[196:197], v7 offset:4104
  v_mfma_f32_16x16x32_bf16 v[24:27], v[188:191], v[44:47], v[24:27]
  ds_read_b64_tr_b16 v[198:199], v7 offset:6152
  s_add_u32 s94, s94, 0x100000
  v_mfma_f32_16x16x32_bf16 v[56:59], v[188:191], v[76:79], v[56:59]
  v_mfma_f32_16x16x32_bf16 v[56:59], v[184:187], v[72:75], v[56:59]
  buffer_load_dwordx4 v18, s[68:71], s39 offen offset:3072 lds
  v_mfma_f32_16x16x32_bf16 v[88:91], v[184:187], v[104:107], v[88:91]
  buffer_store_dwordx4 v[216:219], v19, s[24:27], s38 offen offset:1024 sc1
  v_mfma_f32_16x16x32_bf16 v[88:91], v[188:191], v[108:111], v[88:91]
  ds_read_b64_tr_b16 v[200:201], v7 offset:8192
  v_cvt_pk_bf16_f32 v220, v96, v97
  v_mfma_f32_16x16x32_bf16 v[120:123], v[188:191], v[140:143], v[120:123]
  ds_read_b64_tr_b16 v[202:203], v7 offset:10240
  v_cvt_pk_bf16_f32 v221, v98, v99
  v_mfma_f32_16x16x32_bf16 v[120:123], v[184:187], v[136:139], v[120:123]
  v_mfma_f32_16x16x32_bf16 v[152:155], v[184:187], v[168:171], v[152:155]
  v_cvt_pk_bf16_f32 v222, v100, v101
  v_mfma_f32_16x16x32_bf16 v[152:155], v[188:191], v[172:175], v[152:155]
  s_waitcnt lgkmcnt(2)
  v_mfma_f32_16x16x32_bf16 v[156:159], v[192:195], v[168:171], v[156:159]
  ds_read_b64_tr_b16 v[204:205], v7 offset:12288
  v_cvt_pk_bf16_f32 v223, v102, v103
  v_mfma_f32_16x16x32_bf16 v[156:159], v[196:199], v[172:175], v[156:159]
  ds_read_b64_tr_b16 v[206:207], v7 offset:14336
  v_mfma_f32_16x16x32_bf16 v[124:127], v[196:199], v[140:143], v[124:127]
  ds_read_b64_tr_b16 v[184:185], v7 offset:8200
  v_mfma_f32_16x16x32_bf16 v[124:127], v[192:195], v[136:139], v[124:127]
  ds_read_b64_tr_b16 v[186:187], v7 offset:10248
  v_mfma_f32_16x16x32_bf16 v[92:95], v[192:195], v[104:107], v[92:95]
  v_mfma_f32_16x16x32_bf16 v[92:95], v[196:199], v[108:111], v[92:95]
  ds_read_b64_tr_b16 v[188:189], v7 offset:12296
  v_cvt_pk_bf16_f32 v224, v128, v129
  v_mfma_f32_16x16x32_bf16 v[60:63], v[196:199], v[76:79], v[60:63]
  buffer_store_dwordx4 v[220:223], v19, s[24:27], s38 offen offset:2048 sc1
  v_mfma_f32_16x16x32_bf16 v[60:63], v[192:195], v[72:75], v[60:63]
  ds_read_b64_tr_b16 v[190:191], v7 offset:14344
  v_cvt_pk_bf16_f32 v225, v130, v131
  v_mfma_f32_16x16x32_bf16 v[28:31], v[192:195], v[40:43], v[28:31]
  s_add_u32 s30, s29, s31
  s_add_u32 s29, s29, 53248
  s_cmp_eq_u32 s29, 159744
  v_mfma_f32_16x16x32_bf16 v[28:31], v[196:199], v[44:47], v[28:31]
  s_waitcnt lgkmcnt(4)
  v_cvt_pk_bf16_f32 v226, v132, v133
  v_mfma_f32_16x16x32_bf16 v[24:27], v[200:203], v[48:51], v[24:27]
  s_cselect_b32 s29, 0, s29
  v_add_u32 v6, s29, v244
  v_mfma_f32_16x16x32_bf16 v[24:27], v[204:207], a[220:223], v[24:27]
  v_add_u32 v7, s101, v6
  v_cvt_pk_bf16_f32 v227, v134, v135
  v_mfma_f32_16x16x32_bf16 v[56:59], v[204:207], a[224:227], v[56:59]
  v_mfma_f32_16x16x32_bf16 v[56:59], v[200:203], v[80:83], v[56:59]
  v_mfma_f32_16x16x32_bf16 v[88:91], v[200:203], v[112:115], v[88:91]
  s_waitcnt vmcnt(16) lgkmcnt(0)
  s_barrier
  s_add_u32 m0, s30, s31
  v_mfma_f32_16x16x32_bf16 v[88:91], v[204:207], a[228:231], v[88:91]
  ds_read_b64_tr_b16 v[192:193], v6 offset:0
  v_mfma_f32_16x16x32_bf16 v[120:123], v[204:207], a[232:235], v[120:123]
  ds_read_b64_tr_b16 v[194:195], v6 offset:2048
  v_cvt_pk_bf16_f32 v216, v160, v161
  v_mfma_f32_16x16x32_bf16 v[120:123], v[200:203], v[144:147], v[120:123]
  buffer_store_dwordx4 v[224:227], v19, s[24:27], s38 offen offset:3072 sc1
  v_mfma_f32_16x16x32_bf16 v[152:155], v[200:203], v[176:179], v[152:155]
  buffer_load_dwordx4 v15, s[68:71], s94 offen offset:0 lds
  v_mfma_f32_16x16x32_bf16 v[152:155], v[204:207], a[236:239], v[152:155]
  v_cvt_pk_bf16_f32 v217, v162, v163
  v_mfma_f32_16x16x32_bf16 v[156:159], v[184:187], v[176:179], v[156:159]
  ds_read_b64_tr_b16 v[196:197], v6 offset:4096
  v_cvt_pk_bf16_f32 v218, v164, v165
  v_mfma_f32_16x16x32_bf16 v[156:159], v[188:191], a[236:239], v[156:159]
  ds_read_b64_tr_b16 v[198:199], v6 offset:6144
  v_mfma_f32_16x16x32_bf16 v[124:127], v[188:191], a[232:235], v[124:127]
  v_mfma_f32_16x16x32_bf16 v[124:127], v[184:187], v[144:147], v[124:127]
  buffer_load_dwordx4 v16, s[68:71], s94 offen offset:1024 lds
  v_mfma_f32_16x16x32_bf16 v[92:95], v[184:187], v[112:115], v[92:95]
  v_cvt_pk_bf16_f32 v219, v166, v167
  v_mfma_f32_16x16x32_bf16 v[92:95], v[188:191], a[228:231], v[92:95]
  ds_read_b64_tr_b16 v[200:201], v6 offset:8
  s_add_u32 s38, s38, 4096
  v_mfma_f32_16x16x32_bf16 v[60:63], v[188:191], a[224:227], v[60:63]
  ds_read_b64_tr_b16 v[202:203], v6 offset:2056
  v_mfma_f32_16x16x32_bf16 v[60:63], v[184:187], v[80:83], v[60:63]
  v_mfma_f32_16x16x32_bf16 v[28:31], v[184:187], v[48:51], v[28:31]
  v_mfma_f32_16x16x32_bf16 v[28:31], v[188:191], a[220:223], v[28:31]
  s_waitcnt lgkmcnt(2)
  v_mfma_f32_16x16x32_bf16 v[24:27], v[192:195], a[0:3], v[24:27]
  buffer_store_dwordx4 v[216:219], v19, s[24:27], s38 offen offset:0 sc1
  v_mfma_f32_16x16x32_bf16 v[24:27], v[196:199], a[40:43], v[24:27]
  ds_read_b64_tr_b16 v[204:205], v6 offset:4104
  s_add_u32 s38, s38, 1024
  v_mfma_f32_16x16x32_bf16 v[56:59], v[196:199], a[44:47], v[56:59]
  ds_read_b64_tr_b16 v[206:207], v6 offset:6152
  v_mfma_f32_16x16x32_bf16 v[56:59], v[192:195], a[4:7], v[56:59]
  buffer_load_dwordx4 v17, s[68:71], s94 offen offset:2048 lds
  v_mfma_f32_16x16x32_bf16 v[88:91], v[192:195], a[8:11], v[88:91]
  v_mfma_f32_16x16x32_bf16 v[88:91], v[196:199], a[48:51], v[88:91]
  ds_read_b64_tr_b16 v[184:185], v6 offset:8192
  v_mfma_f32_16x16x32_bf16 v[120:123], v[196:199], a[52:55], v[120:123]
  ds_read_b64_tr_b16 v[186:187], v6 offset:10240
  v_mfma_f32_16x16x32_bf16 v[120:123], v[192:195], a[12:15], v[120:123]
  v_mfma_f32_16x16x32_bf16 v[152:155], v[192:195], a[16:19], v[152:155]
  buffer_load_dwordx4 v18, s[68:71], s94 offen offset:3072 lds
  v_mfma_f32_16x16x32_bf16 v[152:155], v[196:199], a[56:59], v[152:155]
  s_waitcnt lgkmcnt(2)
  v_mfma_f32_16x16x32_bf16 v[156:159], v[200:203], a[16:19], v[156:159]
  ds_read_b64_tr_b16 v[188:189], v6 offset:12288
  v_mfma_f32_16x16x32_bf16 v[156:159], v[204:207], a[56:59], v[156:159]
  ds_read_b64_tr_b16 v[190:191], v6 offset:14336
  v_mfma_f32_16x16x32_bf16 v[124:127], v[204:207], a[52:55], v[124:127]
  v_mfma_f32_16x16x32_bf16 v[124:127], v[200:203], a[12:15], v[124:127]
  s_add_u32 m0, m0, 0x1000
  s_add_u32 s39, s94, 0x8000
  v_mfma_f32_16x16x32_bf16 v[92:95], v[200:203], a[8:11], v[92:95]
  v_mfma_f32_16x16x32_bf16 v[92:95], v[204:207], a[48:51], v[92:95]
  ds_read_b64_tr_b16 v[192:193], v6 offset:8200
  v_mfma_f32_16x16x32_bf16 v[60:63], v[204:207], a[44:47], v[60:63]
  ds_read_b64_tr_b16 v[194:195], v6 offset:10248
  v_mfma_f32_16x16x32_bf16 v[60:63], v[200:203], a[4:7], v[60:63]
  v_mfma_f32_16x16x32_bf16 v[28:31], v[200:203], a[0:3], v[28:31]
  buffer_load_dwordx4 v15, s[68:71], s39 offen offset:0 lds
  v_mfma_f32_16x16x32_bf16 v[28:31], v[204:207], a[40:43], v[28:31]
  s_waitcnt lgkmcnt(2)
  v_mfma_f32_16x16x32_bf16 v[24:27], v[184:187], a[80:83], v[24:27]
  ds_read_b64_tr_b16 v[196:197], v6 offset:12296
  v_mfma_f32_16x16x32_bf16 v[24:27], v[188:191], a[120:123], v[24:27]
  ds_read_b64_tr_b16 v[198:199], v6 offset:14344
  v_mfma_f32_16x16x32_bf16 v[56:59], v[188:191], a[124:127], v[56:59]
  v_mfma_f32_16x16x32_bf16 v[56:59], v[184:187], a[84:87], v[56:59]
  v_mfma_f32_16x16x32_bf16 v[88:91], v[184:187], a[88:91], v[88:91]
  v_mfma_f32_16x16x32_bf16 v[88:91], v[188:191], a[128:131], v[88:91]
  ds_read_b64_tr_b16 v[200:201], v7 offset:0
  v_mfma_f32_16x16x32_bf16 v[120:123], v[188:191], a[132:135], v[120:123]
  ds_read_b64_tr_b16 v[202:203], v7 offset:2048
  v_mfma_f32_16x16x32_bf16 v[120:123], v[184:187], a[92:95], v[120:123]
  v_mfma_f32_16x16x32_bf16 v[152:155], v[184:187], a[96:99], v[152:155]
  buffer_load_dwordx4 v16, s[68:71], s39 offen offset:1024 lds
  v_mfma_f32_16x16x32_bf16 v[152:155], v[188:191], a[136:139], v[152:155]
  s_waitcnt lgkmcnt(2)
  v_mfma_f32_16x16x32_bf16 v[156:159], v[192:195], a[96:99], v[156:159]
  ds_read_b64_tr_b16 v[204:205], v7 offset:4096
  v_mfma_f32_16x16x32_bf16 v[156:159], v[196:199], a[136:139], v[156:159]
  ds_read_b64_tr_b16 v[206:207], v7 offset:6144
  v_mfma_f32_16x16x32_bf16 v[124:127], v[196:199], a[132:135], v[124:127]
  v_mfma_f32_16x16x32_bf16 v[124:127], v[192:195], a[92:95], v[124:127]
  buffer_load_dwordx4 v17, s[68:71], s39 offen offset:2048 lds
  v_mfma_f32_16x16x32_bf16 v[92:95], v[192:195], a[88:91], v[92:95]
  v_mfma_f32_16x16x32_bf16 v[92:95], v[196:199], a[128:131], v[92:95]
  ds_read_b64_tr_b16 v[184:185], v7 offset:8
  v_mfma_f32_16x16x32_bf16 v[60:63], v[196:199], a[124:127], v[60:63]
  ds_read_b64_tr_b16 v[186:187], v7 offset:2056
  v_mfma_f32_16x16x32_bf16 v[60:63], v[192:195], a[84:87], v[60:63]
  v_mfma_f32_16x16x32_bf16 v[28:31], v[192:195], a[80:83], v[28:31]
  v_mfma_f32_16x16x32_bf16 v[28:31], v[196:199], a[120:123], v[28:31]
  s_waitcnt lgkmcnt(2)
  v_mfma_f32_16x16x32_bf16 v[24:27], v[200:203], a[20:23], v[24:27]
  ds_read_b64_tr_b16 v[188:189], v7 offset:4104
  v_mfma_f32_16x16x32_bf16 v[24:27], v[204:207], a[60:63], v[24:27]
  ds_read_b64_tr_b16 v[190:191], v7 offset:6152
  s_add_u32 s94, s88, 5
  v_mfma_f32_16x16x32_bf16 v[56:59], v[204:207], a[64:67], v[56:59]
  s_and_b32 s94, s94, 7
  s_lshl_b32 s94, s94, 7
  s_add_u32 s94, s94, s100
  v_mfma_f32_16x16x32_bf16 v[56:59], v[200:203], a[24:27], v[56:59]
  buffer_load_dwordx4 v18, s[68:71], s39 offen offset:3072 lds
  v_mfma_f32_16x16x32_bf16 v[88:91], v[200:203], a[28:31], v[88:91]
  v_mfma_f32_16x16x32_bf16 v[88:91], v[204:207], a[68:71], v[88:91]
  ds_read_b64_tr_b16 v[192:193], v7 offset:8192
  v_mfma_f32_16x16x32_bf16 v[120:123], v[204:207], a[72:75], v[120:123]
  ds_read_b64_tr_b16 v[194:195], v7 offset:10240
  v_mfma_f32_16x16x32_bf16 v[120:123], v[200:203], a[32:35], v[120:123]
  v_mfma_f32_16x16x32_bf16 v[152:155], v[200:203], a[36:39], v[152:155]
  v_mfma_f32_16x16x32_bf16 v[152:155], v[204:207], a[76:79], v[152:155]
  s_waitcnt lgkmcnt(2)
  v_mfma_f32_16x16x32_bf16 v[156:159], v[184:187], a[36:39], v[156:159]
  ds_read_b64_tr_b16 v[196:197], v7 offset:12288
  v_mfma_f32_16x16x32_bf16 v[156:159], v[188:191], a[76:79], v[156:159]
  ds_read_b64_tr_b16 v[198:199], v7 offset:14336
  v_mfma_f32_16x16x32_bf16 v[124:127], v[188:191], a[72:75], v[124:127]
  ds_read_b64_tr_b16 v[200:201], v7 offset:8200
  v_mfma_f32_16x16x32_bf16 v[124:127], v[184:187], a[32:35], v[124:127]
  ds_read_b64_tr_b16 v[202:203], v7 offset:10248
  v_mfma_f32_16x16x32_bf16 v[92:95], v[184:187], a[28:31], v[92:95]
  v_mfma_f32_16x16x32_bf16 v[92:95], v[188:191], a[68:71], v[92:95]
  ds_read_b64_tr_b16 v[204:205], v7 offset:12296
  v_mfma_f32_16x16x32_bf16 v[60:63], v[188:191], a[64:67], v[60:63]
  ds_read_b64_tr_b16 v[206:207], v7 offset:14344
  s_add_u32 s30, s29, s31
  v_mfma_f32_16x16x32_bf16 v[60:63], v[184:187], a[24:27], v[60:63]
  s_add_u32 s29, s29, 53248
  v_mfma_f32_16x16x32_bf16 v[28:31], v[184:187], a[20:23], v[28:31]
  s_cmp_eq_u32 s29, 159744
  s_cselect_b32 s29, 0, s29
  v_mfma_f32_16x16x32_bf16 v[28:31], v[188:191], a[60:63], v[28:31]
  s_waitcnt lgkmcnt(4)
  v_mfma_f32_16x16x32_bf16 v[24:27], v[192:195], a[100:103], v[24:27]
  v_add_u32 v6, s29, v244
  v_mfma_f32_16x16x32_bf16 v[24:27], v[196:199], a[140:143], v[24:27]
  v_add_u32 v7, s101, v6
  v_mfma_f32_16x16x32_bf16 v[56:59], v[196:199], a[144:147], v[56:59]
  v_mfma_f32_16x16x32_bf16 v[56:59], v[192:195], a[104:107], v[56:59]
  v_mfma_f32_16x16x32_bf16 v[88:91], v[192:195], a[108:111], v[88:91]
  s_waitcnt vmcnt(12) lgkmcnt(0)
  s_barrier
  s_add_u32 s49, s88, 3
  s_add_u32 m0, s30, s31
  v_mfma_f32_16x16x32_bf16 v[88:91], v[196:199], a[148:151], v[88:91]
  ds_read_b64_tr_b16 v[184:185], v6 offset:0
  s_and_b32 s49, s49, 7
  v_mfma_f32_16x16x32_bf16 v[120:123], v[196:199], a[152:155], v[120:123]
  ds_read_b64_tr_b16 v[186:187], v6 offset:2048
  s_sub_u32 s49, s49, s88
  v_mfma_f32_16x16x32_bf16 v[120:123], v[192:195], a[112:115], v[120:123]
  s_waitcnt vmcnt(6)
  v_mfma_f32_16x16x32_bf16 v[152:155], v[192:195], a[116:119], v[152:155]
  buffer_store_dwordx2 v[208:209], v211, s[24:27], s91 offen sc1
  v_mfma_f32_16x16x32_bf16 v[152:155], v[196:199], a[156:159], v[152:155]
  buffer_load_dwordx4 v15, s[68:71], s94 offen offset:0 lds
  v_mfma_f32_16x16x32_bf16 v[156:159], v[200:203], a[116:119], v[156:159]
  ds_read_b64_tr_b16 v[188:189], v6 offset:4096
  v_mfma_f32_16x16x32_bf16 v[156:159], v[204:207], a[156:159], v[156:159]
  s_mul_i32 s38, s49, 163840
  s_add_u32 s38, s38, s93
  v_mfma_f32_16x16x32_bf16 v[124:127], v[204:207], a[152:155], v[124:127]
  ds_read_b64_tr_b16 v[190:191], v6 offset:6144
  s_add_u32 s38, s38, 40960
  v_mfma_f32_16x16x32_bf16 v[124:127], v[200:203], a[112:115], v[124:127]
  buffer_load_dwordx4 v16, s[68:71], s94 offen offset:1024 lds
  v_mfma_f32_16x16x32_bf16 v[92:95], v[200:203], a[108:111], v[92:95]
  s_lshl_b32 s49, s49, 11
  v_mfma_f32_16x16x32_bf16 v[92:95], v[204:207], a[148:151], v[92:95]
  ds_read_b64_tr_b16 v[192:193], v6 offset:8
  s_add_u32 s49, s49, s48
  v_mfma_f32_16x16x32_bf16 v[60:63], v[204:207], a[144:147], v[60:63]
  ds_read_b64_tr_b16 v[194:195], v6 offset:2056
  v_mfma_f32_16x16x32_bf16 v[60:63], v[200:203], a[104:107], v[60:63]
  v_mfma_f32_16x16x32_bf16 v[28:31], v[200:203], a[100:103], v[28:31]
  v_mfma_f32_16x16x32_bf16 v[28:31], v[204:207], a[140:143], v[28:31]
  s_waitcnt lgkmcnt(2)
  v_mfma_f32_16x16x32_bf16 v[32:35], v[184:187], a[160:163], 0
  ds_read_b64_tr_b16 v[196:197], v6 offset:4104
  v_cvt_pk_bf16_f32 v220, v24, v25
  v_mfma_f32_16x16x32_bf16 v[32:35], v[188:191], a[180:183], v[32:35]
  ds_read_b64_tr_b16 v[198:199], v6 offset:6152
  v_mfma_f32_16x16x32_bf16 v[64:67], v[188:191], a[184:187], 0
  v_mfma_f32_16x16x32_bf16 v[64:67], v[184:187], a[164:167], v[64:67]
  buffer_load_dwordx4 v17, s[68:71], s94 offen offset:2048 lds
  v_mfma_f32_16x16x32_bf16 v[96:99], v[184:187], a[168:171], 0
  v_cvt_pk_bf16_f32 v221, v26, v27
  v_mfma_f32_16x16x32_bf16 v[96:99], v[188:191], a[188:191], v[96:99]
  ds_read_b64_tr_b16 v[200:201], v6 offset:8192
  v_cvt_pk_bf16_f32 v222, v28, v29
  v_mfma_f32_16x16x32_bf16 v[128:131], v[188:191], a[192:195], 0
  ds_read_b64_tr_b16 v[202:203], v6 offset:10240
  v_mfma_f32_16x16x32_bf16 v[128:131], v[184:187], a[172:175], v[128:131]
  v_cvt_pk_bf16_f32 v223, v30, v31
  v_mfma_f32_16x16x32_bf16 v[160:163], v[184:187], a[176:179], 0
  buffer_load_dwordx4 v18, s[68:71], s94 offen offset:3072 lds
  v_mfma_f32_16x16x32_bf16 v[160:163], v[188:191], a[196:199], v[160:163]
  s_waitcnt lgkmcnt(2)
  v_mfma_f32_16x16x32_bf16 v[164:167], v[192:195], a[176:179], 0
  ds_read_b64_tr_b16 v[204:205], v6 offset:12288
  v_mfma_f32_16x16x32_bf16 v[164:167], v[196:199], a[196:199], v[164:167]
  ds_read_b64_tr_b16 v[206:207], v6 offset:14336
  v_mfma_f32_16x16x32_bf16 v[132:135], v[196:199], a[192:195], 0
  buffer_store_dwordx4 v[220:223], v19, s[24:27], s38 offen offset:0 sc1
  v_mfma_f32_16x16x32_bf16 v[132:135], v[192:195], a[172:175], v[132:135]
  s_add_u32 m0, m0, 0x1000
  v_cvt_pk_bf16_f32 v224, v56, v57
  s_add_u32 s39, s94, 0x8000
  v_mfma_f32_16x16x32_bf16 v[100:103], v[192:195], a[168:171], 0
  v_cvt_pk_bf16_f32 v225, v58, v59
  v_mfma_f32_16x16x32_bf16 v[100:103], v[196:199], a[188:191], v[100:103]
  ds_read_b64_tr_b16 v[184:185], v6 offset:8200
  v_mfma_f32_16x16x32_bf16 v[68:71], v[196:199], a[184:187], 0
  ds_read_b64_tr_b16 v[186:187], v6 offset:10248
  v_cvt_pk_bf16_f32 v226, v60, v61
  v_mfma_f32_16x16x32_bf16 v[68:71], v[192:195], a[164:167], v[68:71]
  v_mfma_f32_16x16x32_bf16 v[36:39], v[192:195], a[160:163], 0
  buffer_load_dwordx4 v15, s[68:71], s39 offen offset:0 lds
  v_mfma_f32_16x16x32_bf16 v[36:39], v[196:199], a[180:183], v[36:39]
  s_waitcnt lgkmcnt(2)
  v_cvt_pk_bf16_f32 v227, v62, v63
  v_mfma_f32_16x16x32_bf16 v[32:35], v[200:203], a[200:203], v[32:35]
  ds_read_b64_tr_b16 v[188:189], v6 offset:12296
  v_mfma_f32_16x16x32_bf16 v[32:35], v[204:207], a[240:243], v[32:35]
  ds_read_b64_tr_b16 v[190:191], v6 offset:14344
  v_mfma_f32_16x16x32_bf16 v[64:67], v[204:207], a[244:247], v[64:67]
  v_mfma_f32_16x16x32_bf16 v[64:67], v[200:203], a[204:207], v[64:67]
  buffer_store_dwordx4 v[224:227], v19, s[24:27], s38 offen offset:1024 sc1
  v_mfma_f32_16x16x32_bf16 v[96:99], v[200:203], a[208:211], v[96:99]
  v_cvt_pk_bf16_f32 v216, v88, v89
  v_mfma_f32_16x16x32_bf16 v[96:99], v[204:207], a[248:251], v[96:99]
  ds_read_b64_tr_b16 v[192:193], v7 offset:0
  v_cvt_pk_bf16_f32 v217, v90, v91
  v_mfma_f32_16x16x32_bf16 v[128:131], v[204:207], a[252:255], v[128:131]
  ds_read_b64_tr_b16 v[194:195], v7 offset:2048
  v_mfma_f32_16x16x32_bf16 v[128:131], v[200:203], a[212:215], v[128:131]
  v_cvt_pk_bf16_f32 v218, v92, v93
  v_mfma_f32_16x16x32_bf16 v[160:163], v[200:203], a[216:219], v[160:163]
  buffer_load_dwordx4 v16, s[68:71], s39 offen offset:1024 lds
  v_mfma_f32_16x16x32_bf16 v[160:163], v[204:207], v[240:243], v[160:163]
  s_waitcnt lgkmcnt(2)
  v_cvt_pk_bf16_f32 v219, v94, v95
  v_mfma_f32_16x16x32_bf16 v[164:167], v[184:187], a[216:219], v[164:167]
  ds_read_b64_tr_b16 v[196:197], v7 offset:4096
  v_mfma_f32_16x16x32_bf16 v[164:167], v[188:191], v[240:243], v[164:167]
  ds_read_b64_tr_b16 v[198:199], v7 offset:6144
  v_mfma_f32_16x16x32_bf16 v[132:135], v[188:191], a[252:255], v[132:135]
  v_mfma_f32_16x16x32_bf16 v[132:135], v[184:187], a[212:215], v[132:135]
  buffer_load_dwordx4 v17, s[68:71], s39 offen offset:2048 lds
  v_mfma_f32_16x16x32_bf16 v[100:103], v[184:187], a[208:211], v[100:103]
  v_cvt_pk_bf16_f32 v220, v120, v121
  v_mfma_f32_16x16x32_bf16 v[100:103], v[188:191], a[248:251], v[100:103]
  buffer_store_dwordx4 v[216:219], v19, s[24:27], s38 offen offset:2048 sc1
  v_mfma_f32_16x16x32_bf16 v[68:71], v[188:191], a[244:247], v[68:71]
  ds_read_b64_tr_b16 v[200:201], v7 offset:8
  v_cvt_pk_bf16_f32 v221, v122, v123
  v_mfma_f32_16x16x32_bf16 v[68:71], v[184:187], a[204:207], v[68:71]
  ds_read_b64_tr_b16 v[202:203], v7 offset:2056
  v_mfma_f32_16x16x32_bf16 v[36:39], v[184:187], a[200:203], v[36:39]
  v_cvt_pk_bf16_f32 v222, v124, v125
  v_mfma_f32_16x16x32_bf16 v[36:39], v[188:191], a[240:243], v[36:39]
  s_waitcnt lgkmcnt(2)
  v_mfma_f32_16x16x32_bf16 v[32:35], v[192:195], v[40:43], v[32:35]
  ds_read_b64_tr_b16 v[204:205], v7 offset:4104
  v_cvt_pk_bf16_f32 v223, v126, v127
  v_mfma_f32_16x16x32_bf16 v[32:35], v[196:199], v[44:47], v[32:35]
  ds_read_b64_tr_b16 v[206:207], v7 offset:6152
  s_add_u32 s94, s94, 0x100000
  v_mfma_f32_16x16x32_bf16 v[64:67], v[196:199], v[76:79], v[64:67]
  v_mfma_f32_16x16x32_bf16 v[64:67], v[192:195], v[72:75], v[64:67]
  buffer_load_dwordx4 v18, s[68:71], s39 offen offset:3072 lds
  v_mfma_f32_16x16x32_bf16 v[96:99], v[192:195], v[104:107], v[96:99]
  v_mfma_f32_16x16x32_bf16 v[96:99], v[196:199], v[108:111], v[96:99]
  ds_read_b64_tr_b16 v[184:185], v7 offset:8192
  v_cvt_pk_bf16_f32 v224, v152, v153
  v_mfma_f32_16x16x32_bf16 v[128:131], v[196:199], v[140:143], v[128:131]
  buffer_store_dwordx4 v[220:223], v19, s[24:27], s38 offen offset:3072 sc1
  v_mfma_f32_16x16x32_bf16 v[128:131], v[192:195], v[136:139], v[128:131]
  ds_read_b64_tr_b16 v[186:187], v7 offset:10240
  v_cvt_pk_bf16_f32 v225, v154, v155
  v_mfma_f32_16x16x32_bf16 v[160:163], v[192:195], v[168:171], v[160:163]
  v_mfma_f32_16x16x32_bf16 v[160:163], v[196:199], v[172:175], v[160:163]
  s_waitcnt lgkmcnt(2)
  v_cvt_pk_bf16_f32 v226, v156, v157
  v_mfma_f32_16x16x32_bf16 v[164:167], v[200:203], v[168:171], v[164:167]
  ds_read_b64_tr_b16 v[188:189], v7 offset:12288
  v_mfma_f32_16x16x32_bf16 v[164:167], v[204:207], v[172:175], v[164:167]
  ds_read_b64_tr_b16 v[190:191], v7 offset:14336
  v_mfma_f32_16x16x32_bf16 v[132:135], v[204:207], v[140:143], v[132:135]
  ds_read_b64_tr_b16 v[192:193], v7 offset:8200
  v_cvt_pk_bf16_f32 v227, v158, v159
  v_mfma_f32_16x16x32_bf16 v[132:135], v[200:203], v[136:139], v[132:135]
  ds_read_b64_tr_b16 v[194:195], v7 offset:10248
  v_mfma_f32_16x16x32_bf16 v[100:103], v[200:203], v[104:107], v[100:103]
  s_add_u32 s38, s38, 4096
  v_mfma_f32_16x16x32_bf16 v[100:103], v[204:207], v[108:111], v[100:103]
  ds_read_b64_tr_b16 v[196:197], v7 offset:12296
  v_mfma_f32_16x16x32_bf16 v[68:71], v[204:207], v[76:79], v[68:71]
  ds_read_b64_tr_b16 v[198:199], v7 offset:14344
  s_add_u32 s30, s29, s31
  v_mfma_f32_16x16x32_bf16 v[68:71], v[200:203], v[72:75], v[68:71]
  s_add_u32 s29, s29, 53248
  v_mfma_f32_16x16x32_bf16 v[36:39], v[200:203], v[40:43], v[36:39]
  s_cmp_eq_u32 s29, 159744
  s_cselect_b32 s29, 0, s29
  v_mfma_f32_16x16x32_bf16 v[36:39], v[204:207], v[44:47], v[36:39]
  buffer_store_dwordx4 v[224:227], v19, s[24:27], s38 offen offset:0 sc1
  s_waitcnt lgkmcnt(6)
  v_mfma_f32_16x16x32_bf16 v[32:35], v[184:187], v[48:51], v[32:35]
  s_waitcnt lgkmcnt(4)
  v_add_u32 v6, s29, v244
  v_mfma_f32_16x16x32_bf16 v[32:35], v[188:191], a[220:223], v[32:35]
  s_add_u32 s38, s38, 1024
  v_add_u32 v7, s101, v6
  v_mfma_f32_16x16x32_bf16 v[64:67], v[188:191], a[224:227], v[64:67]
  v_mfma_f32_16x16x32_bf16 v[64:67], v[184:187], v[80:83], v[64:67]
  v_mfma_f32_16x16x32_bf16 v[96:99], v[184:187], v[112:115], v[96:99]
  s_waitcnt vmcnt(14) lgkmcnt(0)
  s_barrier
  s_add_u32 m0, s30, s31
  v_mfma_f32_16x16x32_bf16 v[96:99], v[188:191], a[228:231], v[96:99]
  ds_read_b64_tr_b16 v[200:201], v6 offset:0
  v_mfma_f32_16x16x32_bf16 v[128:131], v[188:191], a[232:235], v[128:131]
  ds_read_b64_tr_b16 v[202:203], v6 offset:2048
  v_mfma_f32_16x16x32_bf16 v[128:131], v[184:187], v[144:147], v[128:131]
  v_mfma_f32_16x16x32_bf16 v[160:163], v[184:187], v[176:179], v[160:163]
  buffer_load_dwordx4 v15, s[68:71], s94 offen offset:0 lds
  v_mfma_f32_16x16x32_bf16 v[160:163], v[188:191], a[236:239], v[160:163]
  v_mfma_f32_16x16x32_bf16 v[164:167], v[192:195], v[176:179], v[164:167]
  ds_read_b64_tr_b16 v[204:205], v6 offset:4096
  v_mfma_f32_16x16x32_bf16 v[164:167], v[196:199], a[236:239], v[164:167]
  ds_read_b64_tr_b16 v[206:207], v6 offset:6144
  v_mfma_f32_16x16x32_bf16 v[132:135], v[196:199], a[232:235], v[132:135]
  v_mfma_f32_16x16x32_bf16 v[132:135], v[192:195], v[144:147], v[132:135]
  buffer_load_dwordx4 v16, s[68:71], s94 offen offset:1024 lds
  v_mfma_f32_16x16x32_bf16 v[100:103], v[192:195], v[112:115], v[100:103]
  v_mfma_f32_16x16x32_bf16 v[100:103], v[196:199], a[228:231], v[100:103]
  ds_read_b64_tr_b16 v[184:185], v6 offset:8
  v_mfma_f32_16x16x32_bf16 v[68:71], v[196:199], a[224:227], v[68:71]
  ds_read_b64_tr_b16 v[186:187], v6 offset:2056
  v_mfma_f32_16x16x32_bf16 v[68:71], v[192:195], v[80:83], v[68:71]
  v_mfma_f32_16x16x32_bf16 v[36:39], v[192:195], v[48:51], v[36:39]
  v_mfma_f32_16x16x32_bf16 v[36:39], v[196:199], a[220:223], v[36:39]
  s_waitcnt lgkmcnt(2)
  v_mfma_f32_16x16x32_bf16 v[32:35], v[200:203], a[0:3], v[32:35]
  ds_read_b64_tr_b16 v[188:189], v6 offset:4104
  v_mfma_f32_16x16x32_bf16 v[32:35], v[204:207], a[40:43], v[32:35]
  ds_read_b64_tr_b16 v[190:191], v6 offset:6152
  v_mfma_f32_16x16x32_bf16 v[64:67], v[204:207], a[44:47], v[64:67]
  v_mfma_f32_16x16x32_bf16 v[64:67], v[200:203], a[4:7], v[64:67]
  buffer_load_dwordx4 v17, s[68:71], s94 offen offset:2048 lds
  v_mfma_f32_16x16x32_bf16 v[96:99], v[200:203], a[8:11], v[96:99]
  v_mfma_f32_16x16x32_bf16 v[96:99], v[204:207], a[48:51], v[96:99]
  ds_read_b64_tr_b16 v[192:193], v6 offset:8192
  v_mfma_f32_16x16x32_bf16 v[128:131], v[204:207], a[52:55], v[128:131]
  ds_read_b64_tr_b16 v[194:195], v6 offset:10240
  v_mfma_f32_16x16x32_bf16 v[128:131], v[200:203], a[12:15], v[128:131]
  v_mfma_f32_16x16x32_bf16 v[160:163], v[200:203], a[16:19], v[160:163]
  buffer_load_dwordx4 v18, s[68:71], s94 offen offset:3072 lds
  v_mfma_f32_16x16x32_bf16 v[160:163], v[204:207], a[56:59], v[160:163]
  s_waitcnt lgkmcnt(2)
  v_mfma_f32_16x16x32_bf16 v[164:167], v[184:187], a[16:19], v[164:167]
  ds_read_b64_tr_b16 v[196:197], v6 offset:12288
  v_mfma_f32_16x16x32_bf16 v[164:167], v[188:191], a[56:59], v[164:167]
  ds_read_b64_tr_b16 v[198:199], v6 offset:14336
  v_mfma_f32_16x16x32_bf16 v[132:135], v[188:191], a[52:55], v[132:135]
  v_mfma_f32_16x16x32_bf16 v[132:135], v[184:187], a[12:15], v[132:135]
  s_add_u32 m0, m0, 0x1000
  s_add_u32 s39, s94, 0x8000
  v_mfma_f32_16x16x32_bf16 v[100:103], v[184:187], a[8:11], v[100:103]
  v_mfma_f32_16x16x32_bf16 v[100:103], v[188:191], a[48:51], v[100:103]
  ds_read_b64_tr_b16 v[200:201], v6 offset:8200
  v_mfma_f32_16x16x32_bf16 v[68:71], v[188:191], a[44:47], v[68:71]
  ds_read_b64_tr_b16 v[202:203], v6 offset:10248
  v_mfma_f32_16x16x32_bf16 v[68:71], v[184:187], a[4:7], v[68:71]
  v_mfma_f32_16x16x32_bf16 v[36:39], v[184:187], a[0:3], v[36:39]
  buffer_load_dwordx4 v15, s[68:71], s39 offen offset:0 lds
  v_mfma_f32_16x16x32_bf16 v[36:39], v[188:191], a[40:43], v[36:39]
  s_waitcnt lgkmcnt(2)
  v_mfma_f32_16x16x32_bf16 v[32:35], v[192:195], a[80:83], v[32:35]
  ds_read_b64_tr_b16 v[204:205], v6 offset:12296
  v_mfma_f32_16x16x32_bf16 v[32:35], v[196:199], a[120:123], v[32:35]
  ds_read_b64_tr_b16 v[206:207], v6 offset:14344
  v_mfma_f32_16x16x32_bf16 v[64:67], v[196:199], a[124:127], v[64:67]
  v_mfma_f32_16x16x32_bf16 v[64:67], v[192:195], a[84:87], v[64:67]
  buffer_load_dword v210, off, s[24:27], s48 offset:0 sc1
  v_mfma_f32_16x16x32_bf16 v[96:99], v[192:195], a[88:91], v[96:99]
  v_mfma_f32_16x16x32_bf16 v[96:99], v[196:199], a[128:131], v[96:99]
  ds_read_b64_tr_b16 v[184:185], v7 offset:0
  v_mfma_f32_16x16x32_bf16 v[128:131], v[196:199], a[132:135], v[128:131]
  ds_read_b64_tr_b16 v[186:187], v7 offset:2048
  v_mfma_f32_16x16x32_bf16 v[128:131], v[192:195], a[92:95], v[128:131]
  v_mfma_f32_16x16x32_bf16 v[160:163], v[192:195], a[96:99], v[160:163]
  buffer_load_dwordx4 v16, s[68:71], s39 offen offset:1024 lds
  v_mfma_f32_16x16x32_bf16 v[160:163], v[196:199], a[136:139], v[160:163]
  s_waitcnt lgkmcnt(2)
  v_mfma_f32_16x16x32_bf16 v[164:167], v[200:203], a[96:99], v[164:167]
  ds_read_b64_tr_b16 v[188:189], v7 offset:4096
  v_mfma_f32_16x16x32_bf16 v[164:167], v[204:207], a[136:139], v[164:167]
  ds_read_b64_tr_b16 v[190:191], v7 offset:6144
  v_mfma_f32_16x16x32_bf16 v[132:135], v[204:207], a[132:135], v[132:135]
  buffer_load_dword v214, off, s[24:27], s48 offset:256 sc1
  v_mfma_f32_16x16x32_bf16 v[132:135], v[200:203], a[92:95], v[132:135]
  buffer_load_dwordx4 v17, s[68:71], s39 offen offset:2048 lds
  v_mfma_f32_16x16x32_bf16 v[100:103], v[200:203], a[88:91], v[100:103]
  v_mfma_f32_16x16x32_bf16 v[100:103], v[204:207], a[128:131], v[100:103]
  ds_read_b64_tr_b16 v[192:193], v7 offset:8
  v_mfma_f32_16x16x32_bf16 v[68:71], v[204:207], a[124:127], v[68:71]
  ds_read_b64_tr_b16 v[194:195], v7 offset:2056
  v_mfma_f32_16x16x32_bf16 v[68:71], v[200:203], a[84:87], v[68:71]
  v_mfma_f32_16x16x32_bf16 v[36:39], v[200:203], a[80:83], v[36:39]
  v_mfma_f32_16x16x32_bf16 v[36:39], v[204:207], a[120:123], v[36:39]
  s_waitcnt lgkmcnt(2)
  v_mfma_f32_16x16x32_bf16 v[32:35], v[184:187], a[20:23], v[32:35]
  ds_read_b64_tr_b16 v[196:197], v7 offset:4104
  v_mfma_f32_16x16x32_bf16 v[32:35], v[188:191], a[60:63], v[32:35]
  ds_read_b64_tr_b16 v[198:199], v7 offset:6152
  s_add_u32 s94, s88, 6
  v_mfma_f32_16x16x32_bf16 v[64:67], v[188:191], a[64:67], v[64:67]
  s_and_b32 s94, s94, 7
  s_lshl_b32 s94, s94, 7
  s_add_u32 s94, s94, s100
  v_mfma_f32_16x16x32_bf16 v[64:67], v[184:187], a[24:27], v[64:67]
  buffer_load_dwordx4 v18, s[68:71], s39 offen offset:3072 lds
  v_mfma_f32_16x16x32_bf16 v[96:99], v[184:187], a[28:31], v[96:99]
  v_mfma_f32_16x16x32_bf16 v[96:99], v[188:191], a[68:71], v[96:99]
  ds_read_b64_tr_b16 v[200:201], v7 offset:8192
  v_mfma_f32_16x16x32_bf16 v[128:131], v[188:191], a[72:75], v[128:131]
  ds_read_b64_tr_b16 v[202:203], v7 offset:10240
  s_waitcnt vmcnt(10)
  v_mfma_f32_16x16x32_bf16 v[128:131], v[184:187], a[32:35], v[128:131]
  buffer_store_dword v208, v211, s[24:27], s49 offen offset:512 sc1
  v_mfma_f32_16x16x32_bf16 v[160:163], v[184:187], a[36:39], v[160:163]
  v_mfma_f32_16x16x32_bf16 v[160:163], v[188:191], a[76:79], v[160:163]
  s_waitcnt lgkmcnt(2)
  v_mfma_f32_16x16x32_bf16 v[164:167], v[192:195], a[36:39], v[164:167]
  ds_read_b64_tr_b16 v[204:205], v7 offset:12288
  v_mfma_f32_16x16x32_bf16 v[164:167], v[196:199], a[76:79], v[164:167]
  ds_read_b64_tr_b16 v[206:207], v7 offset:14336
  v_mfma_f32_16x16x32_bf16 v[132:135], v[196:199], a[72:75], v[132:135]
  ds_read_b64_tr_b16 v[184:185], v7 offset:8200
  v_mfma_f32_16x16x32_bf16 v[132:135], v[192:195], a[32:35], v[132:135]
  ds_read_b64_tr_b16 v[186:187], v7 offset:10248
  v_mfma_f32_16x16x32_bf16 v[100:103], v[192:195], a[28:31], v[100:103]
  v_mfma_f32_16x16x32_bf16 v[100:103], v[196:199], a[68:71], v[100:103]
  ds_read_b64_tr_b16 v[188:189], v7 offset:12296
  v_mfma_f32_16x16x32_bf16 v[68:71], v[196:199], a[64:67], v[68:71]
  ds_read_b64_tr_b16 v[190:191], v7 offset:14344
  s_add_u32 s30, s29, s31
  v_mfma_f32_16x16x32_bf16 v[68:71], v[192:195], a[24:27], v[68:71]
  s_add_u32 s29, s29, 53248
  v_mfma_f32_16x16x32_bf16 v[36:39], v[192:195], a[20:23], v[36:39]
  s_cmp_eq_u32 s29, 159744
  s_cselect_b32 s29, 0, s29
  v_mfma_f32_16x16x32_bf16 v[36:39], v[196:199], a[60:63], v[36:39]
  s_waitcnt lgkmcnt(4)
  v_mfma_f32_16x16x32_bf16 v[32:35], v[200:203], a[100:103], v[32:35]
  v_add_u32 v6, s29, v244
  v_mfma_f32_16x16x32_bf16 v[32:35], v[204:207], a[140:143], v[32:35]
  v_add_u32 v7, s101, v6
  v_mfma_f32_16x16x32_bf16 v[64:67], v[204:207], a[144:147], v[64:67]
  v_mfma_f32_16x16x32_bf16 v[64:67], v[200:203], a[104:107], v[64:67]
  v_mfma_f32_16x16x32_bf16 v[96:99], v[200:203], a[108:111], v[96:99]
  s_waitcnt vmcnt(13) lgkmcnt(0)
  s_barrier
  s_add_u32 s91, s88, 4
  s_add_u32 m0, s30, s31
  v_mfma_f32_16x16x32_bf16 v[96:99], v[204:207], a[148:151], v[96:99]
  ds_read_b64_tr_b16 v[192:193], v6 offset:0
  s_and_b32 s91, s91, 7
  v_mfma_f32_16x16x32_bf16 v[128:131], v[204:207], a[152:155], v[128:131]
  ds_read_b64_tr_b16 v[194:195], v6 offset:2048
  s_sub_u32 s91, s91, s88
  v_mfma_f32_16x16x32_bf16 v[128:131], v[200:203], a[112:115], v[128:131]
  v_mfma_f32_16x16x32_bf16 v[160:163], v[200:203], a[116:119], v[160:163]
  buffer_load_dwordx4 v15, s[68:71], s94 offen offset:0 lds
  v_mfma_f32_16x16x32_bf16 v[160:163], v[204:207], a[156:159], v[160:163]
  s_mul_i32 s38, s91, 163840
  v_mfma_f32_16x16x32_bf16 v[164:167], v[184:187], a[116:119], v[164:167]
  ds_read_b64_tr_b16 v[196:197], v6 offset:4096
  s_add_u32 s38, s38, s93
  v_mfma_f32_16x16x32_bf16 v[164:167], v[188:191], a[156:159], v[164:167]
  ds_read_b64_tr_b16 v[198:199], v6 offset:6144
  s_add_u32 s38, s38, 61440
  v_mfma_f32_16x16x32_bf16 v[132:135], v[188:191], a[152:155], v[132:135]
  v_mfma_f32_16x16x32_bf16 v[132:135], v[184:187], a[112:115], v[132:135]
  buffer_load_dwordx4 v16, s[68:71], s94 offen offset:1024 lds
  v_mfma_f32_16x16x32_bf16 v[100:103], v[184:187], a[108:111], v[100:103]
  s_lshl_b32 s91, s91, 11
  s_waitcnt vmcnt(7)
  v_readfirstlane_b32 s98, v210
  v_mfma_f32_16x16x32_bf16 v[100:103], v[188:191], a[148:151], v[100:103]
  ds_read_b64_tr_b16 v[200:201], v6 offset:8
  s_add_u32 s91, s91, s48
  v_mfma_f32_16x16x32_bf16 v[68:71], v[188:191], a[144:147], v[68:71]
  ds_read_b64_tr_b16 v[202:203], v6 offset:2056
  v_mfma_f32_16x16x32_bf16 v[68:71], v[184:187], a[104:107], v[68:71]
  s_cmp_eq_u32 s98, s96
  v_mfma_f32_16x16x32_bf16 v[36:39], v[184:187], a[100:103], v[36:39]
  v_mfma_f32_16x16x32_bf16 v[36:39], v[188:191], a[140:143], v[36:39]
  s_waitcnt lgkmcnt(2)
  s_cbranch_scc0 SPIN1
SRET1:
  v_mfma_f32_16x16x32_bf16 v[24:27], v[192:195], a[160:163], 0
  ds_read_b64_tr_b16 v[204:205], v6 offset:4104
  v_cvt_pk_bf16_f32 v216, v32, v33
  v_mfma_f32_16x16x32_bf16 v[24:27], v[196:199], a[180:183], v[24:27]
  ds_read_b64_tr_b16 v[206:207], v6 offset:6152
  s_add_u32 s40, s93, 1024
  v_mfma_f32_16x16x32_bf16 v[56:59], v[196:199], a[184:187], 0
  s_waitcnt vmcnt(5)
  v_readfirstlane_b32 s98, v214
  v_mfma_f32_16x16x32_bf16 v[56:59], v[192:195], a[164:167], v[56:59]
  buffer_load_dwordx4 v17, s[68:71], s94 offen offset:2048 lds
  v_mfma_f32_16x16x32_bf16 v[88:91], v[192:195], a[168:171], 0
  buffer_load_dwordx4 v[84:87], v19, s[24:27], s40 offen offset:0 sc1
  v_mfma_f32_16x16x32_bf16 v[88:91], v[196:199], a[188:191], v[88:91]
  ds_read_b64_tr_b16 v[184:185], v6 offset:8192
  v_cvt_pk_bf16_f32 v217, v34, v35
  v_mfma_f32_16x16x32_bf16 v[120:123], v[196:199], a[192:195], 0
  s_cmp_eq_u32 s98, s96
  v_mfma_f32_16x16x32_bf16 v[120:123], v[192:195], a[172:175], v[120:123]
  ds_read_b64_tr_b16 v[186:187], v6 offset:10240
  s_cbranch_scc0 SPIN2
SRET2:
  v_mfma_f32_16x16x32_bf16 v[152:155], v[192:195], a[176:179], 0
  buffer_load_dwordx4 v[116:119], v19, s[24:27], s40 offen offset:1024 sc1
  v_mfma_f32_16x16x32_bf16 v[152:155], v[196:199], a[196:199], v[152:155]
  buffer_load_dwordx4 v18, s[68:71], s94 offen offset:3072 lds
  s_waitcnt lgkmcnt(4)
  v_mfma_f32_16x16x32_bf16 v[156:159], v[200:203], a[176:179], 0
  buffer_load_dwordx4 v[148:151], v19, s[24:27], s40 offen offset:2048 sc1
  v_cvt_pk_bf16_f32 v218, v36, v37
  s_waitcnt lgkmcnt(2)
  v_mfma_f32_16x16x32_bf16 v[156:159], v[204:207], a[196:199], v[156:159]
  v_cvt_pk_bf16_f32 v219, v38, v39
  v_mfma_f32_16x16x32_bf16 v[124:127], v[204:207], a[192:195], 0
  ds_read_b64_tr_b16 v[188:189], v6 offset:12288
  v_cvt_pk_bf16_f32 v220, v64, v65
  buffer_load_dwordx4 v[180:183], v19, s[24:27], s40 offen offset:3072 sc1
  v_mfma_f32_16x16x32_bf16 v[124:127], v[200:203], a[172:175], v[124:127]
  ds_read_b64_tr_b16 v[190:191], v6 offset:14336
  s_sub_u32 s40, s40, 1024
  v_mfma_f32_16x16x32_bf16 v[92:95], v[200:203], a[168:171], 0
  buffer_store_dwordx4 v[216:219], v19, s[24:27], s38 offen offset:0 sc1
  v_mfma_f32_16x16x32_bf16 v[92:95], v[204:207], a[188:191], v[92:95]
  buffer_load_dwordx4 v[52:55], v19, s[24:27], s40 offen sc1
  v_mfma_f32_16x16x32_bf16 v[60:63], v[204:207], a[184:187], 0
  ds_read_b64_tr_b16 v[192:193], v6 offset:8200
  v_cvt_pk_bf16_f32 v221, v66, v67
  v_mfma_f32_16x16x32_bf16 v[60:63], v[200:203], a[164:167], v[60:63]
  s_add_u32 m0, m0, 0x1000
  v_cvt_pk_bf16_f32 v222, v68, v69
  s_add_u32 s39, s94, 0x8000
  v_mfma_f32_16x16x32_bf16 v[28:31], v[200:203], a[160:163], 0
  ds_read_b64_tr_b16 v[194:195], v6 offset:10248
  v_cvt_pk_bf16_f32 v223, v70, v71
  v_mfma_f32_16x16x32_bf16 v[28:31], v[204:207], a[180:183], v[28:31]
  buffer_load_dwordx4 v15, s[68:71], s39 offen offset:0 lds
  s_waitcnt lgkmcnt(4)
  v_mfma_f32_16x16x32_bf16 v[24:27], v[184:187], a[200:203], v[24:27]
  ds_read_b64_tr_b16 v[196:197], v6 offset:12296
  s_waitcnt lgkmcnt(3)
  v_mfma_f32_16x16x32_bf16 v[24:27], v[188:191], a[240:243], v[24:27]
  v_mfma_f32_16x16x32_bf16 v[56:59], v[188:191], a[244:247], v[56:59]
  ds_read_b64_tr_b16 v[198:199], v6 offset:14344
  v_mfma_f32_16x16x32_bf16 v[56:59], v[184:187], a[204:207], v[56:59]
  buffer_store_dwordx4 v[220:223], v19, s[24:27], s38 offen offset:1024 sc1
  v_mfma_f32_16x16x32_bf16 v[88:91], v[184:187], a[208:211], v[88:91]
  v_cvt_pk_bf16_f32 v224, v96, v97
  v_mfma_f32_16x16x32_bf16 v[88:91], v[188:191], a[248:251], v[88:91]
  ds_read_b64_tr_b16 v[200:201], v7 offset:0
  v_cvt_pk_bf16_f32 v225, v98, v99
  v_mfma_f32_16x16x32_bf16 v[120:123], v[188:191], a[252:255], v[120:123]
  ds_read_b64_tr_b16 v[202:203], v7 offset:2048
  v_mfma_f32_16x16x32_bf16 v[120:123], v[184:187], a[212:215], v[120:123]
  v_cvt_pk_bf16_f32 v226, v100, v101
  v_mfma_f32_16x16x32_bf16 v[152:155], v[184:187], a[216:219], v[152:155]
  buffer_load_dwordx4 v16, s[68:71], s39 offen offset:1024 lds
  v_mfma_f32_16x16x32_bf16 v[152:155], v[188:191], v[240:243], v[152:155]
  s_waitcnt lgkmcnt(2)
  v_cvt_pk_bf16_f32 v227, v102, v103
  v_mfma_f32_16x16x32_bf16 v[156:159], v[192:195], a[216:219], v[156:159]
  ds_read_b64_tr_b16 v[204:205], v7 offset:4096
  v_mfma_f32_16x16x32_bf16 v[156:159], v[196:199], v[240:243], v[156:159]
  ds_read_b64_tr_b16 v[206:207], v7 offset:6144
  v_mfma_f32_16x16x32_bf16 v[124:127], v[196:199], a[252:255], v[124:127]
  v_mfma_f32_16x16x32_bf16 v[124:127], v[192:195], a[212:215], v[124:127]
  buffer_load_dwordx4 v17, s[68:71], s39 offen offset:2048 lds
  v_mfma_f32_16x16x32_bf16 v[92:95], v[192:195], a[208:211], v[92:95]
  v_cvt_pk_bf16_f32 v216, v128, v129
  v_mfma_f32_16x16x32_bf16 v[92:95], v[196:199], a[248:251], v[92:95]
  buffer_store_dwordx4 v[224:227], v19, s[24:27], s38 offen offset:2048 sc1
  v_mfma_f32_16x16x32_bf16 v[60:63], v[196:199], a[244:247], v[60:63]
  ds_read_b64_tr_b16 v[184:185], v7 offset:8
  v_cvt_pk_bf16_f32 v217, v130, v131
  v_mfma_f32_16x16x32_bf16 v[60:63], v[192:195], a[204:207], v[60:63]
  ds_read_b64_tr_b16 v[186:187], v7 offset:2056
  v_mfma_f32_16x16x32_bf16 v[28:31], v[192:195], a[200:203], v[28:31]
  v_cvt_pk_bf16_f32 v218, v132, v133
  v_mfma_f32_16x16x32_bf16 v[28:31], v[196:199], a[240:243], v[28:31]
  s_waitcnt lgkmcnt(2)
  v_mfma_f32_16x16x32_bf16 v[24:27], v[200:203], v[40:43], v[24:27]
  ds_read_b64_tr_b16 v[188:189], v7 offset:4104
  v_cvt_pk_bf16_f32 v219, v134, v135
  v_mfma_f32_16x16x32_bf16 v[24:27], v[204:207], v[44:47], v[24:27]
  ds_read_b64_tr_b16 v[190:191], v7 offset:6152
  s_add_u32 s94, s94, 0x100000
  v_mfma_f32_16x16x32_bf16 v[56:59], v[204:207], v[76:79], v[56:59]
  v_mfma_f32_16x16x32_bf16 v[56:59], v[200:203], v[72:75], v[56:59]
  buffer_load_dwordx4 v18, s[68:71], s39 offen offset:3072 lds
  v_mfma_f32_16x16x32_bf16 v[88:91], v[200:203], v[104:107], v[88:91]
  v_mfma_f32_16x16x32_bf16 v[88:91], v[204:207], v[108:111], v[88:91]
  ds_read_b64_tr_b16 v[192:193], v7 offset:8192
  v_cvt_pk_bf16_f32 v220, v160, v161
  v_mfma_f32_16x16x32_bf16 v[120:123], v[204:207], v[140:143], v[120:123]
  buffer_store_dwordx4 v[216:219], v19, s[24:27], s38 offen offset:3072 sc1
  v_mfma_f32_16x16x32_bf16 v[120:123], v[200:203], v[136:139], v[120:123]
  ds_read_b64_tr_b16 v[194:195], v7 offset:10240
  v_cvt_pk_bf16_f32 v221, v162, v163
  v_mfma_f32_16x16x32_bf16 v[152:155], v[200:203], v[168:171], v[152:155]
  v_mfma_f32_16x16x32_bf16 v[152:155], v[204:207], v[172:175], v[152:155]
  s_waitcnt lgkmcnt(2)
  v_cvt_pk_bf16_f32 v222, v164, v165
  v_mfma_f32_16x16x32_bf16 v[156:159], v[184:187], v[168:171], v[156:159]
  ds_read_b64_tr_b16 v[196:197], v7 offset:12288
  v_mfma_f32_16x16x32_bf16 v[156:159], v[188:191], v[172:175], v[156:159]
  ds_read_b64_tr_b16 v[198:199], v7 offset:14336
  v_mfma_f32_16x16x32_bf16 v[124:127], v[188:191], v[140:143], v[124:127]
  ds_read_b64_tr_b16 v[200:201], v7 offset:8200
  v_cvt_pk_bf16_f32 v223, v166, v167
  v_mfma_f32_16x16x32_bf16 v[124:127], v[184:187], v[136:139], v[124:127]
  ds_read_b64_tr_b16 v[202:203], v7 offset:10248
  v_mfma_f32_16x16x32_bf16 v[92:95], v[184:187], v[104:107], v[92:95]
  s_add_u32 s38, s38, 4096
  v_mfma_f32_16x16x32_bf16 v[92:95], v[188:191], v[108:111], v[92:95]
  ds_read_b64_tr_b16 v[204:205], v7 offset:12296
  v_mfma_f32_16x16x32_bf16 v[60:63], v[188:191], v[76:79], v[60:63]
  ds_read_b64_tr_b16 v[206:207], v7 offset:14344
  s_add_u32 s30, s29, s31
  v_mfma_f32_16x16x32_bf16 v[60:63], v[184:187], v[72:75], v[60:63]
  s_add_u32 s29, s29, 53248
  v_mfma_f32_16x16x32_bf16 v[28:31], v[184:187], v[40:43], v[28:31]
  s_cmp_eq_u32 s29, 159744
  s_cselect_b32 s29, 0, s29
  v_mfma_f32_16x16x32_bf16 v[28:31], v[188:191], v[44:47], v[28:31]
  buffer_store_dwordx4 v[220:223], v19, s[24:27], s38 offen offset:0 sc1
  s_waitcnt lgkmcnt(6)
  v_mfma_f32_16x16x32_bf16 v[24:27], v[192:195], v[48:51], v[24:27]
  s_waitcnt lgkmcnt(4)
  v_add_u32 v6, s29, v244
  v_mfma_f32_16x16x32_bf16 v[24:27], v[196:199], a[220:223], v[24:27]
  s_add_u32 s38, s38, 1024
  v_add_u32 v7, s101, v6
  v_mfma_f32_16x16x32_bf16 v[56:59], v[196:199], a[224:227], v[56:59]
  v_mfma_f32_16x16x32_bf16 v[56:59], v[192:195], v[80:83], v[56:59]
  v_mfma_f32_16x16x32_bf16 v[88:91], v[192:195], v[112:115], v[88:91]
  s_waitcnt vmcnt(19) lgkmcnt(0)
  s_barrier
  s_add_u32 m0, s30, s31
  v_mfma_f32_16x16x32_bf16 v[88:91], v[196:199], a[228:231], v[88:91]
  ds_read_b64_tr_b16 v[184:185], v6 offset:0
  v_mfma_f32_16x16x32_bf16 v[120:123], v[196:199], a[232:235], v[120:123]
  ds_read_b64_tr_b16 v[186:187], v6 offset:2048
  v_mfma_f32_16x16x32_bf16 v[120:123], v[192:195], v[144:147], v[120:123]
  v_mfma_f32_16x16x32_bf16 v[152:155], v[192:195], v[176:179], v[152:155]
  buffer_load_dwordx4 v15, s[68:71], s94 offen offset:0 lds
  v_mfma_f32_16x16x32_bf16 v[152:155], v[196:199], a[236:239], v[152:155]
  v_mfma_f32_16x16x32_bf16 v[156:159], v[200:203], v[176:179], v[156:159]
  ds_read_b64_tr_b16 v[188:189], v6 offset:4096
  v_mfma_f32_16x16x32_bf16 v[156:159], v[204:207], a[236:239], v[156:159]
  ds_read_b64_tr_b16 v[190:191], v6 offset:6144
  v_mfma_f32_16x16x32_bf16 v[124:127], v[204:207], a[232:235], v[124:127]
  v_mfma_f32_16x16x32_bf16 v[124:127], v[200:203], v[144:147], v[124:127]
  buffer_load_dwordx4 v16, s[68:71], s94 offen offset:1024 lds
  v_mfma_f32_16x16x32_bf16 v[92:95], v[200:203], v[112:115], v[92:95]
  v_mfma_f32_16x16x32_bf16 v[92:95], v[204:207], a[228:231], v[92:95]
  ds_read_b64_tr_b16 v[192:193], v6 offset:8
  v_mfma_f32_16x16x32_bf16 v[60:63], v[204:207], a[224:227], v[60:63]
  ds_read_b64_tr_b16 v[194:195], v6 offset:2056
  v_mfma_f32_16x16x32_bf16 v[60:63], v[200:203], v[80:83], v[60:63]
  v_mfma_f32_16x16x32_bf16 v[28:31], v[200:203], v[48:51], v[28:31]
  v_mfma_f32_16x16x32_bf16 v[28:31], v[204:207], a[220:223], v[28:31]
  s_waitcnt lgkmcnt(2)
  v_mfma_f32_16x16x32_bf16 v[24:27], v[184:187], a[0:3], v[24:27]
  ds_read_b64_tr_b16 v[196:197], v6 offset:4104
  v_mfma_f32_16x16x32_bf16 v[24:27], v[188:191], a[40:43], v[24:27]
  ds_read_b64_tr_b16 v[198:199], v6 offset:6152
  v_mfma_f32_16x16x32_bf16 v[56:59], v[188:191], a[44:47], v[56:59]
  v_mfma_f32_16x16x32_bf16 v[56:59], v[184:187], a[4:7], v[56:59]
  buffer_load_dwordx4 v17, s[68:71], s94 offen offset:2048 lds
  v_mfma_f32_16x16x32_bf16 v[88:91], v[184:187], a[8:11], v[88:91]
  s_waitcnt vmcnt(17)
  v_lshlrev_b32 v252, 16, v84
  v_mfma_f32_16x16x32_bf16 v[88:91], v[188:191], a[48:51], v[88:91]
  ds_read_b64_tr_b16 v[200:201], v6 offset:8192
  v_and_b32 v253, s41, v84
  v_mfma_f32_16x16x32_bf16 v[120:123], v[188:191], a[52:55], v[120:123]
  ds_read_b64_tr_b16 v[202:203], v6 offset:10240
  v_lshlrev_b32 v254, 16, v85
  v_mfma_f32_16x16x32_bf16 v[120:123], v[184:187], a[12:15], v[120:123]
  s_waitcnt vmcnt(11)
  v_and_b32 v255, s41, v85
  v_lshlrev_b32 v232, 16, v86
  v_mfma_f32_16x16x32_bf16 v[152:155], v[184:187], a[16:19], v[152:155]
  buffer_load_dwordx4 v18, s[68:71], s94 offen offset:3072 lds
  v_mfma_f32_16x16x32_bf16 v[152:155], v[188:191], a[56:59], v[152:155]
  s_waitcnt lgkmcnt(2)
  v_and_b32 v233, s41, v86
  v_lshlrev_b32 v234, 16, v87
  v_mfma_f32_16x16x32_bf16 v[156:159], v[192:195], a[16:19], v[156:159]
  ds_read_b64_tr_b16 v[204:205], v6 offset:12288
  v_and_b32 v236, s41, v87
  v_mfma_f32_16x16x32_bf16 v[156:159], v[196:199], a[56:59], v[156:159]
  v_lshlrev_b32 v237, 16, v116
  v_and_b32 v238, s41, v116
  v_mfma_f32_16x16x32_bf16 v[124:127], v[196:199], a[52:55], v[124:127]
  ds_read_b64_tr_b16 v[206:207], v6 offset:14336
  v_lshlrev_b32 v239, 16, v117
  v_mfma_f32_16x16x32_bf16 v[124:127], v[192:195], a[12:15], v[124:127]
  s_add_u32 m0, m0, 0x1000
  v_and_b32 v245, s41, v117
  v_lshlrev_b32 v247, 16, v118
  v_mfma_f32_16x16x32_bf16 v[92:95], v[192:195], a[8:11], v[92:95]
  s_add_u32 s39, s94, 0x8000
  v_and_b32 v215, s41, v118
  v_lshlrev_b32 v212, 16, v119
  v_mfma_f32_16x16x32_bf16 v[92:95], v[196:199], a[48:51], v[92:95]
  ds_read_b64_tr_b16 v[184:185], v6 offset:8200
  v_and_b32 v1, s41, v119
  v_mfma_f32_16x16x32_bf16 v[60:63], v[196:199], a[44:47], v[60:63]
  ds_read_b64_tr_b16 v[186:187], v6 offset:10248
  v_lshlrev_b32 v2, 16, v148
  v_mfma_f32_16x16x32_bf16 v[60:63], v[192:195], a[4:7], v[60:63]
  v_and_b32 v3, s41, v148
  v_lshlrev_b32 v4, 16, v149
  v_mfma_f32_16x16x32_bf16 v[28:31], v[192:195], a[0:3], v[28:31]
  buffer_load_dwordx4 v15, s[68:71], s39 offen offset:0 lds
  v_mfma_f32_16x16x32_bf16 v[28:31], v[196:199], a[40:43], v[28:31]
  s_waitcnt lgkmcnt(2)
  v_and_b32 v5, s41, v149
  v_lshlrev_b32 v8, 16, v150
  v_mfma_f32_16x16x32_bf16 v[24:27], v[200:203], a[80:83], v[24:27]
  ds_read_b64_tr_b16 v[188:189], v6 offset:12296
  v_and_b32 v9, s41, v150
  v_mfma_f32_16x16x32_bf16 v[24:27], v[204:207], a[120:123], v[24:27]
  v_lshlrev_b32 v10, 16, v151
  v_and_b32 v11, s41, v151
  v_mfma_f32_16x16x32_bf16 v[56:59], v[204:207], a[124:127], v[56:59]
  ds_read_b64_tr_b16 v[190:191], v6 offset:14344
  v_lshlrev_b32 v12, 16, v180
  v_mfma_f32_16x16x32_bf16 v[56:59], v[200:203], a[84:87], v[56:59]
  v_and_b32 v13, s41, v180
  v_lshlrev_b32 v14, 16, v181
  v_mfma_f32_16x16x32_bf16 v[88:91], v[200:203], a[88:91], v[88:91]
  v_and_b32 v20, s41, v181
  v_lshlrev_b32 v21, 16, v182
  v_mfma_f32_16x16x32_bf16 v[88:91], v[204:207], a[128:131], v[88:91]
  ds_read_b64_tr_b16 v[192:193], v7 offset:0
  v_and_b32 v22, s41, v182
  v_mfma_f32_16x16x32_bf16 v[120:123], v[204:207], a[132:135], v[120:123]
  ds_read_b64_tr_b16 v[194:195], v7 offset:2048
  v_lshlrev_b32 v23, 16, v183
  v_mfma_f32_16x16x32_bf16 v[120:123], v[200:203], a[92:95], v[120:123]
  v_and_b32 v0, s41, v183
  v_lshlrev_b32 v228, 16, v52
  v_mfma_f32_16x16x32_bf16 v[152:155], v[200:203], a[96:99], v[152:155]
  buffer_load_dwordx4 v16, s[68:71], s39 offen offset:1024 lds
  v_mfma_f32_16x16x32_bf16 v[152:155], v[204:207], a[136:139], v[152:155]
  s_waitcnt lgkmcnt(2)
  v_and_b32 v229, s41, v52
  v_lshlrev_b32 v230, 16, v53
  v_mfma_f32_16x16x32_bf16 v[156:159], v[184:187], a[96:99], v[156:159]
  ds_read_b64_tr_b16 v[196:197], v7 offset:4096
  v_and_b32 v231, s41, v53
  v_mfma_f32_16x16x32_bf16 v[156:159], v[188:191], a[136:139], v[156:159]
  v_lshlrev_b32 v248, 16, v54
  v_and_b32 v249, s41, v54
  v_mfma_f32_16x16x32_bf16 v[124:127], v[188:191], a[132:135], v[124:127]
  ds_read_b64_tr_b16 v[198:199], v7 offset:6144
  v_lshlrev_b32 v250, 16, v55
  v_mfma_f32_16x16x32_bf16 v[124:127], v[184:187], a[92:95], v[124:127]
  buffer_load_dwordx4 v17, s[68:71], s39 offen offset:2048 lds
  v_and_b32 v251, s41, v55
  v_mfma_f32_16x16x32_bf16 v[92:95], v[184:187], a[88:91], v[92:95]
  s_add_u32 s40, s93, 21504
  v_mfma_f32_16x16x32_bf16 v[92:95], v[188:191], a[128:131], v[92:95]
  ds_read_b64_tr_b16 v[200:201], v7 offset:8
  v_mfma_f32_16x16x32_bf16 v[60:63], v[188:191], a[124:127], v[60:63]
  ds_read_b64_tr_b16 v[202:203], v7 offset:2056
  v_mfma_f32_16x16x32_bf16 v[60:63], v[184:187], a[84:87], v[60:63]
  buffer_load_dwordx4 v[84:87], v19, s[24:27], s40 offen offset:0 sc1
  v_mfma_f32_16x16x32_bf16 v[28:31], v[184:187], a[80:83], v[28:31]
  buffer_load_dwordx4 v[116:119], v19, s[24:27], s40 offen offset:1024 sc1
  v_mfma_f32_16x16x32_bf16 v[28:31], v[188:191], a[120:123], v[28:31]
  s_waitcnt lgkmcnt(2)
  v_mfma_f32_16x16x32_bf16 v[24:27], v[192:195], a[20:23], v[24:27]
  ds_read_b64_tr_b16 v[204:205], v7 offset:4104
  v_mfma_f32_16x16x32_bf16 v[24:27], v[196:199], a[60:63], v[24:27]
  buffer_load_dwordx4 v[148:151], v19, s[24:27], s40 offen offset:2048 sc1
  v_mfma_f32_16x16x32_bf16 v[56:59], v[196:199], a[64:67], v[56:59]
  ds_read_b64_tr_b16 v[206:207], v7 offset:6152
  s_add_u32 s94, s88, 7
  v_mfma_f32_16x16x32_bf16 v[56:59], v[192:195], a[24:27], v[56:59]
  buffer_load_dwordx4 v[180:183], v19, s[24:27], s40 offen offset:3072 sc1
  v_mfma_f32_16x16x32_bf16 v[88:91], v[192:195], a[28:31], v[88:91]
  buffer_load_dwordx4 v18, s[68:71], s39 offen offset:3072 lds
  v_mfma_f32_16x16x32_bf16 v[88:91], v[196:199], a[68:71], v[88:91]
  s_and_b32 s94, s94, 7
  s_lshl_b32 s94, s94, 7
  s_add_u32 s94, s94, s100
  v_mfma_f32_16x16x32_bf16 v[120:123], v[196:199], a[72:75], v[120:123]
  s_sub_u32 s40, s40, 1024
  s_waitcnt vmcnt(12)
  v_mfma_f32_16x16x32_bf16 v[120:123], v[192:195], a[32:35], v[120:123]
  ds_read_b64_tr_b16 v[184:185], v7 offset:8192
  v_mfma_f32_16x16x32_bf16 v[152:155], v[192:195], a[36:39], v[152:155]
  ds_read_b64_tr_b16 v[186:187], v7 offset:10240
  buffer_load_dwordx4 v[52:55], v19, s[24:27], s40 offen sc1
  v_mfma_f32_16x16x32_bf16 v[152:155], v[196:199], a[76:79], v[152:155]
  buffer_store_dword v208, v211, s[24:27], s91 offen offset:768 sc1
  buffer_load_dword v210, off, s[24:27], s48 offset:512 sc1
  s_waitcnt lgkmcnt(4)
  v_mfma_f32_16x16x32_bf16 v[156:159], v[200:203], a[36:39], v[156:159]
  ds_read_b64_tr_b16 v[188:189], v7 offset:12288
  s_waitcnt lgkmcnt(3)
  v_mfma_f32_16x16x32_bf16 v[156:159], v[204:207], a[76:79], v[156:159]
  v_mfma_f32_16x16x32_bf16 v[124:127], v[204:207], a[72:75], v[124:127]
  ds_read_b64_tr_b16 v[190:191], v7 offset:14336
  v_mfma_f32_16x16x32_bf16 v[124:127], v[200:203], a[32:35], v[124:127]
  ds_read_b64_tr_b16 v[192:193], v7 offset:8200
  v_mfma_f32_16x16x32_bf16 v[92:95], v[200:203], a[28:31], v[92:95]
  ds_read_b64_tr_b16 v[194:195], v7 offset:10248
  v_mfma_f32_16x16x32_bf16 v[92:95], v[204:207], a[68:71], v[92:95]
  ds_read_b64_tr_b16 v[196:197], v7 offset:12296
  v_mfma_f32_16x16x32_bf16 v[60:63], v[204:207], a[64:67], v[60:63]
  ds_read_b64_tr_b16 v[198:199], v7 offset:14344
  s_add_u32 s30, s29, s31
  v_mfma_f32_16x16x32_bf16 v[60:63], v[200:203], a[24:27], v[60:63]
  s_add_u32 s29, s29, 53248
  v_mfma_f32_16x16x32_bf16 v[28:31], v[200:203], a[20:23], v[28:31]
  s_cmp_eq_u32 s29, 159744
  s_cselect_b32 s29, 0, s29
  v_mfma_f32_16x16x32_bf16 v[28:31], v[204:207], a[60:63], v[28:31]
  s_waitcnt lgkmcnt(4)
  v_mfma_f32_16x16x32_bf16 v[24:27], v[184:187], a[100:103], v[24:27]
  v_add_u32 v6, s29, v244
  v_mfma_f32_16x16x32_bf16 v[24:27], v[188:191], a[140:143], v[24:27]
  v_add_u32 v7, s101, v6
  v_mfma_f32_16x16x32_bf16 v[56:59], v[188:191], a[144:147], v[56:59]
  v_mfma_f32_16x16x32_bf16 v[56:59], v[184:187], a[104:107], v[56:59]
  v_mfma_f32_16x16x32_bf16 v[88:91], v[184:187], a[108:111], v[88:91]
  s_waitcnt vmcnt(17) lgkmcnt(0)
  s_barrier
  s_add_u32 s49, s88, 5
  s_add_u32 m0, s30, s31
  v_mfma_f32_16x16x32_bf16 v[88:91], v[188:191], a[148:151], v[88:91]
  ds_read_b64_tr_b16 v[200:201], v6 offset:0
  s_and_b32 s49, s49, 7
  v_mfma_f32_16x16x32_bf16 v[120:123], v[188:191], a[152:155], v[120:123]
  ds_read_b64_tr_b16 v[202:203], v6 offset:2048
  s_sub_u32 s49, s49, s88
  v_mfma_f32_16x16x32_bf16 v[120:123], v[184:187], a[112:115], v[120:123]
  v_mfma_f32_16x16x32_bf16 v[152:155], v[184:187], a[116:119], v[152:155]
  buffer_load_dwordx4 v15, s[68:71], s94 offen offset:0 lds
  v_mfma_f32_16x16x32_bf16 v[152:155], v[188:191], a[156:159], v[152:155]
  s_mul_i32 s38, s49, 163840
  v_mfma_f32_16x16x32_bf16 v[156:159], v[192:195], a[116:119], v[156:159]
  ds_read_b64_tr_b16 v[204:205], v6 offset:4096
  s_add_u32 s38, s38, s93
  v_mfma_f32_16x16x32_bf16 v[156:159], v[196:199], a[156:159], v[156:159]
  ds_read_b64_tr_b16 v[206:207], v6 offset:6144
  s_add_u32 s38, s38, 81920
  v_mfma_f32_16x16x32_bf16 v[124:127], v[196:199], a[152:155], v[124:127]
  v_mfma_f32_16x16x32_bf16 v[124:127], v[192:195], a[112:115], v[124:127]
  buffer_load_dwordx4 v16, s[68:71], s94 offen offset:1024 lds
  v_mfma_f32_16x16x32_bf16 v[92:95], v[192:195], a[108:111], v[92:95]
  s_lshl_b32 s49, s49, 11
  v_mfma_f32_16x16x32_bf16 v[92:95], v[196:199], a[148:151], v[92:95]
  ds_read_b64_tr_b16 v[184:185], v6 offset:8
  s_add_u32 s49, s49, s48
  v_mfma_f32_16x16x32_bf16 v[60:63], v[196:199], a[144:147], v[60:63]
  ds_read_b64_tr_b16 v[186:187], v6 offset:2056
  v_mfma_f32_16x16x32_bf16 v[60:63], v[192:195], a[104:107], v[60:63]
  v_mfma_f32_16x16x32_bf16 v[28:31], v[192:195], a[100:103], v[28:31]
  v_mfma_f32_16x16x32_bf16 v[28:31], v[196:199], a[140:143], v[28:31]
  s_waitcnt lgkmcnt(2)
  v_mfma_f32_16x16x32_bf16 v[32:35], v[200:203], a[160:163], 0
  ds_read_b64_tr_b16 v[188:189], v6 offset:4104
  v_cvt_pk_bf16_f32 v224, v24, v25
  v_mfma_f32_16x16x32_bf16 v[32:35], v[204:207], a[180:183], v[32:35]
  ds_read_b64_tr_b16 v[190:191], v6 offset:6152
  v_mfma_f32_16x16x32_bf16 v[64:67], v[204:207], a[184:187], 0
  v_mfma_f32_16x16x32_bf16 v[64:67], v[200:203], a[164:167], v[64:67]
  buffer_load_dwordx4 v17, s[68:71], s94 offen offset:2048 lds
  v_mfma_f32_16x16x32_bf16 v[96:99], v[200:203], a[168:171], 0
  v_cvt_pk_bf16_f32 v225, v26, v27
  v_mfma_f32_16x16x32_bf16 v[96:99], v[204:207], a[188:191], v[96:99]
  ds_read_b64_tr_b16 v[192:193], v6 offset:8192
  v_cvt_pk_bf16_f32 v226, v28, v29
  v_mfma_f32_16x16x32_bf16 v[128:131], v[204:207], a[192:195], 0
  ds_read_b64_tr_b16 v[194:195], v6 offset:10240
  v_mfma_f32_16x16x32_bf16 v[128:131], v[200:203], a[172:175], v[128:131]
  v_cvt_pk_bf16_f32 v227, v30, v31
  v_mfma_f32_16x16x32_bf16 v[160:163], v[200:203], a[176:179], 0
  buffer_load_dwordx4 v18, s[68:71], s94 offen offset:3072 lds
  v_mfma_f32_16x16x32_bf16 v[160:163], v[204:207], a[196:199], v[160:163]
  s_waitcnt lgkmcnt(2)
  v_mfma_f32_16x16x32_bf16 v[164:167], v[184:187], a[176:179], 0
  ds_read_b64_tr_b16 v[196:197], v6 offset:12288
  v_mfma_f32_16x16x32_bf16 v[164:167], v[188:191], a[196:199], v[164:167]
  ds_read_b64_tr_b16 v[198:199], v6 offset:14336
  v_mfma_f32_16x16x32_bf16 v[132:135], v[188:191], a[192:195], 0
  buffer_store_dwordx4 v[224:227], v19, s[24:27], s38 offen offset:0 sc1
  v_mfma_f32_16x16x32_bf16 v[132:135], v[184:187], a[172:175], v[132:135]
  s_add_u32 m0, m0, 0x1000
  v_cvt_pk_bf16_f32 v216, v56, v57
  s_add_u32 s39, s94, 0x8000
  v_mfma_f32_16x16x32_bf16 v[100:103], v[184:187], a[168:171], 0
  v_cvt_pk_bf16_f32 v217, v58, v59
  v_mfma_f32_16x16x32_bf16 v[100:103], v[188:191], a[188:191], v[100:103]
  ds_read_b64_tr_b16 v[200:201], v6 offset:8200
  v_mfma_f32_16x16x32_bf16 v[68:71], v[188:191], a[184:187], 0
  ds_read_b64_tr_b16 v[202:203], v6 offset:10248
  v_cvt_pk_bf16_f32 v218, v60, v61
  v_mfma_f32_16x16x32_bf16 v[68:71], v[184:187], a[164:167], v[68:71]
  v_mfma_f32_16x16x32_bf16 v[36:39], v[184:187], a[160:163], 0
  buffer_load_dwordx4 v15, s[68:71], s39 offen offset:0 lds
  v_mfma_f32_16x16x32_bf16 v[36:39], v[188:191], a[180:183], v[36:39]
  s_waitcnt lgkmcnt(2)
  v_cvt_pk_bf16_f32 v219, v62, v63
  v_mfma_f32_16x16x32_bf16 v[32:35], v[192:195], a[200:203], v[32:35]
  ds_read_b64_tr_b16 v[204:205], v6 offset:12296
  v_mfma_f32_16x16x32_bf16 v[32:35], v[196:199], a[240:243], v[32:35]
  ds_read_b64_tr_b16 v[206:207], v6 offset:14344
  v_mfma_f32_16x16x32_bf16 v[64:67], v[196:199], a[244:247], v[64:67]
  v_mfma_f32_16x16x32_bf16 v[64:67], v[192:195], a[204:207], v[64:67]
  buffer_store_dwordx4 v[216:219], v19, s[24:27], s38 offen offset:1024 sc1
  v_mfma_f32_16x16x32_bf16 v[96:99], v[192:195], a[208:211], v[96:99]
  v_cvt_pk_bf16_f32 v220, v88, v89
  v_mfma_f32_16x16x32_bf16 v[96:99], v[196:199], a[248:251], v[96:99]
  ds_read_b64_tr_b16 v[184:185], v7 offset:0
  v_cvt_pk_bf16_f32 v221, v90, v91
  v_mfma_f32_16x16x32_bf16 v[128:131], v[196:199], a[252:255], v[128:131]
  ds_read_b64_tr_b16 v[186:187], v7 offset:2048
  v_mfma_f32_16x16x32_bf16 v[128:131], v[192:195], a[212:215], v[128:131]
  v_cvt_pk_bf16_f32 v222, v92, v93
  v_mfma_f32_16x16x32_bf16 v[160:163], v[192:195], a[216:219], v[160:163]
  buffer_load_dwordx4 v16, s[68:71], s39 offen offset:1024 lds
  v_mfma_f32_16x16x32_bf16 v[160:163], v[196:199], v[240:243], v[160:163]
  s_waitcnt lgkmcnt(2)
  v_cvt_pk_bf16_f32 v223, v94, v95
  v_mfma_f32_16x16x32_bf16 v[164:167], v[200:203], a[216:219], v[164:167]
  ds_read_b64_tr_b16 v[188:189], v7 offset:4096
  v_mfma_f32_16x16x32_bf16 v[164:167], v[204:207], v[240:243], v[164:167]
  ds_read_b64_tr_b16 v[190:191], v7 offset:6144
  v_mfma_f32_16x16x32_bf16 v[132:135], v[204:207], a[252:255], v[132:135]
  v_mfma_f32_16x16x32_bf16 v[132:135], v[200:203], a[212:215], v[132:135]
  buffer_load_dwordx4 v17, s[68:71], s39 offen offset:2048 lds
  v_mfma_f32_16x16x32_bf16 v[100:103], v[200:203], a[208:211], v[100:103]
  v_cvt_pk_bf16_f32 v224, v120, v121
  v_mfma_f32_16x16x32_bf16 v[100:103], v[204:207], a[248:251], v[100:103]
  buffer_store_dwordx4 v[220:223], v19, s[24:27], s38 offen offset:2048 sc1
  v_mfma_f32_16x16x32_bf16 v[68:71], v[204:207], a[244:247], v[68:71]
  ds_read_b64_tr_b16 v[192:193], v7 offset:8
  v_cvt_pk_bf16_f32 v225, v122, v123
  v_mfma_f32_16x16x32_bf16 v[68:71], v[200:203], a[204:207], v[68:71]
  ds_read_b64_tr_b16 v[194:195], v7 offset:2056
  s_waitcnt vmcnt(17)
  v_lshlrev_b32 v213, 16, v84
  v_mfma_f32_16x16x32_bf16 v[36:39], v[200:203], a[200:203], v[36:39]
  s_waitcnt vmcnt(12)
  v_and_b32 v84, s41, v84
  v_add_f32 v252, v252, v213
  v_mfma_f32_16x16x32_bf16 v[36:39], v[204:207], a[240:243], v[36:39]
  s_waitcnt lgkmcnt(2)
  v_cvt_pk_bf16_f32 v226, v124, v125
  v_add_f32 v253, v253, v84
  v_mfma_f32_16x16x32_bf16 v[32:35], v[184:187], v[40:43], v[32:35]
  ds_read_b64_tr_b16 v[196:197], v7 offset:4104
  v_lshlrev_b32 v213, 16, v85
  v_mfma_f32_16x16x32_bf16 v[32:35], v[188:191], v[44:47], v[32:35]
  v_and_b32 v85, s41, v85
  v_add_f32 v254, v254, v213
  v_mfma_f32_16x16x32_bf16 v[64:67], v[188:191], v[76:79], v[64:67]
  ds_read_b64_tr_b16 v[198:199], v7 offset:6152
  v_cvt_pk_bf16_f32 v227, v126, v127
  v_mfma_f32_16x16x32_bf16 v[64:67], v[184:187], v[72:75], v[64:67]
  buffer_load_dwordx4 v18, s[68:71], s39 offen offset:3072 lds
  v_mfma_f32_16x16x32_bf16 v[96:99], v[184:187], v[104:107], v[96:99]
  s_add_u32 s94, s94, 0x100000
  v_add_f32 v255, v255, v85
  v_lshlrev_b32 v213, 16, v86
  v_mfma_f32_16x16x32_bf16 v[96:99], v[188:191], v[108:111], v[96:99]
  ds_read_b64_tr_b16 v[200:201], v7 offset:8192
  v_and_b32 v86, s41, v86
  v_mfma_f32_16x16x32_bf16 v[128:131], v[188:191], v[140:143], v[128:131]
  s_waitcnt vmcnt(11)
  v_add_f32 v232, v232, v213
  v_readfirstlane_b32 s98, v210
  v_mfma_f32_16x16x32_bf16 v[128:131], v[184:187], v[136:139], v[128:131]
  buffer_store_dwordx4 v[224:227], v19, s[24:27], s38 offen offset:3072 sc1
  v_add_f32 v233, v233, v86
  v_lshlrev_b32 v213, 16, v87
  v_and_b32 v87, s41, v87
  s_cmp_eq_u32 s98, s96
  s_cbranch_scc0 SPIN3
SRET3:
  v_mfma_f32_16x16x32_bf16 v[160:163], v[184:187], v[168:171], v[160:163]
  ds_read_b64_tr_b16 v[202:203], v7 offset:10240
  v_add_f32 v234, v234, v213
  v_mfma_f32_16x16x32_bf16 v[160:163], v[188:191], v[172:175], v[160:163]
  s_waitcnt lgkmcnt(2)
  v_cvt_pk_bf16_f32 v216, v152, v153
  v_add_f32 v236, v236, v87
  v_mfma_f32_16x16x32_bf16 v[164:167], v[192:195], v[168:171], v[164:167]
  ds_read_b64_tr_b16 v[204:205], v7 offset:12288
  v_lshlrev_b32 v213, 16, v116
  v_mfma_f32_16x16x32_bf16 v[164:167], v[196:199], v[172:175], v[164:167]
  v_and_b32 v116, s41, v116
  v_cvt_pk_bf16_f32 v217, v154, v155
  v_mfma_f32_16x16x32_bf16 v[132:135], v[196:199], v[140:143], v[132:135]
  ds_read_b64_tr_b16 v[206:207], v7 offset:14336
  v_add_f32 v237, v237, v213
  v_mfma_f32_16x16x32_bf16 v[132:135], v[192:195], v[136:139], v[132:135]
  ds_read_b64_tr_b16 v[184:185], v7 offset:8200
  v_add_f32 v238, v238, v116
  v_lshlrev_b32 v213, 16, v117
  v_mfma_f32_16x16x32_bf16 v[100:103], v[192:195], v[104:107], v[100:103]
  ds_read_b64_tr_b16 v[186:187], v7 offset:10248
  v_and_b32 v117, s41, v117
  v_cvt_pk_bf16_f32 v218, v156, v157
  v_mfma_f32_16x16x32_bf16 v[100:103], v[196:199], v[108:111], v[100:103]
  ds_read_b64_tr_b16 v[188:189], v7 offset:12296
  v_add_f32 v239, v239, v213
  v_add_f32 v245, v245, v117
  v_mfma_f32_16x16x32_bf16 v[68:71], v[196:199], v[76:79], v[68:71]
  ds_read_b64_tr_b16 v[190:191], v7 offset:14344
  v_lshlrev_b32 v213, 16, v118
  v_and_b32 v118, s41, v118
  v_mfma_f32_16x16x32_bf16 v[68:71], v[192:195], v[72:75], v[68:71]
  s_add_u32 s38, s38, 4096
  v_cvt_pk_bf16_f32 v219, v158, v159
  v_add_f32 v247, v247, v213
  v_mfma_f32_16x16x32_bf16 v[36:39], v[192:195], v[40:43], v[36:39]
  s_add_u32 s30, s29, s31
  v_add_f32 v215, v215, v118
  v_lshlrev_b32 v213, 16, v119
  v_mfma_f32_16x16x32_bf16 v[36:39], v[196:199], v[44:47], v[36:39]
  buffer_store_dwordx4 v[216:219], v19, s[24:27], s38 offen offset:0 sc1
  v_and_b32 v119, s41, v119
  v_add_f32 v212, v212, v213
  s_waitcnt lgkmcnt(6)
  v_mfma_f32_16x16x32_bf16 v[32:35], v[200:203], v[48:51], v[32:35]
  s_waitcnt lgkmcnt(4)
  v_add_f32 v1, v1, v119
  v_lshlrev_b32 v213, 16, v148
  v_mfma_f32_16x16x32_bf16 v[32:35], v[204:207], a[220:223], v[32:35]
  v_and_b32 v148, s41, v148
  v_add_f32 v2, v2, v213
  v_mfma_f32_16x16x32_bf16 v[64:67], v[204:207], a[224:227], v[64:67]
  s_add_u32 s29, s29, 53248
  v_add_f32 v3, v3, v148
  v_lshlrev_b32 v213, 16, v149
  v_mfma_f32_16x16x32_bf16 v[64:67], v[200:203], v[80:83], v[64:67]
  s_cmp_eq_u32 s29, 159744
  v_and_b32 v149, s41, v149
  v_add_f32 v4, v4, v213
  s_cselect_b32 s29, 0, s29
  s_add_u32 s38, s38, 1024
  v_mfma_f32_16x16x32_bf16 v[96:99], v[200:203], v[112:115], v[96:99]
  s_waitcnt vmcnt(16) lgkmcnt(0)
  s_barrier
  v_add_u32 v6, s29, v244
  v_add_f32 v5, v5, v149
  v_mfma_f32_16x16x32_bf16 v[96:99], v[204:207], a[228:231], v[96:99]
  ds_read_b64_tr_b16 v[192:193], v6 offset:0
  v_lshlrev_b32 v213, 16, v150
  v_mfma_f32_16x16x32_bf16 v[128:131], v[204:207], a[232:235], v[128:131]
  ds_read_b64_tr_b16 v[194:195], v6 offset:2048
  v_add_u32 v7, s101, v6
  v_and_b32 v150, s41, v150
  v_mfma_f32_16x16x32_bf16 v[128:131], v[200:203], v[144:147], v[128:131]
  s_add_u32 m0, s30, s31
  v_add_f32 v8, v8, v213
  v_add_f32 v9, v9, v150
  v_mfma_f32_16x16x32_bf16 v[160:163], v[200:203], v[176:179], v[160:163]
  buffer_load_dwordx4 v15, s[68:71], s94 offen offset:0 lds
  v_lshlrev_b32 v213, 16, v151
  v_and_b32 v151, s41, v151
  v_mfma_f32_16x16x32_bf16 v[160:163], v[204:207], a[236:239], v[160:163]
  v_add_f32 v10, v10, v213
  v_add_f32 v11, v11, v151
  v_mfma_f32_16x16x32_bf16 v[164:167], v[184:187], v[176:179], v[164:167]
  ds_read_b64_tr_b16 v[196:197], v6 offset:4096
  v_lshlrev_b32 v213, 16, v180
  v_mfma_f32_16x16x32_bf16 v[164:167], v[188:191], a[236:239], v[164:167]
  v_and_b32 v180, s41, v180
  v_add_f32 v12, v12, v213
  v_mfma_f32_16x16x32_bf16 v[132:135], v[188:191], a[232:235], v[132:135]
  ds_read_b64_tr_b16 v[198:199], v6 offset:6144
  v_add_f32 v13, v13, v180
  v_mfma_f32_16x16x32_bf16 v[132:135], v[184:187], v[144:147], v[132:135]
  buffer_load_dwordx4 v16, s[68:71], s94 offen offset:1024 lds
  v_lshlrev_b32 v213, 16, v181
  v_and_b32 v181, s41, v181
  v_mfma_f32_16x16x32_bf16 v[100:103], v[184:187], v[112:115], v[100:103]
  v_add_f32 v14, v14, v213
  v_add_f32 v20, v20, v181
  v_mfma_f32_16x16x32_bf16 v[100:103], v[188:191], a[228:231], v[100:103]
  ds_read_b64_tr_b16 v[200:201], v6 offset:8
  v_lshlrev_b32 v213, 16, v182
  v_mfma_f32_16x16x32_bf16 v[68:71], v[188:191], a[224:227], v[68:71]
  ds_read_b64_tr_b16 v[202:203], v6 offset:2056
  v_and_b32 v182, s41, v182
  v_add_f32 v21, v21, v213
  v_mfma_f32_16x16x32_bf16 v[68:71], v[184:187], v[80:83], v[68:71]
  v_add_f32 v22, v22, v182
  v_lshlrev_b32 v213, 16, v183
  v_mfma_f32_16x16x32_bf16 v[36:39], v[184:187], v[48:51], v[36:39]
  v_and_b32 v183, s41, v183
  v_add_f32 v23, v23, v213
  v_mfma_f32_16x16x32_bf16 v[36:39], v[188:191], a[220:223], v[36:39]
  s_waitcnt lgkmcnt(2)
  v_add_f32 v0, v0, v183
  v_lshlrev_b32 v213, 16, v52
  v_mfma_f32_16x16x32_bf16 v[32:35], v[192:195], a[0:3], v[32:35]
  ds_read_b64_tr_b16 v[204:205], v6 offset:4104
  v_and_b32 v52, s41, v52
  v_mfma_f32_16x16x32_bf16 v[32:35], v[196:199], a[40:43], v[32:35]
  v_add_f32 v228, v228, v213
  v_add_f32 v229, v229, v52
  v_mfma_f32_16x16x32_bf16 v[64:67], v[196:199], a[44:47], v[64:67]
  ds_read_b64_tr_b16 v[206:207], v6 offset:6152
  v_lshlrev_b32 v213, 16, v53
  v_mfma_f32_16x16x32_bf16 v[64:67], v[192:195], a[4:7], v[64:67]
  buffer_load_dwordx4 v17, s[68:71], s94 offen offset:2048 lds
  v_and_b32 v53, s41, v53
  v_add_f32 v230, v230, v213
  v_mfma_f32_16x16x32_bf16 v[96:99], v[192:195], a[8:11], v[96:99]
  v_add_f32 v231, v231, v53
  v_lshlrev_b32 v213, 16, v54
  v_mfma_f32_16x16x32_bf16 v[96:99], v[196:199], a[48:51], v[96:99]
  ds_read_b64_tr_b16 v[184:185], v6 offset:8192
  v_and_b32 v54, s41, v54
  v_mfma_f32_16x16x32_bf16 v[128:131], v[196:199], a[52:55], v[128:131]
  ds_read_b64_tr_b16 v[186:187], v6 offset:10240
  v_add_f32 v248, v248, v213
  v_add_f32 v249, v249, v54
  v_mfma_f32_16x16x32_bf16 v[128:131], v[192:195], a[12:15], v[128:131]
  v_lshlrev_b32 v213, 16, v55
  v_and_b32 v55, s41, v55
  v_mfma_f32_16x16x32_bf16 v[160:163], v[192:195], a[16:19], v[160:163]
  buffer_load_dwordx4 v18, s[68:71], s94 offen offset:3072 lds
  v_add_f32 v250, v250, v213
  v_mfma_f32_16x16x32_bf16 v[160:163], v[196:199], a[56:59], v[160:163]
  s_waitcnt lgkmcnt(2)
  v_add_f32 v251, v251, v55
  v_mfma_f32_16x16x32_bf16 v[164:167], v[200:203], a[16:19], v[164:167]
  ds_read_b64_tr_b16 v[188:189], v6 offset:12288
  s_add_u32 s40, s93, 41984
  v_mfma_f32_16x16x32_bf16 v[164:167], v[204:207], a[56:59], v[164:167]
  ds_read_b64_tr_b16 v[190:191], v6 offset:14336
  v_mfma_f32_16x16x32_bf16 v[132:135], v[204:207], a[52:55], v[132:135]
  buffer_load_dwordx4 v[84:87], v19, s[24:27], s40 offen offset:0 sc1
  v_mfma_f32_16x16x32_bf16 v[132:135], v[200:203], a[12:15], v[132:135]
  s_add_u32 m0, m0, 0x1000
  s_add_u32 s39, s94, 0x8000
  v_mfma_f32_16x16x32_bf16 v[100:103], v[200:203], a[8:11], v[100:103]
  buffer_load_dwordx4 v[116:119], v19, s[24:27], s40 offen offset:1024 sc1
  v_mfma_f32_16x16x32_bf16 v[100:103], v[204:207], a[48:51], v[100:103]
  ds_read_b64_tr_b16 v[192:193], v6 offset:8200
  v_mfma_f32_16x16x32_bf16 v[68:71], v[204:207], a[44:47], v[68:71]
  ds_read_b64_tr_b16 v[194:195], v6 offset:10248
  v_mfma_f32_16x16x32_bf16 v[68:71], v[200:203], a[4:7], v[68:71]
  buffer_load_dwordx4 v[148:151], v19, s[24:27], s40 offen offset:2048 sc1
  v_mfma_f32_16x16x32_bf16 v[36:39], v[200:203], a[0:3], v[36:39]
  buffer_load_dwordx4 v15, s[68:71], s39 offen offset:0 lds
  v_mfma_f32_16x16x32_bf16 v[36:39], v[204:207], a[40:43], v[36:39]
  buffer_load_dwordx4 v[180:183], v19, s[24:27], s40 offen offset:3072 sc1
  s_waitcnt lgkmcnt(4)
  v_mfma_f32_16x16x32_bf16 v[32:35], v[184:187], a[80:83], v[32:35]
  ds_read_b64_tr_b16 v[196:197], v6 offset:12296
  s_waitcnt lgkmcnt(3)
  v_mfma_f32_16x16x32_bf16 v[32:35], v[188:191], a[120:123], v[32:35]
  s_sub_u32 s40, s40, 1024
  v_mfma_f32_16x16x32_bf16 v[64:67], v[188:191], a[124:127], v[64:67]
  ds_read_b64_tr_b16 v[198:199], v6 offset:14344
  v_mfma_f32_16x16x32_bf16 v[64:67], v[184:187], a[84:87], v[64:67]
  buffer_load_dwordx4 v[52:55], v19, s[24:27], s40 offen sc1
  v_mfma_f32_16x16x32_bf16 v[96:99], v[184:187], a[88:91], v[96:99]
  v_mfma_f32_16x16x32_bf16 v[96:99], v[188:191], a[128:131], v[96:99]
  ds_read_b64_tr_b16 v[200:201], v7 offset:0
  v_mfma_f32_16x16x32_bf16 v[128:131], v[188:191], a[132:135], v[128:131]
  ds_read_b64_tr_b16 v[202:203], v7 offset:2048
  v_mfma_f32_16x16x32_bf16 v[128:131], v[184:187], a[92:95], v[128:131]
  v_mfma_f32_16x16x32_bf16 v[160:163], v[184:187], a[96:99], v[160:163]
  buffer_load_dwordx4 v16, s[68:71], s39 offen offset:1024 lds
  v_mfma_f32_16x16x32_bf16 v[160:163], v[188:191], a[136:139], v[160:163]
  s_waitcnt lgkmcnt(2)
  v_mfma_f32_16x16x32_bf16 v[164:167], v[192:195], a[96:99], v[164:167]
  ds_read_b64_tr_b16 v[204:205], v7 offset:4096
  v_mfma_f32_16x16x32_bf16 v[164:167], v[196:199], a[136:139], v[164:167]
  ds_read_b64_tr_b16 v[206:207], v7 offset:6144
  v_mfma_f32_16x16x32_bf16 v[132:135], v[196:199], a[132:135], v[132:135]
  v_mfma_f32_16x16x32_bf16 v[132:135], v[192:195], a[92:95], v[132:135]
  buffer_load_dwordx4 v17, s[68:71], s39 offen offset:2048 lds
  v_mfma_f32_16x16x32_bf16 v[100:103], v[192:195], a[88:91], v[100:103]
  v_mfma_f32_16x16x32_bf16 v[100:103], v[196:199], a[128:131], v[100:103]
  ds_read_b64_tr_b16 v[184:185], v7 offset:8
  v_mfma_f32_16x16x32_bf16 v[68:71], v[196:199], a[124:127], v[68:71]
  ds_read_b64_tr_b16 v[186:187], v7 offset:2056
  v_mfma_f32_16x16x32_bf16 v[68:71], v[192:195], a[84:87], v[68:71]
  v_mfma_f32_16x16x32_bf16 v[36:39], v[192:195], a[80:83], v[36:39]
  v_mfma_f32_16x16x32_bf16 v[36:39], v[196:199], a[120:123], v[36:39]
  s_waitcnt lgkmcnt(2)
  v_mfma_f32_16x16x32_bf16 v[32:35], v[200:203], a[20:23], v[32:35]
  ds_read_b64_tr_b16 v[188:189], v7 offset:4104
  v_mfma_f32_16x16x32_bf16 v[32:35], v[204:207], a[60:63], v[32:35]
  ds_read_b64_tr_b16 v[190:191], v7 offset:6152
  s_add_u32 s94, s88, 8
  v_mfma_f32_16x16x32_bf16 v[64:67], v[204:207], a[64:67], v[64:67]
  s_and_b32 s94, s94, 7
  s_lshl_b32 s94, s94, 7
  s_add_u32 s94, s94, s100
  v_mfma_f32_16x16x32_bf16 v[64:67], v[200:203], a[24:27], v[64:67]
  buffer_load_dwordx4 v18, s[68:71], s39 offen offset:3072 lds
  v_mfma_f32_16x16x32_bf16 v[96:99], v[200:203], a[28:31], v[96:99]
  v_mfma_f32_16x16x32_bf16 v[96:99], v[204:207], a[68:71], v[96:99]
  ds_read_b64_tr_b16 v[192:193], v7 offset:8192
  v_mfma_f32_16x16x32_bf16 v[128:131], v[204:207], a[72:75], v[128:131]
  ds_read_b64_tr_b16 v[194:195], v7 offset:10240
  s_waitcnt vmcnt(13)
  v_mfma_f32_16x16x32_bf16 v[128:131], v[200:203], a[32:35], v[128:131]
  buffer_store_dword v208, v211, s[24:27], s49 offen offset:1024 sc1
  v_mfma_f32_16x16x32_bf16 v[160:163], v[200:203], a[36:39], v[160:163]
  buffer_load_dword v214, off, s[24:27], s48 offset:768 sc1
  v_mfma_f32_16x16x32_bf16 v[160:163], v[204:207], a[76:79], v[160:163]
  s_waitcnt lgkmcnt(2)
  v_mfma_f32_16x16x32_bf16 v[164:167], v[184:187], a[36:39], v[164:167]
  ds_read_b64_tr_b16 v[196:197], v7 offset:12288
  v_mfma_f32_16x16x32_bf16 v[164:167], v[188:191], a[76:79], v[164:167]
  ds_read_b64_tr_b16 v[198:199], v7 offset:14336
  v_mfma_f32_16x16x32_bf16 v[132:135], v[188:191], a[72:75], v[132:135]
  ds_read_b64_tr_b16 v[200:201], v7 offset:8200
  v_mfma_f32_16x16x32_bf16 v[132:135], v[184:187], a[32:35], v[132:135]
  ds_read_b64_tr_b16 v[202:203], v7 offset:10248
  v_mfma_f32_16x16x32_bf16 v[100:103], v[184:187], a[28:31], v[100:103]
  v_mfma_f32_16x16x32_bf16 v[100:103], v[188:191], a[68:71], v[100:103]
  ds_read_b64_tr_b16 v[204:205], v7 offset:12296
  v_mfma_f32_16x16x32_bf16 v[68:71], v[188:191], a[64:67], v[68:71]
  ds_read_b64_tr_b16 v[206:207], v7 offset:14344
  s_add_u32 s30, s29, s31
  v_mfma_f32_16x16x32_bf16 v[68:71], v[184:187], a[24:27], v[68:71]
  s_add_u32 s29, s29, 53248
  v_mfma_f32_16x16x32_bf16 v[36:39], v[184:187], a[20:23], v[36:39]
  s_cmp_eq_u32 s29, 159744
  s_cselect_b32 s29, 0, s29
  v_mfma_f32_16x16x32_bf16 v[36:39], v[188:191], a[60:63], v[36:39]
  s_waitcnt lgkmcnt(4)
  v_mfma_f32_16x16x32_bf16 v[32:35], v[192:195], a[100:103], v[32:35]
  v_add_u32 v6, s29, v244
  v_mfma_f32_16x16x32_bf16 v[32:35], v[196:199], a[140:143], v[32:35]
  v_add_u32 v7, s101, v6
  v_mfma_f32_16x16x32_bf16 v[64:67], v[196:199], a[144:147], v[64:67]
  v_mfma_f32_16x16x32_bf16 v[64:67], v[192:195], a[104:107], v[64:67]
  v_mfma_f32_16x16x32_bf16 v[96:99], v[192:195], a[108:111], v[96:99]
  s_waitcnt vmcnt(17) lgkmcnt(0)
  s_barrier
  s_add_u32 s91, s88, 6
  s_add_u32 m0, s30, s31
  v_mfma_f32_16x16x32_bf16 v[96:99], v[196:199], a[148:151], v[96:99]
  ds_read_b64_tr_b16 v[184:185], v6 offset:0
  s_and_b32 s91, s91, 7
  v_mfma_f32_16x16x32_bf16 v[128:131], v[196:199], a[152:155], v[128:131]
  ds_read_b64_tr_b16 v[186:187], v6 offset:2048
  s_sub_u32 s91, s91, s88
  v_mfma_f32_16x16x32_bf16 v[128:131], v[192:195], a[112:115], v[128:131]
  v_mfma_f32_16x16x32_bf16 v[160:163], v[192:195], a[116:119], v[160:163]
  buffer_load_dwordx4 v15, s[68:71], s94 offen offset:0 lds
  v_mfma_f32_16x16x32_bf16 v[160:163], v[196:199], a[156:159], v[160:163]
  s_mul_i32 s38, s91, 163840
  v_mfma_f32_16x16x32_bf16 v[164:167], v[200:203], a[116:119], v[164:167]
  ds_read_b64_tr_b16 v[188:189], v6 offset:4096
  s_add_u32 s38, s38, s93
  v_mfma_f32_16x16x32_bf16 v[164:167], v[204:207], a[156:159], v[164:167]
  ds_read_b64_tr_b16 v[190:191], v6 offset:6144
  s_add_u32 s38, s38, 102400
  v_mfma_f32_16x16x32_bf16 v[132:135], v[204:207], a[152:155], v[132:135]
  v_mfma_f32_16x16x32_bf16 v[132:135], v[200:203], a[112:115], v[132:135]
  buffer_load_dwordx4 v16, s[68:71], s94 offen offset:1024 lds
  v_mfma_f32_16x16x32_bf16 v[100:103], v[200:203], a[108:111], v[100:103]
  s_lshl_b32 s91, s91, 11
  v_mfma_f32_16x16x32_bf16 v[100:103], v[204:207], a[148:151], v[100:103]
  ds_read_b64_tr_b16 v[192:193], v6 offset:8
  s_add_u32 s91, s91, s48
  v_mfma_f32_16x16x32_bf16 v[68:71], v[204:207], a[144:147], v[68:71]
  ds_read_b64_tr_b16 v[194:195], v6 offset:2056
  v_mfma_f32_16x16x32_bf16 v[68:71], v[200:203], a[104:107], v[68:71]
  v_mfma_f32_16x16x32_bf16 v[36:39], v[200:203], a[100:103], v[36:39]
  v_mfma_f32_16x16x32_bf16 v[36:39], v[204:207], a[140:143], v[36:39]
  s_waitcnt lgkmcnt(2)
  v_mfma_f32_16x16x32_bf16 v[24:27], v[184:187], a[160:163], 0
  ds_read_b64_tr_b16 v[196:197], v6 offset:4104
  v_cvt_pk_bf16_f32 v220, v32, v33
  v_mfma_f32_16x16x32_bf16 v[24:27], v[188:191], a[180:183], v[24:27]
  ds_read_b64_tr_b16 v[198:199], v6 offset:6152
  v_mfma_f32_16x16x32_bf16 v[56:59], v[188:191], a[184:187], 0
  v_mfma_f32_16x16x32_bf16 v[56:59], v[184:187], a[164:167], v[56:59]
  buffer_load_dwordx4 v17, s[68:71], s94 offen offset:2048 lds
  v_mfma_f32_16x16x32_bf16 v[88:91], v[184:187], a[168:171], 0
  v_cvt_pk_bf16_f32 v221, v34, v35
  v_mfma_f32_16x16x32_bf16 v[88:91], v[188:191], a[188:191], v[88:91]
  ds_read_b64_tr_b16 v[200:201], v6 offset:8192
  v_cvt_pk_bf16_f32 v222, v36, v37
  v_mfma_f32_16x16x32_bf16 v[120:123], v[188:191], a[192:195], 0
  ds_read_b64_tr_b16 v[202:203], v6 offset:10240
  v_mfma_f32_16x16x32_bf16 v[120:123], v[184:187], a[172:175], v[120:123]
  v_cvt_pk_bf16_f32 v223, v38, v39
  v_mfma_f32_16x16x32_bf16 v[152:155], v[184:187], a[176:179], 0
  buffer_load_dwordx4 v18, s[68:71], s94 offen offset:3072 lds
  v_mfma_f32_16x16x32_bf16 v[152:155], v[188:191], a[196:199], v[152:155]
  s_waitcnt lgkmcnt(2)
  v_mfma_f32_16x16x32_bf16 v[156:159], v[192:195], a[176:179], 0
  ds_read_b64_tr_b16 v[204:205], v6 offset:12288
  v_mfma_f32_16x16x32_bf16 v[156:159], v[196:199], a[196:199], v[156:159]
  ds_read_b64_tr_b16 v[206:207], v6 offset:14336
  v_mfma_f32_16x16x32_bf16 v[124:127], v[196:199], a[192:195], 0
  buffer_store_dwordx4 v[220:223], v19, s[24:27], s38 offen offset:0 sc1
  v_mfma_f32_16x16x32_bf16 v[124:127], v[192:195], a[172:175], v[124:127]
  s_add_u32 m0, m0, 0x1000
  v_cvt_pk_bf16_f32 v224, v64, v65
  s_waitcnt vmcnt(15)
  v_lshlrev_b32 v213, 16, v84
  v_mfma_f32_16x16x32_bf16 v[92:95], v[192:195], a[168:171], 0
  s_waitcnt vmcnt(10)
  v_and_b32 v84, s41, v84
  v_add_f32 v252, v252, v213
  v_mfma_f32_16x16x32_bf16 v[92:95], v[196:199], a[188:191], v[92:95]
  ds_read_b64_tr_b16 v[184:185], v6 offset:8200
  v_cvt_pk_bf16_f32 v225, v66, v67
  v_mfma_f32_16x16x32_bf16 v[60:63], v[196:199], a[184:187], 0
  ds_read_b64_tr_b16 v[186:187], v6 offset:10248
  v_add_f32 v253, v253, v84
  v_mfma_f32_16x16x32_bf16 v[60:63], v[192:195], a[164:167], v[60:63]
  s_add_u32 s39, s94, 0x8000
  v_lshlrev_b32 v213, 16, v85
  v_and_b32 v85, s41, v85
  v_mfma_f32_16x16x32_bf16 v[28:31], v[192:195], a[160:163], 0
  buffer_load_dwordx4 v15, s[68:71], s39 offen offset:0 lds
  v_mfma_f32_16x16x32_bf16 v[28:31], v[196:199], a[180:183], v[28:31]
  s_waitcnt lgkmcnt(2)
  v_cvt_pk_bf16_f32 v226, v68, v69
  v_add_f32 v254, v254, v213
  v_mfma_f32_16x16x32_bf16 v[24:27], v[200:203], a[200:203], v[24:27]
  ds_read_b64_tr_b16 v[188:189], v6 offset:12296
  v_add_f32 v255, v255, v85
  v_mfma_f32_16x16x32_bf16 v[24:27], v[204:207], a[240:243], v[24:27]
  v_lshlrev_b32 v213, 16, v86
  v_and_b32 v86, s41, v86
  v_mfma_f32_16x16x32_bf16 v[56:59], v[204:207], a[244:247], v[56:59]
  ds_read_b64_tr_b16 v[190:191], v6 offset:14344
  v_cvt_pk_bf16_f32 v227, v70, v71
  v_mfma_f32_16x16x32_bf16 v[56:59], v[200:203], a[204:207], v[56:59]
  buffer_store_dwordx4 v[224:227], v19, s[24:27], s38 offen offset:1024 sc1
  v_add_f32 v232, v232, v213
  v_mfma_f32_16x16x32_bf16 v[88:91], v[200:203], a[208:211], v[88:91]
  v_add_f32 v233, v233, v86
  v_lshlrev_b32 v213, 16, v87
  v_mfma_f32_16x16x32_bf16 v[88:91], v[204:207], a[248:251], v[88:91]
  ds_read_b64_tr_b16 v[192:193], v7 offset:0
  v_and_b32 v87, s41, v87
  v_mfma_f32_16x16x32_bf16 v[120:123], v[204:207], a[252:255], v[120:123]
  ds_read_b64_tr_b16 v[194:195], v7 offset:2048
  v_add_f32 v234, v234, v213
  v_add_f32 v236, v236, v87
  v_mfma_f32_16x16x32_bf16 v[120:123], v[200:203], a[212:215], v[120:123]
  v_lshlrev_b32 v213, 16, v116
  v_and_b32 v116, s41, v116
  v_mfma_f32_16x16x32_bf16 v[152:155], v[200:203], a[216:219], v[152:155]
  buffer_load_dwordx4 v16, s[68:71], s39 offen offset:1024 lds
  v_cvt_pk_bf16_f32 v216, v96, v97
  v_add_f32 v237, v237, v213
  v_mfma_f32_16x16x32_bf16 v[152:155], v[204:207], v[240:243], v[152:155]
  s_waitcnt lgkmcnt(2)
  v_add_f32 v238, v238, v116
  v_lshlrev_b32 v213, 16, v117
  v_mfma_f32_16x16x32_bf16 v[156:159], v[184:187], a[216:219], v[156:159]
  ds_read_b64_tr_b16 v[196:197], v7 offset:4096
  v_cvt_pk_bf16_f32 v217, v98, v99
  v_and_b32 v117, s41, v117
  v_mfma_f32_16x16x32_bf16 v[156:159], v[188:191], v[240:243], v[156:159]
  v_add_f32 v239, v239, v213
  v_add_f32 v245, v245, v117
  v_mfma_f32_16x16x32_bf16 v[124:127], v[188:191], a[252:255], v[124:127]
  ds_read_b64_tr_b16 v[198:199], v7 offset:6144
  v_lshlrev_b32 v213, 16, v118
  v_cvt_pk_bf16_f32 v218, v100, v101
  v_and_b32 v118, s41, v118
  v_mfma_f32_16x16x32_bf16 v[124:127], v[184:187], a[212:215], v[124:127]
  buffer_load_dwordx4 v17, s[68:71], s39 offen offset:2048 lds
  v_add_f32 v247, v247, v213
  v_mfma_f32_16x16x32_bf16 v[92:95], v[184:187], a[208:211], v[92:95]
  v_add_f32 v215, v215, v118
  v_lshlrev_b32 v213, 16, v119
  v_cvt_pk_bf16_f32 v219, v102, v103
  v_mfma_f32_16x16x32_bf16 v[92:95], v[188:191], a[248:251], v[92:95]
  buffer_store_dwordx4 v[216:219], v19, s[24:27], s38 offen offset:2048 sc1
  v_and_b32 v119, s41, v119
  v_add_f32 v212, v212, v213
  v_mfma_f32_16x16x32_bf16 v[60:63], v[188:191], a[244:247], v[60:63]
  ds_read_b64_tr_b16 v[200:201], v7 offset:8
  v_add_f32 v1, v1, v119
  v_mfma_f32_16x16x32_bf16 v[60:63], v[184:187], a[204:207], v[60:63]
  ds_read_b64_tr_b16 v[202:203], v7 offset:2056
  v_lshlrev_b32 v213, 16, v148
  v_and_b32 v148, s41, v148
  v_mfma_f32_16x16x32_bf16 v[28:31], v[184:187], a[200:203], v[28:31]
  v_add_f32 v2, v2, v213
  v_add_f32 v3, v3, v148
  v_mfma_f32_16x16x32_bf16 v[28:31], v[188:191], a[240:243], v[28:31]
  s_waitcnt lgkmcnt(2)
  v_cvt_pk_bf16_f32 v220, v128, v129
  v_lshlrev_b32 v213, 16, v149
  v_mfma_f32_16x16x32_bf16 v[24:27], v[192:195], v[40:43], v[24:27]
  ds_read_b64_tr_b16 v[204:205], v7 offset:4104
  v_and_b32 v149, s41, v149
  v_add_f32 v4, v4, v213
  v_mfma_f32_16x16x32_bf16 v[24:27], v[196:199], v[44:47], v[24:27]
  v_add_f32 v5, v5, v149
  v_cvt_pk_bf16_f32 v221, v130, v131
  v_lshlrev_b32 v213, 16, v150
  v_mfma_f32_16x16x32_bf16 v[56:59], v[196:199], v[76:79], v[56:59]
  ds_read_b64_tr_b16 v[206:207], v7 offset:6152
  v_and_b32 v150, s41, v150
  v_mfma_f32_16x16x32_bf16 v[56:59], v[192:195], v[72:75], v[56:59]
  buffer_load_dwordx4 v18, s[68:71], s39 offen offset:3072 lds
  v_add_f32 v8, v8, v213
  v_cvt_pk_bf16_f32 v222, v132, v133
  v_add_f32 v9, v9, v150
  v_mfma_f32_16x16x32_bf16 v[88:91], v[192:195], v[104:107], v[88:91]
  s_add_u32 s94, s94, 0x100000
  v_lshlrev_b32 v213, 16, v151
  v_and_b32 v151, s41, v151
  v_mfma_f32_16x16x32_bf16 v[88:91], v[196:199], v[108:111], v[88:91]
  ds_read_b64_tr_b16 v[184:185], v7 offset:8192
  v_add_f32 v10, v10, v213
  v_cvt_pk_bf16_f32 v223, v134, v135
  v_mfma_f32_16x16x32_bf16 v[120:123], v[196:199], v[140:143], v[120:123]
  s_waitcnt vmcnt(11)
  v_add_f32 v11, v11, v151
  v_lshlrev_b32 v213, 16, v180
  v_mfma_f32_16x16x32_bf16 v[120:123], v[192:195], v[136:139], v[120:123]
  buffer_store_dwordx4 v[220:223], v19, s[24:27], s38 offen offset:3072 sc1
  v_and_b32 v180, s41, v180
  v_add_f32 v12, v12, v213
  v_readfirstlane_b32 s98, v214
  v_add_f32 v13, v13, v180
  v_lshlrev_b32 v213, 16, v181
  v_and_b32 v181, s41, v181
  s_cmp_eq_u32 s98, s96
  s_cbranch_scc0 SPIN4
SRET4:
  v_mfma_f32_16x16x32_bf16 v[152:155], v[192:195], v[168:171], v[152:155]
  ds_read_b64_tr_b16 v[186:187], v7 offset:10240
  v_add_f32 v14, v14, v213
  v_mfma_f32_16x16x32_bf16 v[152:155], v[196:199], v[172:175], v[152:155]
  s_waitcnt lgkmcnt(2)
  v_cvt_pk_bf16_f32 v224, v160, v161
  v_add_f32 v20, v20, v181
  v_mfma_f32_16x16x32_bf16 v[156:159], v[200:203], v[168:171], v[156:159]
  ds_read_b64_tr_b16 v[188:189], v7 offset:12288
  v_lshlrev_b32 v213, 16, v182
  v_mfma_f32_16x16x32_bf16 v[156:159], v[204:207], v[172:175], v[156:159]
  v_and_b32 v182, s41, v182
  v_cvt_pk_bf16_f32 v225, v162, v163
  v_mfma_f32_16x16x32_bf16 v[124:127], v[204:207], v[140:143], v[124:127]
  ds_read_b64_tr_b16 v[190:191], v7 offset:14336
  v_add_f32 v21, v21, v213
  v_mfma_f32_16x16x32_bf16 v[124:127], v[200:203], v[136:139], v[124:127]
  ds_read_b64_tr_b16 v[192:193], v7 offset:8200
  v_add_f32 v22, v22, v182
  v_lshlrev_b32 v213, 16, v183
  v_mfma_f32_16x16x32_bf16 v[92:95], v[200:203], v[104:107], v[92:95]
  ds_read_b64_tr_b16 v[194:195], v7 offset:10248
  v_and_b32 v183, s41, v183
  v_cvt_pk_bf16_f32 v226, v164, v165
  v_mfma_f32_16x16x32_bf16 v[92:95], v[204:207], v[108:111], v[92:95]
  ds_read_b64_tr_b16 v[196:197], v7 offset:12296
  v_add_f32 v23, v23, v213
  v_add_f32 v0, v0, v183
  v_mfma_f32_16x16x32_bf16 v[60:63], v[204:207], v[76:79], v[60:63]
  ds_read_b64_tr_b16 v[198:199], v7 offset:14344
  v_lshlrev_b32 v213, 16, v52
  v_and_b32 v52, s41, v52
  v_mfma_f32_16x16x32_bf16 v[60:63], v[200:203], v[72:75], v[60:63]
  s_add_u32 s38, s38, 4096
  v_cvt_pk_bf16_f32 v227, v166, v167
  v_add_f32 v228, v228, v213
  v_mfma_f32_16x16x32_bf16 v[28:31], v[200:203], v[40:43], v[28:31]
  s_add_u32 s30, s29, s31
  v_add_f32 v229, v229, v52
  v_lshlrev_b32 v213, 16, v53
  v_mfma_f32_16x16x32_bf16 v[28:31], v[204:207], v[44:47], v[28:31]
  buffer_store_dwordx4 v[224:227], v19, s[24:27], s38 offen offset:0 sc1
  v_and_b32 v53, s41, v53
  v_add_f32 v230, v230, v213
  s_waitcnt lgkmcnt(6)
  v_mfma_f32_16x16x32_bf16 v[24:27], v[184:187], v[48:51], v[24:27]
  s_waitcnt lgkmcnt(4)
  v_add_f32 v231, v231, v53
  v_lshlrev_b32 v213, 16, v54
  v_mfma_f32_16x16x32_bf16 v[24:27], v[188:191], a[220:223], v[24:27]
  v_and_b32 v54, s41, v54
  v_add_f32 v248, v248, v213
  v_mfma_f32_16x16x32_bf16 v[56:59], v[188:191], a[224:227], v[56:59]
  s_add_u32 s29, s29, 53248
  v_add_f32 v249, v249, v54
  v_lshlrev_b32 v213, 16, v55
  v_mfma_f32_16x16x32_bf16 v[56:59], v[184:187], v[80:83], v[56:59]
  s_cmp_eq_u32 s29, 159744
  v_and_b32 v55, s41, v55
  v_add_f32 v250, v250, v213
  s_cselect_b32 s29, 0, s29
  s_add_u32 s38, s38, 1024
  v_mfma_f32_16x16x32_bf16 v[88:91], v[184:187], v[112:115], v[88:91]
  s_waitcnt vmcnt(15) lgkmcnt(0)
  s_barrier
  v_add_u32 v6, s29, v244
  v_add_f32 v251, v251, v55
  v_mfma_f32_16x16x32_bf16 v[88:91], v[188:191], a[228:231], v[88:91]
  ds_read_b64_tr_b16 v[200:201], v6 offset:0
  v_add_u32 v7, s101, v6
  v_mfma_f32_16x16x32_bf16 v[120:123], v[188:191], a[232:235], v[120:123]
  ds_read_b64_tr_b16 v[202:203], v6 offset:2048
  s_add_u32 m0, s30, s31
  v_mfma_f32_16x16x32_bf16 v[120:123], v[184:187], v[144:147], v[120:123]
  s_add_u32 s40, s93, 62464
  v_mfma_f32_16x16x32_bf16 v[152:155], v[184:187], v[176:179], v[152:155]
  buffer_load_dwordx4 v15, s[68:71], s94 offen offset:0 lds
  v_mfma_f32_16x16x32_bf16 v[152:155], v[188:191], a[236:239], v[152:155]
  buffer_load_dwordx4 v[84:87], v19, s[24:27], s40 offen offset:0 sc1
  v_mfma_f32_16x16x32_bf16 v[156:159], v[192:195], v[176:179], v[156:159]
  ds_read_b64_tr_b16 v[204:205], v6 offset:4096
  v_mfma_f32_16x16x32_bf16 v[156:159], v[196:199], a[236:239], v[156:159]
  v_mfma_f32_16x16x32_bf16 v[124:127], v[196:199], a[232:235], v[124:127]
  buffer_load_dwordx4 v[116:119], v19, s[24:27], s40 offen offset:1024 sc1
  v_mfma_f32_16x16x32_bf16 v[124:127], v[192:195], v[144:147], v[124:127]
  ds_read_b64_tr_b16 v[206:207], v6 offset:6144
  v_mfma_f32_16x16x32_bf16 v[92:95], v[192:195], v[112:115], v[92:95]
  buffer_load_dwordx4 v[148:151], v19, s[24:27], s40 offen offset:2048 sc1
  v_mfma_f32_16x16x32_bf16 v[92:95], v[196:199], a[228:231], v[92:95]
  buffer_load_dwordx4 v16, s[68:71], s94 offen offset:1024 lds
  v_mfma_f32_16x16x32_bf16 v[60:63], v[196:199], a[224:227], v[60:63]
  buffer_load_dwordx4 v[180:183], v19, s[24:27], s40 offen offset:3072 sc1
  v_mfma_f32_16x16x32_bf16 v[60:63], v[192:195], v[80:83], v[60:63]
  ds_read_b64_tr_b16 v[184:185], v6 offset:8
  s_sub_u32 s40, s40, 1024
  v_mfma_f32_16x16x32_bf16 v[28:31], v[192:195], v[48:51], v[28:31]
  ds_read_b64_tr_b16 v[186:187], v6 offset:2056
  v_mfma_f32_16x16x32_bf16 v[28:31], v[196:199], a[220:223], v[28:31]
  buffer_load_dwordx4 v[52:55], v19, s[24:27], s40 offen sc1
  s_waitcnt lgkmcnt(4)
  v_mfma_f32_16x16x32_bf16 v[24:27], v[200:203], a[0:3], v[24:27]
  ds_read_b64_tr_b16 v[188:189], v6 offset:4104
  s_waitcnt lgkmcnt(3)
  v_mfma_f32_16x16x32_bf16 v[24:27], v[204:207], a[40:43], v[24:27]
  v_mfma_f32_16x16x32_bf16 v[56:59], v[204:207], a[44:47], v[56:59]
  ds_read_b64_tr_b16 v[190:191], v6 offset:6152
  v_mfma_f32_16x16x32_bf16 v[56:59], v[200:203], a[4:7], v[56:59]
  buffer_load_dwordx4 v17, s[68:71], s94 offen offset:2048 lds
  v_mfma_f32_16x16x32_bf16 v[88:91], v[200:203], a[8:11], v[88:91]
  v_mfma_f32_16x16x32_bf16 v[88:91], v[204:207], a[48:51], v[88:91]
  ds_read_b64_tr_b16 v[192:193], v6 offset:8192
  v_mfma_f32_16x16x32_bf16 v[120:123], v[204:207], a[52:55], v[120:123]
  ds_read_b64_tr_b16 v[194:195], v6 offset:10240
  v_mfma_f32_16x16x32_bf16 v[120:123], v[200:203], a[12:15], v[120:123]
  v_mfma_f32_16x16x32_bf16 v[152:155], v[200:203], a[16:19], v[152:155]
  buffer_load_dwordx4 v18, s[68:71], s94 offen offset:3072 lds
  v_mfma_f32_16x16x32_bf16 v[152:155], v[204:207], a[56:59], v[152:155]
  s_waitcnt lgkmcnt(2)
  v_mfma_f32_16x16x32_bf16 v[156:159], v[184:187], a[16:19], v[156:159]
  ds_read_b64_tr_b16 v[196:197], v6 offset:12288
  v_mfma_f32_16x16x32_bf16 v[156:159], v[188:191], a[56:59], v[156:159]
  ds_read_b64_tr_b16 v[198:199], v6 offset:14336
  v_mfma_f32_16x16x32_bf16 v[124:127], v[188:191], a[52:55], v[124:127]
  v_mfma_f32_16x16x32_bf16 v[124:127], v[184:187], a[12:15], v[124:127]
  s_add_u32 m0, m0, 0x1000
  s_add_u32 s39, s94, 0x8000
  v_mfma_f32_16x16x32_bf16 v[92:95], v[184:187], a[8:11], v[92:95]
  v_mfma_f32_16x16x32_bf16 v[92:95], v[188:191], a[48:51], v[92:95]
  ds_read_b64_tr_b16 v[200:201], v6 offset:8200
  v_mfma_f32_16x16x32_bf16 v[60:63], v[188:191], a[44:47], v[60:63]
  ds_read_b64_tr_b16 v[202:203], v6 offset:10248
  v_mfma_f32_16x16x32_bf16 v[60:63], v[184:187], a[4:7], v[60:63]
  v_mfma_f32_16x16x32_bf16 v[28:31], v[184:187], a[0:3], v[28:31]
  buffer_load_dwordx4 v15, s[68:71], s39 offen offset:0 lds
  v_mfma_f32_16x16x32_bf16 v[28:31], v[188:191], a[40:43], v[28:31]
  s_waitcnt lgkmcnt(2)
  v_mfma_f32_16x16x32_bf16 v[24:27], v[192:195], a[80:83], v[24:27]
  ds_read_b64_tr_b16 v[204:205], v6 offset:12296
  v_mfma_f32_16x16x32_bf16 v[24:27], v[196:199], a[120:123], v[24:27]
  ds_read_b64_tr_b16 v[206:207], v6 offset:14344
  v_mfma_f32_16x16x32_bf16 v[56:59], v[196:199], a[124:127], v[56:59]
  v_mfma_f32_16x16x32_bf16 v[56:59], v[192:195], a[84:87], v[56:59]
  v_mfma_f32_16x16x32_bf16 v[88:91], v[192:195], a[88:91], v[88:91]
  v_mfma_f32_16x16x32_bf16 v[88:91], v[196:199], a[128:131], v[88:91]
  ds_read_b64_tr_b16 v[184:185], v7 offset:0
  v_mfma_f32_16x16x32_bf16 v[120:123], v[196:199], a[132:135], v[120:123]
  ds_read_b64_tr_b16 v[186:187], v7 offset:2048
  v_mfma_f32_16x16x32_bf16 v[120:123], v[192:195], a[92:95], v[120:123]
  v_mfma_f32_16x16x32_bf16 v[152:155], v[192:195], a[96:99], v[152:155]
  buffer_load_dwordx4 v16, s[68:71], s39 offen offset:1024 lds
  v_mfma_f32_16x16x32_bf16 v[152:155], v[196:199], a[136:139], v[152:155]
  s_waitcnt lgkmcnt(2)
  v_mfma_f32_16x16x32_bf16 v[156:159], v[200:203], a[96:99], v[156:159]
  ds_read_b64_tr_b16 v[188:189], v7 offset:4096
  v_mfma_f32_16x16x32_bf16 v[156:159], v[204:207], a[136:139], v[156:159]
  ds_read_b64_tr_b16 v[190:191], v7 offset:6144
  v_mfma_f32_16x16x32_bf16 v[124:127], v[204:207], a[132:135], v[124:127]
  buffer_load_dword v210, off, s[24:27], s48 offset:1024 sc1
  v_mfma_f32_16x16x32_bf16 v[124:127], v[200:203], a[92:95], v[124:127]
  buffer_load_dwordx4 v17, s[68:71], s39 offen offset:2048 lds
  v_mfma_f32_16x16x32_bf16 v[92:95], v[200:203], a[88:91], v[92:95]
  v_mfma_f32_16x16x32_bf16 v[92:95], v[204:207], a[128:131], v[92:95]
  ds_read_b64_tr_b16 v[192:193], v7 offset:8
  v_mfma_f32_16x16x32_bf16 v[60:63], v[204:207], a[124:127], v[60:63]
  ds_read_b64_tr_b16 v[194:195], v7 offset:2056
  v_mfma_f32_16x16x32_bf16 v[60:63], v[200:203], a[84:87], v[60:63]
  v_mfma_f32_16x16x32_bf16 v[28:31], v[200:203], a[80:83], v[28:31]
  v_mfma_f32_16x16x32_bf16 v[28:31], v[204:207], a[120:123], v[28:31]
  s_waitcnt lgkmcnt(2)
  v_mfma_f32_16x16x32_bf16 v[24:27], v[184:187], a[20:23], v[24:27]
  ds_read_b64_tr_b16 v[196:197], v7 offset:4104
  v_mfma_f32_16x16x32_bf16 v[24:27], v[188:191], a[60:63], v[24:27]
  ds_read_b64_tr_b16 v[198:199], v7 offset:6152
  s_add_u32 s94, s88, 9
  v_mfma_f32_16x16x32_bf16 v[56:59], v[188:191], a[64:67], v[56:59]
  s_and_b32 s94, s94, 7
  s_lshl_b32 s94, s94, 7
  s_add_u32 s94, s94, s100
  v_mfma_f32_16x16x32_bf16 v[56:59], v[184:187], a[24:27], v[56:59]
  buffer_load_dwordx4 v18, s[68:71], s39 offen offset:3072 lds
  v_mfma_f32_16x16x32_bf16 v[88:91], v[184:187], a[28:31], v[88:91]
  v_mfma_f32_16x16x32_bf16 v[88:91], v[188:191], a[68:71], v[88:91]
  ds_read_b64_tr_b16 v[200:201], v7 offset:8192
  v_mfma_f32_16x16x32_bf16 v[120:123], v[188:191], a[72:75], v[120:123]
  ds_read_b64_tr_b16 v[202:203], v7 offset:10240
  s_waitcnt vmcnt(14)
  v_mfma_f32_16x16x32_bf16 v[120:123], v[184:187], a[32:35], v[120:123]
  buffer_store_dword v208, v211, s[24:27], s91 offen offset:1280 sc1
  v_mfma_f32_16x16x32_bf16 v[152:155], v[184:187], a[36:39], v[152:155]
  v_mfma_f32_16x16x32_bf16 v[152:155], v[188:191], a[76:79], v[152:155]
  s_waitcnt lgkmcnt(2)
  v_mfma_f32_16x16x32_bf16 v[156:159], v[192:195], a[36:39], v[156:159]
  ds_read_b64_tr_b16 v[204:205], v7 offset:12288
  v_mfma_f32_16x16x32_bf16 v[156:159], v[196:199], a[76:79], v[156:159]
  ds_read_b64_tr_b16 v[206:207], v7 offset:14336
  v_mfma_f32_16x16x32_bf16 v[124:127], v[196:199], a[72:75], v[124:127]
  ds_read_b64_tr_b16 v[184:185], v7 offset:8200
  v_mfma_f32_16x16x32_bf16 v[124:127], v[192:195], a[32:35], v[124:127]
  ds_read_b64_tr_b16 v[186:187], v7 offset:10248
  v_mfma_f32_16x16x32_bf16 v[92:95], v[192:195], a[28:31], v[92:95]
  v_mfma_f32_16x16x32_bf16 v[92:95], v[196:199], a[68:71], v[92:95]
  ds_read_b64_tr_b16 v[188:189], v7 offset:12296
  v_mfma_f32_16x16x32_bf16 v[60:63], v[196:199], a[64:67], v[60:63]
  ds_read_b64_tr_b16 v[190:191], v7 offset:14344
  s_add_u32 s30, s29, s31
  v_mfma_f32_16x16x32_bf16 v[60:63], v[192:195], a[24:27], v[60:63]
  s_add_u32 s29, s29, 53248
  v_mfma_f32_16x16x32_bf16 v[28:31], v[192:195], a[20:23], v[28:31]
  s_cmp_eq_u32 s29, 159744
  s_cselect_b32 s29, 0, s29
  v_mfma_f32_16x16x32_bf16 v[28:31], v[196:199], a[60:63], v[28:31]
  s_waitcnt lgkmcnt(4)
  v_mfma_f32_16x16x32_bf16 v[24:27], v[200:203], a[100:103], v[24:27]
  v_add_u32 v6, s29, v244
  v_mfma_f32_16x16x32_bf16 v[24:27], v[204:207], a[140:143], v[24:27]
  v_add_u32 v7, s101, v6
  v_mfma_f32_16x16x32_bf16 v[56:59], v[204:207], a[144:147], v[56:59]
  v_mfma_f32_16x16x32_bf16 v[56:59], v[200:203], a[104:107], v[56:59]
  v_mfma_f32_16x16x32_bf16 v[88:91], v[200:203], a[108:111], v[88:91]
  s_waitcnt vmcnt(17) lgkmcnt(0)
  s_barrier
  s_add_u32 s49, s88, 7
  s_and_b32 s49, s49, 7
  v_mfma_f32_16x16x32_bf16 v[88:91], v[204:207], a[148:151], v[88:91]
  ds_read_b64_tr_b16 v[192:193], v6 offset:0
  v_mfma_f32_16x16x32_bf16 v[120:123], v[204:207], a[152:155], v[120:123]
  ds_read_b64_tr_b16 v[194:195], v6 offset:2048
  s_sub_u32 s49, s49, s88
  v_mfma_f32_16x16x32_bf16 v[120:123], v[200:203], a[112:115], v[120:123]
  v_mfma_f32_16x16x32_bf16 v[152:155], v[200:203], a[116:119], v[152:155]
  s_mul_i32 s38, s49, 163840
  s_waitcnt vmcnt(13)
  v_lshlrev_b32 v213, 16, v84
  v_mfma_f32_16x16x32_bf16 v[152:155], v[204:207], a[156:159], v[152:155]
  v_and_b32 v84, s41, v84
  v_mfma_f32_16x16x32_bf16 v[156:159], v[184:187], a[116:119], v[156:159]
  ds_read_b64_tr_b16 v[196:197], v6 offset:4096
  v_add_f32 v252, v252, v213
  v_mfma_f32_16x16x32_bf16 v[156:159], v[188:191], a[156:159], v[156:159]
  ds_read_b64_tr_b16 v[198:199], v6 offset:6144
  v_add_f32 v253, v253, v84
  v_mfma_f32_16x16x32_bf16 v[124:127], v[188:191], a[152:155], v[124:127]
  s_waitcnt vmcnt(8)
  v_lshlrev_b32 v213, 16, v85
  v_and_b32 v85, s41, v85
  v_mfma_f32_16x16x32_bf16 v[124:127], v[184:187], a[112:115], v[124:127]
  s_add_u32 s38, s38, s93
  v_add_f32 v254, v254, v213
  v_add_f32 v255, v255, v85
  v_mfma_f32_16x16x32_bf16 v[92:95], v[184:187], a[108:111], v[92:95]
  s_add_u32 s38, s38, 122880
  v_lshlrev_b32 v213, 16, v86
  v_and_b32 v86, s41, v86
  v_mfma_f32_16x16x32_bf16 v[92:95], v[188:191], a[148:151], v[92:95]
  ds_read_b64_tr_b16 v[200:201], v6 offset:8
  v_add_f32 v232, v232, v213
  v_mfma_f32_16x16x32_bf16 v[60:63], v[188:191], a[144:147], v[60:63]
  ds_read_b64_tr_b16 v[202:203], v6 offset:2056
  v_add_f32 v233, v233, v86
  v_mfma_f32_16x16x32_bf16 v[60:63], v[184:187], a[104:107], v[60:63]
  s_lshl_b32 s49, s49, 11
  v_lshlrev_b32 v213, 16, v87
  v_and_b32 v87, s41, v87
  v_mfma_f32_16x16x32_bf16 v[28:31], v[184:187], a[100:103], v[28:31]
  s_add_u32 s49, s49, s48
  v_add_f32 v234, v234, v213
  v_add_f32 v236, v236, v87
  v_mfma_f32_16x16x32_bf16 v[28:31], v[188:191], a[140:143], v[28:31]
  s_waitcnt lgkmcnt(2)
  v_lshlrev_b32 v213, 16, v116
  v_and_b32 v116, s41, v116
  v_mfma_f32_16x16x32_bf16 v[32:35], v[192:195], a[160:163], 0
  ds_read_b64_tr_b16 v[204:205], v6 offset:4104
  v_add_f32 v237, v237, v213
  v_mfma_f32_16x16x32_bf16 v[32:35], v[196:199], a[180:183], v[32:35]
  v_add_f32 v238, v238, v116
  v_cvt_pk_bf16_f32 v216, v24, v25
  v_mfma_f32_16x16x32_bf16 v[64:67], v[196:199], a[184:187], 0
  ds_read_b64_tr_b16 v[206:207], v6 offset:6152
  v_lshlrev_b32 v213, 16, v117
  v_mfma_f32_16x16x32_bf16 v[64:67], v[192:195], a[164:167], v[64:67]
  v_and_b32 v117, s41, v117
  v_cvt_pk_bf16_f32 v217, v26, v27
  v_mfma_f32_16x16x32_bf16 v[96:99], v[192:195], a[168:171], 0
  v_add_f32 v239, v239, v213
  v_cvt_pk_bf16_f32 v218, v28, v29
  v_mfma_f32_16x16x32_bf16 v[96:99], v[196:199], a[188:191], v[96:99]
  ds_read_b64_tr_b16 v[184:185], v6 offset:8192
  v_add_f32 v245, v245, v117
  v_mfma_f32_16x16x32_bf16 v[128:131], v[196:199], a[192:195], 0
  ds_read_b64_tr_b16 v[186:187], v6 offset:10240
  v_cvt_pk_bf16_f32 v219, v30, v31
  v_mfma_f32_16x16x32_bf16 v[128:131], v[192:195], a[172:175], v[128:131]
  buffer_store_dwordx4 v[216:219], v19, s[24:27], s38 offen offset:0 sc1
  v_mfma_f32_16x16x32_bf16 v[160:163], v[192:195], a[176:179], 0
  v_lshlrev_b32 v213, 16, v118
  v_and_b32 v118, s41, v118
  v_mfma_f32_16x16x32_bf16 v[160:163], v[196:199], a[196:199], v[160:163]
  s_waitcnt lgkmcnt(2)
  v_add_f32 v247, v247, v213
  v_cvt_pk_bf16_f32 v220, v56, v57
  v_mfma_f32_16x16x32_bf16 v[164:167], v[200:203], a[176:179], 0
  ds_read_b64_tr_b16 v[188:189], v6 offset:12288
  v_add_f32 v215, v215, v118
  v_cvt_pk_bf16_f32 v221, v58, v59
  v_lshlrev_b32 v213, 16, v119
  v_mfma_f32_16x16x32_bf16 v[164:167], v[204:207], a[196:199], v[164:167]
  v_cvt_pk_bf16_f32 v222, v60, v61
  v_and_b32 v119, s41, v119
  v_cvt_pk_bf16_f32 v223, v62, v63
  v_add_f32 v212, v212, v213
  v_mfma_f32_16x16x32_bf16 v[132:135], v[204:207], a[192:195], 0
  buffer_store_dwordx4 v[220:223], v19, s[24:27], s38 offen offset:1024 sc1
  v_add_f32 v1, v1, v119
  v_mfma_f32_16x16x32_bf16 v[132:135], v[200:203], a[172:175], v[132:135]
  ds_read_b64_tr_b16 v[190:191], v6 offset:14336
  v_lshlrev_b32 v213, 16, v148
  v_cvt_pk_bf16_f32 v224, v88, v89
  v_and_b32 v148, s41, v148
  v_mfma_f32_16x16x32_bf16 v[100:103], v[200:203], a[168:171], 0
  v_cvt_pk_bf16_f32 v225, v90, v91
  v_add_f32 v2, v2, v213
  v_cvt_pk_bf16_f32 v226, v92, v93
  v_add_f32 v3, v3, v148
  v_mfma_f32_16x16x32_bf16 v[100:103], v[204:207], a[188:191], v[100:103]
  ds_read_b64_tr_b16 v[192:193], v6 offset:8200
  v_lshlrev_b32 v213, 16, v149
  v_cvt_pk_bf16_f32 v227, v94, v95
  v_mfma_f32_16x16x32_bf16 v[68:71], v[204:207], a[184:187], 0
  buffer_store_dwordx4 v[224:227], v19, s[24:27], s38 offen offset:2048 sc1
  v_and_b32 v149, s41, v149
  v_add_f32 v4, v4, v213
  v_mfma_f32_16x16x32_bf16 v[68:71], v[200:203], a[164:167], v[68:71]
  ds_read_b64_tr_b16 v[194:195], v6 offset:10248
  v_cvt_pk_bf16_f32 v216, v120, v121
  v_add_f32 v5, v5, v149
  v_cvt_pk_bf16_f32 v217, v122, v123
  v_lshlrev_b32 v213, 16, v150
  v_mfma_f32_16x16x32_bf16 v[36:39], v[200:203], a[160:163], 0
  v_cvt_pk_bf16_f32 v218, v124, v125
  v_and_b32 v150, s41, v150
  v_mfma_f32_16x16x32_bf16 v[36:39], v[204:207], a[180:183], v[36:39]
  s_waitcnt lgkmcnt(2)
  v_add_f32 v8, v8, v213
  v_cvt_pk_bf16_f32 v219, v126, v127
  v_add_f32 v9, v9, v150
  v_mfma_f32_16x16x32_bf16 v[32:35], v[184:187], a[200:203], v[32:35]
  buffer_store_dwordx4 v[216:219], v19, s[24:27], s38 offen offset:3072 sc1
  v_lshlrev_b32 v213, 16, v151
  v_cvt_pk_bf16_f32 v220, v152, v153
  v_and_b32 v151, s41, v151
  v_mfma_f32_16x16x32_bf16 v[32:35], v[188:191], a[240:243], v[32:35]
  v_cvt_pk_bf16_f32 v221, v154, v155
  v_add_f32 v10, v10, v213
  v_mfma_f32_16x16x32_bf16 v[64:67], v[188:191], a[244:247], v[64:67]
  ds_read_b64_tr_b16 v[196:197], v6 offset:12296
  v_add_f32 v11, v11, v151
  v_cvt_pk_bf16_f32 v222, v156, v157
  v_lshlrev_b32 v213, 16, v180
  s_waitcnt vmcnt(7)
  v_mfma_f32_16x16x32_bf16 v[64:67], v[184:187], a[204:207], v[64:67]
  s_add_u32 s38, s38, 4096
  v_cvt_pk_bf16_f32 v223, v158, v159
  v_and_b32 v180, s41, v180
  ds_read_b64_tr_b16 v[198:199], v6 offset:14344
  v_add_f32 v12, v12, v213
  v_readfirstlane_b32 s98, v210
  buffer_store_dwordx4 v[220:223], v19, s[24:27], s38 offen offset:0 sc1
  v_add_f32 v13, v13, v180
  v_lshlrev_b32 v213, 16, v181
  s_add_u32 s38, s38, 1024
  v_and_b32 v181, s41, v181
  s_cmp_eq_u32 s98, s96
  s_cbranch_scc0 SPIN5
SRET5:
  v_mfma_f32_16x16x32_bf16 v[96:99], v[184:187], a[208:211], v[96:99]
  v_add_f32 v14, v14, v213
  v_add_f32 v20, v20, v181
  v_mfma_f32_16x16x32_bf16 v[96:99], v[188:191], a[248:251], v[96:99]
  ds_read_b64_tr_b16 v[200:201], v7 offset:0
  v_lshlrev_b32 v213, 16, v182
  v_mfma_f32_16x16x32_bf16 v[128:131], v[188:191], a[252:255], v[128:131]
  ds_read_b64_tr_b16 v[202:203], v7 offset:2048
  v_and_b32 v182, s41, v182
  v_mfma_f32_16x16x32_bf16 v[128:131], v[184:187], a[212:215], v[128:131]
  v_add_f32 v21, v21, v213
  v_add_f32 v22, v22, v182
  v_mfma_f32_16x16x32_bf16 v[160:163], v[184:187], a[216:219], v[160:163]
  v_lshlrev_b32 v213, 16, v183
  v_and_b32 v183, s41, v183
  v_mfma_f32_16x16x32_bf16 v[160:163], v[188:191], v[240:243], v[160:163]
  s_waitcnt lgkmcnt(2)
  v_add_f32 v23, v23, v213
  v_add_f32 v0, v0, v183
  v_mfma_f32_16x16x32_bf16 v[164:167], v[192:195], a[216:219], v[164:167]
  ds_read_b64_tr_b16 v[204:205], v7 offset:4096
  v_lshlrev_b32 v213, 16, v52
  v_mfma_f32_16x16x32_bf16 v[164:167], v[196:199], v[240:243], v[164:167]
  v_and_b32 v52, s41, v52
  v_add_f32 v228, v228, v213
  v_mfma_f32_16x16x32_bf16 v[132:135], v[196:199], a[252:255], v[132:135]
  ds_read_b64_tr_b16 v[206:207], v7 offset:6144
  v_add_f32 v229, v229, v52
  v_mfma_f32_16x16x32_bf16 v[132:135], v[192:195], a[212:215], v[132:135]
  v_lshlrev_b32 v213, 16, v53
  v_and_b32 v53, s41, v53
  v_mfma_f32_16x16x32_bf16 v[100:103], v[192:195], a[208:211], v[100:103]
  v_add_f32 v230, v230, v213
  v_add_f32 v231, v231, v53
  v_mfma_f32_16x16x32_bf16 v[100:103], v[196:199], a[248:251], v[100:103]
  ds_read_b64_tr_b16 v[184:185], v7 offset:8
  v_lshlrev_b32 v213, 16, v54
  v_mfma_f32_16x16x32_bf16 v[68:71], v[196:199], a[244:247], v[68:71]
  ds_read_b64_tr_b16 v[186:187], v7 offset:2056
  v_and_b32 v54, s41, v54
  v_mfma_f32_16x16x32_bf16 v[68:71], v[192:195], a[204:207], v[68:71]
  v_add_f32 v248, v248, v213
  v_add_f32 v249, v249, v54
  v_mfma_f32_16x16x32_bf16 v[36:39], v[192:195], a[200:203], v[36:39]
  v_lshlrev_b32 v213, 16, v55
  v_and_b32 v55, s41, v55
  v_mfma_f32_16x16x32_bf16 v[36:39], v[196:199], a[240:243], v[36:39]
  s_waitcnt lgkmcnt(2)
  v_add_f32 v250, v250, v213
  v_add_f32 v251, v251, v55
  v_mfma_f32_16x16x32_bf16 v[32:35], v[200:203], v[40:43], v[32:35]
  ds_read_b64_tr_b16 v[188:189], v7 offset:4104
  v_mfma_f32_16x16x32_bf16 v[32:35], v[204:207], v[44:47], v[32:35]
  ds_read_b64_tr_b16 v[190:191], v7 offset:6152
  s_add_u32 s40, s93, 82944
  v_mfma_f32_16x16x32_bf16 v[64:67], v[204:207], v[76:79], v[64:67]
  v_mfma_f32_16x16x32_bf16 v[64:67], v[200:203], v[72:75], v[64:67]
  v_mfma_f32_16x16x32_bf16 v[96:99], v[200:203], v[104:107], v[96:99]
  buffer_load_dwordx4 v[84:87], v19, s[24:27], s40 offen offset:0 sc1
  v_mfma_f32_16x16x32_bf16 v[96:99], v[204:207], v[108:111], v[96:99]
  ds_read_b64_tr_b16 v[192:193], v7 offset:8192
  v_mfma_f32_16x16x32_bf16 v[128:131], v[204:207], v[140:143], v[128:131]
  ds_read_b64_tr_b16 v[194:195], v7 offset:10240
  v_mfma_f32_16x16x32_bf16 v[128:131], v[200:203], v[136:139], v[128:131]
  buffer_load_dwordx4 v[116:119], v19, s[24:27], s40 offen offset:1024 sc1
  v_mfma_f32_16x16x32_bf16 v[160:163], v[200:203], v[168:171], v[160:163]
  buffer_load_dword v214, off, s[24:27], s48 offset:1280 sc1
  v_mfma_f32_16x16x32_bf16 v[160:163], v[204:207], v[172:175], v[160:163]
  buffer_load_dwordx4 v[148:151], v19, s[24:27], s40 offen offset:2048 sc1
  s_waitcnt lgkmcnt(4)
  v_mfma_f32_16x16x32_bf16 v[164:167], v[184:187], v[168:171], v[164:167]
  ds_read_b64_tr_b16 v[196:197], v7 offset:12288
  s_waitcnt lgkmcnt(3)
  v_mfma_f32_16x16x32_bf16 v[164:167], v[188:191], v[172:175], v[164:167]
  v_mfma_f32_16x16x32_bf16 v[132:135], v[188:191], v[140:143], v[132:135]
  buffer_load_dwordx4 v[180:183], v19, s[24:27], s40 offen offset:3072 sc1
  v_mfma_f32_16x16x32_bf16 v[132:135], v[184:187], v[136:139], v[132:135]
  ds_read_b64_tr_b16 v[198:199], v7 offset:14336
  s_sub_u32 s40, s40, 1024
  v_mfma_f32_16x16x32_bf16 v[100:103], v[184:187], v[104:107], v[100:103]
  ds_read_b64_tr_b16 v[200:201], v7 offset:8200
  v_mfma_f32_16x16x32_bf16 v[100:103], v[188:191], v[108:111], v[100:103]
  ds_read_b64_tr_b16 v[202:203], v7 offset:10248
  v_mfma_f32_16x16x32_bf16 v[68:71], v[188:191], v[76:79], v[68:71]
  buffer_load_dwordx4 v[52:55], v19, s[24:27], s40 offen sc1
  v_mfma_f32_16x16x32_bf16 v[68:71], v[184:187], v[72:75], v[68:71]
  ds_read_b64_tr_b16 v[204:205], v7 offset:12296
  s_add_u32 s30, s29, s31
  v_mfma_f32_16x16x32_bf16 v[36:39], v[184:187], v[40:43], v[36:39]
  ds_read_b64_tr_b16 v[206:207], v7 offset:14344
  s_add_u32 s29, s29, 53248
  v_mfma_f32_16x16x32_bf16 v[36:39], v[188:191], v[44:47], v[36:39]
  s_waitcnt lgkmcnt(4)
  s_cmp_eq_u32 s29, 159744
  v_mfma_f32_16x16x32_bf16 v[32:35], v[192:195], v[48:51], v[32:35]
  s_cselect_b32 s29, 0, s29
  v_add_u32 v6, s29, v244
  v_mfma_f32_16x16x32_bf16 v[32:35], v[196:199], a[220:223], v[32:35]
  v_add_u32 v7, s101, v6
  v_mfma_f32_16x16x32_bf16 v[64:67], v[196:199], a[224:227], v[64:67]
  s_waitcnt vmcnt(6)
  v_mfma_f32_16x16x32_bf16 v[64:67], v[192:195], v[80:83], v[64:67]
  buffer_store_dword v208, v211, s[24:27], s49 offen offset:1536 sc1
  v_mfma_f32_16x16x32_bf16 v[96:99], v[192:195], v[112:115], v[96:99]
  s_waitcnt vmcnt(13) lgkmcnt(0)
  s_barrier
  v_mfma_f32_16x16x32_bf16 v[96:99], v[196:199], a[228:231], v[96:99]
  ds_read_b64_tr_b16 v[184:185], v6 offset:0
  v_mfma_f32_16x16x32_bf16 v[128:131], v[196:199], a[232:235], v[128:131]
  ds_read_b64_tr_b16 v[186:187], v6 offset:2048
  v_mfma_f32_16x16x32_bf16 v[128:131], v[192:195], v[144:147], v[128:131]
  v_mfma_f32_16x16x32_bf16 v[160:163], v[192:195], v[176:179], v[160:163]
  v_mfma_f32_16x16x32_bf16 v[160:163], v[196:199], a[236:239], v[160:163]
  v_mfma_f32_16x16x32_bf16 v[164:167], v[200:203], v[176:179], v[164:167]
  ds_read_b64_tr_b16 v[188:189], v6 offset:4096
  v_mfma_f32_16x16x32_bf16 v[164:167], v[204:207], a[236:239], v[164:167]
  ds_read_b64_tr_b16 v[190:191], v6 offset:6144
  v_mfma_f32_16x16x32_bf16 v[132:135], v[204:207], a[232:235], v[132:135]
  v_mfma_f32_16x16x32_bf16 v[132:135], v[200:203], v[144:147], v[132:135]
  v_mfma_f32_16x16x32_bf16 v[100:103], v[200:203], v[112:115], v[100:103]
  v_mfma_f32_16x16x32_bf16 v[100:103], v[204:207], a[228:231], v[100:103]
  ds_read_b64_tr_b16 v[192:193], v6 offset:8
  v_mfma_f32_16x16x32_bf16 v[68:71], v[204:207], a[224:227], v[68:71]
  ds_read_b64_tr_b16 v[194:195], v6 offset:2056
  v_mfma_f32_16x16x32_bf16 v[68:71], v[200:203], v[80:83], v[68:71]
  v_mfma_f32_16x16x32_bf16 v[36:39], v[200:203], v[48:51], v[36:39]
  v_mfma_f32_16x16x32_bf16 v[36:39], v[204:207], a[220:223], v[36:39]
  s_waitcnt lgkmcnt(2)
  v_mfma_f32_16x16x32_bf16 v[32:35], v[184:187], a[0:3], v[32:35]
  ds_read_b64_tr_b16 v[196:197], v6 offset:4104
  v_mfma_f32_16x16x32_bf16 v[32:35], v[188:191], a[40:43], v[32:35]
  ds_read_b64_tr_b16 v[198:199], v6 offset:6152
  v_mfma_f32_16x16x32_bf16 v[64:67], v[188:191], a[44:47], v[64:67]
  s_waitcnt vmcnt(4)
  v_readfirstlane_b32 s98, v214
  v_mfma_f32_16x16x32_bf16 v[64:67], v[184:187], a[4:7], v[64:67]
  v_mfma_f32_16x16x32_bf16 v[96:99], v[184:187], a[8:11], v[96:99]
  s_cmp_eq_u32 s98, s96
  v_mfma_f32_16x16x32_bf16 v[96:99], v[188:191], a[48:51], v[96:99]
  ds_read_b64_tr_b16 v[200:201], v6 offset:8192
  v_mfma_f32_16x16x32_bf16 v[128:131], v[188:191], a[52:55], v[128:131]
  ds_read_b64_tr_b16 v[202:203], v6 offset:10240
  v_mfma_f32_16x16x32_bf16 v[128:131], v[184:187], a[12:15], v[128:131]
  s_cbranch_scc0 SPIN6
SRET6:
  v_mfma_f32_16x16x32_bf16 v[160:163], v[184:187], a[16:19], v[160:163]
  s_add_u32 s40, s93, 103424
  v_mfma_f32_16x16x32_bf16 v[160:163], v[188:191], a[56:59], v[160:163]
  s_waitcnt lgkmcnt(2)
  v_mfma_f32_16x16x32_bf16 v[164:167], v[192:195], a[16:19], v[164:167]
  ds_read_b64_tr_b16 v[204:205], v6 offset:12288
  v_mfma_f32_16x16x32_bf16 v[164:167], v[196:199], a[56:59], v[164:167]
  ds_read_b64_tr_b16 v[206:207], v6 offset:14336
  v_mfma_f32_16x16x32_bf16 v[132:135], v[196:199], a[52:55], v[132:135]
  buffer_load_dwordx4 v[56:59], v19, s[24:27], s40 offen offset:0 sc1
  v_mfma_f32_16x16x32_bf16 v[132:135], v[192:195], a[12:15], v[132:135]
  v_mfma_f32_16x16x32_bf16 v[100:103], v[192:195], a[8:11], v[100:103]
  buffer_load_dwordx4 v[88:91], v19, s[24:27], s40 offen offset:1024 sc1
  v_mfma_f32_16x16x32_bf16 v[100:103], v[196:199], a[48:51], v[100:103]
  ds_read_b64_tr_b16 v[184:185], v6 offset:8200
  v_mfma_f32_16x16x32_bf16 v[68:71], v[196:199], a[44:47], v[68:71]
  ds_read_b64_tr_b16 v[186:187], v6 offset:10248
  v_mfma_f32_16x16x32_bf16 v[68:71], v[192:195], a[4:7], v[68:71]
  buffer_load_dwordx4 v[120:123], v19, s[24:27], s40 offen offset:2048 sc1
  v_mfma_f32_16x16x32_bf16 v[36:39], v[192:195], a[0:3], v[36:39]
  buffer_load_dwordx4 v[152:155], v19, s[24:27], s40 offen offset:3072 sc1
  v_mfma_f32_16x16x32_bf16 v[36:39], v[196:199], a[40:43], v[36:39]
  s_waitcnt lgkmcnt(2)
  s_sub_u32 s40, s40, 1024
  v_mfma_f32_16x16x32_bf16 v[32:35], v[200:203], a[80:83], v[32:35]
  ds_read_b64_tr_b16 v[188:189], v6 offset:12296
  v_mfma_f32_16x16x32_bf16 v[32:35], v[204:207], a[120:123], v[32:35]
  ds_read_b64_tr_b16 v[190:191], v6 offset:14344
  v_mfma_f32_16x16x32_bf16 v[64:67], v[204:207], a[124:127], v[64:67]
  buffer_load_dwordx4 v[24:27], v19, s[24:27], s40 offen sc1
  v_mfma_f32_16x16x32_bf16 v[64:67], v[200:203], a[84:87], v[64:67]
  v_mfma_f32_16x16x32_bf16 v[96:99], v[200:203], a[88:91], v[96:99]
  v_mfma_f32_16x16x32_bf16 v[96:99], v[204:207], a[128:131], v[96:99]
  ds_read_b64_tr_b16 v[192:193], v7 offset:0
  v_mfma_f32_16x16x32_bf16 v[128:131], v[204:207], a[132:135], v[128:131]
  ds_read_b64_tr_b16 v[194:195], v7 offset:2048
  v_mfma_f32_16x16x32_bf16 v[128:131], v[200:203], a[92:95], v[128:131]
  v_mfma_f32_16x16x32_bf16 v[160:163], v[200:203], a[96:99], v[160:163]
  v_mfma_f32_16x16x32_bf16 v[160:163], v[204:207], a[136:139], v[160:163]
  s_waitcnt lgkmcnt(2)
  v_mfma_f32_16x16x32_bf16 v[164:167], v[184:187], a[96:99], v[164:167]
  ds_read_b64_tr_b16 v[196:197], v7 offset:4096
  v_mfma_f32_16x16x32_bf16 v[164:167], v[188:191], a[136:139], v[164:167]
  ds_read_b64_tr_b16 v[198:199], v7 offset:6144
  v_mfma_f32_16x16x32_bf16 v[132:135], v[188:191], a[132:135], v[132:135]
  v_mfma_f32_16x16x32_bf16 v[132:135], v[184:187], a[92:95], v[132:135]
  v_mfma_f32_16x16x32_bf16 v[100:103], v[184:187], a[88:91], v[100:103]
  v_mfma_f32_16x16x32_bf16 v[100:103], v[188:191], a[128:131], v[100:103]
  ds_read_b64_tr_b16 v[200:201], v7 offset:8
  v_mfma_f32_16x16x32_bf16 v[68:71], v[188:191], a[124:127], v[68:71]
  ds_read_b64_tr_b16 v[202:203], v7 offset:2056
  v_lshlrev_b32 v213, 16, v84
  v_mfma_f32_16x16x32_bf16 v[68:71], v[184:187], a[84:87], v[68:71]
  v_and_b32 v84, s41, v84
  v_add_f32 v252, v252, v213
  v_mfma_f32_16x16x32_bf16 v[36:39], v[184:187], a[80:83], v[36:39]
  s_waitcnt vmcnt(6)
  v_add_f32 v253, v253, v84
  v_lshlrev_b32 v213, 16, v85
  v_mfma_f32_16x16x32_bf16 v[36:39], v[188:191], a[120:123], v[36:39]
  s_waitcnt lgkmcnt(2)
  v_and_b32 v85, s41, v85
  v_add_f32 v254, v254, v213
  v_mfma_f32_16x16x32_bf16 v[32:35], v[192:195], a[20:23], v[32:35]
  ds_read_b64_tr_b16 v[204:205], v7 offset:4104
  v_add_f32 v255, v255, v85
  v_mfma_f32_16x16x32_bf16 v[32:35], v[196:199], a[60:63], v[32:35]
  v_lshlrev_b32 v213, 16, v86
  v_and_b32 v86, s41, v86
  v_mfma_f32_16x16x32_bf16 v[64:67], v[196:199], a[64:67], v[64:67]
  ds_read_b64_tr_b16 v[206:207], v7 offset:6152
  v_add_f32 v232, v232, v213
  v_mfma_f32_16x16x32_bf16 v[64:67], v[192:195], a[24:27], v[64:67]
  v_add_f32 v233, v233, v86
  v_lshlrev_b32 v213, 16, v87
  v_mfma_f32_16x16x32_bf16 v[96:99], v[192:195], a[28:31], v[96:99]
  v_and_b32 v87, s41, v87
  v_add_f32 v234, v234, v213
  v_mfma_f32_16x16x32_bf16 v[96:99], v[196:199], a[68:71], v[96:99]
  ds_read_b64_tr_b16 v[184:185], v7 offset:8192
  v_add_f32 v236, v236, v87
  v_mfma_f32_16x16x32_bf16 v[128:131], v[196:199], a[72:75], v[128:131]
  ds_read_b64_tr_b16 v[186:187], v7 offset:10240
  v_lshlrev_b32 v213, 16, v116
  v_mfma_f32_16x16x32_bf16 v[128:131], v[192:195], a[32:35], v[128:131]
  v_and_b32 v116, s41, v116
  v_add_f32 v237, v237, v213
  v_mfma_f32_16x16x32_bf16 v[160:163], v[192:195], a[36:39], v[160:163]
  v_add_f32 v238, v238, v116
  v_lshlrev_b32 v213, 16, v117
  v_mfma_f32_16x16x32_bf16 v[160:163], v[196:199], a[76:79], v[160:163]
  s_waitcnt lgkmcnt(2)
  v_and_b32 v15, 0xf0, v19
  v_and_b32 v117, s41, v117
  v_mfma_f32_16x16x32_bf16 v[164:167], v[200:203], a[36:39], v[164:167]
  ds_read_b64_tr_b16 v[188:189], v7 offset:12288
  v_add_f32 v239, v239, v213
  v_mfma_f32_16x16x32_bf16 v[164:167], v[204:207], a[76:79], v[164:167]
  v_add_f32 v245, v245, v117
  v_lshlrev_b32 v213, 16, v118
  v_mfma_f32_16x16x32_bf16 v[132:135], v[204:207], a[72:75], v[132:135]
  ds_read_b64_tr_b16 v[190:191], v7 offset:14336
  v_and_b32 v118, s41, v118
  v_mfma_f32_16x16x32_bf16 v[132:135], v[200:203], a[32:35], v[132:135]
  ds_read_b64_tr_b16 v[192:193], v7 offset:8200
  v_lshlrev_b32 v15, 7, v15
  v_mfma_f32_16x16x32_bf16 v[100:103], v[200:203], a[28:31], v[100:103]
  ds_read_b64_tr_b16 v[194:195], v7 offset:10248
  v_add_f32 v247, v247, v213
  v_mfma_f32_16x16x32_bf16 v[100:103], v[204:207], a[68:71], v[100:103]
  ds_read_b64_tr_b16 v[196:197], v7 offset:12296
  v_add_f32 v215, v215, v118
  v_lshlrev_b32 v213, 16, v119
  v_mfma_f32_16x16x32_bf16 v[68:71], v[204:207], a[64:67], v[68:71]
  ds_read_b64_tr_b16 v[198:199], v7 offset:14344
  v_and_b32 v119, s41, v119
  v_add_f32 v212, v212, v213
  v_lshrrev_b32 v16, 8, v19
  v_mfma_f32_16x16x32_bf16 v[68:71], v[200:203], a[24:27], v[68:71]
  v_add_f32 v1, v1, v119
  v_lshlrev_b32 v213, 16, v148
  v_mfma_f32_16x16x32_bf16 v[36:39], v[200:203], a[20:23], v[36:39]
  v_and_b32 v148, s41, v148
  v_add_f32 v2, v2, v213
  v_mfma_f32_16x16x32_bf16 v[36:39], v[204:207], a[60:63], v[36:39]
  s_waitcnt lgkmcnt(4)
  v_add_f32 v3, v3, v148
  v_lshl_add_u32 v15, v16, 4, v15
  v_lshlrev_b32 v213, 16, v149
  v_mfma_f32_16x16x32_bf16 v[32:35], v[184:187], a[100:103], v[32:35]
  v_and_b32 v149, s41, v149
  v_add_f32 v4, v4, v213
  v_mfma_f32_16x16x32_bf16 v[32:35], v[188:191], a[140:143], v[32:35]
  v_add_f32 v5, v5, v149
  v_lshlrev_b32 v213, 16, v150
  v_and_b32 v150, s41, v150
  v_mfma_f32_16x16x32_bf16 v[64:67], v[188:191], a[144:147], v[64:67]
  v_add_f32 v8, v8, v213
  v_add_f32 v9, v9, v150
  v_mfma_f32_16x16x32_bf16 v[64:67], v[184:187], a[104:107], v[64:67]
  buffer_load_dword v210, off, s[24:27], s48 offset:1536 sc1
  v_lshlrev_b32 v213, 16, v151
  v_and_b32 v151, s41, v151
  v_mfma_f32_16x16x32_bf16 v[96:99], v[184:187], a[108:111], v[96:99]
  v_add_f32 v10, v10, v213
  v_add_f32 v11, v11, v151
  v_mfma_f32_16x16x32_bf16 v[96:99], v[188:191], a[148:151], v[96:99]
  v_lshlrev_b32 v213, 16, v180
  v_and_b32 v180, s41, v180
  v_mfma_f32_16x16x32_bf16 v[128:131], v[188:191], a[152:155], v[128:131]
  v_add_f32 v12, v12, v213
  v_add_f32 v13, v13, v180
  v_mfma_f32_16x16x32_bf16 v[128:131], v[184:187], a[112:115], v[128:131]
  v_lshlrev_b32 v213, 16, v181
  v_and_b32 v181, s41, v181
  v_mfma_f32_16x16x32_bf16 v[160:163], v[184:187], a[116:119], v[160:163]
  v_add_f32 v14, v14, v213
  v_add_f32 v20, v20, v181
  v_mfma_f32_16x16x32_bf16 v[160:163], v[188:191], a[156:159], v[160:163]
  s_waitcnt lgkmcnt(0)
  v_lshlrev_b32 v213, 16, v182
  v_and_b32 v182, s41, v182
  v_mfma_f32_16x16x32_bf16 v[164:167], v[192:195], a[116:119], v[164:167]
  v_add_f32 v21, v21, v213
  v_add_f32 v22, v22, v182
  v_mfma_f32_16x16x32_bf16 v[164:167], v[196:199], a[156:159], v[164:167]
  v_lshlrev_b32 v213, 16, v183
  v_and_b32 v183, s41, v183
  v_mfma_f32_16x16x32_bf16 v[132:135], v[196:199], a[152:155], v[132:135]
  v_add_f32 v23, v23, v213
  v_add_f32 v0, v0, v183
  v_mfma_f32_16x16x32_bf16 v[132:135], v[192:195], a[112:115], v[132:135]
  v_lshlrev_b32 v213, 16, v52
  v_and_b32 v52, s41, v52
  v_mfma_f32_16x16x32_bf16 v[100:103], v[192:195], a[108:111], v[100:103]
  v_add_f32 v228, v228, v213
  v_add_f32 v229, v229, v52
  v_mfma_f32_16x16x32_bf16 v[100:103], v[196:199], a[148:151], v[100:103]
  v_lshlrev_b32 v213, 16, v53
  v_and_b32 v53, s41, v53
  v_mfma_f32_16x16x32_bf16 v[68:71], v[196:199], a[144:147], v[68:71]
  v_add_f32 v230, v230, v213
  v_add_f32 v231, v231, v53
  v_mfma_f32_16x16x32_bf16 v[68:71], v[192:195], a[104:107], v[68:71]
  v_lshlrev_b32 v213, 16, v54
  v_and_b32 v54, s41, v54
  v_mfma_f32_16x16x32_bf16 v[36:39], v[192:195], a[100:103], v[36:39]
  v_add_f32 v248, v248, v213
  v_add_f32 v249, v249, v54
  v_mfma_f32_16x16x32_bf16 v[36:39], v[196:199], a[140:143], v[36:39]
  v_lshlrev_b32 v213, 16, v55
  v_and_b32 v55, s41, v55
  v_add_f32 v250, v250, v213
  v_add_f32 v251, v251, v55
  s_waitcnt vmcnt(0)
  v_readfirstlane_b32 s98, v210
  s_nop 0
  s_cmp_eq_u32 s98, s96
  s_cbranch_scc0 SPIN7
SRET7:
  s_add_u32 s40, s93, 123904
  buffer_load_dwordx4 v[60:63], v19, s[24:27], s40 offen offset:0 sc1
  buffer_load_dwordx4 v[92:95], v19, s[24:27], s40 offen offset:1024 sc1
  buffer_load_dwordx4 v[124:127], v19, s[24:27], s40 offen offset:2048 sc1
  buffer_load_dwordx4 v[156:159], v19, s[24:27], s40 offen offset:3072 sc1
  s_sub_u32 s40, s40, 1024
  buffer_load_dwordx4 v[28:31], v19, s[24:27], s40 offen sc1
  v_add_f32 v32, v32, v228
  v_add_f32 v33, v33, v229
  v_add_f32 v34, v34, v230
  v_add_f32 v35, v35, v231
  v_add_f32 v36, v36, v248
  v_add_f32 v37, v37, v249
  v_add_f32 v38, v38, v250
  v_add_f32 v39, v39, v251
  v_add_f32 v64, v64, v252
  v_add_f32 v65, v65, v253
  v_add_f32 v66, v66, v254
  v_add_f32 v67, v67, v255
  v_add_f32 v68, v68, v232
  v_add_f32 v69, v69, v233
  v_add_f32 v70, v70, v234
  v_add_f32 v71, v71, v236
  v_add_f32 v96, v96, v237
  v_add_f32 v97, v97, v238
  v_add_f32 v98, v98, v239
  v_add_f32 v99, v99, v245
  v_add_f32 v100, v100, v247
  v_add_f32 v101, v101, v215
  v_add_f32 v102, v102, v212
  v_add_f32 v103, v103, v1
  v_add_f32 v128, v128, v2
  v_add_f32 v129, v129, v3
  v_add_f32 v130, v130, v4
  v_add_f32 v131, v131, v5
  v_add_f32 v132, v132, v8
  v_add_f32 v133, v133, v9
  v_add_f32 v134, v134, v10
  v_add_f32 v135, v135, v11
  v_add_f32 v160, v160, v12
  v_add_f32 v161, v161, v13
  v_add_f32 v162, v162, v14
  v_add_f32 v163, v163, v20
  v_add_f32 v164, v164, v21
  v_add_f32 v165, v165, v22
  v_add_f32 v166, v166, v23
  v_add_f32 v167, v167, v0
  v_lshlrev_b32 v213, 16, v56
  v_and_b32 v56, s41, v56
  v_add_f32 v64, v64, v213
  v_add_f32 v65, v65, v56
  v_lshlrev_b32 v213, 16, v57
  v_and_b32 v57, s41, v57
  v_add_f32 v66, v66, v213
  v_add_f32 v67, v67, v57
  v_lshlrev_b32 v213, 16, v58
  v_and_b32 v58, s41, v58
  v_add_f32 v68, v68, v213
  v_add_f32 v69, v69, v58
  v_lshlrev_b32 v213, 16, v59
  v_and_b32 v59, s41, v59
  v_add_f32 v70, v70, v213
  v_add_f32 v71, v71, v59
  v_lshlrev_b32 v213, 16, v88
  v_and_b32 v88, s41, v88
  v_add_f32 v96, v96, v213
  v_add_f32 v97, v97, v88
  v_lshlrev_b32 v213, 16, v89
  v_and_b32 v89, s41, v89
  v_add_f32 v98, v98, v213
  v_add_f32 v99, v99, v89
  v_lshlrev_b32 v213, 16, v90
  v_and_b32 v90, s41, v90
  v_add_f32 v100, v100, v213
  v_add_f32 v101, v101, v90
  v_lshlrev_b32 v213, 16, v91
  v_and_b32 v91, s41, v91
  v_add_f32 v102, v102, v213
  v_add_f32 v103, v103, v91
  v_lshlrev_b32 v213, 16, v120
  v_and_b32 v120, s41, v120
  v_add_f32 v128, v128, v213
  v_add_f32 v129, v129, v120
  v_lshlrev_b32 v213, 16, v121
  v_and_b32 v121, s41, v121
  v_add_f32 v130, v130, v213
  v_add_f32 v131, v131, v121
  v_lshlrev_b32 v213, 16, v122
  v_and_b32 v122, s41, v122
  v_add_f32 v132, v132, v213
  v_add_f32 v133, v133, v122
  v_lshlrev_b32 v213, 16, v123
  v_and_b32 v123, s41, v123
  v_add_f32 v134, v134, v213
  v_add_f32 v135, v135, v123
  v_lshlrev_b32 v213, 16, v152
  v_and_b32 v152, s41, v152
  v_add_f32 v160, v160, v213
  v_add_f32 v161, v161, v152
  v_lshlrev_b32 v213, 16, v153
  v_and_b32 v153, s41, v153
  v_add_f32 v162, v162, v213
  v_add_f32 v163, v163, v153
  v_lshlrev_b32 v213, 16, v154
  v_and_b32 v154, s41, v154
  v_add_f32 v164, v164, v213
  v_add_f32 v165, v165, v154
  v_lshlrev_b32 v213, 16, v155
  v_and_b32 v155, s41, v155
  v_add_f32 v166, v166, v213
  v_add_f32 v167, v167, v155
  v_lshlrev_b32 v213, 16, v24
  v_and_b32 v24, s41, v24
  v_add_f32 v32, v32, v213
  v_add_f32 v33, v33, v24
  v_lshlrev_b32 v213, 16, v25
  v_and_b32 v25, s41, v25
  v_add_f32 v34, v34, v213
  v_add_f32 v35, v35, v25
  v_lshlrev_b32 v213, 16, v26
  v_and_b32 v26, s41, v26
  v_add_f32 v36, v36, v213
  v_add_f32 v37, v37, v26
  v_lshlrev_b32 v213, 16, v27
  v_and_b32 v27, s41, v27
  v_add_f32 v38, v38, v213
  v_add_f32 v39, v39, v27
  s_waitcnt vmcnt(4)
  v_lshlrev_b32 v213, 16, v60
  v_and_b32 v60, s41, v60
  v_add_f32 v64, v64, v213
  v_add_f32 v65, v65, v60
  v_lshlrev_b32 v213, 16, v61
  v_and_b32 v61, s41, v61
  v_add_f32 v66, v66, v213
  v_add_f32 v67, v67, v61
  v_lshlrev_b32 v213, 16, v62
  v_and_b32 v62, s41, v62
  v_add_f32 v68, v68, v213
  v_add_f32 v69, v69, v62
  v_lshlrev_b32 v213, 16, v63
  v_and_b32 v63, s41, v63
  v_add_f32 v70, v70, v213
  v_add_f32 v71, v71, v63
  v_cvt_pk_bf16_f32 v64, v64, v65
  v_cvt_pk_bf16_f32 v65, v66, v67
  v_cvt_pk_bf16_f32 v66, v68, v69
  v_cvt_pk_bf16_f32 v67, v70, v71
  s_add_u32 s39, s97, 32768
  buffer_store_dwordx4 v[64:67], v15, s[80:83], s39 offen
  s_waitcnt vmcnt(4)
  v_lshlrev_b32 v213, 16, v92
  v_and_b32 v92, s41, v92
  v_add_f32 v96, v96, v213
  v_add_f32 v97, v97, v92
  v_lshlrev_b32 v213, 16, v93
  v_and_b32 v93, s41, v93
  v_add_f32 v98, v98, v213
  v_add_f32 v99, v99, v93
  v_lshlrev_b32 v213, 16, v94
  v_and_b32 v94, s41, v94
  v_add_f32 v100, v100, v213
  v_add_f32 v101, v101, v94
  v_lshlrev_b32 v213, 16, v95
  v_and_b32 v95, s41, v95
  v_add_f32 v102, v102, v213
  v_add_f32 v103, v103, v95
  v_cvt_pk_bf16_f32 v96, v96, v97
  v_cvt_pk_bf16_f32 v97, v98, v99
  v_cvt_pk_bf16_f32 v98, v100, v101
  v_cvt_pk_bf16_f32 v99, v102, v103
  s_add_u32 s39, s97, 65536
  buffer_store_dwordx4 v[96:99], v15, s[80:83], s39 offen
  s_waitcnt vmcnt(4)
  v_lshlrev_b32 v213, 16, v124
  v_and_b32 v124, s41, v124
  v_add_f32 v128, v128, v213
  v_add_f32 v129, v129, v124
  v_lshlrev_b32 v213, 16, v125
  v_and_b32 v125, s41, v125
  v_add_f32 v130, v130, v213
  v_add_f32 v131, v131, v125
  v_lshlrev_b32 v213, 16, v126
  v_and_b32 v126, s41, v126
  v_add_f32 v132, v132, v213
  v_add_f32 v133, v133, v126
  v_lshlrev_b32 v213, 16, v127
  v_and_b32 v127, s41, v127
  v_add_f32 v134, v134, v213
  v_add_f32 v135, v135, v127
  v_cvt_pk_bf16_f32 v128, v128, v129
  v_cvt_pk_bf16_f32 v129, v130, v131
  v_cvt_pk_bf16_f32 v130, v132, v133
  v_cvt_pk_bf16_f32 v131, v134, v135
  s_add_u32 s39, s97, 98304
  buffer_store_dwordx4 v[128:131], v15, s[80:83], s39 offen
  s_waitcnt vmcnt(4)
  v_lshlrev_b32 v213, 16, v156
  v_and_b32 v156, s41, v156
  v_add_f32 v160, v160, v213
  v_add_f32 v161, v161, v156
  v_lshlrev_b32 v213, 16, v157
  v_and_b32 v157, s41, v157
  v_add_f32 v162, v162, v213
  v_add_f32 v163, v163, v157
  v_lshlrev_b32 v213, 16, v158
  v_and_b32 v158, s41, v158
  v_add_f32 v164, v164, v213
  v_add_f32 v165, v165, v158
  v_lshlrev_b32 v213, 16, v159
  v_and_b32 v159, s41, v159
  v_add_f32 v166, v166, v213
  v_add_f32 v167, v167, v159
  v_cvt_pk_bf16_f32 v160, v160, v161
  v_cvt_pk_bf16_f32 v161, v162, v163
  v_cvt_pk_bf16_f32 v162, v164, v165
  v_cvt_pk_bf16_f32 v163, v166, v167
  s_add_u32 s39, s97, 131072
  buffer_store_dwordx4 v[160:163], v15, s[80:83], s39 offen
  s_waitcnt vmcnt(4)
  v_lshlrev_b32 v213, 16, v28
  v_and_b32 v28, s41, v28
  v_add_f32 v32, v32, v213
  v_add_f32 v33, v33, v28
  v_lshlrev_b32 v213, 16, v29
  v_and_b32 v29, s41, v29
  v_add_f32 v34, v34, v213
  v_add_f32 v35, v35, v29
  v_lshlrev_b32 v213, 16, v30
  v_and_b32 v30, s41, v30
  v_add_f32 v36, v36, v213
  v_add_f32 v37, v37, v30
  v_lshlrev_b32 v213, 16, v31
  v_and_b32 v31, s41, v31
  v_add_f32 v38, v38, v213
  v_add_f32 v39, v39, v31
  v_cvt_pk_bf16_f32 v32, v32, v33
  v_cvt_pk_bf16_f32 v33, v34, v35
  v_cvt_pk_bf16_f32 v34, v36, v37
  v_cvt_pk_bf16_f32 v35, v38, v39
  s_add_u32 s39, s97, 0
  buffer_store_dwordx4 v[32:35], v15, s[80:83], s39 offen
K1_END:
  s_endpgm
RARE1_2:
  s_call_b64 s[46:47], RARE1
  s_branch RET_2
RARE0_3:
  s_call_b64 s[46:47], RARE0
  s_branch RET_3
RARE1_4:
  s_call_b64 s[46:47], RARE1
  s_branch RET_4
RARE0_5:
  s_call_b64 s[46:47], RARE0
  s_branch RET_5
RARE1_7:
  s_call_b64 s[46:47], RARE1
  s_branch RET_7
RARE0_8:
  s_call_b64 s[46:47], RARE0
  s_branch RET_8
RARE1_9:
  s_call_b64 s[46:47], RARE1
  s_branch RET_9
RARE0_10:
  s_call_b64 s[46:47], RARE0
  s_branch RET_10
RARE1_11:
  s_call_b64 s[46:47], RARE1
  s_branch RET_11
RARE0_12:
  s_call_b64 s[46:47], RARE0
  s_branch RET_12
RARE1_13:
  s_call_b64 s[46:47], RARE1
  s_branch RET_13
RARE0_14:
  s_call_b64 s[46:47], RARE0
  s_branch RET_14
RARE1_15:
  s_call_b64 s[46:47], RARE1
  s_branch RET_15
RARE0_17:
  s_call_b64 s[46:47], RARE0
  s_branch RET_17
RARE1_18:
  s_call_b64 s[46:47], RARE1
  s_branch RET_18
RARE0_19:
  s_call_b64 s[46:47], RARE0
  s_branch RET_19
RARE1_20:
  s_call_b64 s[46:47], RARE1
  s_branch RET_20
SPIN0:
  s_mov_b32 s5, 0
SPINL0:
  s_sleep 2
  buffer_load_dword v232, off, s[84:87], s99 sc1
  s_add_u32 s5, s5, 1
  s_waitcnt vmcnt(0)
  v_readfirstlane_b32 s98, v232
  s_cmp_gt_u32 s5, 0x8000
  s_cbranch_scc1 SRET0
  s_cmp_lg_u32 s98, 0
  s_cbranch_scc0 SPINL0
  s_branch SRET0
SPIN1:
  s_mov_b32 s5, 0
SPINL1:
  s_sleep 2
  buffer_load_dword v210, off, s[24:27], s48 offset:0 sc1
  s_add_u32 s5, s5, 1
  s_waitcnt vmcnt(0)
  v_readfirstlane_b32 s98, v210
  s_cmp_gt_u32 s5, 0x8000
  s_cbranch_scc1 SRET1
  s_cmp_eq_u32 s98, s96
  s_cbranch_scc0 SPINL1
  s_branch SRET1
SPIN2:
  s_mov_b32 s5, 0
SPINL2:
  s_sleep 2
  buffer_load_dword v214, off, s[24:27], s48 offset:256 sc1
  s_add_u32 s5, s5, 1
  s_waitcnt vmcnt(0)
  v_readfirstlane_b32 s98, v214
  s_cmp_gt_u32 s5, 0x8000
  s_cbranch_scc1 SRET2
  s_cmp_eq_u32 s98, s96
  s_cbranch_scc0 SPINL2
  s_branch SRET2
SPIN3:
  s_mov_b32 s5, 0
SPINL3:
  s_sleep 2
  buffer_load_dword v210, off, s[24:27], s48 offset:512 sc1
  s_add_u32 s5, s5, 1
  s_waitcnt vmcnt(0)
  v_readfirstlane_b32 s98, v210
  s_cmp_gt_u32 s5, 0x8000
  s_cbranch_scc1 SRET3
  s_cmp_eq_u32 s98, s96
  s_cbranch_scc0 SPINL3
  s_branch SRET3
SPIN4:
  s_mov_b32 s5, 0
SPINL4:
  s_sleep 2
  buffer_load_dword v214, off, s[24:27], s48 offset:768 sc1
  s_add_u32 s5, s5, 1
  s_waitcnt vmcnt(0)
  v_readfirstlane_b32 s98, v214
  s_cmp_gt_u32 s5, 0x8000
  s_cbranch_scc1 SRET4
  s_cmp_eq_u32 s98, s96
  s_cbranch_scc0 SPINL4
  s_branch SRET4
SPIN5:
  s_mov_b32 s5, 0
SPINL5:
  s_sleep 2
  buffer_load_dword v210, off, s[24:27], s48 offset:1024 sc1
  s_add_u32 s5, s5, 1
  s_waitcnt vmcnt(0)
  v_readfirstlane_b32 s98, v210
  s_cmp_gt_u32 s5, 0x8000
  s_cbranch_scc1 SRET5
  s_cmp_eq_u32 s98, s96
  s_cbranch_scc0 SPINL5
  s_branch SRET5
SPIN6:
  s_mov_b32 s5, 0
SPINL6:
  s_sleep 2
  buffer_load_dword v214, off, s[24:27], s48 offset:1280 sc1
  s_add_u32 s5, s5, 1
  s_waitcnt vmcnt(0)
  v_readfirstlane_b32 s98, v214
  s_cmp_gt_u32 s5, 0x8000
  s_cbranch_scc1 SRET6
  s_cmp_eq_u32 s98, s96
  s_cbranch_scc0 SPINL6
  s_branch SRET6
SPIN7:
  s_mov_b32 s5, 0
SPINL7:
  s_sleep 2
  buffer_load_dword v210, off, s[24:27], s48 offset:1536 sc1
  s_add_u32 s5, s5, 1
  s_waitcnt vmcnt(0)
  v_readfirstlane_b32 s98, v210
  s_cmp_gt_u32 s5, 0x8000
  s_cbranch_scc1 SRET7
  s_cmp_eq_u32 s98, s96
  s_cbranch_scc0 SPINL7
  s_branch SRET7
RARE0:
  s_nop 15
  v_max3_f32 v248, v24, v25, v26
  v_max3_f32 v249, v27, v28, v29
  v_max3_f32 v248, v248, v30, v31
  v_max_f32 v248, v248, v249
  v_mov_b32 v249, v248
  s_nop 1
  v_permlane16_swap_b32 v248, v249
  v_max_f32 v248, v248, v249
  v_mov_b32 v249, v248
  s_nop 1
  v_permlane32_swap_b32 v248, v249
  v_max_f32 v248, v248, v249
  v_max_f32 v248, 0, v248
  v_ceil_f32 v248, v248
  v_exp_f32 v250, -v248
  v_sub_f32 v48, v48, v248
  v_sub_f32 v49, v49, v248
  v_sub_f32 v50, v50, v248
  v_sub_f32 v51, v51, v248
  v_sub_f32 v24, v24, v248
  v_sub_f32 v25, v25, v248
  v_sub_f32 v26, v26, v248
  v_sub_f32 v27, v27, v248
  v_sub_f32 v28, v28, v248
  v_sub_f32 v29, v29, v248
  v_sub_f32 v30, v30, v248
  v_sub_f32 v31, v31, v248
  v_sub_f32 v32, v32, v248
  v_sub_f32 v33, v33, v248
  v_sub_f32 v34, v34, v248
  v_sub_f32 v35, v35, v248
  v_sub_f32 v36, v36, v248
  v_sub_f32 v37, v37, v248
  v_sub_f32 v38, v38, v248
  v_sub_f32 v39, v39, v248
  v_mul_f32 v52, v52, v250
  v_accvgpr_read_b32 v252, a0
  v_accvgpr_read_b32 v253, a1
  v_accvgpr_read_b32 v254, a2
  v_accvgpr_read_b32 v255, a3
  v_mul_f32 v252, v252, v250
  v_mul_f32 v253, v253, v250
  v_mul_f32 v254, v254, v250
  v_mul_f32 v255, v255, v250
  v_accvgpr_write_b32 a0, v252
  v_accvgpr_write_b32 a1, v253
  v_accvgpr_write_b32 a2, v254
  v_accvgpr_write_b32 a3, v255
  v_accvgpr_read_b32 v252, a20
  v_accvgpr_read_b32 v253, a21
  v_accvgpr_read_b32 v254, a22
  v_accvgpr_read_b32 v255, a23
  v_mul_f32 v252, v252, v250
  v_mul_f32 v253, v253, v250
  v_mul_f32 v254, v254, v250
  v_mul_f32 v255, v255, v250
  v_accvgpr_write_b32 a20, v252
  v_accvgpr_write_b32 a21, v253
  v_accvgpr_write_b32 a22, v254
  v_accvgpr_write_b32 a23, v255
  v_accvgpr_read_b32 v252, a40
  v_accvgpr_read_b32 v253, a41
  v_accvgpr_read_b32 v254, a42
  v_accvgpr_read_b32 v255, a43
  v_mul_f32 v252, v252, v250
  v_mul_f32 v253, v253, v250
  v_mul_f32 v254, v254, v250
  v_mul_f32 v255, v255, v250
  v_accvgpr_write_b32 a40, v252
  v_accvgpr_write_b32 a41, v253
  v_accvgpr_write_b32 a42, v254
  v_accvgpr_write_b32 a43, v255
  v_accvgpr_read_b32 v252, a60
  v_accvgpr_read_b32 v253, a61
  v_accvgpr_read_b32 v254, a62
  v_accvgpr_read_b32 v255, a63
  v_mul_f32 v252, v252, v250
  v_mul_f32 v253, v253, v250
  v_mul_f32 v254, v254, v250
  v_mul_f32 v255, v255, v250
  v_accvgpr_write_b32 a60, v252
  v_accvgpr_write_b32 a61, v253
  v_accvgpr_write_b32 a62, v254
  v_accvgpr_write_b32 a63, v255
  v_accvgpr_read_b32 v252, a80
  v_accvgpr_read_b32 v253, a81
  v_accvgpr_read_b32 v254, a82
  v_accvgpr_read_b32 v255, a83
  v_mul_f32 v252, v252, v250
  v_mul_f32 v253, v253, v250
  v_mul_f32 v254, v254, v250
  v_mul_f32 v255, v255, v250
  v_accvgpr_write_b32 a80, v252
  v_accvgpr_write_b32 a81, v253
  v_accvgpr_write_b32 a82, v254
  v_accvgpr_write_b32 a83, v255
  v_accvgpr_read_b32 v252, a100
  v_accvgpr_read_b32 v253, a101
  v_accvgpr_read_b32 v254, a102
  v_accvgpr_read_b32 v255, a103
  v_mul_f32 v252, v252, v250
  v_mul_f32 v253, v253, v250
  v_mul_f32 v254, v254, v250
  v_mul_f32 v255, v255, v250
  v_accvgpr_write_b32 a100, v252
  v_accvgpr_write_b32 a101, v253
  v_accvgpr_write_b32 a102, v254
  v_accvgpr_write_b32 a103, v255
  v_accvgpr_read_b32 v252, a120
  v_accvgpr_read_b32 v253, a121
  v_accvgpr_read_b32 v254, a122
  v_accvgpr_read_b32 v255, a123
  v_mul_f32 v252, v252, v250
  v_mul_f32 v253, v253, v250
  v_mul_f32 v254, v254, v250
  v_mul_f32 v255, v255, v250
  v_accvgpr_write_b32 a120, v252
  v_accvgpr_write_b32 a121, v253
  v_accvgpr_write_b32 a122, v254
  v_accvgpr_write_b32 a123, v255
  v_accvgpr_read_b32 v252, a140
  v_accvgpr_read_b32 v253, a141
  v_accvgpr_read_b32 v254, a142
  v_accvgpr_read_b32 v255, a143
  v_mul_f32 v252, v252, v250
  v_mul_f32 v253, v253, v250
  v_mul_f32 v254, v254, v250
  v_mul_f32 v255, v255, v250
  v_accvgpr_write_b32 a140, v252
  v_accvgpr_write_b32 a141, v253
  v_accvgpr_write_b32 a142, v254
  v_accvgpr_write_b32 a143, v255
  v_max3_f32 v248, v56, v57, v58
  v_max3_f32 v249, v59, v60, v61
  v_max3_f32 v248, v248, v62, v63
  v_max_f32 v248, v248, v249
  v_mov_b32 v249, v248
  s_nop 1
  v_permlane16_swap_b32 v248, v249
  v_max_f32 v248, v248, v249
  v_mov_b32 v249, v248
  s_nop 1
  v_permlane32_swap_b32 v248, v249
  v_max_f32 v248, v248, v249
  v_max_f32 v248, 0, v248
  v_ceil_f32 v248, v248
  v_exp_f32 v250, -v248
  v_sub_f32 v80, v80, v248
  v_sub_f32 v81, v81, v248
  v_sub_f32 v82, v82, v248
  v_sub_f32 v83, v83, v248
  v_sub_f32 v56, v56, v248
  v_sub_f32 v57, v57, v248
  v_sub_f32 v58, v58, v248
  v_sub_f32 v59, v59, v248
  v_sub_f32 v60, v60, v248
  v_sub_f32 v61, v61, v248
  v_sub_f32 v62, v62, v248
  v_sub_f32 v63, v63, v248
  v_sub_f32 v64, v64, v248
  v_sub_f32 v65, v65, v248
  v_sub_f32 v66, v66, v248
  v_sub_f32 v67, v67, v248
  v_sub_f32 v68, v68, v248
  v_sub_f32 v69, v69, v248
  v_sub_f32 v70, v70, v248
  v_sub_f32 v71, v71, v248
  v_mul_f32 v84, v84, v250
  v_accvgpr_read_b32 v252, a4
  v_accvgpr_read_b32 v253, a5
  v_accvgpr_read_b32 v254, a6
  v_accvgpr_read_b32 v255, a7
  v_mul_f32 v252, v252, v250
  v_mul_f32 v253, v253, v250
  v_mul_f32 v254, v254, v250
  v_mul_f32 v255, v255, v250
  v_accvgpr_write_b32 a4, v252
  v_accvgpr_write_b32 a5, v253
  v_accvgpr_write_b32 a6, v254
  v_accvgpr_write_b32 a7, v255
  v_accvgpr_read_b32 v252, a24
  v_accvgpr_read_b32 v253, a25
  v_accvgpr_read_b32 v254, a26
  v_accvgpr_read_b32 v255, a27
  v_mul_f32 v252, v252, v250
  v_mul_f32 v253, v253, v250
  v_mul_f32 v254, v254, v250
  v_mul_f32 v255, v255, v250
  v_accvgpr_write_b32 a24, v252
  v_accvgpr_write_b32 a25, v253
  v_accvgpr_write_b32 a26, v254
  v_accvgpr_write_b32 a27, v255
  v_accvgpr_read_b32 v252, a44
  v_accvgpr_read_b32 v253, a45
  v_accvgpr_read_b32 v254, a46
  v_accvgpr_read_b32 v255, a47
  v_mul_f32 v252, v252, v250
  v_mul_f32 v253, v253, v250
  v_mul_f32 v254, v254, v250
  v_mul_f32 v255, v255, v250
  v_accvgpr_write_b32 a44, v252
  v_accvgpr_write_b32 a45, v253
  v_accvgpr_write_b32 a46, v254
  v_accvgpr_write_b32 a47, v255
  v_accvgpr_read_b32 v252, a64
  v_accvgpr_read_b32 v253, a65
  v_accvgpr_read_b32 v254, a66
  v_accvgpr_read_b32 v255, a67
  v_mul_f32 v252, v252, v250
  v_mul_f32 v253, v253, v250
  v_mul_f32 v254, v254, v250
  v_mul_f32 v255, v255, v250
  v_accvgpr_write_b32 a64, v252
  v_accvgpr_write_b32 a65, v253
  v_accvgpr_write_b32 a66, v254
  v_accvgpr_write_b32 a67, v255
  v_accvgpr_read_b32 v252, a84
  v_accvgpr_read_b32 v253, a85
  v_accvgpr_read_b32 v254, a86
  v_accvgpr_read_b32 v255, a87
  v_mul_f32 v252, v252, v250
  v_mul_f32 v253, v253, v250
  v_mul_f32 v254, v254, v250
  v_mul_f32 v255, v255, v250
  v_accvgpr_write_b32 a84, v252
  v_accvgpr_write_b32 a85, v253
  v_accvgpr_write_b32 a86, v254
  v_accvgpr_write_b32 a87, v255
  v_accvgpr_read_b32 v252, a104
  v_accvgpr_read_b32 v253, a105
  v_accvgpr_read_b32 v254, a106
  v_accvgpr_read_b32 v255, a107
  v_mul_f32 v252, v252, v250
  v_mul_f32 v253, v253, v250
  v_mul_f32 v254, v254, v250
  v_mul_f32 v255, v255, v250
  v_accvgpr_write_b32 a104, v252
  v_accvgpr_write_b32 a105, v253
  v_accvgpr_write_b32 a106, v254
  v_accvgpr_write_b32 a107, v255
  v_accvgpr_read_b32 v252, a124
  v_accvgpr_read_b32 v253, a125
  v_accvgpr_read_b32 v254, a126
  v_accvgpr_read_b32 v255, a127
  v_mul_f32 v252, v252, v250
  v_mul_f32 v253, v253, v250
  v_mul_f32 v254, v254, v250
  v_mul_f32 v255, v255, v250
  v_accvgpr_write_b32 a124, v252
  v_accvgpr_write_b32 a125, v253
  v_accvgpr_write_b32 a126, v254
  v_accvgpr_write_b32 a127, v255
  v_accvgpr_read_b32 v252, a144
  v_accvgpr_read_b32 v253, a145
  v_accvgpr_read_b32 v254, a146
  v_accvgpr_read_b32 v255, a147
  v_mul_f32 v252, v252, v250
  v_mul_f32 v253, v253, v250
  v_mul_f32 v254, v254, v250
  v_mul_f32 v255, v255, v250
  v_accvgpr_write_b32 a144, v252
  v_accvgpr_write_b32 a145, v253
  v_accvgpr_write_b32 a146, v254
  v_accvgpr_write_b32 a147, v255
  v_max3_f32 v248, v88, v89, v90
  v_max3_f32 v249, v91, v92, v93
  v_max3_f32 v248, v248, v94, v95
  v_max_f32 v248, v248, v249
  v_mov_b32 v249, v248
  s_nop 1
  v_permlane16_swap_b32 v248, v249
  v_max_f32 v248, v248, v249
  v_mov_b32 v249, v248
  s_nop 1
  v_permlane32_swap_b32 v248, v249
  v_max_f32 v248, v248, v249
  v_max_f32 v248, 0, v248
  v_ceil_f32 v248, v248
  v_exp_f32 v250, -v248
  v_sub_f32 v112, v112, v248
  v_sub_f32 v113, v113, v248
  v_sub_f32 v114, v114, v248
  v_sub_f32 v115, v115, v248
  v_sub_f32 v88, v88, v248
  v_sub_f32 v89, v89, v248
  v_sub_f32 v90, v90, v248
  v_sub_f32 v91, v91, v248
  v_sub_f32 v92, v92, v248
  v_sub_f32 v93, v93, v248
  v_sub_f32 v94, v94, v248
  v_sub_f32 v95, v95, v248
  v_sub_f32 v96, v96, v248
  v_sub_f32 v97, v97, v248
  v_sub_f32 v98, v98, v248
  v_sub_f32 v99, v99, v248
  v_sub_f32 v100, v100, v248
  v_sub_f32 v101, v101, v248
  v_sub_f32 v102, v102, v248
  v_sub_f32 v103, v103, v248
  v_mul_f32 v116, v116, v250
  v_accvgpr_read_b32 v252, a8
  v_accvgpr_read_b32 v253, a9
  v_accvgpr_read_b32 v254, a10
  v_accvgpr_read_b32 v255, a11
  v_mul_f32 v252, v252, v250
  v_mul_f32 v253, v253, v250
  v_mul_f32 v254, v254, v250
  v_mul_f32 v255, v255, v250
  v_accvgpr_write_b32 a8, v252
  v_accvgpr_write_b32 a9, v253
  v_accvgpr_write_b32 a10, v254
  v_accvgpr_write_b32 a11, v255
  v_accvgpr_read_b32 v252, a28
  v_accvgpr_read_b32 v253, a29
  v_accvgpr_read_b32 v254, a30
  v_accvgpr_read_b32 v255, a31
  v_mul_f32 v252, v252, v250
  v_mul_f32 v253, v253, v250
  v_mul_f32 v254, v254, v250
  v_mul_f32 v255, v255, v250
  v_accvgpr_write_b32 a28, v252
  v_accvgpr_write_b32 a29, v253
  v_accvgpr_write_b32 a30, v254
  v_accvgpr_write_b32 a31, v255
  v_accvgpr_read_b32 v252, a48
  v_accvgpr_read_b32 v253, a49
  v_accvgpr_read_b32 v254, a50
  v_accvgpr_read_b32 v255, a51
  v_mul_f32 v252, v252, v250
  v_mul_f32 v253, v253, v250
  v_mul_f32 v254, v254, v250
  v_mul_f32 v255, v255, v250
  v_accvgpr_write_b32 a48, v252
  v_accvgpr_write_b32 a49, v253
  v_accvgpr_write_b32 a50, v254
  v_accvgpr_write_b32 a51, v255
  v_accvgpr_read_b32 v252, a68
  v_accvgpr_read_b32 v253, a69
  v_accvgpr_read_b32 v254, a70
  v_accvgpr_read_b32 v255, a71
  v_mul_f32 v252, v252, v250
  v_mul_f32 v253, v253, v250
  v_mul_f32 v254, v254, v250
  v_mul_f32 v255, v255, v250
  v_accvgpr_write_b32 a68, v252
  v_accvgpr_write_b32 a69, v253
  v_accvgpr_write_b32 a70, v254
  v_accvgpr_write_b32 a71, v255
  v_accvgpr_read_b32 v252, a88
  v_accvgpr_read_b32 v253, a89
  v_accvgpr_read_b32 v254, a90
  v_accvgpr_read_b32 v255, a91
  v_mul_f32 v252, v252, v250
  v_mul_f32 v253, v253, v250
  v_mul_f32 v254, v254, v250
  v_mul_f32 v255, v255, v250
  v_accvgpr_write_b32 a88, v252
  v_accvgpr_write_b32 a89, v253
  v_accvgpr_write_b32 a90, v254
  v_accvgpr_write_b32 a91, v255
  v_accvgpr_read_b32 v252, a108
  v_accvgpr_read_b32 v253, a109
  v_accvgpr_read_b32 v254, a110
  v_accvgpr_read_b32 v255, a111
  v_mul_f32 v252, v252, v250
  v_mul_f32 v253, v253, v250
  v_mul_f32 v254, v254, v250
  v_mul_f32 v255, v255, v250
  v_accvgpr_write_b32 a108, v252
  v_accvgpr_write_b32 a109, v253
  v_accvgpr_write_b32 a110, v254
  v_accvgpr_write_b32 a111, v255
  v_accvgpr_read_b32 v252, a128
  v_accvgpr_read_b32 v253, a129
  v_accvgpr_read_b32 v254, a130
  v_accvgpr_read_b32 v255, a131
  v_mul_f32 v252, v252, v250
  v_mul_f32 v253, v253, v250
  v_mul_f32 v254, v254, v250
  v_mul_f32 v255, v255, v250
  v_accvgpr_write_b32 a128, v252
  v_accvgpr_write_b32 a129, v253
  v_accvgpr_write_b32 a130, v254
  v_accvgpr_write_b32 a131, v255
  v_accvgpr_read_b32 v252, a148
  v_accvgpr_read_b32 v253, a149
  v_accvgpr_read_b32 v254, a150
  v_accvgpr_read_b32 v255, a151
  v_mul_f32 v252, v252, v250
  v_mul_f32 v253, v253, v250
  v_mul_f32 v254, v254, v250
  v_mul_f32 v255, v255, v250
  v_accvgpr_write_b32 a148, v252
  v_accvgpr_write_b32 a149, v253
  v_accvgpr_write_b32 a150, v254
  v_accvgpr_write_b32 a151, v255
  v_max3_f32 v248, v120, v121, v122
  v_max3_f32 v249, v123, v124, v125
  v_max3_f32 v248, v248, v126, v127
  v_max_f32 v248, v248, v249
  v_mov_b32 v249, v248
  s_nop 1
  v_permlane16_swap_b32 v248, v249
  v_max_f32 v248, v248, v249
  v_mov_b32 v249, v248
  s_nop 1
  v_permlane32_swap_b32 v248, v249
  v_max_f32 v248, v248, v249
  v_max_f32 v248, 0, v248
  v_ceil_f32 v248, v248
  v_exp_f32 v250, -v248
  v_sub_f32 v144, v144, v248
  v_sub_f32 v145, v145, v248
  v_sub_f32 v146, v146, v248
  v_sub_f32 v147, v147, v248
  v_sub_f32 v120, v120, v248
  v_sub_f32 v121, v121, v248
  v_sub_f32 v122, v122, v248
  v_sub_f32 v123, v123, v248
  v_sub_f32 v124, v124, v248
  v_sub_f32 v125, v125, v248
  v_sub_f32 v126, v126, v248
  v_sub_f32 v127, v127, v248
  v_sub_f32 v128, v128, v248
  v_sub_f32 v129, v129, v248
  v_sub_f32 v130, v130, v248
  v_sub_f32 v131, v131, v248
  v_sub_f32 v132, v132, v248
  v_sub_f32 v133, v133, v248
  v_sub_f32 v134, v134, v248
  v_sub_f32 v135, v135, v248
  v_mul_f32 v148, v148, v250
  v_accvgpr_read_b32 v252, a12
  v_accvgpr_read_b32 v253, a13
  v_accvgpr_read_b32 v254, a14
  v_accvgpr_read_b32 v255, a15
  v_mul_f32 v252, v252, v250
  v_mul_f32 v253, v253, v250
  v_mul_f32 v254, v254, v250
  v_mul_f32 v255, v255, v250
  v_accvgpr_write_b32 a12, v252
  v_accvgpr_write_b32 a13, v253
  v_accvgpr_write_b32 a14, v254
  v_accvgpr_write_b32 a15, v255
  v_accvgpr_read_b32 v252, a32
  v_accvgpr_read_b32 v253, a33
  v_accvgpr_read_b32 v254, a34
  v_accvgpr_read_b32 v255, a35
  v_mul_f32 v252, v252, v250
  v_mul_f32 v253, v253, v250
  v_mul_f32 v254, v254, v250
  v_mul_f32 v255, v255, v250
  v_accvgpr_write_b32 a32, v252
  v_accvgpr_write_b32 a33, v253
  v_accvgpr_write_b32 a34, v254
  v_accvgpr_write_b32 a35, v255
  v_accvgpr_read_b32 v252, a52
  v_accvgpr_read_b32 v253, a53
  v_accvgpr_read_b32 v254, a54
  v_accvgpr_read_b32 v255, a55
  v_mul_f32 v252, v252, v250
  v_mul_f32 v253, v253, v250
  v_mul_f32 v254, v254, v250
  v_mul_f32 v255, v255, v250
  v_accvgpr_write_b32 a52, v252
  v_accvgpr_write_b32 a53, v253
  v_accvgpr_write_b32 a54, v254
  v_accvgpr_write_b32 a55, v255
  v_accvgpr_read_b32 v252, a72
  v_accvgpr_read_b32 v253, a73
  v_accvgpr_read_b32 v254, a74
  v_accvgpr_read_b32 v255, a75
  v_mul_f32 v252, v252, v250
  v_mul_f32 v253, v253, v250
  v_mul_f32 v254, v254, v250
  v_mul_f32 v255, v255, v250
  v_accvgpr_write_b32 a72, v252
  v_accvgpr_write_b32 a73, v253
  v_accvgpr_write_b32 a74, v254
  v_accvgpr_write_b32 a75, v255
  v_accvgpr_read_b32 v252, a92
  v_accvgpr_read_b32 v253, a93
  v_accvgpr_read_b32 v254, a94
  v_accvgpr_read_b32 v255, a95
  v_mul_f32 v252, v252, v250
  v_mul_f32 v253, v253, v250
  v_mul_f32 v254, v254, v250
  v_mul_f32 v255, v255, v250
  v_accvgpr_write_b32 a92, v252
  v_accvgpr_write_b32 a93, v253
  v_accvgpr_write_b32 a94, v254
  v_accvgpr_write_b32 a95, v255
  v_accvgpr_read_b32 v252, a112
  v_accvgpr_read_b32 v253, a113
  v_accvgpr_read_b32 v254, a114
  v_accvgpr_read_b32 v255, a115
  v_mul_f32 v252, v252, v250
  v_mul_f32 v253, v253, v250
  v_mul_f32 v254, v254, v250
  v_mul_f32 v255, v255, v250
  v_accvgpr_write_b32 a112, v252
  v_accvgpr_write_b32 a113, v253
  v_accvgpr_write_b32 a114, v254
  v_accvgpr_write_b32 a115, v255
  v_accvgpr_read_b32 v252, a132
  v_accvgpr_read_b32 v253, a133
  v_accvgpr_read_b32 v254, a134
  v_accvgpr_read_b32 v255, a135
  v_mul_f32 v252, v252, v250
  v_mul_f32 v253, v253, v250
  v_mul_f32 v254, v254, v250
  v_mul_f32 v255, v255, v250
  v_accvgpr_write_b32 a132, v252
  v_accvgpr_write_b32 a133, v253
  v_accvgpr_write_b32 a134, v254
  v_accvgpr_write_b32 a135, v255
  v_accvgpr_read_b32 v252, a152
  v_accvgpr_read_b32 v253, a153
  v_accvgpr_read_b32 v254, a154
  v_accvgpr_read_b32 v255, a155
  v_mul_f32 v252, v252, v250
  v_mul_f32 v253, v253, v250
  v_mul_f32 v254, v254, v250
  v_mul_f32 v255, v255, v250
  v_accvgpr_write_b32 a152, v252
  v_accvgpr_write_b32 a153, v253
  v_accvgpr_write_b32 a154, v254
  v_accvgpr_write_b32 a155, v255
  v_max3_f32 v248, v152, v153, v154
  v_max3_f32 v249, v155, v156, v157
  v_max3_f32 v248, v248, v158, v159
  v_max_f32 v248, v248, v249
  v_mov_b32 v249, v248
  s_nop 1
  v_permlane16_swap_b32 v248, v249
  v_max_f32 v248, v248, v249
  v_mov_b32 v249, v248
  s_nop 1
  v_permlane32_swap_b32 v248, v249
  v_max_f32 v248, v248, v249
  v_max_f32 v248, 0, v248
  v_ceil_f32 v248, v248
  v_exp_f32 v250, -v248
  v_sub_f32 v176, v176, v248
  v_sub_f32 v177, v177, v248
  v_sub_f32 v178, v178, v248
  v_sub_f32 v179, v179, v248
  v_sub_f32 v152, v152, v248
  v_sub_f32 v153, v153, v248
  v_sub_f32 v154, v154, v248
  v_sub_f32 v155, v155, v248
  v_sub_f32 v156, v156, v248
  v_sub_f32 v157, v157, v248
  v_sub_f32 v158, v158, v248
  v_sub_f32 v159, v159, v248
  v_sub_f32 v160, v160, v248
  v_sub_f32 v161, v161, v248
  v_sub_f32 v162, v162, v248
  v_sub_f32 v163, v163, v248
  v_sub_f32 v164, v164, v248
  v_sub_f32 v165, v165, v248
  v_sub_f32 v166, v166, v248
  v_sub_f32 v167, v167, v248
  v_mul_f32 v180, v180, v250
  v_accvgpr_read_b32 v252, a16
  v_accvgpr_read_b32 v253, a17
  v_accvgpr_read_b32 v254, a18
  v_accvgpr_read_b32 v255, a19
  v_mul_f32 v252, v252, v250
  v_mul_f32 v253, v253, v250
  v_mul_f32 v254, v254, v250
  v_mul_f32 v255, v255, v250
  v_accvgpr_write_b32 a16, v252
  v_accvgpr_write_b32 a17, v253
  v_accvgpr_write_b32 a18, v254
  v_accvgpr_write_b32 a19, v255
  v_accvgpr_read_b32 v252, a36
  v_accvgpr_read_b32 v253, a37
  v_accvgpr_read_b32 v254, a38
  v_accvgpr_read_b32 v255, a39
  v_mul_f32 v252, v252, v250
  v_mul_f32 v253, v253, v250
  v_mul_f32 v254, v254, v250
  v_mul_f32 v255, v255, v250
  v_accvgpr_write_b32 a36, v252
  v_accvgpr_write_b32 a37, v253
  v_accvgpr_write_b32 a38, v254
  v_accvgpr_write_b32 a39, v255
  v_accvgpr_read_b32 v252, a56
  v_accvgpr_read_b32 v253, a57
  v_accvgpr_read_b32 v254, a58
  v_accvgpr_read_b32 v255, a59
  v_mul_f32 v252, v252, v250
  v_mul_f32 v253, v253, v250
  v_mul_f32 v254, v254, v250
  v_mul_f32 v255, v255, v250
  v_accvgpr_write_b32 a56, v252
  v_accvgpr_write_b32 a57, v253
  v_accvgpr_write_b32 a58, v254
  v_accvgpr_write_b32 a59, v255
  v_accvgpr_read_b32 v252, a76
  v_accvgpr_read_b32 v253, a77
  v_accvgpr_read_b32 v254, a78
  v_accvgpr_read_b32 v255, a79
  v_mul_f32 v252, v252, v250
  v_mul_f32 v253, v253, v250
  v_mul_f32 v254, v254, v250
  v_mul_f32 v255, v255, v250
  v_accvgpr_write_b32 a76, v252
  v_accvgpr_write_b32 a77, v253
  v_accvgpr_write_b32 a78, v254
  v_accvgpr_write_b32 a79, v255
  v_accvgpr_read_b32 v252, a96
  v_accvgpr_read_b32 v253, a97
  v_accvgpr_read_b32 v254, a98
  v_accvgpr_read_b32 v255, a99
  v_mul_f32 v252, v252, v250
  v_mul_f32 v253, v253, v250
  v_mul_f32 v254, v254, v250
  v_mul_f32 v255, v255, v250
  v_accvgpr_write_b32 a96, v252
  v_accvgpr_write_b32 a97, v253
  v_accvgpr_write_b32 a98, v254
  v_accvgpr_write_b32 a99, v255
  v_accvgpr_read_b32 v252, a116
  v_accvgpr_read_b32 v253, a117
  v_accvgpr_read_b32 v254, a118
  v_accvgpr_read_b32 v255, a119
  v_mul_f32 v252, v252, v250
  v_mul_f32 v253, v253, v250
  v_mul_f32 v254, v254, v250
  v_mul_f32 v255, v255, v250
  v_accvgpr_write_b32 a116, v252
  v_accvgpr_write_b32 a117, v253
  v_accvgpr_write_b32 a118, v254
  v_accvgpr_write_b32 a119, v255
  v_accvgpr_read_b32 v252, a136
  v_accvgpr_read_b32 v253, a137
  v_accvgpr_read_b32 v254, a138
  v_accvgpr_read_b32 v255, a139
  v_mul_f32 v252, v252, v250
  v_mul_f32 v253, v253, v250
  v_mul_f32 v254, v254, v250
  v_mul_f32 v255, v255, v250
  v_accvgpr_write_b32 a136, v252
  v_accvgpr_write_b32 a137, v253
  v_accvgpr_write_b32 a138, v254
  v_accvgpr_write_b32 a139, v255
  v_accvgpr_read_b32 v252, a156
  v_accvgpr_read_b32 v253, a157
  v_accvgpr_read_b32 v254, a158
  v_accvgpr_read_b32 v255, a159
  v_mul_f32 v252, v252, v250
  v_mul_f32 v253, v253, v250
  v_mul_f32 v254, v254, v250
  v_mul_f32 v255, v255, v250
  v_accvgpr_write_b32 a156, v252
  v_accvgpr_write_b32 a157, v253
  v_accvgpr_write_b32 a158, v254
  v_accvgpr_write_b32 a159, v255
  v_exp_f32 v216, v24
  v_exp_f32 v217, v25
  v_exp_f32 v218, v26
  v_cvt_pk_bf16_f32 v40, v216, v217
  v_exp_f32 v219, v27
  v_add_f32 v53, v216, v217
  v_exp_f32 v220, v56
  v_cvt_pk_bf16_f32 v41, v218, v219
  v_exp_f32 v221, v57
  v_add_f32 v53, v53, v218
  v_add_f32 v53, v53, v219
  v_exp_f32 v222, v58
  v_cvt_pk_bf16_f32 v72, v220, v221
  v_exp_f32 v223, v59
  v_add_f32 v85, v220, v221
  v_exp_f32 v224, v88
  v_cvt_pk_bf16_f32 v73, v222, v223
  v_exp_f32 v225, v89
  v_add_f32 v85, v85, v222
  v_add_f32 v85, v85, v223
  v_exp_f32 v226, v90
  v_cvt_pk_bf16_f32 v104, v224, v225
  v_exp_f32 v227, v91
  v_add_f32 v117, v224, v225
  v_exp_f32 v228, v120
  v_cvt_pk_bf16_f32 v105, v226, v227
  v_exp_f32 v229, v121
  v_add_f32 v117, v117, v226
  v_add_f32 v117, v117, v227
  v_exp_f32 v230, v122
  v_cvt_pk_bf16_f32 v136, v228, v229
  v_exp_f32 v231, v123
  v_add_f32 v149, v228, v229
  v_exp_f32 v216, v152
  v_cvt_pk_bf16_f32 v137, v230, v231
  v_exp_f32 v217, v153
  v_add_f32 v149, v149, v230
  v_add_f32 v149, v149, v231
  v_exp_f32 v218, v154
  v_cvt_pk_bf16_f32 v168, v216, v217
  v_exp_f32 v219, v155
  v_add_f32 v181, v216, v217
  v_exp_f32 v220, v28
  v_cvt_pk_bf16_f32 v169, v218, v219
  v_exp_f32 v221, v29
  v_add_f32 v181, v181, v218
  v_add_f32 v181, v181, v219
  v_exp_f32 v222, v30
  v_cvt_pk_bf16_f32 v42, v220, v221
  v_exp_f32 v223, v31
  v_add_f32 v53, v53, v220
  v_add_f32 v53, v53, v221
  v_exp_f32 v224, v60
  v_cvt_pk_bf16_f32 v43, v222, v223
  v_exp_f32 v225, v61
  v_add_f32 v53, v53, v222
  v_add_f32 v53, v53, v223
  v_exp_f32 v226, v62
  v_cvt_pk_bf16_f32 v74, v224, v225
  v_exp_f32 v227, v63
  v_add_f32 v85, v85, v224
  v_add_f32 v85, v85, v225
  v_exp_f32 v228, v92
  v_cvt_pk_bf16_f32 v75, v226, v227
  v_exp_f32 v229, v93
  v_add_f32 v85, v85, v226
  v_add_f32 v85, v85, v227
  v_exp_f32 v230, v94
  v_cvt_pk_bf16_f32 v106, v228, v229
  v_exp_f32 v231, v95
  v_add_f32 v117, v117, v228
  v_add_f32 v117, v117, v229
  v_exp_f32 v216, v124
  v_cvt_pk_bf16_f32 v107, v230, v231
  v_exp_f32 v217, v125
  v_add_f32 v117, v117, v230
  v_add_f32 v117, v117, v231
  v_exp_f32 v218, v126
  v_cvt_pk_bf16_f32 v138, v216, v217
  v_exp_f32 v219, v127
  v_add_f32 v149, v149, v216
  v_add_f32 v149, v149, v217
  v_exp_f32 v220, v156
  v_cvt_pk_bf16_f32 v139, v218, v219
  v_exp_f32 v221, v157
  v_add_f32 v149, v149, v218
  v_add_f32 v149, v149, v219
  v_exp_f32 v222, v158
  v_cvt_pk_bf16_f32 v170, v220, v221
  v_exp_f32 v223, v159
  v_add_f32 v181, v181, v220
  v_add_f32 v181, v181, v221
  v_cvt_pk_bf16_f32 v171, v222, v223
  v_add_f32 v181, v181, v222
  v_add_f32 v181, v181, v223
  s_nop 3
  s_setpc_b64 s[46:47]
RARE1:
  s_nop 15
  v_max3_f32 v248, v32, v33, v34
  v_max3_f32 v249, v35, v36, v37
  v_max3_f32 v248, v248, v38, v39
  v_max_f32 v248, v248, v249
  v_mov_b32 v249, v248
  s_nop 1
  v_permlane16_swap_b32 v248, v249
  v_max_f32 v248, v248, v249
  v_mov_b32 v249, v248
  s_nop 1
  v_permlane32_swap_b32 v248, v249
  v_max_f32 v248, v248, v249
  v_max_f32 v248, 0, v248
  v_ceil_f32 v248, v248
  v_exp_f32 v250, -v248
  v_sub_f32 v48, v48, v248
  v_sub_f32 v49, v49, v248
  v_sub_f32 v50, v50, v248
  v_sub_f32 v51, v51, v248
  v_sub_f32 v24, v24, v248
  v_sub_f32 v25, v25, v248
  v_sub_f32 v26, v26, v248
  v_sub_f32 v27, v27, v248
  v_sub_f32 v28, v28, v248
  v_sub_f32 v29, v29, v248
  v_sub_f32 v30, v30, v248
  v_sub_f32 v31, v31, v248
  v_sub_f32 v32, v32, v248
  v_sub_f32 v33, v33, v248
  v_sub_f32 v34, v34, v248
  v_sub_f32 v35, v35, v248
  v_sub_f32 v36, v36, v248
  v_sub_f32 v37, v37, v248
  v_sub_f32 v38, v38, v248
  v_sub_f32 v39, v39, v248
  v_mul_f32 v52, v52, v250
  v_accvgpr_read_b32 v252, a0
  v_accvgpr_read_b32 v253, a1
  v_accvgpr_read_b32 v254, a2
  v_accvgpr_read_b32 v255, a3
  v_mul_f32 v252, v252, v250
  v_mul_f32 v253, v253, v250
  v_mul_f32 v254, v254, v250
  v_mul_f32 v255, v255, v250
  v_accvgpr_write_b32 a0, v252
  v_accvgpr_write_b32 a1, v253
  v_accvgpr_write_b32 a2, v254
  v_accvgpr_write_b32 a3, v255
  v_accvgpr_read_b32 v252, a20
  v_accvgpr_read_b32 v253, a21
  v_accvgpr_read_b32 v254, a22
  v_accvgpr_read_b32 v255, a23
  v_mul_f32 v252, v252, v250
  v_mul_f32 v253, v253, v250
  v_mul_f32 v254, v254, v250
  v_mul_f32 v255, v255, v250
  v_accvgpr_write_b32 a20, v252
  v_accvgpr_write_b32 a21, v253
  v_accvgpr_write_b32 a22, v254
  v_accvgpr_write_b32 a23, v255
  v_accvgpr_read_b32 v252, a40
  v_accvgpr_read_b32 v253, a41
  v_accvgpr_read_b32 v254, a42
  v_accvgpr_read_b32 v255, a43
  v_mul_f32 v252, v252, v250
  v_mul_f32 v253, v253, v250
  v_mul_f32 v254, v254, v250
  v_mul_f32 v255, v255, v250
  v_accvgpr_write_b32 a40, v252
  v_accvgpr_write_b32 a41, v253
  v_accvgpr_write_b32 a42, v254
  v_accvgpr_write_b32 a43, v255
  v_accvgpr_read_b32 v252, a60
  v_accvgpr_read_b32 v253, a61
  v_accvgpr_read_b32 v254, a62
  v_accvgpr_read_b32 v255, a63
  v_mul_f32 v252, v252, v250
  v_mul_f32 v253, v253, v250
  v_mul_f32 v254, v254, v250
  v_mul_f32 v255, v255, v250
  v_accvgpr_write_b32 a60, v252
  v_accvgpr_write_b32 a61, v253
  v_accvgpr_write_b32 a62, v254
  v_accvgpr_write_b32 a63, v255
  v_accvgpr_read_b32 v252, a80
  v_accvgpr_read_b32 v253, a81
  v_accvgpr_read_b32 v254, a82
  v_accvgpr_read_b32 v255, a83
  v_mul_f32 v252, v252, v250
  v_mul_f32 v253, v253, v250
  v_mul_f32 v254, v254, v250
  v_mul_f32 v255, v255, v250
  v_accvgpr_write_b32 a80, v252
  v_accvgpr_write_b32 a81, v253
  v_accvgpr_write_b32 a82, v254
  v_accvgpr_write_b32 a83, v255
  v_accvgpr_read_b32 v252, a100
  v_accvgpr_read_b32 v253, a101
  v_accvgpr_read_b32 v254, a102
  v_accvgpr_read_b32 v255, a103
  v_mul_f32 v252, v252, v250
  v_mul_f32 v253, v253, v250
  v_mul_f32 v254, v254, v250
  v_mul_f32 v255, v255, v250
  v_accvgpr_write_b32 a100, v252
  v_accvgpr_write_b32 a101, v253
  v_accvgpr_write_b32 a102, v254
  v_accvgpr_write_b32 a103, v255
  v_accvgpr_read_b32 v252, a120
  v_accvgpr_read_b32 v253, a121
  v_accvgpr_read_b32 v254, a122
  v_accvgpr_read_b32 v255, a123
  v_mul_f32 v252, v252, v250
  v_mul_f32 v253, v253, v250
  v_mul_f32 v254, v254, v250
  v_mul_f32 v255, v255, v250
  v_accvgpr_write_b32 a120, v252
  v_accvgpr_write_b32 a121, v253
  v_accvgpr_write_b32 a122, v254
  v_accvgpr_write_b32 a123, v255
  v_accvgpr_read_b32 v252, a140
  v_accvgpr_read_b32 v253, a141
  v_accvgpr_read_b32 v254, a142
  v_accvgpr_read_b32 v255, a143
  v_mul_f32 v252, v252, v250
  v_mul_f32 v253, v253, v250
  v_mul_f32 v254, v254, v250
  v_mul_f32 v255, v255, v250
  v_accvgpr_write_b32 a140, v252
  v_accvgpr_write_b32 a141, v253
  v_accvgpr_write_b32 a142, v254
  v_accvgpr_write_b32 a143, v255
  v_max3_f32 v248, v64, v65, v66
  v_max3_f32 v249, v67, v68, v69
  v_max3_f32 v248, v248, v70, v71
  v_max_f32 v248, v248, v249
  v_mov_b32 v249, v248
  s_nop 1
  v_permlane16_swap_b32 v248, v249
  v_max_f32 v248, v248, v249
  v_mov_b32 v249, v248
  s_nop 1
  v_permlane32_swap_b32 v248, v249
  v_max_f32 v248, v248, v249
  v_max_f32 v248, 0, v248
  v_ceil_f32 v248, v248
  v_exp_f32 v250, -v248
  v_sub_f32 v80, v80, v248
  v_sub_f32 v81, v81, v248
  v_sub_f32 v82, v82, v248
  v_sub_f32 v83, v83, v248
  v_sub_f32 v56, v56, v248
  v_sub_f32 v57, v57, v248
  v_sub_f32 v58, v58, v248
  v_sub_f32 v59, v59, v248
  v_sub_f32 v60, v60, v248
  v_sub_f32 v61, v61, v248
  v_sub_f32 v62, v62, v248
  v_sub_f32 v63, v63, v248
  v_sub_f32 v64, v64, v248
  v_sub_f32 v65, v65, v248
  v_sub_f32 v66, v66, v248
  v_sub_f32 v67, v67, v248
  v_sub_f32 v68, v68, v248
  v_sub_f32 v69, v69, v248
  v_sub_f32 v70, v70, v248
  v_sub_f32 v71, v71, v248
  v_mul_f32 v84, v84, v250
  v_accvgpr_read_b32 v252, a4
  v_accvgpr_read_b32 v253, a5
  v_accvgpr_read_b32 v254, a6
  v_accvgpr_read_b32 v255, a7
  v_mul_f32 v252, v252, v250
  v_mul_f32 v253, v253, v250
  v_mul_f32 v254, v254, v250
  v_mul_f32 v255, v255, v250
  v_accvgpr_write_b32 a4, v252
  v_accvgpr_write_b32 a5, v253
  v_accvgpr_write_b32 a6, v254
  v_accvgpr_write_b32 a7, v255
  v_accvgpr_read_b32 v252, a24
  v_accvgpr_read_b32 v253, a25
  v_accvgpr_read_b32 v254, a26
  v_accvgpr_read_b32 v255, a27
  v_mul_f32 v252, v252, v250
  v_mul_f32 v253, v253, v250
  v_mul_f32 v254, v254, v250
  v_mul_f32 v255, v255, v250
  v_accvgpr_write_b32 a24, v252
  v_accvgpr_write_b32 a25, v253
  v_accvgpr_write_b32 a26, v254
  v_accvgpr_write_b32 a27, v255
  v_accvgpr_read_b32 v252, a44
  v_accvgpr_read_b32 v253, a45
  v_accvgpr_read_b32 v254, a46
  v_accvgpr_read_b32 v255, a47
  v_mul_f32 v252, v252, v250
  v_mul_f32 v253, v253, v250
  v_mul_f32 v254, v254, v250
  v_mul_f32 v255, v255, v250
  v_accvgpr_write_b32 a44, v252
  v_accvgpr_write_b32 a45, v253
  v_accvgpr_write_b32 a46, v254
  v_accvgpr_write_b32 a47, v255
  v_accvgpr_read_b32 v252, a64
  v_accvgpr_read_b32 v253, a65
  v_accvgpr_read_b32 v254, a66
  v_accvgpr_read_b32 v255, a67
  v_mul_f32 v252, v252, v250
  v_mul_f32 v253, v253, v250
  v_mul_f32 v254, v254, v250
  v_mul_f32 v255, v255, v250
  v_accvgpr_write_b32 a64, v252
  v_accvgpr_write_b32 a65, v253
  v_accvgpr_write_b32 a66, v254
  v_accvgpr_write_b32 a67, v255
  v_accvgpr_read_b32 v252, a84
  v_accvgpr_read_b32 v253, a85
  v_accvgpr_read_b32 v254, a86
  v_accvgpr_read_b32 v255, a87
  v_mul_f32 v252, v252, v250
  v_mul_f32 v253, v253, v250
  v_mul_f32 v254, v254, v250
  v_mul_f32 v255, v255, v250
  v_accvgpr_write_b32 a84, v252
  v_accvgpr_write_b32 a85, v253
  v_accvgpr_write_b32 a86, v254
  v_accvgpr_write_b32 a87, v255
  v_accvgpr_read_b32 v252, a104
  v_accvgpr_read_b32 v253, a105
  v_accvgpr_read_b32 v254, a106
  v_accvgpr_read_b32 v255, a107
  v_mul_f32 v252, v252, v250
  v_mul_f32 v253, v253, v250
  v_mul_f32 v254, v254, v250
  v_mul_f32 v255, v255, v250
  v_accvgpr_write_b32 a104, v252
  v_accvgpr_write_b32 a105, v253
  v_accvgpr_write_b32 a106, v254
  v_accvgpr_write_b32 a107, v255
  v_accvgpr_read_b32 v252, a124
  v_accvgpr_read_b32 v253, a125
  v_accvgpr_read_b32 v254, a126
  v_accvgpr_read_b32 v255, a127
  v_mul_f32 v252, v252, v250
  v_mul_f32 v253, v253, v250
  v_mul_f32 v254, v254, v250
  v_mul_f32 v255, v255, v250
  v_accvgpr_write_b32 a124, v252
  v_accvgpr_write_b32 a125, v253
  v_accvgpr_write_b32 a126, v254
  v_accvgpr_write_b32 a127, v255
  v_accvgpr_read_b32 v252, a144
  v_accvgpr_read_b32 v253, a145
  v_accvgpr_read_b32 v254, a146
  v_accvgpr_read_b32 v255, a147
  v_mul_f32 v252, v252, v250
  v_mul_f32 v253, v253, v250
  v_mul_f32 v254, v254, v250
  v_mul_f32 v255, v255, v250
  v_accvgpr_write_b32 a144, v252
  v_accvgpr_write_b32 a145, v253
  v_accvgpr_write_b32 a146, v254
  v_accvgpr_write_b32 a147, v255
  v_max3_f32 v248, v96, v97, v98
  v_max3_f32 v249, v99, v100, v101
  v_max3_f32 v248, v248, v102, v103
  v_max_f32 v248, v248, v249
  v_mov_b32 v249, v248
  s_nop 1
  v_permlane16_swap_b32 v248, v249
  v_max_f32 v248, v248, v249
  v_mov_b32 v249, v248
  s_nop 1
  v_permlane32_swap_b32 v248, v249
  v_max_f32 v248, v248, v249
  v_max_f32 v248, 0, v248
  v_ceil_f32 v248, v248
  v_exp_f32 v250, -v248
  v_sub_f32 v112, v112, v248
  v_sub_f32 v113, v113, v248
  v_sub_f32 v114, v114, v248
  v_sub_f32 v115, v115, v248
  v_sub_f32 v88, v88, v248
  v_sub_f32 v89, v89, v248
  v_sub_f32 v90, v90, v248
  v_sub_f32 v91, v91, v248
  v_sub_f32 v92, v92, v248
  v_sub_f32 v93, v93, v248
  v_sub_f32 v94, v94, v248
  v_sub_f32 v95, v95, v248
  v_sub_f32 v96, v96, v248
  v_sub_f32 v97, v97, v248
  v_sub_f32 v98, v98, v248
  v_sub_f32 v99, v99, v248
  v_sub_f32 v100, v100, v248
  v_sub_f32 v101, v101, v248
  v_sub_f32 v102, v102, v248
  v_sub_f32 v103, v103, v248
  v_mul_f32 v116, v116, v250
  v_accvgpr_read_b32 v252, a8
  v_accvgpr_read_b32 v253, a9
  v_accvgpr_read_b32 v254, a10
  v_accvgpr_read_b32 v255, a11
  v_mul_f32 v252, v252, v250
  v_mul_f32 v253, v253, v250
  v_mul_f32 v254, v254, v250
  v_mul_f32 v255, v255, v250
  v_accvgpr_write_b32 a8, v252
  v_accvgpr_write_b32 a9, v253
  v_accvgpr_write_b32 a10, v254
  v_accvgpr_write_b32 a11, v255
  v_accvgpr_read_b32 v252, a28
  v_accvgpr_read_b32 v253, a29
  v_accvgpr_read_b32 v254, a30
  v_accvgpr_read_b32 v255, a31
  v_mul_f32 v252, v252, v250
  v_mul_f32 v253, v253, v250
  v_mul_f32 v254, v254, v250
  v_mul_f32 v255, v255, v250
  v_accvgpr_write_b32 a28, v252
  v_accvgpr_write_b32 a29, v253
  v_accvgpr_write_b32 a30, v254
  v_accvgpr_write_b32 a31, v255
  v_accvgpr_read_b32 v252, a48
  v_accvgpr_read_b32 v253, a49
  v_accvgpr_read_b32 v254, a50
  v_accvgpr_read_b32 v255, a51
  v_mul_f32 v252, v252, v250
  v_mul_f32 v253, v253, v250
  v_mul_f32 v254, v254, v250
  v_mul_f32 v255, v255, v250
  v_accvgpr_write_b32 a48, v252
  v_accvgpr_write_b32 a49, v253
  v_accvgpr_write_b32 a50, v254
  v_accvgpr_write_b32 a51, v255
  v_accvgpr_read_b32 v252, a68
  v_accvgpr_read_b32 v253, a69
  v_accvgpr_read_b32 v254, a70
  v_accvgpr_read_b32 v255, a71
  v_mul_f32 v252, v252, v250
  v_mul_f32 v253, v253, v250
  v_mul_f32 v254, v254, v250
  v_mul_f32 v255, v255, v250
  v_accvgpr_write_b32 a68, v252
  v_accvgpr_write_b32 a69, v253
  v_accvgpr_write_b32 a70, v254
  v_accvgpr_write_b32 a71, v255
  v_accvgpr_read_b32 v252, a88
  v_accvgpr_read_b32 v253, a89
  v_accvgpr_read_b32 v254, a90
  v_accvgpr_read_b32 v255, a91
  v_mul_f32 v252, v252, v250
  v_mul_f32 v253, v253, v250
  v_mul_f32 v254, v254, v250
  v_mul_f32 v255, v255, v250
  v_accvgpr_write_b32 a88, v252
  v_accvgpr_write_b32 a89, v253
  v_accvgpr_write_b32 a90, v254
  v_accvgpr_write_b32 a91, v255
  v_accvgpr_read_b32 v252, a108
  v_accvgpr_read_b32 v253, a109
  v_accvgpr_read_b32 v254, a110
  v_accvgpr_read_b32 v255, a111
  v_mul_f32 v252, v252, v250
  v_mul_f32 v253, v253, v250
  v_mul_f32 v254, v254, v250
  v_mul_f32 v255, v255, v250
  v_accvgpr_write_b32 a108, v252
  v_accvgpr_write_b32 a109, v253
  v_accvgpr_write_b32 a110, v254
  v_accvgpr_write_b32 a111, v255
  v_accvgpr_read_b32 v252, a128
  v_accvgpr_read_b32 v253, a129
  v_accvgpr_read_b32 v254, a130
  v_accvgpr_read_b32 v255, a131
  v_mul_f32 v252, v252, v250
  v_mul_f32 v253, v253, v250
  v_mul_f32 v254, v254, v250
  v_mul_f32 v255, v255, v250
  v_accvgpr_write_b32 a128, v252
  v_accvgpr_write_b32 a129, v253
  v_accvgpr_write_b32 a130, v254
  v_accvgpr_write_b32 a131, v255
  v_accvgpr_read_b32 v252, a148
  v_accvgpr_read_b32 v253, a149
  v_accvgpr_read_b32 v254, a150
  v_accvgpr_read_b32 v255, a151
  v_mul_f32 v252, v252, v250
  v_mul_f32 v253, v253, v250
  v_mul_f32 v254, v254, v250
  v_mul_f32 v255, v255, v250
  v_accvgpr_write_b32 a148, v252
  v_accvgpr_write_b32 a149, v253
  v_accvgpr_write_b32 a150, v254
  v_accvgpr_write_b32 a151, v255
  v_max3_f32 v248, v128, v129, v130
  v_max3_f32 v249, v131, v132, v133
  v_max3_f32 v248, v248, v134, v135
  v_max_f32 v248, v248, v249
  v_mov_b32 v249, v248
  s_nop 1
  v_permlane16_swap_b32 v248, v249
  v_max_f32 v248, v248, v249
  v_mov_b32 v249, v248
  s_nop 1
  v_permlane32_swap_b32 v248, v249
  v_max_f32 v248, v248, v249
  v_max_f32 v248, 0, v248
  v_ceil_f32 v248, v248
  v_exp_f32 v250, -v248
  v_sub_f32 v144, v144, v248
  v_sub_f32 v145, v145, v248
  v_sub_f32 v146, v146, v248
  v_sub_f32 v147, v147, v248
  v_sub_f32 v120, v120, v248
  v_sub_f32 v121, v121, v248
  v_sub_f32 v122, v122, v248
  v_sub_f32 v123, v123, v248
  v_sub_f32 v124, v124, v248
  v_sub_f32 v125, v125, v248
  v_sub_f32 v126, v126, v248
  v_sub_f32 v127, v127, v248
  v_sub_f32 v128, v128, v248
  v_sub_f32 v129, v129, v248
  v_sub_f32 v130, v130, v248
  v_sub_f32 v131, v131, v248
  v_sub_f32 v132, v132, v248
  v_sub_f32 v133, v133, v248
  v_sub_f32 v134, v134, v248
  v_sub_f32 v135, v135, v248
  v_mul_f32 v148, v148, v250
  v_accvgpr_read_b32 v252, a12
  v_accvgpr_read_b32 v253, a13
  v_accvgpr_read_b32 v254, a14
  v_accvgpr_read_b32 v255, a15
  v_mul_f32 v252, v252, v250
  v_mul_f32 v253, v253, v250
  v_mul_f32 v254, v254, v250
  v_mul_f32 v255, v255, v250
  v_accvgpr_write_b32 a12, v252
  v_accvgpr_write_b32 a13, v253
  v_accvgpr_write_b32 a14, v254
  v_accvgpr_write_b32 a15, v255
  v_accvgpr_read_b32 v252, a32
  v_accvgpr_read_b32 v253, a33
  v_accvgpr_read_b32 v254, a34
  v_accvgpr_read_b32 v255, a35
  v_mul_f32 v252, v252, v250
  v_mul_f32 v253, v253, v250
  v_mul_f32 v254, v254, v250
  v_mul_f32 v255, v255, v250
  v_accvgpr_write_b32 a32, v252
  v_accvgpr_write_b32 a33, v253
  v_accvgpr_write_b32 a34, v254
  v_accvgpr_write_b32 a35, v255
  v_accvgpr_read_b32 v252, a52
  v_accvgpr_read_b32 v253, a53
  v_accvgpr_read_b32 v254, a54
  v_accvgpr_read_b32 v255, a55
  v_mul_f32 v252, v252, v250
  v_mul_f32 v253, v253, v250
  v_mul_f32 v254, v254, v250
  v_mul_f32 v255, v255, v250
  v_accvgpr_write_b32 a52, v252
  v_accvgpr_write_b32 a53, v253
  v_accvgpr_write_b32 a54, v254
  v_accvgpr_write_b32 a55, v255
  v_accvgpr_read_b32 v252, a72
  v_accvgpr_read_b32 v253, a73
  v_accvgpr_read_b32 v254, a74
  v_accvgpr_read_b32 v255, a75
  v_mul_f32 v252, v252, v250
  v_mul_f32 v253, v253, v250
  v_mul_f32 v254, v254, v250
  v_mul_f32 v255, v255, v250
  v_accvgpr_write_b32 a72, v252
  v_accvgpr_write_b32 a73, v253
  v_accvgpr_write_b32 a74, v254
  v_accvgpr_write_b32 a75, v255
  v_accvgpr_read_b32 v252, a92
  v_accvgpr_read_b32 v253, a93
  v_accvgpr_read_b32 v254, a94
  v_accvgpr_read_b32 v255, a95
  v_mul_f32 v252, v252, v250
  v_mul_f32 v253, v253, v250
  v_mul_f32 v254, v254, v250
  v_mul_f32 v255, v255, v250
  v_accvgpr_write_b32 a92, v252
  v_accvgpr_write_b32 a93, v253
  v_accvgpr_write_b32 a94, v254
  v_accvgpr_write_b32 a95, v255
  v_accvgpr_read_b32 v252, a112
  v_accvgpr_read_b32 v253, a113
  v_accvgpr_read_b32 v254, a114
  v_accvgpr_read_b32 v255, a115
  v_mul_f32 v252, v252, v250
  v_mul_f32 v253, v253, v250
  v_mul_f32 v254, v254, v250
  v_mul_f32 v255, v255, v250
  v_accvgpr_write_b32 a112, v252
  v_accvgpr_write_b32 a113, v253
  v_accvgpr_write_b32 a114, v254
  v_accvgpr_write_b32 a115, v255
  v_accvgpr_read_b32 v252, a132
  v_accvgpr_read_b32 v253, a133
  v_accvgpr_read_b32 v254, a134
  v_accvgpr_read_b32 v255, a135
  v_mul_f32 v252, v252, v250
  v_mul_f32 v253, v253, v250
  v_mul_f32 v254, v254, v250
  v_mul_f32 v255, v255, v250
  v_accvgpr_write_b32 a132, v252
  v_accvgpr_write_b32 a133, v253
  v_accvgpr_write_b32 a134, v254
  v_accvgpr_write_b32 a135, v255
  v_accvgpr_read_b32 v252, a152
  v_accvgpr_read_b32 v253, a153
  v_accvgpr_read_b32 v254, a154
  v_accvgpr_read_b32 v255, a155
  v_mul_f32 v252, v252, v250
  v_mul_f32 v253, v253, v250
  v_mul_f32 v254, v254, v250
  v_mul_f32 v255, v255, v250
  v_accvgpr_write_b32 a152, v252
  v_accvgpr_write_b32 a153, v253
  v_accvgpr_write_b32 a154, v254
  v_accvgpr_write_b32 a155, v255
  v_max3_f32 v248, v160, v161, v162
  v_max3_f32 v249, v163, v164, v165
  v_max3_f32 v248, v248, v166, v167
  v_max_f32 v248, v248, v249
  v_mov_b32 v249, v248
  s_nop 1
  v_permlane16_swap_b32 v248, v249
  v_max_f32 v248, v248, v249
  v_mov_b32 v249, v248
  s_nop 1
  v_permlane32_swap_b32 v248, v249
  v_max_f32 v248, v248, v249
  v_max_f32 v248, 0, v248
  v_ceil_f32 v248, v248
  v_exp_f32 v250, -v248
  v_sub_f32 v176, v176, v248
  v_sub_f32 v177, v177, v248
  v_sub_f32 v178, v178, v248
  v_sub_f32 v179, v179, v248
  v_sub_f32 v152, v152, v248
  v_sub_f32 v153, v153, v248
  v_sub_f32 v154, v154, v248
  v_sub_f32 v155, v155, v248
  v_sub_f32 v156, v156, v248
  v_sub_f32 v157, v157, v248
  v_sub_f32 v158, v158, v248
  v_sub_f32 v159, v159, v248
  v_sub_f32 v160, v160, v248
  v_sub_f32 v161, v161, v248
  v_sub_f32 v162, v162, v248
  v_sub_f32 v163, v163, v248
  v_sub_f32 v164, v164, v248
  v_sub_f32 v165, v165, v248
  v_sub_f32 v166, v166, v248
  v_sub_f32 v167, v167, v248
  v_mul_f32 v180, v180, v250
  v_accvgpr_read_b32 v252, a16
  v_accvgpr_read_b32 v253, a17
  v_accvgpr_read_b32 v254, a18
  v_accvgpr_read_b32 v255, a19
  v_mul_f32 v252, v252, v250
  v_mul_f32 v253, v253, v250
  v_mul_f32 v254, v254, v250
  v_mul_f32 v255, v255, v250
  v_accvgpr_write_b32 a16, v252
  v_accvgpr_write_b32 a17, v253
  v_accvgpr_write_b32 a18, v254
  v_accvgpr_write_b32 a19, v255
  v_accvgpr_read_b32 v252, a36
  v_accvgpr_read_b32 v253, a37
  v_accvgpr_read_b32 v254, a38
  v_accvgpr_read_b32 v255, a39
  v_mul_f32 v252, v252, v250
  v_mul_f32 v253, v253, v250
  v_mul_f32 v254, v254, v250
  v_mul_f32 v255, v255, v250
  v_accvgpr_write_b32 a36, v252
  v_accvgpr_write_b32 a37, v253
  v_accvgpr_write_b32 a38, v254
  v_accvgpr_write_b32 a39, v255
  v_accvgpr_read_b32 v252, a56
  v_accvgpr_read_b32 v253, a57
  v_accvgpr_read_b32 v254, a58
  v_accvgpr_read_b32 v255, a59
  v_mul_f32 v252, v252, v250
  v_mul_f32 v253, v253, v250
  v_mul_f32 v254, v254, v250
  v_mul_f32 v255, v255, v250
  v_accvgpr_write_b32 a56, v252
  v_accvgpr_write_b32 a57, v253
  v_accvgpr_write_b32 a58, v254
  v_accvgpr_write_b32 a59, v255
  v_accvgpr_read_b32 v252, a76
  v_accvgpr_read_b32 v253, a77
  v_accvgpr_read_b32 v254, a78
  v_accvgpr_read_b32 v255, a79
  v_mul_f32 v252, v252, v250
  v_mul_f32 v253, v253, v250
  v_mul_f32 v254, v254, v250
  v_mul_f32 v255, v255, v250
  v_accvgpr_write_b32 a76, v252
  v_accvgpr_write_b32 a77, v253
  v_accvgpr_write_b32 a78, v254
  v_accvgpr_write_b32 a79, v255
  v_accvgpr_read_b32 v252, a96
  v_accvgpr_read_b32 v253, a97
  v_accvgpr_read_b32 v254, a98
  v_accvgpr_read_b32 v255, a99
  v_mul_f32 v252, v252, v250
  v_mul_f32 v253, v253, v250
  v_mul_f32 v254, v254, v250
  v_mul_f32 v255, v255, v250
  v_accvgpr_write_b32 a96, v252
  v_accvgpr_write_b32 a97, v253
  v_accvgpr_write_b32 a98, v254
  v_accvgpr_write_b32 a99, v255
  v_accvgpr_read_b32 v252, a116
  v_accvgpr_read_b32 v253, a117
  v_accvgpr_read_b32 v254, a118
  v_accvgpr_read_b32 v255, a119
  v_mul_f32 v252, v252, v250
  v_mul_f32 v253, v253, v250
  v_mul_f32 v254, v254, v250
  v_mul_f32 v255, v255, v250
  v_accvgpr_write_b32 a116, v252
  v_accvgpr_write_b32 a117, v253
  v_accvgpr_write_b32 a118, v254
  v_accvgpr_write_b32 a119, v255
  v_accvgpr_read_b32 v252, a136
  v_accvgpr_read_b32 v253, a137
  v_accvgpr_read_b32 v254, a138
  v_accvgpr_read_b32 v255, a139
  v_mul_f32 v252, v252, v250
  v_mul_f32 v253, v253, v250
  v_mul_f32 v254, v254, v250
  v_mul_f32 v255, v255, v250
  v_accvgpr_write_b32 a136, v252
  v_accvgpr_write_b32 a137, v253
  v_accvgpr_write_b32 a138, v254
  v_accvgpr_write_b32 a139, v255
  v_accvgpr_read_b32 v252, a156
  v_accvgpr_read_b32 v253, a157
  v_accvgpr_read_b32 v254, a158
  v_accvgpr_read_b32 v255, a159
  v_mul_f32 v252, v252, v250
  v_mul_f32 v253, v253, v250
  v_mul_f32 v254, v254, v250
  v_mul_f32 v255, v255, v250
  v_accvgpr_write_b32 a156, v252
  v_accvgpr_write_b32 a157, v253
  v_accvgpr_write_b32 a158, v254
  v_accvgpr_write_b32 a159, v255
  v_exp_f32 v216, v32
  v_exp_f32 v217, v33
  v_exp_f32 v218, v34
  v_cvt_pk_bf16_f32 v44, v216, v217
  v_exp_f32 v219, v35
  v_add_f32 v53, v216, v217
  v_exp_f32 v220, v64
  v_cvt_pk_bf16_f32 v45, v218, v219
  v_exp_f32 v221, v65
  v_add_f32 v53, v53, v218
  v_add_f32 v53, v53, v219
  v_exp_f32 v222, v66
  v_cvt_pk_bf16_f32 v76, v220, v221
  v_exp_f32 v223, v67
  v_add_f32 v85, v220, v221
  v_exp_f32 v224, v96
  v_cvt_pk_bf16_f32 v77, v222, v223
  v_exp_f32 v225, v97
  v_add_f32 v85, v85, v222
  v_add_f32 v85, v85, v223
  v_exp_f32 v226, v98
  v_cvt_pk_bf16_f32 v108, v224, v225
  v_exp_f32 v227, v99
  v_add_f32 v117, v224, v225
  v_exp_f32 v228, v128
  v_cvt_pk_bf16_f32 v109, v226, v227
  v_exp_f32 v229, v129
  v_add_f32 v117, v117, v226
  v_add_f32 v117, v117, v227
  v_exp_f32 v230, v130
  v_cvt_pk_bf16_f32 v140, v228, v229
  v_exp_f32 v231, v131
  v_add_f32 v149, v228, v229
  v_exp_f32 v216, v160
  v_cvt_pk_bf16_f32 v141, v230, v231
  v_exp_f32 v217, v161
  v_add_f32 v149, v149, v230
  v_add_f32 v149, v149, v231
  v_exp_f32 v218, v162
  v_cvt_pk_bf16_f32 v172, v216, v217
  v_exp_f32 v219, v163
  v_add_f32 v181, v216, v217
  v_exp_f32 v220, v36
  v_cvt_pk_bf16_f32 v173, v218, v219
  v_exp_f32 v221, v37
  v_add_f32 v181, v181, v218
  v_add_f32 v181, v181, v219
  v_exp_f32 v222, v38
  v_cvt_pk_bf16_f32 v46, v220, v221
  v_exp_f32 v223, v39
  v_add_f32 v53, v53, v220
  v_add_f32 v53, v53, v221
  v_exp_f32 v224, v68
  v_cvt_pk_bf16_f32 v47, v222, v223
  v_exp_f32 v225, v69
  v_add_f32 v53, v53, v222
  v_add_f32 v53, v53, v223
  v_exp_f32 v226, v70
  v_cvt_pk_bf16_f32 v78, v224, v225
  v_exp_f32 v227, v71
  v_add_f32 v85, v85, v224
  v_add_f32 v85, v85, v225
  v_exp_f32 v228, v100
  v_cvt_pk_bf16_f32 v79, v226, v227
  v_exp_f32 v229, v101
  v_add_f32 v85, v85, v226
  v_add_f32 v85, v85, v227
  v_exp_f32 v230, v102
  v_cvt_pk_bf16_f32 v110, v228, v229
  v_exp_f32 v231, v103
  v_add_f32 v117, v117, v228
  v_add_f32 v117, v117, v229
  v_exp_f32 v216, v132
  v_cvt_pk_bf16_f32 v111, v230, v231
  v_exp_f32 v217, v133
  v_add_f32 v117, v117, v230
  v_add_f32 v117, v117, v231
  v_exp_f32 v218, v134
  v_cvt_pk_bf16_f32 v142, v216, v217
  v_exp_f32 v219, v135
  v_add_f32 v149, v149, v216
  v_add_f32 v149, v149, v217
  v_exp_f32 v220, v164
  v_cvt_pk_bf16_f32 v143, v218, v219
  v_exp_f32 v221, v165
  v_add_f32 v149, v149, v218
  v_add_f32 v149, v149, v219
  v_exp_f32 v222, v166
  v_cvt_pk_bf16_f32 v174, v220, v221
  v_exp_f32 v223, v167
  v_add_f32 v181, v181, v220
  v_add_f32 v181, v181, v221
  v_cvt_pk_bf16_f32 v175, v222, v223
  v_add_f32 v181, v181, v222
  v_add_f32 v181, v181, v223
  s_nop 3
  s_setpc_b64 s[46:47]
.section .rodata,"a"
.p2align 6
.amdhsa_kernel concat_heads__gqa_block_cached__mha_block_cached__near_ridge_kernel
  .amdhsa_next_free_vgpr 512
  .amdhsa_next_free_sgpr 102
  .amdhsa_accum_offset 256
  .amdhsa_group_segment_fixed_size 0
  .amdhsa_kernarg_size 104
  .amdhsa_user_sgpr_count 2
  .amdhsa_user_sgpr_kernarg_segment_ptr 1
  .amdhsa_system_sgpr_workgroup_id_x 1
.end_amdhsa_kernel
```
